```python
import torch

def _softmax(x, axis=-1):
    return torch.softmax(x, dim=axis)
def _gelu(x):
    return torch.nn.functional.gelu(x, approximate="tanh")
def _silu(x):
    return torch.nn.functional.silu(x)
def _sigmoid(x):
    return torch.sigmoid(x)
def _layernorm(x, axis=-1, eps=1e-5):
    m = x.mean(dim=axis, keepdim=True)
    v = x.var(dim=axis, keepdim=True, unbiased=False)
    return (x - m) / torch.sqrt(v + eps)
def _scatter_add(tgt, idx, src, axis=0):
    return tgt.clone().index_add_(axis, idx, src)
def _segment_sum(src, seg, n):
    out = torch.zeros((n,) + src.shape[1:], dtype=src.dtype)
    return out.index_add_(0, seg, src)
def _pad(x, pw):
    flat = tuple(v for pair in reversed(pw) for v in pair)
    return torch.nn.functional.pad(x, flat)

kernel_name = 'parallel_sum__sliding_block__glu_gated_geglu__prompt'

def setup_inputs():

    _w = (lambda a: (lambda t: t.to(torch.bfloat16) if t.is_floating_point() else t)(torch.as_tensor(a)))
    def _A_setup():
        B, S, D = 1, 2048, 640
        return {
            "x": _w((lambda *s: torch.randn(*s, dtype=torch.bfloat16) * 0.05)(B, S, D)),
            "wqkv": _w((lambda *s: torch.randn(*s, dtype=torch.bfloat16) * 0.05)(D, 3 * D)),
            "wo": _w((lambda *s: torch.randn(*s, dtype=torch.bfloat16) * 0.05)(D, D)),
        }
    _A_in = _A_setup()

    def _B_setup():
        B, S, Dm, Df = 1, 2048, 640, 1536
        return {
            "x": _w((lambda *s: torch.randn(*s, dtype=torch.bfloat16) * 0.05)(B, S, Dm)),
            "w_gate": _w((lambda *s: torch.randn(*s, dtype=torch.bfloat16) * 0.8)(Dm, Df) * (Dm ** -0.5)),
            "w_up": _w((lambda *s: torch.randn(*s, dtype=torch.bfloat16) * 0.8)(Dm, Df) * (Dm ** -0.5)),
            "w_down": _w((lambda *s: torch.randn(*s, dtype=torch.bfloat16) * 0.8)(Df, Dm) * (Df ** -0.5)),
        }
    _B_in = _B_setup()

    return {
        "A_x": _A_in["x"],
        "A_wqkv": _A_in["wqkv"],
        "A_wo": _A_in["wo"],
        "B_x": _B_in["x"],
        "B_w_gate": _B_in["w_gate"],
        "B_w_up": _B_in["w_up"],
        "B_w_down": _B_in["w_down"],
    }

def reference(A_x, A_wqkv, A_wo, B_x, B_w_gate, B_w_up, B_w_down):
    def _A_ref(x, wqkv, wo):
        B, S, D = x.shape
        H = 32; Dh = D // H; W = 256
        qkv = (lambda x, *d: x.permute(*d))((x @ wqkv).reshape(B, S, 3, H, Dh), 2, 0, 3, 1, 4)
        q, k, v = qkv[0], qkv[1], qkv[2]
        scores = torch.einsum("bhqd,bhkd->bhqk", q, k) * (Dh ** -0.5)
        idx = torch.arange(S)
        mask = (idx[:, None] - idx[None, :] >= 0) & (idx[:, None] - idx[None, :] < W)
        scores = torch.where(mask[None, None], scores, -1e9)
        p = _softmax(scores, axis=-1)
        o = torch.einsum("bhqk,bhkd->bhqd", p, v)
        return (lambda x, *d: x.permute(*d))(o, 0, 2, 1, 3).reshape(B, S, D) @ wo

    def _B_ref(x, w_gate, w_up, w_down):
        g = torch.einsum("bsd,df->bsf", x, w_gate)
        u = torch.einsum("bsd,df->bsf", x, w_up)
        h = _gelu(g) * u
        return torch.einsum("bsf,fd->bsd", h, w_down)

    x = A_x
    xn = _layernorm(x, axis=-1)
    return x + _A_ref(xn, A_wqkv, A_wo) + _B_ref(xn, B_w_gate, B_w_up, B_w_down)
```

```asm
; @launch grid=(256,1,1) block=(256,1,1) lds=163840
.amdgcn_target "amdgcn-amd-amdhsa--gfx950"
.text
.globl parallel_sum__sliding_block__glu_gated_geglu__prompt_kernel
.p2align 8
.type parallel_sum__sliding_block__glu_gated_geglu__prompt_kernel,@function
parallel_sum__sliding_block__glu_gated_geglu__prompt_kernel:
    s_cmp_ge_u32 s2, 256
s_cbranch_scc1 L_end
s_load_dwordx16 s[4:19], s[0:1], 0
s_load_dwordx4 s[20:23], s[0:1], 64
v_lshrrev_b32 v200, 6, v0
v_and_b32 v1, 63, v0
s_getpc_b64 s[90:91]
L_pc:
v_readfirstlane_b32 s54, v200
v_lshlrev_b32 v2, 4, v1
s_and_b32 s58, s2, 7
s_lshr_b32 s59, s2, 3
s_mul_i32 s60, s59, 13
v_add_u32 v201, s60, v0
v_lshlrev_b32 v201, 7, v201
v_cmp_gt_u32 vcc, 13, v0
s_lshl_b32 s60, s2, 2
s_add_u32 s60, s60, s54
s_lshl_b32 s60, s60, 8
s_add_u32 s60, s60, 0x9fd8
v_and_b32 v202, 128, v2
v_add_u32 v202, s60, v202
v_cndmask_b32 v201, v202, v201, vcc
global_load_dword v202, v201, s[90:91]
s_add_u32 s90, s90, s60
s_addc_u32 s91, s91, 0
s_lshr_b32 s60, s58, 2
s_lshl_b32 s60, s60, 3
s_lshr_b32 s61, s59, 2
s_add_u32 s52, s60, s61
s_and_b32 s60, s58, 3
s_lshl_b32 s60, s60, 2
s_and_b32 s62, s59, 3
s_add_u32 s53, s60, s62
s_lshl_b32 s62, s62, 1
s_add_u32 s55, s61, s62
s_and_b32 s55, s55, 7
s_lshl_b32 s55, s55, 2
s_mov_b32 s88, 0x98765432
s_mov_b32 s89, s88
s_lshr_b64 s[88:89], s[88:89], s55
s_mov_b32 s55, s88
v_and_b32 v203, 7, v1
v_lshrrev_b32 v204, 3, v1
s_lshl_b32 s84, s54, 12
s_lshl_b32 s58, s52, 7
s_lshl_b32 s59, s54, 5
s_add_u32 s58, s58, s59
v_add_u32 v207, s58, v204
v_mul_u32_u24 v207, 1280, v207
v_lshrrev_b32 v200, 4, v1
v_xor_b32 v200, v203, v200
v_lshl_add_u32 v56, v200, 4, v207
v_xor_b32 v200, 4, v200
v_lshl_add_u32 v57, v200, 4, v207
v_add_u32 v58, 18432, v56
v_add_u32 v59, 27648, v57
v_add_u32 v57, 9216, v57
v_lshlrev_b32 v207, 1, v204
v_and_b32 v207, 4, v207
v_xor_b32 v207, v203, v207
v_lshlrev_b32 v207, 4, v207
s_and_b32 s61, s59, 32
v_add_u32 v200, s61, v204
s_lshr_b32 s59, s54, 1
s_lshl_b32 s59, s59, 7
s_lshl_b32 s60, s53, 8
s_add_u32 s59, s59, s60
v_mul_u32_u24 v52, 3840, v200
v_add3_u32 v52, v52, v207, s59
v_add_u32 v53, 29696, v52
v_add_u32 v54, 59392, v52
v_add_u32 v55, 89088, v52
s_lshr_b32 s59, s53, 1
s_mul_i32 s59, s59, 384
s_and_b32 s60, s60, 256
s_add_u32 s59, s60, s59
v_mul_u32_u24 v16, 3072, v200
v_add3_u32 v16, v16, v207, s59
v_add_u32 v17, 23552, v16
v_add_u32 v18, 47104, v16
v_add_u32 v19, 70656, v16
s_mov_b32 s38, 2621440
s_mov_b32 s39, 0x20000
s_mov_b32 s34, 1966080
s_mov_b32 s35, 0x20000
s_cmp_lt_u32 s53, 15
s_cselect_b32 s30, 2457600, 0
s_cselect_b32 s46, 21553152, 0
s_mov_b32 s31, 0x20000
s_waitcnt lgkmcnt(0)
s_load_dwordx16 s[64:79], s[90:91], 0
s_mov_b32 s36, s4
s_mov_b32 s37, s5
s_mov_b32 s28, s6
s_mov_b32 s29, s7
s_cmp_lt_u32 s54, 2
s_cselect_b32 s32, s12, s14
s_cselect_b32 s33, s13, s15
s_add_u32 m0, s84, 0
s_nop 0
buffer_load_dwordx4 v56, s[36:39], 0 offen lds
buffer_load_dwordx4 v57, s[36:39], 0 offen offset:1024 lds
buffer_load_dwordx4 v58, s[36:39], 0 offen offset:2048 lds
buffer_load_dwordx4 v59, s[36:39], 0 offen offset:3072 lds
s_add_u32 m0, s84, 114688
s_nop 0
buffer_load_dwordx4 v52, s[28:31], 0 offen lds
buffer_load_dwordx4 v53, s[28:31], 0 offen offset:1024 lds
buffer_load_dwordx4 v54, s[28:31], 0 offen offset:2048 lds
buffer_load_dwordx4 v55, s[28:31], 0 offen offset:3072 lds
s_mov_b32 s24, s22
s_mov_b32 s25, s23
s_mov_b32 s26, 21553152
s_mov_b32 s27, 0x20000
s_mov_b32 s44, s22
s_mov_b32 s45, s23
s_mov_b32 s47, 0x20000
s_mov_b32 s40, s18
s_mov_b32 s41, s19
s_mov_b32 s42, 2621440
s_mov_b32 s43, 0x20000
s_lshl_b32 s58, s54, 8
s_add_u32 s58, s58, s2
s_mov_b32 s51, 0x20000
s_cmp_lt_u32 s58, 840
s_cselect_b32 s48, s12, s14
s_cselect_b32 s49, s13, s15
s_cmp_lt_u32 s58, 680
s_cselect_b32 s48, s8, s48
s_cselect_b32 s49, s9, s49
s_cselect_b64 s[88:89], -1, 0
s_cselect_b32 s62, 32, 64
s_cselect_b32 s63, 64, 2048
s_cmp_lt_u32 s58, 480
s_cselect_b32 s48, s16, s48
s_cselect_b32 s49, s17, s49
s_mov_b32 s58, 21549056
buffer_load_dword v247, off, s[24:27], s58 sc1
s_load_dwordx16 s[4:19], s[90:91], 64
s_load_dwordx4 s[20:23], s[90:91], 192
s_load_dword s3, s[90:91], 128
v_and_b32 v198, 31, v1
v_lshlrev_b32 v30, 4, v198
v_lshrrev_b32 v45, 5, v1
v_bfe_u32 v197, v1, 1, 3
v_xor_b32 v197, v45, v197
v_lshlrev_b32 v197, 4, v197
v_lshl_add_u32 v197, v198, 7, v197
v_add_u32 v60, s84, v197
v_xor_b32 v61, 32, v60
v_xor_b32 v62, 64, v60
v_xor_b32 v63, 96, v60
v_bfe_u32 v192, v1, 2, 2
v_and_b32 v193, 3, v1
v_bfe_u32 v194, v1, 4, 1
v_lshrrev_b32 v195, 1, v193
v_and_b32 v197, 1, v193
v_lshl_or_b32 v195, v197, 1, v195
v_lshl_add_u32 v196, v45, 3, v192
v_lshlrev_b32 v196, 7, v196
v_lshl_add_u32 v196, v194, 5, v196
v_lshrrev_b32 v198, 1, v192
v_lshl_add_u32 v197, v198, 6, v196
s_cmp_ge_u32 s53, 10
s_cselect_b64 vcc, -1, 0
v_add_u32 v197, 49152, v197
v_lshl_add_u32 v29, v195, 3, v197
v_cndmask_b32 v198, v195, v193, vcc
v_lshl_add_u32 v48, v198, 3, v197
v_xor_b32 v50, 64, v48
v_xor_b32 v6, 64, v29
s_lshl_b32 s59, s61, 1
s_and_b32 s60, s84, 8192
s_or_b32 s59, s59, s60
v_xor_b32 v5, s59, v48
v_xor_b32 v9, s59, v29
v_add_u32 v49, 65536, v48
v_add_u32 v51, 65536, v50
v_add_u32 v8, 65536, v5
v_add_u32 v4, 65536, v29
v_add_u32 v7, 65536, v6
v_add_u32 v10, 65536, v9
v_and_b32 v198, 1, v192
v_cmp_eq_u32 vcc, v198, v194
v_mov_b32 v198, 0x3f803f80
s_lshr_b32 s85, s84, 1
v_cndmask_b32_e64 v41, 0, v198, vcc
v_accvgpr_write_b32 a236, v41
v_accvgpr_write_b32 a237, v41
v_accvgpr_write_b32 a238, v41
v_accvgpr_write_b32 a239, v41
s_add_u32 m0, s84, 131072
s_nop 0
buffer_load_dwordx4 v16, s[32:35], 0 offen lds
buffer_load_dwordx4 v17, s[32:35], 0 offen offset:1024 lds
buffer_load_dwordx4 v18, s[32:35], 0 offen offset:2048 lds
buffer_load_dwordx4 v19, s[32:35], 0 offen offset:3072 lds
s_add_u32 m0, s84, 16384
s_bfe_u32 s83, s55, 0x40000
s_mul_i32 s83, s83, 128
buffer_load_dwordx4 v56, s[36:39], s83 offen lds
buffer_load_dwordx4 v57, s[36:39], s83 offen offset:1024 lds
buffer_load_dwordx4 v58, s[36:39], s83 offen offset:2048 lds
buffer_load_dwordx4 v59, s[36:39], s83 offen offset:3072 lds
v_lshrrev_b32 v197, 4, v1
v_lshl_add_u32 v197, v197, 3, v192
v_lshlrev_b32 v197, 7, v197
v_lshl_add_u32 v197, v193, 3, v197
v_lshl_add_u32 v198, v195, 3, v196
s_add_u32 s58, s84, 147456
v_cndmask_b32_e64 v197, v198, v197, s[88:89]
v_add_u32 v36, s58, v197
v_add_u32 v37, s62, v36
v_add_u32 v38, s63, v36
v_add_u32 v39, s63, v37
v_mul_u32_u24 v46, 1280, v45
v_add_u32 v46, v46, v30
v_lshl_add_u32 v47, v194, 30, v46
v_and_b32 v197, 48, v1
v_lshl_add_u32 v197, v192, 6, v197
v_and_b32 v198, 11, v1
v_lshl_add_u32 v197, v198, 26, v197
v_min_u32 v246, 1, v1
v_lshlrev_b32 v246, 30, v246
v_min_u32 v198, 4, v1
v_lshlrev_b32 v198, 7, v198
s_waitcnt lgkmcnt(0)
v_and_b32 v40, s20, v41
v_and_b32 v41, s21, v41
v_accvgpr_write_b32 a240, v40
v_accvgpr_write_b32 a241, v40
v_accvgpr_write_b32 a242, v40
v_accvgpr_write_b32 a243, v40
v_accvgpr_write_b32 a244, v41
v_accvgpr_write_b32 a245, v41
v_accvgpr_write_b32 a246, v41
v_accvgpr_write_b32 a247, v41
v_add_u32 v42, s22, v197
v_add_u32 v15, s79, v197
v_add_u32 v43, s67, v246
s_mov_b32 s50, s71
v_mul_lo_u32 v32, v204, s72
v_lshl_add_u32 v32, v203, 4, v32
s_lshl_b32 s58, s72, 3
s_sub_u32 s58, s58, 1024
v_add_u32 v33, s58, v32
v_add_u32 v34, s58, v33
v_add_u32 v35, s58, v34
v_lshlrev_b32 v11, 14, v203
v_bfe_u32 v31, v1, 3, 2
v_lshlrev_b32 v31, 10, v31
v_lshl_add_u32 v31, v203, 4, v31
s_cmp_ge_u32 s53, 10
s_cbranch_scc1 L_vpath
s_waitcnt vmcnt(13)
ds_read_b128 a[0:3], v60 offset:0
ds_read_b128 a[4:7], v61 offset:0
ds_read_b128 a[8:11], v62 offset:0
ds_read_b128 a[12:15], v63 offset:0
s_waitcnt vmcnt(9)
s_barrier
ds_read_b64_tr_b16 a[160:161], v49 offset:0
ds_read_b64_tr_b16 a[162:163], v49 offset:512
ds_read_b64_tr_b16 a[164:165], v51 offset:0
ds_read_b64_tr_b16 a[166:167], v51 offset:512
ds_read_b64_tr_b16 a[168:169], v49 offset:8192
ds_read_b64_tr_b16 a[170:171], v49 offset:8704
ds_read_b64_tr_b16 a[172:173], v51 offset:8192
ds_read_b64_tr_b16 a[174:175], v51 offset:8704
ds_read_b64_tr_b16 a[176:177], v8 offset:0
ds_read_b64_tr_b16 a[178:179], v8 offset:512
ds_read_b64_tr_b16 a[180:181], v49 offset:2048
ds_read_b64_tr_b16 a[182:183], v49 offset:2560
ds_read_b64_tr_b16 a[184:185], v51 offset:2048
ds_read_b64_tr_b16 a[186:187], v51 offset:2560
ds_read_b64_tr_b16 a[188:189], v49 offset:10240
ds_read_b64_tr_b16 a[190:191], v49 offset:10752
ds_read_b64_tr_b16 a[192:193], v51 offset:10240
ds_read_b64_tr_b16 a[194:195], v51 offset:10752
ds_read_b64_tr_b16 a[196:197], v8 offset:2048
ds_read_b64_tr_b16 a[198:199], v8 offset:2560
s_waitcnt lgkmcnt(10)
v_mfma_f32_32x32x16_bf16 v[64:79], a[160:163], a[0:3], 0
ds_read_b64_tr_b16 a[200:201], v49 offset:4096
ds_read_b64_tr_b16 a[202:203], v49 offset:4608
ds_read_b64_tr_b16 a[204:205], v51 offset:4096
s_add_u32 m0, s84, 49152
s_bfe_u32 s80, s55, 0x40000
s_mul_i32 s80, s80, 245760
v_mfma_f32_32x32x16_bf16 v[80:95], a[164:167], a[0:3], 0
ds_read_b64_tr_b16 a[206:207], v51 offset:4608
ds_read_b64_tr_b16 a[208:209], v49 offset:12288
ds_read_b64_tr_b16 a[210:211], v49 offset:12800
buffer_load_dwordx4 v52, s[28:31], s80 offen lds
v_add_u32 v28, s78, v2
v_mfma_f32_32x32x16_bf16 v[96:111], a[168:171], a[0:3], 0
ds_read_b64_tr_b16 a[212:213], v51 offset:12288
ds_read_b64_tr_b16 a[214:215], v51 offset:12800
ds_read_b64_tr_b16 a[216:217], v8 offset:4096
v_add_u32 v12, 65536, v2
v_lshlrev_b32 v14, 2, v1
v_lshl_add_u32 v14, v45, 28, v14
v_mfma_f32_32x32x16_bf16 v[112:127], a[172:175], a[0:3], 0
ds_read_b64_tr_b16 a[218:219], v8 offset:4608
buffer_load_dwordx4 v53, s[28:31], s80 offen offset:1024 lds
v_add_u32 v13, s15, v2
v_mad_u32_u24 v27, v45, s12, v30
v_lshl_add_u32 v233, v45, 30, v2
v_and_b32 v253, 15, v1
v_mfma_f32_16x16x32_bf16 v[212:215], a[176:179], a[240:243], 0
v_lshlrev_b32 v244, 10, v253
s_waitcnt lgkmcnt(10)
v_mfma_f32_32x32x16_bf16 v[64:79], a[180:183], a[4:7], v[64:79]
ds_read_b64_tr_b16 a[160:161], v49 offset:6144
ds_read_b64_tr_b16 a[162:163], v49 offset:6656
ds_read_b64_tr_b16 a[164:165], v51 offset:6144
buffer_load_dwordx4 v54, s[28:31], s80 offen offset:2048 lds
v_lshrrev_b32 v252, 4, v1
v_mfma_f32_32x32x16_bf16 v[80:95], a[184:187], a[4:7], v[80:95]
ds_read_b64_tr_b16 a[166:167], v51 offset:6656
ds_read_b64_tr_b16 a[168:169], v49 offset:14336
ds_read_b64_tr_b16 a[170:171], v49 offset:14848
buffer_load_dwordx4 v55, s[28:31], s80 offen offset:3072 lds
v_lshlrev_b32 v240, 9, v252
v_mfma_f32_32x32x16_bf16 v[96:111], a[188:191], a[4:7], v[96:111]
ds_read_b64_tr_b16 a[172:173], v51 offset:14336
ds_read_b64_tr_b16 a[174:175], v51 offset:14848
ds_read_b64_tr_b16 a[176:177], v8 offset:6144
s_add_u32 m0, s84, 65536
s_bfe_u32 s81, s55, 0x40000
s_mul_i32 s81, s81, 196608
v_mfma_f32_32x32x16_bf16 v[112:127], a[192:195], a[4:7], v[112:127]
ds_read_b64_tr_b16 a[178:179], v8 offset:6656
v_lshl_add_u32 v240, v253, 4, v240
v_mul_u32_u24 v253, 1280, v253
v_lshl_add_u32 v245, v252, 3, v253
v_and_b32 v255, 1, v252
v_lshl_add_u32 v253, v255, 5, v253
v_lshl_add_u32 v3, v45, 4, v253
v_mfma_f32_16x16x32_bf16 v[212:215], a[196:199], a[240:243], v[212:215]
s_mul_i32 s59, s54, 2560
s_waitcnt lgkmcnt(10)
v_mfma_f32_32x32x16_bf16 v[64:79], a[200:203], a[8:11], v[64:79]
s_waitcnt vmcnt(8)
s_barrier
ds_read_b64_tr_b16 a[180:181], v4 offset:16384
ds_read_b64_tr_b16 a[182:183], v4 offset:16896
ds_read_b64_tr_b16 a[184:185], v7 offset:16384
s_add_u32 s60, s59, 81920
v_mfma_f32_32x32x16_bf16 v[80:95], a[204:207], a[8:11], v[80:95]
ds_read_b64_tr_b16 a[186:187], v7 offset:16896
ds_read_b64_tr_b16 a[188:189], v4 offset:24576
ds_read_b64_tr_b16 a[190:191], v4 offset:25088
v_add_u32 v229, s60, v2
v_add_u32 v230, s60, v30
v_bfe_u32 v237, v1, 2, 1
v_mfma_f32_32x32x16_bf16 v[96:111], a[208:211], a[8:11], v[96:111]
ds_read_b64_tr_b16 a[192:193], v7 offset:24576
ds_read_b64_tr_b16 a[194:195], v7 offset:25088
ds_read_b64_tr_b16 a[196:197], v10 offset:16384
v_bfe_u32 v238, v1, 3, 1
v_and_b32 v239, 3, v1
v_lshl_add_u32 v237, v237, 3, v239
v_mfma_f32_32x32x16_bf16 v[112:127], a[212:215], a[8:11], v[112:127]
ds_read_b64_tr_b16 a[198:199], v10 offset:16896
v_lshl_add_u32 v237, v238, 2, v237
v_mul_u32_u24 v238, 640, v45
s_add_u32 s60, s59, 112640
v_add_u32 v238, s60, v238
v_mov_b32 v254, s59
v_and_b32 v235, 31, v1
v_mfma_f32_16x16x32_bf16 v[212:215], a[216:219], a[240:243], v[212:215]
v_cmp_gt_u32 vcc, 16, v235
s_waitcnt lgkmcnt(10)
v_mfma_f32_32x32x16_bf16 v[64:79], a[160:163], a[12:15], v[64:79]
ds_read_b64_tr_b16 a[200:201], v4 offset:18432
ds_read_b64_tr_b16 a[202:203], v4 offset:18944
ds_read_b64_tr_b16 a[204:205], v7 offset:18432
v_cmp_gt_u32_e64 s[88:89], 20, v235
v_add_u32 v252, 0, v237
v_add_u32 v253, 16, v239
v_mfma_f32_32x32x16_bf16 v[80:95], a[164:167], a[12:15], v[80:95]
ds_read_b64_tr_b16 a[206:207], v7 offset:18944
ds_read_b64_tr_b16 a[208:209], v4 offset:26624
ds_read_b64_tr_b16 a[210:211], v4 offset:27136
v_cndmask_b32 v252, v253, v252, vcc
v_lshl_add_u32 v252, v252, 4, v238
v_cndmask_b32_e64 v231, v254, v252, s[88:89]
v_mfma_f32_32x32x16_bf16 v[96:111], a[168:171], a[12:15], v[96:111]
ds_read_b64_tr_b16 a[212:213], v7 offset:26624
ds_read_b64_tr_b16 a[214:215], v7 offset:27136
ds_read_b64_tr_b16 a[216:217], v10 offset:18432
v_add_u32 v252, 24, v237
v_add_u32 v253, 20, v239
v_cndmask_b32 v252, v253, v252, vcc
v_mfma_f32_32x32x16_bf16 v[112:127], a[172:175], a[12:15], v[112:127]
ds_read_b64_tr_b16 a[218:219], v10 offset:18944
v_lshl_add_u32 v252, v252, 4, v238
v_cndmask_b32_e64 v232, v254, v252, s[88:89]
v_cmp_gt_u32 vcc, 2, v1
v_cmp_gt_u32_e64 s[88:89], 4, v1
v_mov_b32 v252, s16
v_mov_b32 v253, s17
v_mfma_f32_16x16x32_bf16 v[212:215], a[176:179], a[240:243], v[212:215]
v_mov_b32 v254, s18
s_waitcnt lgkmcnt(10)
v_mfma_f32_32x32x16_bf16 v[128:143], a[180:183], a[0:3], 0
ds_read_b64_tr_b16 a[160:161], v4 offset:20480
ds_read_b64_tr_b16 a[162:163], v4 offset:20992
ds_read_b64_tr_b16 a[164:165], v7 offset:20480
v_and_b32 v255, 1, v1
v_cndmask_b32_e64 v253, v254, v253, s[88:89]
v_cndmask_b32 v252, v253, v252, vcc
v_mfma_f32_32x32x16_bf16 v[144:159], a[184:187], a[0:3], 0
ds_read_b64_tr_b16 a[166:167], v7 offset:20992
ds_read_b64_tr_b16 a[168:169], v4 offset:28672
ds_read_b64_tr_b16 a[170:171], v4 offset:29184
v_mad_u32_u24 v234, v255, s19, v252
s_cmp_ge_u32 s54, 2
s_cselect_b32 s61, 9600, 0
v_mfma_f32_32x32x16_bf16 v[160:175], a[188:191], a[0:3], 0
ds_read_b64_tr_b16 a[172:173], v7 offset:28672
ds_read_b64_tr_b16 a[174:175], v7 offset:29184
ds_read_b64_tr_b16 a[176:177], v10 offset:20480
buffer_load_dwordx4 v16, s[32:35], s81 offen lds
v_add_u32 v253, 0, v1
v_mfma_f32_32x32x16_bf16 v[176:191], a[192:195], a[0:3], 0
ds_read_b64_tr_b16 a[178:179], v10 offset:20992
buffer_load_dwordx4 v17, s[32:35], s81 offen offset:1024 lds
v_mul_u32_u24 v253, 205, v253
v_lshrrev_b32 v253, 13, v253
v_mad_u32_u24 v224, v253, s61, v2
v_add_u32 v253, 64, v1
v_mfma_f32_16x16x32_bf16 v[216:219], a[196:199], a[240:243], 0
v_mul_u32_u24 v253, 205, v253
s_waitcnt lgkmcnt(10)
v_mfma_f32_32x32x16_bf16 v[128:143], a[200:203], a[4:7], v[128:143]
ds_read_b64_tr_b16 a[180:181], v4 offset:22528
ds_read_b64_tr_b16 a[182:183], v4 offset:23040
ds_read_b64_tr_b16 a[184:185], v7 offset:22528
s_waitcnt vmcnt(6)
ds_read_b128 a[16:19], v60 offset:16384
v_lshrrev_b32 v253, 13, v253
v_mfma_f32_32x32x16_bf16 v[144:159], a[204:207], a[4:7], v[144:159]
ds_read_b64_tr_b16 a[186:187], v7 offset:23040
ds_read_b64_tr_b16 a[188:189], v4 offset:30720
ds_read_b64_tr_b16 a[190:191], v4 offset:31232
ds_read_b128 a[20:23], v61 offset:16384
buffer_load_dwordx4 v18, s[32:35], s81 offen offset:2048 lds
v_mfma_f32_32x32x16_bf16 v[160:175], a[208:211], a[4:7], v[160:175]
ds_read_b64_tr_b16 a[192:193], v7 offset:30720
ds_read_b64_tr_b16 a[194:195], v7 offset:31232
ds_read_b64_tr_b16 a[196:197], v10 offset:22528
ds_read_b128 a[24:27], v62 offset:16384
buffer_load_dwordx4 v19, s[32:35], s81 offen offset:3072 lds
v_mfma_f32_32x32x16_bf16 v[176:191], a[212:215], a[4:7], v[176:191]
ds_read_b64_tr_b16 a[198:199], v10 offset:23040
ds_read_b128 a[28:31], v63 offset:16384
v_mad_u32_u24 v225, v253, s61, v2
v_mul_u32_u24 v252, 38400, v45
v_xor_b32 v253, 1, v45
v_mul_u32_u24 v253, 3, v253
v_add_u32 v252, v252, v2
v_mfma_f32_16x16x32_bf16 v[216:219], a[216:219], a[240:243], v[216:219]
v_mad_u32_u24 v226, v253, s61, v252
s_waitcnt lgkmcnt(14)
v_mfma_f32_32x32x16_bf16 v[128:143], a[160:163], a[8:11], v[128:143]
s_waitcnt vmcnt(4)
s_barrier
ds_read_b64_tr_b16 a[200:201], v48 offset:0
ds_read_b64_tr_b16 a[202:203], v48 offset:512
ds_read_b64_tr_b16 a[204:205], v50 offset:0
v_add_u32 v253, 32, v1
v_mfma_f32_32x32x16_bf16 v[144:159], a[164:167], a[8:11], v[144:159]
ds_read_b64_tr_b16 a[206:207], v50 offset:512
ds_read_b64_tr_b16 a[208:209], v48 offset:8192
ds_read_b64_tr_b16 a[210:211], v48 offset:8704
buffer_load_dword v223, v198, s[24:27], s23 offen sc1
v_mul_u32_u24 v253, 205, v253
v_mfma_f32_32x32x16_bf16 v[160:175], a[168:171], a[8:11], v[160:175]
ds_read_b64_tr_b16 a[212:213], v50 offset:8192
ds_read_b64_tr_b16 a[214:215], v50 offset:8704
ds_read_b64_tr_b16 a[216:217], v5 offset:0
buffer_load_dword v223, v43, s[24:27], 0 offen sc1
v_lshrrev_b32 v253, 13, v253
v_mfma_f32_32x32x16_bf16 v[176:191], a[172:175], a[8:11], v[176:191]
ds_read_b64_tr_b16 a[218:219], v5 offset:512
s_add_u32 m0, s84, 32768
s_mov_b32 s83, 128
v_mad_u32_u24 v227, v253, s61, v2
v_add_u32 v227, 38400, v227
v_add_u32 v253, 96, v1
v_mul_u32_u24 v253, 205, v253
v_mfma_f32_16x16x32_bf16 v[216:219], a[176:179], a[240:243], v[216:219]
v_lshrrev_b32 v253, 13, v253
s_waitcnt lgkmcnt(11)
v_mfma_f32_32x32x16_bf16 v[128:143], a[180:183], a[12:15], v[128:143]
ds_read_b64_tr_b16 a[160:161], v48 offset:2048
ds_read_b64_tr_b16 a[162:163], v48 offset:2560
ds_read_b64_tr_b16 a[164:165], v50 offset:2048
buffer_load_dwordx4 v56, s[36:39], s83 offen lds
v_mad_u32_u24 v228, v253, s61, v2
v_mfma_f32_32x32x16_bf16 v[144:159], a[184:187], a[12:15], v[144:159]
ds_read_b64_tr_b16 a[166:167], v50 offset:2560
ds_read_b64_tr_b16 a[168:169], v48 offset:10240
ds_read_b64_tr_b16 a[170:171], v48 offset:10752
buffer_load_dwordx4 v57, s[36:39], s83 offen offset:1024 lds
v_add_u32 v228, 42496, v228
v_mfma_f32_32x32x16_bf16 v[160:175], a[188:191], a[12:15], v[160:175]
ds_read_b64_tr_b16 a[172:173], v50 offset:10240
ds_read_b64_tr_b16 a[174:175], v50 offset:10752
ds_read_b64_tr_b16 a[176:177], v5 offset:2048
v_add_u32 v247, 0x9e3779b9, v247
v_min_u32 v44, 1, v30
v_mfma_f32_32x32x16_bf16 v[176:191], a[192:195], a[12:15], v[176:191]
ds_read_b64_tr_b16 a[178:179], v5 offset:2560
buffer_load_dwordx4 v58, s[36:39], s83 offen offset:2048 lds
v_lshlrev_b32 v44, 30, v44
v_readfirstlane_b32 s56, v247
v_lshl_add_u32 v44, v45, 4, v44
s_mov_b32 s57, s56
v_mfma_f32_16x16x32_bf16 v[216:219], a[196:199], a[240:243], v[216:219]
s_waitcnt lgkmcnt(10)
v_mfma_f32_32x32x16_bf16 v[64:79], a[200:203], a[16:19], v[64:79]
ds_read_b64_tr_b16 a[180:181], v48 offset:4096
ds_read_b64_tr_b16 a[182:183], v48 offset:4608
ds_read_b64_tr_b16 a[184:185], v50 offset:4096
buffer_load_dwordx4 v59, s[36:39], s83 offen offset:3072 lds
v_mfma_f32_32x32x16_bf16 v[80:95], a[204:207], a[16:19], v[80:95]
ds_read_b64_tr_b16 a[186:187], v50 offset:4608
ds_read_b64_tr_b16 a[188:189], v48 offset:12288
ds_read_b64_tr_b16 a[190:191], v48 offset:12800
s_add_u32 m0, s84, 81920
s_mov_b32 s80, 245760
v_mfma_f32_32x32x16_bf16 v[96:111], a[208:211], a[16:19], v[96:111]
ds_read_b64_tr_b16 a[192:193], v50 offset:12288
ds_read_b64_tr_b16 a[194:195], v50 offset:12800
ds_read_b64_tr_b16 a[196:197], v5 offset:4096
buffer_load_dwordx4 v52, s[28:31], s80 offen lds
v_mfma_f32_32x32x16_bf16 v[112:127], a[212:215], a[16:19], v[112:127]
ds_read_b64_tr_b16 a[198:199], v5 offset:4608
v_mfma_f32_16x16x32_bf16 v[212:215], a[216:219], a[236:239], v[212:215]
s_waitcnt lgkmcnt(10)
v_mfma_f32_32x32x16_bf16 v[64:79], a[160:163], a[20:23], v[64:79]
ds_read_b64_tr_b16 a[200:201], v48 offset:6144
ds_read_b64_tr_b16 a[202:203], v48 offset:6656
ds_read_b64_tr_b16 a[204:205], v50 offset:6144
buffer_load_dwordx4 v53, s[28:31], s80 offen offset:1024 lds
v_mfma_f32_32x32x16_bf16 v[80:95], a[164:167], a[20:23], v[80:95]
ds_read_b64_tr_b16 a[206:207], v50 offset:6656
ds_read_b64_tr_b16 a[208:209], v48 offset:14336
ds_read_b64_tr_b16 a[210:211], v48 offset:14848
buffer_load_dwordx4 v54, s[28:31], s80 offen offset:2048 lds
v_mfma_f32_32x32x16_bf16 v[96:111], a[168:171], a[20:23], v[96:111]
ds_read_b64_tr_b16 a[212:213], v50 offset:14336
ds_read_b64_tr_b16 a[214:215], v50 offset:14848
ds_read_b64_tr_b16 a[216:217], v5 offset:6144
v_mfma_f32_32x32x16_bf16 v[112:127], a[172:175], a[20:23], v[112:127]
ds_read_b64_tr_b16 a[218:219], v5 offset:6656
buffer_load_dwordx4 v55, s[28:31], s80 offen offset:3072 lds
v_mfma_f32_16x16x32_bf16 v[212:215], a[176:179], a[236:239], v[212:215]
s_waitcnt lgkmcnt(10)
v_mfma_f32_32x32x16_bf16 v[64:79], a[180:183], a[24:27], v[64:79]
s_waitcnt vmcnt(10)
s_barrier
ds_read_b64_tr_b16 a[160:161], v29 offset:16384
ds_read_b64_tr_b16 a[162:163], v29 offset:16896
ds_read_b64_tr_b16 a[164:165], v6 offset:16384
v_mfma_f32_32x32x16_bf16 v[80:95], a[184:187], a[24:27], v[80:95]
ds_read_b64_tr_b16 a[166:167], v6 offset:16896
ds_read_b64_tr_b16 a[168:169], v29 offset:24576
ds_read_b64_tr_b16 a[170:171], v29 offset:25088
buffer_load_dwordx4 v[200:203], v46, s[36:39], s64 offen
v_mfma_f32_32x32x16_bf16 v[96:111], a[188:191], a[24:27], v[96:111]
ds_read_b64_tr_b16 a[172:173], v6 offset:24576
ds_read_b64_tr_b16 a[174:175], v6 offset:25088
ds_read_b64_tr_b16 a[176:177], v9 offset:16384
buffer_load_dwordx4 v[204:207], v46, s[36:39], s64 offen offset:512
v_mfma_f32_32x32x16_bf16 v[112:127], a[192:195], a[24:27], v[112:127]
ds_read_b64_tr_b16 a[178:179], v9 offset:16896
v_mfma_f32_16x16x32_bf16 v[212:215], a[196:199], a[236:239], v[212:215]
s_waitcnt lgkmcnt(10)
v_mfma_f32_32x32x16_bf16 v[64:79], a[200:203], a[28:31], v[64:79]
ds_read_b64_tr_b16 a[180:181], v29 offset:18432
ds_read_b64_tr_b16 a[182:183], v29 offset:18944
ds_read_b64_tr_b16 a[184:185], v6 offset:18432
buffer_load_dwordx4 v[208:211], v47, s[36:39], s64 offen offset:1024
v_mfma_f32_32x32x16_bf16 v[80:95], a[204:207], a[28:31], v[80:95]
ds_read_b64_tr_b16 a[186:187], v6 offset:18944
ds_read_b64_tr_b16 a[188:189], v29 offset:26624
ds_read_b64_tr_b16 a[190:191], v29 offset:27136
s_add_u32 m0, s84, 98304
s_mov_b32 s81, 196608
v_mfma_f32_32x32x16_bf16 v[96:111], a[208:211], a[28:31], v[96:111]
ds_read_b64_tr_b16 a[192:193], v6 offset:26624
ds_read_b64_tr_b16 a[194:195], v6 offset:27136
ds_read_b64_tr_b16 a[196:197], v9 offset:18432
buffer_load_dwordx4 v16, s[32:35], s81 offen lds
v_mfma_f32_32x32x16_bf16 v[112:127], a[212:215], a[28:31], v[112:127]
ds_read_b64_tr_b16 a[198:199], v9 offset:18944
v_mfma_f32_16x16x32_bf16 v[212:215], a[216:219], a[236:239], v[212:215]
s_waitcnt lgkmcnt(10)
v_mfma_f32_32x32x16_bf16 v[128:143], a[160:163], a[16:19], v[128:143]
ds_read_b64_tr_b16 a[200:201], v29 offset:20480
ds_read_b64_tr_b16 a[202:203], v29 offset:20992
ds_read_b64_tr_b16 a[204:205], v6 offset:20480
buffer_load_dwordx4 v17, s[32:35], s81 offen offset:1024 lds
v_mfma_f32_32x32x16_bf16 v[144:159], a[164:167], a[16:19], v[144:159]
ds_read_b64_tr_b16 a[206:207], v6 offset:20992
ds_read_b64_tr_b16 a[208:209], v29 offset:28672
ds_read_b64_tr_b16 a[210:211], v29 offset:29184
buffer_load_dwordx4 v18, s[32:35], s81 offen offset:2048 lds
v_mfma_f32_32x32x16_bf16 v[160:175], a[168:171], a[16:19], v[160:175]
ds_read_b64_tr_b16 a[212:213], v6 offset:28672
ds_read_b64_tr_b16 a[214:215], v6 offset:29184
ds_read_b64_tr_b16 a[216:217], v9 offset:20480
v_mfma_f32_32x32x16_bf16 v[176:191], a[172:175], a[16:19], v[176:191]
ds_read_b64_tr_b16 a[218:219], v9 offset:20992
buffer_load_dwordx4 v19, s[32:35], s81 offen offset:3072 lds
s_add_u32 m0, s84, 0
s_bfe_u32 s83, s55, 0x40004
s_mul_i32 s83, s83, 128
v_mfma_f32_16x16x32_bf16 v[216:219], a[176:179], a[236:239], v[216:219]
s_waitcnt lgkmcnt(10)
v_mfma_f32_32x32x16_bf16 v[128:143], a[180:183], a[20:23], v[128:143]
ds_read_b64_tr_b16 a[160:161], v29 offset:22528
ds_read_b64_tr_b16 a[162:163], v29 offset:23040
ds_read_b64_tr_b16 a[164:165], v6 offset:22528
s_waitcnt vmcnt(11)
ds_read_b128 a[32:35], v60 offset:32768
v_mfma_f32_32x32x16_bf16 v[144:159], a[184:187], a[20:23], v[144:159]
ds_read_b64_tr_b16 a[166:167], v6 offset:23040
ds_read_b64_tr_b16 a[168:169], v29 offset:30720
ds_read_b64_tr_b16 a[170:171], v29 offset:31232
ds_read_b128 a[36:39], v61 offset:32768
buffer_load_dwordx4 v56, s[36:39], s83 offen lds
v_mfma_f32_32x32x16_bf16 v[160:175], a[188:191], a[20:23], v[160:175]
ds_read_b64_tr_b16 a[172:173], v6 offset:30720
ds_read_b64_tr_b16 a[174:175], v6 offset:31232
ds_read_b64_tr_b16 a[176:177], v9 offset:22528
ds_read_b128 a[40:43], v62 offset:32768
buffer_load_dwordx4 v57, s[36:39], s83 offen offset:1024 lds
v_mfma_f32_32x32x16_bf16 v[176:191], a[192:195], a[20:23], v[176:191]
ds_read_b64_tr_b16 a[178:179], v9 offset:23040
ds_read_b128 a[44:47], v63 offset:32768
s_waitcnt vmcnt(8)
v_lshlrev_b32 v252, 16, v200
v_and_b32 v253, 0xffff0000, v200
v_add_f32 v236, v252, v253
v_mul_f32 v238, v252, v252
v_mfma_f32_16x16x32_bf16 v[216:219], a[196:199], a[236:239], v[216:219]
v_fmac_f32 v238, v253, v253
s_waitcnt lgkmcnt(14)
v_mfma_f32_32x32x16_bf16 v[128:143], a[200:203], a[24:27], v[128:143]
s_barrier
ds_read_b64_tr_b16 a[180:181], v48 offset:32768
ds_read_b64_tr_b16 a[182:183], v48 offset:33280
ds_read_b64_tr_b16 a[184:185], v50 offset:32768
v_lshlrev_b32 v252, 16, v201
v_mfma_f32_32x32x16_bf16 v[144:159], a[204:207], a[24:27], v[144:159]
ds_read_b64_tr_b16 a[186:187], v50 offset:33280
ds_read_b64_tr_b16 a[188:189], v48 offset:40960
ds_read_b64_tr_b16 a[190:191], v48 offset:41472
buffer_load_dwordx4 v58, s[36:39], s83 offen offset:2048 lds
v_and_b32 v253, 0xffff0000, v201
v_mfma_f32_32x32x16_bf16 v[160:175], a[208:211], a[24:27], v[160:175]
ds_read_b64_tr_b16 a[192:193], v50 offset:40960
ds_read_b64_tr_b16 a[194:195], v50 offset:41472
ds_read_b64_tr_b16 a[196:197], v5 offset:32768
buffer_load_dwordx4 v59, s[36:39], s83 offen offset:3072 lds
v_add_f32 v236, v236, v252
v_mfma_f32_32x32x16_bf16 v[176:191], a[212:215], a[24:27], v[176:191]
ds_read_b64_tr_b16 a[198:199], v5 offset:33280
s_add_u32 m0, s84, 114688
s_bfe_u32 s80, s55, 0x40004
s_mul_i32 s80, s80, 245760
v_fmac_f32 v238, v252, v252
v_add_f32 v236, v236, v253
v_fmac_f32 v238, v253, v253
v_mfma_f32_16x16x32_bf16 v[216:219], a[216:219], a[236:239], v[216:219]
v_lshlrev_b32 v252, 16, v202
s_waitcnt lgkmcnt(11)
v_mfma_f32_32x32x16_bf16 v[128:143], a[160:163], a[28:31], v[128:143]
ds_read_b64_tr_b16 a[200:201], v48 offset:34816
ds_read_b64_tr_b16 a[202:203], v48 offset:35328
ds_read_b64_tr_b16 a[204:205], v50 offset:34816
buffer_load_dwordx4 v52, s[28:31], s80 offen lds
v_and_b32 v253, 0xffff0000, v202
v_mfma_f32_32x32x16_bf16 v[144:159], a[164:167], a[28:31], v[144:159]
ds_read_b64_tr_b16 a[206:207], v50 offset:35328
ds_read_b64_tr_b16 a[208:209], v48 offset:43008
ds_read_b64_tr_b16 a[210:211], v48 offset:43520
buffer_load_dwordx4 v53, s[28:31], s80 offen offset:1024 lds
v_add_f32 v236, v236, v252
v_mfma_f32_32x32x16_bf16 v[160:175], a[168:171], a[28:31], v[160:175]
ds_read_b64_tr_b16 a[212:213], v50 offset:43008
ds_read_b64_tr_b16 a[214:215], v50 offset:43520
ds_read_b64_tr_b16 a[216:217], v5 offset:34816
v_fmac_f32 v238, v252, v252
v_add_f32 v236, v236, v253
v_fmac_f32 v238, v253, v253
v_mfma_f32_32x32x16_bf16 v[176:191], a[172:175], a[28:31], v[176:191]
ds_read_b64_tr_b16 a[218:219], v5 offset:35328
buffer_load_dwordx4 v54, s[28:31], s80 offen offset:2048 lds
v_lshlrev_b32 v252, 16, v203
v_and_b32 v253, 0xffff0000, v203
v_add_f32 v236, v236, v252
v_fmac_f32 v238, v252, v252
v_mfma_f32_16x16x32_bf16 v[216:219], a[176:179], a[236:239], v[216:219]
v_add_f32 v236, v236, v253
s_waitcnt lgkmcnt(10)
v_mfma_f32_32x32x16_bf16 v[64:79], a[180:183], a[32:35], v[64:79]
ds_read_b64_tr_b16 a[160:161], v48 offset:36864
ds_read_b64_tr_b16 a[162:163], v48 offset:37376
ds_read_b64_tr_b16 a[164:165], v50 offset:36864
buffer_load_dwordx4 v55, s[28:31], s80 offen offset:3072 lds
v_fmac_f32 v238, v253, v253
v_mfma_f32_32x32x16_bf16 v[80:95], a[184:187], a[32:35], v[80:95]
ds_read_b64_tr_b16 a[166:167], v50 offset:37376
ds_read_b64_tr_b16 a[168:169], v48 offset:45056
ds_read_b64_tr_b16 a[170:171], v48 offset:45568
s_add_u32 m0, s84, 16384
s_bfe_u32 s83, s55, 0x40008
s_mul_i32 s83, s83, 128
v_mfma_f32_32x32x16_bf16 v[96:111], a[188:191], a[32:35], v[96:111]
ds_read_b64_tr_b16 a[172:173], v50 offset:45056
ds_read_b64_tr_b16 a[174:175], v50 offset:45568
ds_read_b64_tr_b16 a[176:177], v5 offset:36864
buffer_load_dwordx4 v56, s[36:39], s83 offen lds
v_mfma_f32_32x32x16_bf16 v[112:127], a[192:195], a[32:35], v[112:127]
ds_read_b64_tr_b16 a[178:179], v5 offset:37376
s_waitcnt vmcnt(14)
v_lshlrev_b32 v252, 16, v204
v_and_b32 v253, 0xffff0000, v204
v_add_f32 v236, v236, v252
v_fmac_f32 v238, v252, v252
v_add_f32 v236, v236, v253
v_mfma_f32_16x16x32_bf16 v[212:215], a[196:199], a[244:247], v[212:215]
v_fmac_f32 v238, v253, v253
s_waitcnt lgkmcnt(10)
v_mfma_f32_32x32x16_bf16 v[64:79], a[200:203], a[36:39], v[64:79]
ds_read_b64_tr_b16 a[180:181], v48 offset:38912
ds_read_b64_tr_b16 a[182:183], v48 offset:39424
ds_read_b64_tr_b16 a[184:185], v50 offset:38912
buffer_load_dwordx4 v57, s[36:39], s83 offen offset:1024 lds
v_lshlrev_b32 v252, 16, v205
v_mfma_f32_32x32x16_bf16 v[80:95], a[204:207], a[36:39], v[80:95]
ds_read_b64_tr_b16 a[186:187], v50 offset:39424
ds_read_b64_tr_b16 a[188:189], v48 offset:47104
ds_read_b64_tr_b16 a[190:191], v48 offset:47616
buffer_load_dwordx4 v58, s[36:39], s83 offen offset:2048 lds
v_and_b32 v253, 0xffff0000, v205
v_mfma_f32_32x32x16_bf16 v[96:111], a[208:211], a[36:39], v[96:111]
ds_read_b64_tr_b16 a[192:193], v50 offset:47104
ds_read_b64_tr_b16 a[194:195], v50 offset:47616
ds_read_b64_tr_b16 a[196:197], v5 offset:38912
v_add_f32 v236, v236, v252
v_fmac_f32 v238, v252, v252
v_add_f32 v236, v236, v253
v_mfma_f32_32x32x16_bf16 v[112:127], a[212:215], a[36:39], v[112:127]
ds_read_b64_tr_b16 a[198:199], v5 offset:39424
buffer_load_dwordx4 v59, s[36:39], s83 offen offset:3072 lds
s_add_u32 m0, s84, 147456
v_fmac_f32 v238, v253, v253
v_lshlrev_b32 v252, 16, v206
v_and_b32 v253, 0xffff0000, v206
v_mfma_f32_16x16x32_bf16 v[212:215], a[216:219], a[244:247], v[212:215]
v_add_f32 v236, v236, v252
s_waitcnt lgkmcnt(10)
v_mfma_f32_32x32x16_bf16 v[64:79], a[160:163], a[40:43], v[64:79]
s_waitcnt vmcnt(12)
s_barrier
ds_read_b64_tr_b16 a[200:201], v29 offset:49152
ds_read_b64_tr_b16 a[202:203], v29 offset:49664
ds_read_b64_tr_b16 a[204:205], v6 offset:49152
v_fmac_f32 v238, v252, v252
v_mfma_f32_32x32x16_bf16 v[80:95], a[164:167], a[40:43], v[80:95]
ds_read_b64_tr_b16 a[206:207], v6 offset:49664
ds_read_b64_tr_b16 a[208:209], v29 offset:57344
ds_read_b64_tr_b16 a[210:211], v29 offset:57856
buffer_load_dwordx4 v32, s[48:51], s70 offen offset:0 lds
v_add_f32 v236, v236, v253
v_mfma_f32_32x32x16_bf16 v[96:111], a[168:171], a[40:43], v[96:111]
ds_read_b64_tr_b16 a[212:213], v6 offset:57344
ds_read_b64_tr_b16 a[214:215], v6 offset:57856
ds_read_b64_tr_b16 a[216:217], v9 offset:49152
buffer_load_dwordx4 v33, s[48:51], s70 offen offset:1024 lds
v_fmac_f32 v238, v253, v253
v_mfma_f32_32x32x16_bf16 v[112:127], a[172:175], a[40:43], v[112:127]
ds_read_b64_tr_b16 a[218:219], v9 offset:49664
v_lshlrev_b32 v252, 16, v207
v_and_b32 v253, 0xffff0000, v207
v_add_f32 v236, v236, v252
v_fmac_f32 v238, v252, v252
v_add_f32 v236, v236, v253
v_fmac_f32 v238, v253, v253
v_mfma_f32_16x16x32_bf16 v[212:215], a[176:179], a[244:247], v[212:215]
s_waitcnt lgkmcnt(10)
v_mfma_f32_32x32x16_bf16 v[64:79], a[180:183], a[44:47], v[64:79]
ds_read_b64_tr_b16 a[160:161], v29 offset:51200
ds_read_b64_tr_b16 a[162:163], v29 offset:51712
ds_read_b64_tr_b16 a[164:165], v6 offset:51200
buffer_load_dwordx4 v34, s[48:51], s70 offen offset:2048 lds
v_mfma_f32_32x32x16_bf16 v[80:95], a[184:187], a[44:47], v[80:95]
ds_read_b64_tr_b16 a[166:167], v6 offset:51712
ds_read_b64_tr_b16 a[168:169], v29 offset:59392
ds_read_b64_tr_b16 a[170:171], v29 offset:59904
buffer_load_dwordx4 v35, s[48:51], s70 offen offset:3072 lds
v_mfma_f32_32x32x16_bf16 v[96:111], a[188:191], a[44:47], v[96:111]
ds_read_b64_tr_b16 a[172:173], v6 offset:59392
ds_read_b64_tr_b16 a[174:175], v6 offset:59904
ds_read_b64_tr_b16 a[176:177], v9 offset:51200
s_add_u32 m0, s84, 131072
s_bfe_u32 s80, s55, 0x40008
s_mul_i32 s80, s80, 245760
v_mfma_f32_32x32x16_bf16 v[112:127], a[192:195], a[44:47], v[112:127]
ds_read_b64_tr_b16 a[178:179], v9 offset:51712
buffer_load_dwordx4 v52, s[28:31], s80 offen lds
v_lshlrev_b32 v252, 16, v208
v_and_b32 v253, 0xffff0000, v208
v_add_f32 v236, v236, v252
v_mfma_f32_16x16x32_bf16 v[212:215], a[196:199], a[244:247], v[212:215]
v_fmac_f32 v238, v252, v252
s_waitcnt lgkmcnt(10)
v_mfma_f32_32x32x16_bf16 v[128:143], a[200:203], a[32:35], v[128:143]
ds_read_b64_tr_b16 a[180:181], v29 offset:53248
ds_read_b64_tr_b16 a[182:183], v29 offset:53760
ds_read_b64_tr_b16 a[184:185], v6 offset:53248
buffer_load_dwordx4 v53, s[28:31], s80 offen offset:1024 lds
v_add_f32 v236, v236, v253
v_mfma_f32_32x32x16_bf16 v[144:159], a[204:207], a[32:35], v[144:159]
ds_read_b64_tr_b16 a[186:187], v6 offset:53760
ds_read_b64_tr_b16 a[188:189], v29 offset:61440
ds_read_b64_tr_b16 a[190:191], v29 offset:61952
v_fmac_f32 v238, v253, v253
v_lshlrev_b32 v252, 16, v209
v_and_b32 v253, 0xffff0000, v209
v_mfma_f32_32x32x16_bf16 v[160:175], a[208:211], a[32:35], v[160:175]
ds_read_b64_tr_b16 a[192:193], v6 offset:61440
ds_read_b64_tr_b16 a[194:195], v6 offset:61952
ds_read_b64_tr_b16 a[196:197], v9 offset:53248
buffer_load_dwordx4 v54, s[28:31], s80 offen offset:2048 lds
v_add_f32 v236, v236, v252
v_mfma_f32_32x32x16_bf16 v[176:191], a[212:215], a[32:35], v[176:191]
ds_read_b64_tr_b16 a[198:199], v9 offset:53760
buffer_load_dwordx4 v55, s[28:31], s80 offen offset:3072 lds
s_add_u32 m0, s84, 32768
s_bfe_u32 s83, s55, 0x4000c
s_mul_i32 s83, s83, 128
buffer_store_dwordx4 v[212:215], v42, s[24:27], s6 offen sc1
v_mfma_f32_16x16x32_bf16 v[216:219], a[216:219], a[244:247], v[216:219]
v_fmac_f32 v238, v252, v252
s_waitcnt lgkmcnt(10)
v_mfma_f32_32x32x16_bf16 v[128:143], a[160:163], a[36:39], v[128:143]
ds_read_b64_tr_b16 a[200:201], v29 offset:55296
ds_read_b64_tr_b16 a[202:203], v29 offset:55808
ds_read_b64_tr_b16 a[204:205], v6 offset:55296
s_waitcnt vmcnt(17)
ds_read_b128 a[48:51], v60 offset:0
v_add_f32 v236, v236, v253
v_mfma_f32_32x32x16_bf16 v[144:159], a[164:167], a[36:39], v[144:159]
ds_read_b64_tr_b16 a[206:207], v6 offset:55808
ds_read_b64_tr_b16 a[208:209], v29 offset:63488
ds_read_b64_tr_b16 a[210:211], v29 offset:64000
ds_read_b128 a[52:55], v61 offset:0
buffer_load_dwordx4 v56, s[36:39], s83 offen lds
v_mfma_f32_32x32x16_bf16 v[160:175], a[168:171], a[36:39], v[160:175]
ds_read_b64_tr_b16 a[212:213], v6 offset:63488
ds_read_b64_tr_b16 a[214:215], v6 offset:64000
ds_read_b64_tr_b16 a[216:217], v9 offset:55296
ds_read_b128 a[56:59], v62 offset:0
buffer_load_dwordx4 v57, s[36:39], s83 offen offset:1024 lds
v_mfma_f32_32x32x16_bf16 v[176:191], a[172:175], a[36:39], v[176:191]
ds_read_b64_tr_b16 a[218:219], v9 offset:55808
ds_read_b128 a[60:63], v63 offset:0
v_fmac_f32 v238, v253, v253
v_lshlrev_b32 v252, 16, v210
v_and_b32 v253, 0xffff0000, v210
v_add_f32 v236, v236, v252
v_fmac_f32 v238, v252, v252
v_mfma_f32_16x16x32_bf16 v[216:219], a[176:179], a[244:247], v[216:219]
v_add_f32 v236, v236, v253
s_waitcnt lgkmcnt(14)
v_mfma_f32_32x32x16_bf16 v[128:143], a[180:183], a[40:43], v[128:143]
s_waitcnt vmcnt(15)
s_barrier
ds_read_b64_tr_b16 a[160:161], v49 offset:0
ds_read_b64_tr_b16 a[162:163], v49 offset:512
buffer_load_dwordx4 v58, s[36:39], s83 offen offset:2048 lds
v_fmac_f32 v238, v253, v253
v_mfma_f32_32x32x16_bf16 v[144:159], a[184:187], a[40:43], v[144:159]
ds_read_b64_tr_b16 a[164:165], v51 offset:0
ds_read_b64_tr_b16 a[166:167], v51 offset:512
buffer_load_dwordx4 v59, s[36:39], s83 offen offset:3072 lds
s_add_u32 m0, s84, 49152
s_bfe_u32 s80, s55, 0x4000c
s_mul_i32 s80, s80, 245760
v_mfma_f32_32x32x16_bf16 v[160:175], a[188:191], a[40:43], v[160:175]
ds_read_b64_tr_b16 a[168:169], v49 offset:8192
ds_read_b64_tr_b16 a[170:171], v49 offset:8704
v_lshlrev_b32 v252, 16, v211
v_and_b32 v253, 0xffff0000, v211
v_add_f32 v236, v236, v252
v_fmac_f32 v238, v252, v252
v_add_f32 v236, v236, v253
v_mfma_f32_32x32x16_bf16 v[176:191], a[192:195], a[40:43], v[176:191]
ds_read_b64_tr_b16 a[172:173], v51 offset:8192
ds_read_b64_tr_b16 a[174:175], v51 offset:8704
buffer_load_dwordx4 v52, s[28:31], s80 offen lds
v_fmac_f32 v238, v253, v253
v_add_f32_dpp v236, v236, v236 row_ror:1 row_mask:0xf bank_mask:0xf
s_nop 0
v_add_f32_dpp v238, v238, v238 row_ror:1 row_mask:0xf bank_mask:0xf
v_mfma_f32_16x16x32_bf16 v[216:219], a[196:199], a[244:247], v[216:219]
v_add_f32_dpp v236, v236, v236 row_ror:2 row_mask:0xf bank_mask:0xf
s_waitcnt lgkmcnt(9)
v_mfma_f32_32x32x16_bf16 v[128:143], a[200:203], a[44:47], v[128:143]
ds_read_b64_tr_b16 a[180:181], v49 offset:2048
ds_read_b64_tr_b16 a[182:183], v49 offset:2560
buffer_load_dwordx4 v53, s[28:31], s80 offen offset:1024 lds
v_add_f32_dpp v238, v238, v238 row_ror:2 row_mask:0xf bank_mask:0xf
v_add_f32_dpp v236, v236, v236 row_ror:4 row_mask:0xf bank_mask:0xf
s_nop 0
v_add_f32_dpp v238, v238, v238 row_ror:4 row_mask:0xf bank_mask:0xf
v_mfma_f32_32x32x16_bf16 v[144:159], a[204:207], a[44:47], v[144:159]
ds_read_b64_tr_b16 a[184:185], v51 offset:2048
ds_read_b64_tr_b16 a[186:187], v51 offset:2560
buffer_load_dwordx4 v54, s[28:31], s80 offen offset:2048 lds
v_add_f32_dpp v236, v236, v236 row_ror:8 row_mask:0xf bank_mask:0xf
v_add_f32_dpp v238, v238, v238 row_ror:8 row_mask:0xf bank_mask:0xf
v_mov_b32 v252, v236
v_mfma_f32_32x32x16_bf16 v[160:175], a[208:211], a[44:47], v[160:175]
ds_read_b64_tr_b16 a[188:189], v49 offset:10240
ds_read_b64_tr_b16 a[190:191], v49 offset:10752
v_mov_b32 v253, v238
v_permlane16_swap_b32 v236, v252
s_nop 0
v_permlane16_swap_b32 v238, v253
v_add_f32 v236, v236, v252
v_add_f32 v238, v238, v253
v_mfma_f32_32x32x16_bf16 v[176:191], a[212:215], a[44:47], v[176:191]
ds_read_b64_tr_b16 a[192:193], v51 offset:10240
ds_read_b64_tr_b16 a[194:195], v51 offset:10752
buffer_load_dwordx4 v55, s[28:31], s80 offen offset:3072 lds
s_add_u32 m0, s84, 65536
s_bfe_u32 s81, s55, 0x40004
s_mul_i32 s81, s81, 196608
v_mfma_f32_16x16x32_bf16 v[216:219], a[216:219], a[244:247], v[216:219]
s_waitcnt vmcnt(8)
buffer_store_dword v247, v246, s[24:27], s4 offen offset:0 sc1
s_waitcnt lgkmcnt(8)
v_mfma_f32_32x32x16_bf16 v[64:79], a[160:163], a[48:51], v[64:79]
ds_read_b64_tr_b16 a[200:201], v49 offset:4096
ds_read_b64_tr_b16 a[202:203], v49 offset:4608
buffer_load_dwordx4 v16, s[32:35], s81 offen lds
v_mul_f32 v236, 0x3acccccd, v236
v_mul_f32 v238, 0x3acccccd, v238
v_fma_f32 v238, -v236, v236, v238
v_mfma_f32_32x32x16_bf16 v[80:95], a[164:167], a[48:51], v[80:95]
ds_read_b64_tr_b16 a[204:205], v51 offset:4096
ds_read_b64_tr_b16 a[206:207], v51 offset:4608
buffer_load_dwordx4 v17, s[32:35], s81 offen offset:1024 lds
v_max_f32 v238, 0, v238
v_cvt_pk_bf16_f32 v238, v238, v238
v_and_b32 v238, 0xffff0000, v238
v_mfma_f32_32x32x16_bf16 v[96:111], a[168:171], a[48:51], v[96:111]
ds_read_b64_tr_b16 a[208:209], v49 offset:12288
ds_read_b64_tr_b16 a[210:211], v49 offset:12800
v_add_f32 v238, 0x3727c5ac, v238
v_cvt_pk_bf16_f32 v238, v238, v238
v_and_b32 v238, 0xffff0000, v238
v_sqrt_f32 v238, v238
v_mfma_f32_32x32x16_bf16 v[112:127], a[172:175], a[48:51], v[112:127]
ds_read_b64_tr_b16 a[212:213], v51 offset:12288
ds_read_b64_tr_b16 a[214:215], v51 offset:12800
buffer_load_dwordx4 v18, s[32:35], s81 offen offset:2048 lds
s_add_u32 s87, s6, 5120
buffer_store_dwordx4 v[216:219], v42, s[24:27], s87 offen sc1
s_waitcnt lgkmcnt(8)
v_mfma_f32_32x32x16_bf16 v[64:79], a[180:183], a[52:55], v[64:79]
ds_read_b64_tr_b16 a[160:161], v49 offset:6144
ds_read_b64_tr_b16 a[162:163], v49 offset:6656
ds_read_b128 a[64:67], v60 offset:16384
buffer_load_dwordx4 v19, s[32:35], s81 offen offset:3072 lds
v_mfma_f32_32x32x16_bf16 v[80:95], a[184:187], a[52:55], v[80:95]
ds_read_b64_tr_b16 a[164:165], v51 offset:6144
ds_read_b64_tr_b16 a[166:167], v51 offset:6656
ds_read_b128 a[68:71], v61 offset:16384
s_add_u32 m0, s84, 0
s_bfe_u32 s83, s55, 0x40010
s_mul_i32 s83, s83, 128
v_mfma_f32_32x32x16_bf16 v[96:111], a[188:191], a[52:55], v[96:111]
ds_read_b64_tr_b16 a[168:169], v49 offset:14336
ds_read_b64_tr_b16 a[170:171], v49 offset:14848
ds_read_b128 a[72:75], v62 offset:16384
buffer_load_dwordx4 v56, s[36:39], s83 offen lds
v_mov_b32 v237, v247
v_mfma_f32_32x32x16_bf16 v[112:127], a[192:195], a[52:55], v[112:127]
ds_read_b64_tr_b16 a[172:173], v51 offset:14336
ds_read_b64_tr_b16 a[174:175], v51 offset:14848
ds_read_b128 a[76:79], v63 offset:16384
ds_read_b64_tr_b16 a[220:221], v36 offset:0
s_waitcnt lgkmcnt(13)
v_mfma_f32_32x32x16_bf16 v[64:79], a[200:203], a[56:59], v[64:79]
s_barrier
ds_read_b64_tr_b16 a[180:181], v49 offset:16384
ds_read_b64_tr_b16 a[182:183], v49 offset:16896
buffer_load_dwordx4 v57, s[36:39], s83 offen offset:1024 lds
v_mov_b32 v239, v247
v_mfma_f32_32x32x16_bf16 v[80:95], a[204:207], a[56:59], v[80:95]
ds_read_b64_tr_b16 a[184:185], v51 offset:16384
ds_read_b64_tr_b16 a[186:187], v51 offset:16896
ds_read_b64_tr_b16 a[222:223], v36 offset:512
ds_read_b64_tr_b16 a[224:225], v37 offset:0
ds_read_b64_tr_b16 a[226:227], v37 offset:512
ds_read_b64_tr_b16 a[228:229], v38 offset:0
v_mfma_f32_32x32x16_bf16 v[96:111], a[208:211], a[56:59], v[96:111]
ds_read_b64_tr_b16 a[188:189], v49 offset:24576
ds_read_b64_tr_b16 a[190:191], v49 offset:25088
buffer_load_dwordx4 v58, s[36:39], s83 offen offset:2048 lds
ds_read_b64_tr_b16 a[230:231], v38 offset:512
ds_read_b64_tr_b16 a[232:233], v39 offset:0
v_mfma_f32_32x32x16_bf16 v[112:127], a[212:215], a[56:59], v[112:127]
ds_read_b64_tr_b16 a[192:193], v51 offset:24576
ds_read_b64_tr_b16 a[194:195], v51 offset:25088
ds_read_b64_tr_b16 a[234:235], v39 offset:512
v_cvt_pk_bf16_f32 v236, v236, v238
v_mov_b32 v238, v236
s_waitcnt lgkmcnt(15)
v_mfma_f32_32x32x16_bf16 v[64:79], a[160:163], a[60:63], v[64:79]
ds_read_b64_tr_b16 a[200:201], v49 offset:18432
ds_read_b64_tr_b16 a[202:203], v49 offset:18944
buffer_load_dwordx4 v59, s[36:39], s83 offen offset:3072 lds
s_add_u32 m0, s84, 81920
s_bfe_u32 s80, s55, 0x40010
s_mul_i32 s80, s80, 245760
v_mfma_f32_32x32x16_bf16 v[80:95], a[164:167], a[60:63], v[80:95]
ds_read_b64_tr_b16 a[204:205], v51 offset:18432
ds_read_b64_tr_b16 a[206:207], v51 offset:18944
buffer_store_dwordx4 v[236:239], v44, s[24:27], s65 offen sc1
v_mfma_f32_32x32x16_bf16 v[96:111], a[168:171], a[60:63], v[96:111]
ds_read_b64_tr_b16 a[208:209], v49 offset:26624
ds_read_b64_tr_b16 a[210:211], v49 offset:27136
buffer_load_dwordx4 v52, s[28:31], s80 offen lds
s_waitcnt lgkmcnt(6)
buffer_store_dwordx4 a[220:223], v28, s[24:27], s73 offen sc1
v_mfma_f32_16x16x32_bf16 v[212:215], a[220:223], a[236:239], 0
v_mfma_f32_16x16x32_bf16 v[216:219], a[224:227], a[236:239], 0
v_mfma_f32_16x16x32_bf16 v[212:215], a[228:231], a[236:239], v[212:215]
v_mfma_f32_16x16x32_bf16 v[216:219], a[232:235], a[236:239], v[216:219]
v_mfma_f32_32x32x16_bf16 v[112:127], a[172:175], a[60:63], v[112:127]
ds_read_b64_tr_b16 a[212:213], v51 offset:26624
ds_read_b64_tr_b16 a[214:215], v51 offset:27136
v_mfma_f32_32x32x16_bf16 v[64:79], a[180:183], a[64:67], v[64:79]
ds_read_b64_tr_b16 a[160:161], v49 offset:20480
ds_read_b64_tr_b16 a[162:163], v49 offset:20992
buffer_load_dwordx4 v53, s[28:31], s80 offen offset:1024 lds
v_mfma_f32_32x32x16_bf16 v[80:95], a[184:187], a[64:67], v[80:95]
ds_read_b64_tr_b16 a[164:165], v51 offset:20480
ds_read_b64_tr_b16 a[166:167], v51 offset:20992
v_mfma_f32_32x32x16_bf16 v[96:111], a[188:191], a[64:67], v[96:111]
ds_read_b64_tr_b16 a[168:169], v49 offset:28672
ds_read_b64_tr_b16 a[170:171], v49 offset:29184
buffer_load_dwordx4 v54, s[28:31], s80 offen offset:2048 lds
buffer_store_dwordx4 v[212:215], v15, s[24:27], s77 offen offset:0 sc1
buffer_store_dwordx4 v[216:219], v15, s[24:27], s77 offen offset:128 sc1
v_mfma_f32_32x32x16_bf16 v[112:127], a[192:195], a[64:67], v[112:127]
ds_read_b64_tr_b16 a[172:173], v51 offset:28672
ds_read_b64_tr_b16 a[174:175], v51 offset:29184
buffer_store_dwordx4 a[224:227], v28, s[24:27], s74 offen sc1
s_waitcnt lgkmcnt(8)
v_mfma_f32_32x32x16_bf16 v[64:79], a[200:203], a[68:71], v[64:79]
ds_read_b64_tr_b16 a[180:181], v49 offset:22528
ds_read_b64_tr_b16 a[182:183], v49 offset:23040
s_waitcnt vmcnt(22)
ds_read_b128 a[80:83], v60 offset:32768
v_mfma_f32_32x32x16_bf16 v[80:95], a[204:207], a[68:71], v[80:95]
ds_read_b64_tr_b16 a[184:185], v51 offset:22528
ds_read_b64_tr_b16 a[186:187], v51 offset:23040
ds_read_b128 a[84:87], v61 offset:32768
buffer_load_dwordx4 v55, s[28:31], s80 offen offset:3072 lds
v_mfma_f32_32x32x16_bf16 v[96:111], a[208:211], a[68:71], v[96:111]
ds_read_b64_tr_b16 a[188:189], v49 offset:30720
ds_read_b64_tr_b16 a[190:191], v49 offset:31232
ds_read_b128 a[88:91], v62 offset:32768
v_mfma_f32_32x32x16_bf16 v[112:127], a[212:215], a[68:71], v[112:127]
ds_read_b64_tr_b16 a[192:193], v51 offset:30720
ds_read_b64_tr_b16 a[194:195], v51 offset:31232
ds_read_b128 a[92:95], v63 offset:32768
s_waitcnt lgkmcnt(12)
v_mfma_f32_32x32x16_bf16 v[64:79], a[160:163], a[72:75], v[64:79]
s_waitcnt vmcnt(19)
s_barrier
ds_read_b64_tr_b16 a[200:201], v48 offset:0
ds_read_b64_tr_b16 a[202:203], v48 offset:512
buffer_store_dwordx4 a[228:231], v28, s[24:27], s75 offen sc1
v_mfma_f32_32x32x16_bf16 v[80:95], a[164:167], a[72:75], v[80:95]
ds_read_b64_tr_b16 a[204:205], v50 offset:0
ds_read_b64_tr_b16 a[206:207], v50 offset:512
s_add_u32 m0, s84, 16384
s_bfe_u32 s83, s55, 0x40014
s_mul_i32 s83, s83, 128
v_mfma_f32_32x32x16_bf16 v[96:111], a[168:171], a[72:75], v[96:111]
ds_read_b64_tr_b16 a[208:209], v48 offset:8192
ds_read_b64_tr_b16 a[210:211], v48 offset:8704
buffer_load_dwordx4 v56, s[36:39], s83 offen lds
v_mfma_f32_32x32x16_bf16 v[112:127], a[172:175], a[72:75], v[112:127]
ds_read_b64_tr_b16 a[212:213], v50 offset:8192
ds_read_b64_tr_b16 a[214:215], v50 offset:8704
s_waitcnt lgkmcnt(9)
v_mfma_f32_32x32x16_bf16 v[64:79], a[180:183], a[76:79], v[64:79]
ds_read_b64_tr_b16 a[160:161], v48 offset:2048
ds_read_b64_tr_b16 a[162:163], v48 offset:2560
v_mfma_f32_32x32x16_bf16 v[80:95], a[184:187], a[76:79], v[80:95]
ds_read_b64_tr_b16 a[164:165], v50 offset:2048
ds_read_b64_tr_b16 a[166:167], v50 offset:2560
buffer_load_dwordx4 v57, s[36:39], s83 offen offset:1024 lds
buffer_store_dwordx4 a[232:235], v28, s[24:27], s76 offen sc1
v_mfma_f32_32x32x16_bf16 v[96:111], a[188:191], a[76:79], v[96:111]
ds_read_b64_tr_b16 a[168:169], v48 offset:10240
ds_read_b64_tr_b16 a[170:171], v48 offset:10752
v_mfma_f32_32x32x16_bf16 v[112:127], a[192:195], a[76:79], v[112:127]
ds_read_b64_tr_b16 a[172:173], v50 offset:10240
ds_read_b64_tr_b16 a[174:175], v50 offset:10752
buffer_load_dwordx4 v58, s[36:39], s83 offen offset:2048 lds
s_waitcnt lgkmcnt(8)
v_mfma_f32_32x32x16_bf16 v[64:79], a[200:203], a[80:83], v[64:79]
ds_read_b64_tr_b16 a[180:181], v48 offset:4096
ds_read_b64_tr_b16 a[182:183], v48 offset:4608
buffer_load_dword v222, v11, s[24:27], s69 offen offset:0 sc1
v_mfma_f32_32x32x16_bf16 v[80:95], a[204:207], a[80:83], v[80:95]
ds_read_b64_tr_b16 a[184:185], v50 offset:4096
ds_read_b64_tr_b16 a[186:187], v50 offset:4608
buffer_load_dwordx4 v59, s[36:39], s83 offen offset:3072 lds
v_mfma_f32_32x32x16_bf16 v[96:111], a[208:211], a[80:83], v[96:111]
ds_read_b64_tr_b16 a[188:189], v48 offset:12288
ds_read_b64_tr_b16 a[190:191], v48 offset:12800
s_add_u32 m0, s84, 98304
s_bfe_u32 s80, s55, 0x40014
s_mul_i32 s80, s80, 245760
v_mfma_f32_32x32x16_bf16 v[112:127], a[212:215], a[80:83], v[112:127]
ds_read_b64_tr_b16 a[192:193], v50 offset:12288
ds_read_b64_tr_b16 a[194:195], v50 offset:12800
buffer_load_dwordx4 v52, s[28:31], s80 offen lds
s_waitcnt lgkmcnt(8)
v_mfma_f32_32x32x16_bf16 v[64:79], a[160:163], a[84:87], v[64:79]
ds_read_b64_tr_b16 a[200:201], v48 offset:6144
ds_read_b64_tr_b16 a[202:203], v48 offset:6656
v_mfma_f32_32x32x16_bf16 v[80:95], a[164:167], a[84:87], v[80:95]
ds_read_b64_tr_b16 a[204:205], v50 offset:6144
ds_read_b64_tr_b16 a[206:207], v50 offset:6656
v_mfma_f32_32x32x16_bf16 v[96:111], a[168:171], a[84:87], v[96:111]
ds_read_b64_tr_b16 a[208:209], v48 offset:14336
ds_read_b64_tr_b16 a[210:211], v48 offset:14848
buffer_load_dwordx4 v53, s[28:31], s80 offen offset:1024 lds
v_mfma_f32_32x32x16_bf16 v[112:127], a[172:175], a[84:87], v[112:127]
ds_read_b64_tr_b16 a[212:213], v50 offset:14336
ds_read_b64_tr_b16 a[214:215], v50 offset:14848
s_waitcnt lgkmcnt(8)
v_mfma_f32_32x32x16_bf16 v[64:79], a[180:183], a[88:91], v[64:79]
s_waitcnt vmcnt(22)
s_barrier
ds_read_b64_tr_b16 a[160:161], v29 offset:16384
ds_read_b64_tr_b16 a[162:163], v29 offset:16896
buffer_load_dwordx4 v54, s[28:31], s80 offen offset:2048 lds
v_mfma_f32_32x32x16_bf16 v[80:95], a[184:187], a[88:91], v[80:95]
ds_read_b64_tr_b16 a[164:165], v6 offset:16384
ds_read_b64_tr_b16 a[166:167], v6 offset:16896
v_mfma_f32_32x32x16_bf16 v[96:111], a[188:191], a[88:91], v[96:111]
ds_read_b64_tr_b16 a[168:169], v29 offset:24576
ds_read_b64_tr_b16 a[170:171], v29 offset:25088
buffer_load_dwordx4 v55, s[28:31], s80 offen offset:3072 lds
v_mfma_f32_32x32x16_bf16 v[112:127], a[192:195], a[88:91], v[112:127]
ds_read_b64_tr_b16 a[172:173], v6 offset:24576
ds_read_b64_tr_b16 a[174:175], v6 offset:25088
s_add_u32 m0, s84, 32768
s_bfe_u32 s83, s55, 0x40018
s_mul_i32 s83, s83, 128
s_waitcnt lgkmcnt(8)
v_mfma_f32_32x32x16_bf16 v[64:79], a[200:203], a[92:95], v[64:79]
ds_read_b64_tr_b16 a[180:181], v29 offset:18432
ds_read_b64_tr_b16 a[182:183], v29 offset:18944
buffer_load_dwordx4 v56, s[36:39], s83 offen lds
v_mfma_f32_32x32x16_bf16 v[80:95], a[204:207], a[92:95], v[80:95]
ds_read_b64_tr_b16 a[184:185], v6 offset:18432
ds_read_b64_tr_b16 a[186:187], v6 offset:18944
v_mfma_f32_32x32x16_bf16 v[96:111], a[208:211], a[92:95], v[96:111]
ds_read_b64_tr_b16 a[188:189], v29 offset:26624
ds_read_b64_tr_b16 a[190:191], v29 offset:27136
v_mfma_f32_32x32x16_bf16 v[112:127], a[212:215], a[92:95], v[112:127]
ds_read_b64_tr_b16 a[192:193], v6 offset:26624
ds_read_b64_tr_b16 a[194:195], v6 offset:27136
buffer_load_dwordx4 v57, s[36:39], s83 offen offset:1024 lds
s_waitcnt lgkmcnt(8)
v_mfma_f32_32x32x16_bf16 v[128:143], a[160:163], a[48:51], v[128:143]
ds_read_b64_tr_b16 a[200:201], v29 offset:20480
ds_read_b64_tr_b16 a[202:203], v29 offset:20992
v_mfma_f32_32x32x16_bf16 v[144:159], a[164:167], a[48:51], v[144:159]
ds_read_b64_tr_b16 a[204:205], v6 offset:20480
ds_read_b64_tr_b16 a[206:207], v6 offset:20992
buffer_load_dwordx4 v58, s[36:39], s83 offen offset:2048 lds
v_mfma_f32_32x32x16_bf16 v[160:175], a[168:171], a[48:51], v[160:175]
ds_read_b64_tr_b16 a[208:209], v29 offset:28672
ds_read_b64_tr_b16 a[210:211], v29 offset:29184
v_mfma_f32_32x32x16_bf16 v[176:191], a[172:175], a[48:51], v[176:191]
ds_read_b64_tr_b16 a[212:213], v6 offset:28672
ds_read_b64_tr_b16 a[214:215], v6 offset:29184
buffer_load_dwordx4 v59, s[36:39], s83 offen offset:3072 lds
s_waitcnt lgkmcnt(8)
v_mfma_f32_32x32x16_bf16 v[128:143], a[180:183], a[52:55], v[128:143]
ds_read_b64_tr_b16 a[160:161], v29 offset:22528
ds_read_b64_tr_b16 a[162:163], v29 offset:23040
s_waitcnt vmcnt(24)
ds_read_b128 a[96:99], v60 offset:0
v_mfma_f32_32x32x16_bf16 v[144:159], a[184:187], a[52:55], v[144:159]
ds_read_b64_tr_b16 a[164:165], v6 offset:22528
ds_read_b64_tr_b16 a[166:167], v6 offset:23040
ds_read_b128 a[100:103], v61 offset:0
v_mfma_f32_32x32x16_bf16 v[160:175], a[188:191], a[52:55], v[160:175]
ds_read_b64_tr_b16 a[168:169], v29 offset:30720
ds_read_b64_tr_b16 a[170:171], v29 offset:31232
ds_read_b128 a[104:107], v62 offset:0
v_mfma_f32_32x32x16_bf16 v[176:191], a[192:195], a[52:55], v[176:191]
ds_read_b64_tr_b16 a[172:173], v6 offset:30720
ds_read_b64_tr_b16 a[174:175], v6 offset:31232
ds_read_b128 a[108:111], v63 offset:0
s_waitcnt lgkmcnt(12)
v_mfma_f32_32x32x16_bf16 v[128:143], a[200:203], a[56:59], v[128:143]
s_waitcnt vmcnt(11)
s_barrier
ds_read_b64_tr_b16 a[180:181], v48 offset:32768
ds_read_b64_tr_b16 a[182:183], v48 offset:33280
s_waitcnt vmcnt(9)
v_cmp_ne_u32 vcc, s56, v222
s_cbranch_vccnz L_sp2_slow
L_sp2_back:
v_mfma_f32_32x32x16_bf16 v[144:159], a[204:207], a[56:59], v[144:159]
ds_read_b64_tr_b16 a[184:185], v50 offset:32768
ds_read_b64_tr_b16 a[186:187], v50 offset:33280
s_add_u32 m0, s84, 114688
s_bfe_u32 s80, s55, 0x40018
s_mul_i32 s80, s80, 245760
buffer_store_dword v247, v43, s[24:27], 0 offen sc1
v_mfma_f32_32x32x16_bf16 v[160:175], a[208:211], a[56:59], v[160:175]
ds_read_b64_tr_b16 a[188:189], v48 offset:40960
ds_read_b64_tr_b16 a[190:191], v48 offset:41472
buffer_load_dwordx4 v52, s[28:31], s80 offen lds
buffer_load_dword v192, v14, s[24:27], s6 offen offset:0 sc1
v_mfma_f32_32x32x16_bf16 v[176:191], a[212:215], a[56:59], v[176:191]
ds_read_b64_tr_b16 a[192:193], v50 offset:40960
ds_read_b64_tr_b16 a[194:195], v50 offset:41472
buffer_load_dword v193, v14, s[24:27], s6 offen offset:512 sc1
v_lshrrev_b32 v235, 4, v30
s_waitcnt lgkmcnt(9)
v_mfma_f32_32x32x16_bf16 v[128:143], a[160:163], a[60:63], v[128:143]
ds_read_b64_tr_b16 a[200:201], v48 offset:34816
ds_read_b64_tr_b16 a[202:203], v48 offset:35328
buffer_load_dword v194, v14, s[24:27], s6 offen offset:1024 sc1
v_lshlrev_b32 v236, 2, v45
s_lshl_b32 s59, s54, 3
v_mfma_f32_32x32x16_bf16 v[144:159], a[164:167], a[60:63], v[144:159]
ds_read_b64_tr_b16 a[204:205], v50 offset:34816
ds_read_b64_tr_b16 a[206:207], v50 offset:35328
buffer_load_dwordx4 v53, s[28:31], s80 offen offset:1024 lds
buffer_load_dword v195, v14, s[24:27], s6 offen offset:1536 sc1
v_mfma_f32_32x32x16_bf16 v[160:175], a[168:171], a[60:63], v[160:175]
ds_read_b64_tr_b16 a[208:209], v48 offset:43008
ds_read_b64_tr_b16 a[210:211], v48 offset:43520
buffer_load_dword v196, v14, s[24:27], s6 offen offset:2048 sc1
v_sub_u32 v235, v235, v236
v_subrev_u32 v235, s59, v235
v_mfma_f32_32x32x16_bf16 v[176:191], a[172:175], a[60:63], v[176:191]
ds_read_b64_tr_b16 a[212:213], v50 offset:43008
ds_read_b64_tr_b16 a[214:215], v50 offset:43520
buffer_load_dwordx4 v54, s[28:31], s80 offen offset:2048 lds
v_mov_b32 v238, 0xff800000
s_waitcnt lgkmcnt(8)
v_mfma_f32_32x32x16_bf16 v[64:79], a[180:183], a[96:99], v[64:79]
ds_read_b64_tr_b16 a[160:161], v48 offset:36864
ds_read_b64_tr_b16 a[162:163], v48 offset:37376
buffer_load_dword v197, v14, s[24:27], s6 offen offset:2560 sc1
v_cmp_le_i32 vcc, 0, v235
v_cmp_le_i32_e64 s[88:89], 1, v235
v_mfma_f32_32x32x16_bf16 v[80:95], a[184:187], a[96:99], v[80:95]
ds_read_b64_tr_b16 a[164:165], v50 offset:36864
ds_read_b64_tr_b16 a[166:167], v50 offset:37376
buffer_load_dwordx4 v55, s[28:31], s80 offen offset:3072 lds
buffer_load_dword v198, v14, s[24:27], s6 offen offset:3072 sc1
v_mfma_f32_32x32x16_bf16 v[96:111], a[188:191], a[96:99], v[96:111]
ds_read_b64_tr_b16 a[168:169], v48 offset:45056
ds_read_b64_tr_b16 a[170:171], v48 offset:45568
s_add_u32 m0, s84, 0
s_bfe_u32 s83, s55, 0x4001c
s_mul_i32 s83, s83, 128
v_cndmask_b32_e64 v208, v238, 0, vcc
v_mfma_f32_32x32x16_bf16 v[112:127], a[192:195], a[96:99], v[112:127]
ds_read_b64_tr_b16 a[172:173], v50 offset:45056
ds_read_b64_tr_b16 a[174:175], v50 offset:45568
buffer_load_dwordx4 v56, s[36:39], s83 offen lds
v_cndmask_b32_e64 v204, 0, v238, vcc
s_waitcnt lgkmcnt(8)
v_mfma_f32_32x32x16_bf16 v[64:79], a[200:203], a[100:103], v[64:79]
ds_read_b64_tr_b16 a[180:181], v48 offset:38912
ds_read_b64_tr_b16 a[182:183], v48 offset:39424
s_waitcnt vmcnt(21)
ds_read_b128 a[112:115], v60 offset:16384
v_cndmask_b32_e64 v209, v238, 0, s[88:89]
v_mfma_f32_32x32x16_bf16 v[80:95], a[204:207], a[100:103], v[80:95]
ds_read_b64_tr_b16 a[184:185], v50 offset:38912
ds_read_b64_tr_b16 a[186:187], v50 offset:39424
ds_read_b128 a[116:119], v61 offset:16384
buffer_load_dword v199, v14, s[24:27], s6 offen offset:3584 sc1
v_mfma_f32_32x32x16_bf16 v[96:111], a[208:211], a[100:103], v[96:111]
ds_read_b64_tr_b16 a[188:189], v48 offset:47104
ds_read_b64_tr_b16 a[190:191], v48 offset:47616
ds_read_b128 a[120:123], v62 offset:16384
buffer_load_dwordx4 v57, s[36:39], s83 offen offset:1024 lds
v_mfma_f32_32x32x16_bf16 v[112:127], a[212:215], a[100:103], v[112:127]
ds_read_b64_tr_b16 a[192:193], v50 offset:47104
ds_read_b64_tr_b16 a[194:195], v50 offset:47616
ds_read_b128 a[124:127], v63 offset:16384
v_cndmask_b32_e64 v205, 0, v238, s[88:89]
s_waitcnt lgkmcnt(12)
v_mfma_f32_32x32x16_bf16 v[64:79], a[160:163], a[104:107], v[64:79]
s_waitcnt vmcnt(19)
s_barrier
ds_read_b64_tr_b16 a[200:201], v48 offset:49152
ds_read_b64_tr_b16 a[202:203], v48 offset:49664
buffer_load_dwordx4 v58, s[36:39], s83 offen offset:2048 lds
v_mfma_f32_32x32x16_bf16 v[80:95], a[164:167], a[104:107], v[80:95]
ds_read_b64_tr_b16 a[204:205], v50 offset:49152
ds_read_b64_tr_b16 a[206:207], v50 offset:49664
v_cmp_le_i32 vcc, 2, v235
v_cmp_le_i32_e64 s[88:89], 3, v235
s_nop 0
v_cndmask_b32_e64 v210, v238, 0, vcc
v_cndmask_b32_e64 v206, 0, v238, vcc
v_mfma_f32_32x32x16_bf16 v[96:111], a[168:171], a[104:107], v[96:111]
ds_read_b64_tr_b16 a[208:209], v48 offset:57344
ds_read_b64_tr_b16 a[210:211], v48 offset:57856
buffer_load_dwordx4 v59, s[36:39], s83 offen offset:3072 lds
v_cndmask_b32_e64 v211, v238, 0, s[88:89]
v_cndmask_b32_e64 v207, 0, v238, s[88:89]
buffer_load_dwordx2 v[220:221], v31, s[24:27], s66 offen offset:0 sc1
v_mfma_f32_32x32x16_bf16 v[112:127], a[172:175], a[104:107], v[112:127]
ds_read_b64_tr_b16 a[212:213], v50 offset:57344
ds_read_b64_tr_b16 a[214:215], v50 offset:57856
s_add_u32 m0, s84, 131072
s_bfe_u32 s80, s55, 0x4001c
s_mul_i32 s80, s80, 245760
s_waitcnt lgkmcnt(9)
v_mfma_f32_32x32x16_bf16 v[64:79], a[180:183], a[108:111], v[64:79]
ds_read_b64_tr_b16 a[160:161], v48 offset:51200
ds_read_b64_tr_b16 a[162:163], v48 offset:51712
buffer_load_dwordx4 v52, s[28:31], s80 offen lds
s_lshr_b32 s59, s84, 2
s_add_u32 s59, s59, 155648
v_mfma_f32_32x32x16_bf16 v[80:95], a[184:187], a[108:111], v[80:95]
ds_read_b64_tr_b16 a[164:165], v50 offset:51200
ds_read_b64_tr_b16 a[166:167], v50 offset:51712
v_add_u32 v236, s59, v2
ds_write_b128 v236, v[204:207]
ds_write_b128 v236, v[208:211] offset:4096
v_mfma_f32_32x32x16_bf16 v[96:111], a[188:191], a[108:111], v[96:111]
ds_read_b64_tr_b16 a[168:169], v48 offset:59392
ds_read_b64_tr_b16 a[170:171], v48 offset:59904
v_mfma_f32_32x32x16_bf16 v[112:127], a[192:195], a[108:111], v[112:127]
ds_read_b64_tr_b16 a[172:173], v50 offset:59392
ds_read_b64_tr_b16 a[174:175], v50 offset:59904
buffer_load_dwordx4 v53, s[28:31], s80 offen offset:1024 lds
s_waitcnt lgkmcnt(10)
v_mfma_f32_32x32x16_bf16 v[64:79], a[200:203], a[112:115], v[64:79]
ds_read_b64_tr_b16 a[180:181], v48 offset:53248
ds_read_b64_tr_b16 a[182:183], v48 offset:53760
v_mfma_f32_32x32x16_bf16 v[80:95], a[204:207], a[112:115], v[80:95]
ds_read_b64_tr_b16 a[184:185], v50 offset:53248
ds_read_b64_tr_b16 a[186:187], v50 offset:53760
buffer_load_dwordx4 v54, s[28:31], s80 offen offset:2048 lds
v_mfma_f32_32x32x16_bf16 v[96:111], a[208:211], a[112:115], v[96:111]
ds_read_b64_tr_b16 a[188:189], v48 offset:61440
ds_read_b64_tr_b16 a[190:191], v48 offset:61952
v_mfma_f32_32x32x16_bf16 v[112:127], a[212:215], a[112:115], v[112:127]
ds_read_b64_tr_b16 a[192:193], v50 offset:61440
ds_read_b64_tr_b16 a[194:195], v50 offset:61952
buffer_load_dwordx4 v55, s[28:31], s80 offen offset:3072 lds
s_waitcnt lgkmcnt(8)
v_mfma_f32_32x32x16_bf16 v[64:79], a[160:163], a[116:119], v[64:79]
ds_read_b64_tr_b16 a[200:201], v48 offset:55296
ds_read_b64_tr_b16 a[202:203], v48 offset:55808
s_waitcnt vmcnt(22)
ds_read_b128 a[128:131], v60 offset:32768
v_lshlrev_b32 v212, 3, v1
v_mfma_f32_32x32x16_bf16 v[80:95], a[164:167], a[116:119], v[80:95]
ds_read_b64_tr_b16 a[204:205], v50 offset:55296
ds_read_b64_tr_b16 a[206:207], v50 offset:55808
ds_read_b128 a[132:135], v61 offset:32768
v_add_u32 v212, 147456, v212
s_lshl_b32 s60, s54, 9
v_mfma_f32_32x32x16_bf16 v[96:111], a[168:171], a[116:119], v[96:111]
ds_read_b64_tr_b16 a[208:209], v48 offset:63488
ds_read_b64_tr_b16 a[210:211], v48 offset:64000
ds_read_b128 a[136:139], v62 offset:32768
v_add_u32 v213, s60, v212
v_mfma_f32_32x32x16_bf16 v[112:127], a[172:175], a[116:119], v[112:127]
ds_read_b64_tr_b16 a[212:213], v50 offset:63488
ds_read_b64_tr_b16 a[214:215], v50 offset:64000
ds_read_b128 a[140:143], v63 offset:32768
s_waitcnt lgkmcnt(12)
v_mfma_f32_32x32x16_bf16 v[64:79], a[180:183], a[120:123], v[64:79]
s_waitcnt vmcnt(11)
s_barrier
ds_read_b64_tr_b16 a[160:161], v49 offset:0
ds_read_b64_tr_b16 a[162:163], v49 offset:512
s_waitcnt vmcnt(8)
v_add_f32 v192, v192, v197
v_mfma_f32_32x32x16_bf16 v[80:95], a[184:187], a[120:123], v[80:95]
ds_read_b64_tr_b16 a[164:165], v51 offset:0
ds_read_b64_tr_b16 a[166:167], v51 offset:512
s_add_u32 m0, s84, 49152
s_bfe_u32 s81, s55, 0x40008
s_mul_i32 s81, s81, 196608
v_add_f32 v193, v193, v198
v_mfma_f32_32x32x16_bf16 v[96:111], a[188:191], a[120:123], v[96:111]
ds_read_b64_tr_b16 a[168:169], v49 offset:8192
ds_read_b64_tr_b16 a[170:171], v49 offset:8704
buffer_load_dwordx4 v16, s[32:35], s81 offen lds
v_add_f32 v194, v194, v199
v_add_f32 v192, v192, v193
v_mfma_f32_32x32x16_bf16 v[112:127], a[192:195], a[120:123], v[112:127]
ds_read_b64_tr_b16 a[172:173], v51 offset:8192
ds_read_b64_tr_b16 a[174:175], v51 offset:8704
v_add_f32 v194, v194, v195
v_add_f32 v192, v192, v196
v_add_f32 v192, v192, v194
s_waitcnt lgkmcnt(9)
v_mfma_f32_32x32x16_bf16 v[64:79], a[200:203], a[124:127], v[64:79]
ds_read_b64_tr_b16 a[180:181], v49 offset:2048
ds_read_b64_tr_b16 a[182:183], v49 offset:2560
v_cvt_pk_bf16_f32 v193, v192, v192
v_and_b32 v193, 0xffff0000, v193
v_sub_f32 v193, v192, v193
v_cvt_pk_bf16_f32 v194, v192, v193
v_mfma_f32_32x32x16_bf16 v[80:95], a[204:207], a[124:127], v[80:95]
ds_read_b64_tr_b16 a[184:185], v51 offset:2048
ds_read_b64_tr_b16 a[186:187], v51 offset:2560
buffer_load_dwordx4 v17, s[32:35], s81 offen offset:1024 lds
v_and_b32 v196, 0xffff0000, v194
v_sub_f32 v193, v193, v196
v_mfma_f32_32x32x16_bf16 v[96:111], a[208:211], a[124:127], v[96:111]
ds_read_b64_tr_b16 a[188:189], v49 offset:10240
ds_read_b64_tr_b16 a[190:191], v49 offset:10752
v_cvt_pk_bf16_f32 v195, v193, 0
ds_write_b64 v213, v[194:195] offset:0
v_mfma_f32_32x32x16_bf16 v[112:127], a[212:215], a[124:127], v[112:127]
ds_read_b64_tr_b16 a[192:193], v51 offset:10240
ds_read_b64_tr_b16 a[194:195], v51 offset:10752
buffer_load_dwordx4 v18, s[32:35], s81 offen offset:2048 lds
s_waitcnt lgkmcnt(9)
v_mfma_f32_32x32x16_bf16 v[64:79], a[160:163], a[128:131], v[64:79]
ds_read_b64_tr_b16 a[200:201], v49 offset:4096
ds_read_b64_tr_b16 a[202:203], v49 offset:4608
v_mfma_f32_32x32x16_bf16 v[80:95], a[164:167], a[128:131], v[80:95]
ds_read_b64_tr_b16 a[204:205], v51 offset:4096
ds_read_b64_tr_b16 a[206:207], v51 offset:4608
buffer_load_dwordx4 v19, s[32:35], s81 offen offset:3072 lds
v_mfma_f32_32x32x16_bf16 v[96:111], a[168:171], a[128:131], v[96:111]
ds_read_b64_tr_b16 a[208:209], v49 offset:12288
ds_read_b64_tr_b16 a[210:211], v49 offset:12800
s_add_u32 m0, s84, 65536
s_bfe_u32 s81, s55, 0x4000c
s_mul_i32 s81, s81, 196608
s_waitcnt vmcnt(8)
v_cmp_ne_u32 vcc, s56, v221
s_cbranch_vccnz L_sp1_slow
L_sp1_back:
v_mfma_f32_32x32x16_bf16 v[112:127], a[172:175], a[128:131], v[112:127]
ds_read_b64_tr_b16 a[212:213], v51 offset:12288
ds_read_b64_tr_b16 a[214:215], v51 offset:12800
buffer_load_dwordx4 v16, s[32:35], s81 offen lds
v_and_b32 v235, 0xffff0000, v220
v_and_b32 v23, 0xffff, v220
s_waitcnt lgkmcnt(8)
v_mfma_f32_32x32x16_bf16 v[64:79], a[180:183], a[132:135], v[64:79]
ds_read_b64_tr_b16 a[160:161], v49 offset:6144
ds_read_b64_tr_b16 a[162:163], v49 offset:6656
ds_read_b128 a[144:147], v60 offset:0
v_rcp_f32 v236, v235
v_mfma_f32_32x32x16_bf16 v[80:95], a[184:187], a[132:135], v[80:95]
ds_read_b64_tr_b16 a[164:165], v51 offset:6144
ds_read_b64_tr_b16 a[166:167], v51 offset:6656
ds_read_b128 a[148:151], v61 offset:0
v_xor_b32 v23, 0x8000, v23
v_mul_f32 v26, v235, v235
v_lshl_or_b32 v22, v23, 16, v23
v_mfma_f32_32x32x16_bf16 v[96:111], a[188:191], a[132:135], v[96:111]
ds_read_b64_tr_b16 a[168:169], v49 offset:14336
ds_read_b64_tr_b16 a[170:171], v49 offset:14848
ds_read_b128 a[152:155], v62 offset:0
buffer_load_dwordx4 v17, s[32:35], s81 offen offset:1024 lds
v_mul_f32 v237, s8, v236
v_mfma_f32_32x32x16_bf16 v[112:127], a[192:195], a[132:135], v[112:127]
ds_read_b64_tr_b16 a[172:173], v51 offset:14336
ds_read_b64_tr_b16 a[174:175], v51 offset:14848
ds_read_b128 a[156:159], v63 offset:0
v_mul_f32 v24, 0xc0135761, v236
v_mul_f32 v25, v236, v236
s_waitcnt lgkmcnt(12)
v_mfma_f32_32x32x16_bf16 v[64:79], a[200:203], a[136:139], v[64:79]
s_waitcnt vmcnt(6)
s_barrier
ds_read_b64_tr_b16 a[180:181], v49 offset:16384
ds_read_b64_tr_b16 a[182:183], v49 offset:16896
buffer_load_dwordx4 v18, s[32:35], s81 offen offset:2048 lds
s_lshr_b32 s59, s84, 5
v_mfma_f32_32x32x16_bf16 v[80:95], a[204:207], a[136:139], v[80:95]
ds_read_b64_tr_b16 a[184:185], v51 offset:16384
ds_read_b64_tr_b16 a[186:187], v51 offset:16896
ds_read_b64 a[240:241], v212 offset:0
ds_read_b64 a[242:243], v212 offset:512
ds_read_b64 a[244:245], v212 offset:1024
ds_read_b64 a[246:247], v212 offset:1536
v_mfma_f32_32x32x16_bf16 v[96:111], a[208:211], a[136:139], v[96:111]
ds_read_b64_tr_b16 a[188:189], v49 offset:24576
ds_read_b64_tr_b16 a[190:191], v49 offset:25088
buffer_load_dwordx4 v19, s[32:35], s81 offen offset:3072 lds
s_add_u32 s59, s59, 153600
v_lshrrev_b32 v235, 2, v30
v_add_u32 v235, s59, v235
v_mfma_f32_32x32x16_bf16 v[112:127], a[212:215], a[136:139], v[112:127]
ds_read_b64_tr_b16 a[192:193], v51 offset:24576
ds_read_b64_tr_b16 a[194:195], v51 offset:25088
s_add_u32 m0, s84, 81920
s_bfe_u32 s81, s55, 0x40010
s_mul_i32 s81, s81, 196608
s_waitcnt lgkmcnt(13)
v_mfma_f32_32x32x16_bf16 v[64:79], a[160:163], a[140:143], v[64:79]
ds_read_b64_tr_b16 a[200:201], v49 offset:18432
ds_read_b64_tr_b16 a[202:203], v49 offset:18944
buffer_load_dwordx4 v16, s[32:35], s81 offen lds
ds_write_b32 v235, v237
v_mul_f32 v25, v25, v236
buffer_load_dword v222, v2, s[24:27], s68 offen offset:0 sc1
v_mfma_f32_32x32x16_bf16 v[80:95], a[164:167], a[140:143], v[80:95]
ds_read_b64_tr_b16 a[204:205], v51 offset:18432
ds_read_b64_tr_b16 a[206:207], v51 offset:18944
v_lshlrev_b32 v235, 4, v45
v_add_u32 v235, s59, v235
v_mul_f32 v25, 0xbdd2d3e8, v25
ds_read_b128 v[32:35], v235 offset:0
v_mfma_f32_32x32x16_bf16 v[96:111], a[168:171], a[140:143], v[96:111]
ds_read_b64_tr_b16 a[208:209], v49 offset:26624
ds_read_b64_tr_b16 a[210:211], v49 offset:27136
ds_read_b128 v[36:39], v235 offset:32
ds_read_b128 v[40:43], v235 offset:64
ds_read_b128 v[44:47], v235 offset:96
v_mfma_f32_32x32x16_bf16 v[112:127], a[172:175], a[140:143], v[112:127]
ds_read_b64_tr_b16 a[212:213], v51 offset:26624
ds_read_b64_tr_b16 a[214:215], v51 offset:27136
buffer_load_dwordx4 v17, s[32:35], s81 offen offset:1024 lds
s_cmp_ge_u32 s53, 10
s_cselect_b64 vcc, -1, 0
s_waitcnt lgkmcnt(13)
v_mfma_f32_32x32x16_bf16 v[64:79], a[180:183], a[144:147], v[64:79]
ds_read_b64_tr_b16 a[160:161], v49 offset:20480
ds_read_b64_tr_b16 a[162:163], v49 offset:20992
s_waitcnt lgkmcnt(4)
v_cndmask_b32 v32, v237, v32, vcc
v_cndmask_b32 v33, v237, v33, vcc
v_cndmask_b32 v34, v237, v34, vcc
v_cndmask_b32 v35, v237, v35, vcc
v_mfma_f32_32x32x16_bf16 v[80:95], a[184:187], a[144:147], v[80:95]
ds_read_b64_tr_b16 a[164:165], v51 offset:20480
ds_read_b64_tr_b16 a[166:167], v51 offset:20992
buffer_load_dwordx4 v18, s[32:35], s81 offen offset:2048 lds
v_cndmask_b32 v36, v237, v36, vcc
v_cndmask_b32 v37, v237, v37, vcc
v_cndmask_b32 v38, v237, v38, vcc
v_mfma_f32_32x32x16_bf16 v[96:111], a[188:191], a[144:147], v[96:111]
ds_read_b64_tr_b16 a[168:169], v49 offset:28672
ds_read_b64_tr_b16 a[170:171], v49 offset:29184
v_cndmask_b32 v39, v237, v39, vcc
v_cndmask_b32 v40, v237, v40, vcc
v_cndmask_b32 v41, v237, v41, vcc
v_cndmask_b32 v42, v237, v42, vcc
v_cndmask_b32 v43, v237, v43, vcc
v_mfma_f32_32x32x16_bf16 v[112:127], a[192:195], a[144:147], v[112:127]
ds_read_b64_tr_b16 a[172:173], v51 offset:28672
ds_read_b64_tr_b16 a[174:175], v51 offset:29184
buffer_load_dwordx4 v19, s[32:35], s81 offen offset:3072 lds
v_cndmask_b32 v44, v237, v44, vcc
v_cndmask_b32 v45, v237, v45, vcc
s_waitcnt lgkmcnt(8)
v_mfma_f32_32x32x16_bf16 v[64:79], a[200:203], a[148:151], v[64:79]
ds_read_b64_tr_b16 a[180:181], v49 offset:22528
ds_read_b64_tr_b16 a[182:183], v49 offset:23040
s_add_u32 m0, s84, 98304
s_bfe_u32 s81, s55, 0x40014
s_mul_i32 s81, s81, 196608
v_cndmask_b32 v46, v237, v46, vcc
v_cndmask_b32 v47, v237, v47, vcc
v_mfma_f32_32x32x16_bf16 v[80:95], a[204:207], a[148:151], v[80:95]
ds_read_b64_tr_b16 a[184:185], v51 offset:22528
ds_read_b64_tr_b16 a[186:187], v51 offset:23040
buffer_load_dwordx4 v16, s[32:35], s81 offen lds
v_mfma_f32_32x32x16_bf16 v[96:111], a[208:211], a[148:151], v[96:111]
ds_read_b64_tr_b16 a[188:189], v49 offset:30720
ds_read_b64_tr_b16 a[190:191], v49 offset:31232
v_mfma_f32_32x32x16_bf16 v[112:127], a[212:215], a[148:151], v[112:127]
ds_read_b64_tr_b16 a[192:193], v51 offset:30720
ds_read_b64_tr_b16 a[194:195], v51 offset:31232
s_waitcnt lgkmcnt(8)
v_mfma_f32_32x32x16_bf16 v[64:79], a[160:163], a[152:155], v[64:79]
s_waitcnt vmcnt(10)
s_barrier
ds_read_b64_tr_b16 a[200:201], v29 offset:0
ds_read_b64_tr_b16 a[202:203], v29 offset:512
buffer_load_dwordx4 v17, s[32:35], s81 offen offset:1024 lds
v_mfma_f32_32x32x16_bf16 v[80:95], a[164:167], a[152:155], v[80:95]
ds_read_b64_tr_b16 a[204:205], v6 offset:0
ds_read_b64_tr_b16 a[206:207], v6 offset:512
v_mfma_f32_32x32x16_bf16 v[96:111], a[168:171], a[152:155], v[96:111]
ds_read_b64_tr_b16 a[208:209], v29 offset:8192
ds_read_b64_tr_b16 a[210:211], v29 offset:8704
buffer_load_dwordx4 v18, s[32:35], s81 offen offset:2048 lds
v_mfma_f32_32x32x16_bf16 v[112:127], a[172:175], a[152:155], v[112:127]
ds_read_b64_tr_b16 a[212:213], v6 offset:8192
ds_read_b64_tr_b16 a[214:215], v6 offset:8704
s_waitcnt lgkmcnt(8)
v_mfma_f32_32x32x16_bf16 v[64:79], a[180:183], a[156:159], v[64:79]
ds_read_b64_tr_b16 a[160:161], v29 offset:2048
ds_read_b64_tr_b16 a[162:163], v29 offset:2560
v_mfma_f32_32x32x8_bf16 v[64:79], a[240:241], v[22:23], v[64:79]
buffer_load_dwordx4 v19, s[32:35], s81 offen offset:3072 lds
v_mfma_f32_32x32x16_bf16 v[80:95], a[184:187], a[156:159], v[80:95]
ds_read_b64_tr_b16 a[164:165], v6 offset:2048
ds_read_b64_tr_b16 a[166:167], v6 offset:2560
v_mfma_f32_32x32x8_bf16 v[80:95], a[242:243], v[22:23], v[80:95]
s_add_u32 m0, s84, 114688
s_bfe_u32 s81, s55, 0x40018
s_mul_i32 s81, s81, 196608
v_mfma_f32_32x32x16_bf16 v[96:111], a[188:191], a[156:159], v[96:111]
ds_read_b64_tr_b16 a[168:169], v29 offset:10240
ds_read_b64_tr_b16 a[170:171], v29 offset:10752
v_mfma_f32_32x32x8_bf16 v[96:111], a[244:245], v[22:23], v[96:111]
buffer_load_dwordx4 v16, s[32:35], s81 offen lds
v_mfma_f32_32x32x16_bf16 v[112:127], a[192:195], a[156:159], v[112:127]
ds_read_b64_tr_b16 a[172:173], v6 offset:10240
ds_read_b64_tr_b16 a[174:175], v6 offset:10752
v_mfma_f32_32x32x8_bf16 v[112:127], a[246:247], v[22:23], v[112:127]
s_branch L_gua
L_vpath:
s_waitcnt vmcnt(13)
ds_read_b128 a[0:3], v60 offset:0
ds_read_b128 a[4:7], v61 offset:0
ds_read_b128 a[8:11], v62 offset:0
ds_read_b128 a[12:15], v63 offset:0
s_waitcnt vmcnt(9)
s_barrier
ds_read_b64_tr_b16 a[160:161], v49 offset:0
ds_read_b64_tr_b16 a[162:163], v49 offset:512
ds_read_b64_tr_b16 a[164:165], v51 offset:0
ds_read_b64_tr_b16 a[166:167], v51 offset:512
ds_read_b64_tr_b16 a[168:169], v49 offset:8192
ds_read_b64_tr_b16 a[170:171], v49 offset:8704
ds_read_b64_tr_b16 a[172:173], v51 offset:8192
ds_read_b64_tr_b16 a[174:175], v51 offset:8704
ds_read_b64_tr_b16 a[176:177], v8 offset:0
ds_read_b64_tr_b16 a[178:179], v8 offset:512
ds_read_b64_tr_b16 a[180:181], v49 offset:2048
ds_read_b64_tr_b16 a[182:183], v49 offset:2560
ds_read_b64_tr_b16 a[184:185], v51 offset:2048
ds_read_b64_tr_b16 a[186:187], v51 offset:2560
ds_read_b64_tr_b16 a[188:189], v49 offset:10240
ds_read_b64_tr_b16 a[190:191], v49 offset:10752
ds_read_b64_tr_b16 a[192:193], v51 offset:10240
ds_read_b64_tr_b16 a[194:195], v51 offset:10752
ds_read_b64_tr_b16 a[196:197], v8 offset:2048
ds_read_b64_tr_b16 a[198:199], v8 offset:2560
s_waitcnt lgkmcnt(10)
v_mfma_f32_32x32x16_bf16 v[64:79], a[0:3], a[160:163], 0
ds_read_b64_tr_b16 a[200:201], v49 offset:4096
ds_read_b64_tr_b16 a[202:203], v49 offset:4608
ds_read_b64_tr_b16 a[204:205], v51 offset:4096
s_add_u32 m0, s84, 49152
s_bfe_u32 s80, s55, 0x40000
s_mul_i32 s80, s80, 245760
v_mfma_f32_32x32x16_bf16 v[80:95], a[0:3], a[164:167], 0
ds_read_b64_tr_b16 a[206:207], v51 offset:4608
ds_read_b64_tr_b16 a[208:209], v49 offset:12288
ds_read_b64_tr_b16 a[210:211], v49 offset:12800
buffer_load_dwordx4 v52, s[28:31], s80 offen lds
v_add_u32 v28, s78, v2
v_mfma_f32_32x32x16_bf16 v[96:111], a[0:3], a[168:171], 0
ds_read_b64_tr_b16 a[212:213], v51 offset:12288
ds_read_b64_tr_b16 a[214:215], v51 offset:12800
ds_read_b64_tr_b16 a[216:217], v8 offset:4096
v_add_u32 v12, 65536, v2
v_lshlrev_b32 v14, 2, v1
v_lshl_add_u32 v14, v45, 28, v14
v_mfma_f32_32x32x16_bf16 v[112:127], a[0:3], a[172:175], 0
ds_read_b64_tr_b16 a[218:219], v8 offset:4608
buffer_load_dwordx4 v53, s[28:31], s80 offen offset:1024 lds
v_add_u32 v13, s15, v2
v_mad_u32_u24 v27, v45, s12, v30
v_lshl_add_u32 v233, v45, 30, v2
v_and_b32 v253, 15, v1
v_mfma_f32_16x16x32_bf16 v[212:215], a[176:179], a[240:243], 0
v_lshlrev_b32 v244, 10, v253
s_waitcnt lgkmcnt(10)
v_mfma_f32_32x32x16_bf16 v[64:79], a[4:7], a[180:183], v[64:79]
ds_read_b64_tr_b16 a[160:161], v49 offset:6144
ds_read_b64_tr_b16 a[162:163], v49 offset:6656
ds_read_b64_tr_b16 a[164:165], v51 offset:6144
buffer_load_dwordx4 v54, s[28:31], s80 offen offset:2048 lds
v_lshrrev_b32 v252, 4, v1
v_mfma_f32_32x32x16_bf16 v[80:95], a[4:7], a[184:187], v[80:95]
ds_read_b64_tr_b16 a[166:167], v51 offset:6656
ds_read_b64_tr_b16 a[168:169], v49 offset:14336
ds_read_b64_tr_b16 a[170:171], v49 offset:14848
buffer_load_dwordx4 v55, s[28:31], s80 offen offset:3072 lds
v_lshlrev_b32 v240, 9, v252
v_mfma_f32_32x32x16_bf16 v[96:111], a[4:7], a[188:191], v[96:111]
ds_read_b64_tr_b16 a[172:173], v51 offset:14336
ds_read_b64_tr_b16 a[174:175], v51 offset:14848
ds_read_b64_tr_b16 a[176:177], v8 offset:6144
s_add_u32 m0, s84, 65536
s_bfe_u32 s81, s55, 0x40000
s_mul_i32 s81, s81, 196608
v_mfma_f32_32x32x16_bf16 v[112:127], a[4:7], a[192:195], v[112:127]
ds_read_b64_tr_b16 a[178:179], v8 offset:6656
v_lshl_add_u32 v240, v253, 4, v240
v_mul_u32_u24 v253, 1280, v253
v_lshl_add_u32 v245, v252, 3, v253
v_and_b32 v255, 1, v252
v_lshl_add_u32 v253, v255, 5, v253
v_lshl_add_u32 v3, v45, 4, v253
v_mfma_f32_16x16x32_bf16 v[212:215], a[196:199], a[240:243], v[212:215]
s_mul_i32 s59, s54, 2560
s_waitcnt lgkmcnt(10)
v_mfma_f32_32x32x16_bf16 v[64:79], a[8:11], a[200:203], v[64:79]
s_waitcnt vmcnt(8)
s_barrier
ds_read_b64_tr_b16 a[180:181], v4 offset:16384
ds_read_b64_tr_b16 a[182:183], v4 offset:16896
ds_read_b64_tr_b16 a[184:185], v7 offset:16384
s_add_u32 s60, s59, 81920
v_mfma_f32_32x32x16_bf16 v[80:95], a[8:11], a[204:207], v[80:95]
ds_read_b64_tr_b16 a[186:187], v7 offset:16896
ds_read_b64_tr_b16 a[188:189], v4 offset:24576
ds_read_b64_tr_b16 a[190:191], v4 offset:25088
v_add_u32 v229, s60, v2
v_add_u32 v230, s60, v30
v_bfe_u32 v237, v1, 2, 1
v_mfma_f32_32x32x16_bf16 v[96:111], a[8:11], a[208:211], v[96:111]
ds_read_b64_tr_b16 a[192:193], v7 offset:24576
ds_read_b64_tr_b16 a[194:195], v7 offset:25088
ds_read_b64_tr_b16 a[196:197], v10 offset:16384
v_bfe_u32 v238, v1, 3, 1
v_and_b32 v239, 3, v1
v_lshl_add_u32 v237, v237, 3, v239
v_mfma_f32_32x32x16_bf16 v[112:127], a[8:11], a[212:215], v[112:127]
ds_read_b64_tr_b16 a[198:199], v10 offset:16896
v_lshl_add_u32 v237, v238, 2, v237
v_mul_u32_u24 v238, 640, v45
s_add_u32 s60, s59, 112640
v_add_u32 v238, s60, v238
v_mov_b32 v254, s59
v_and_b32 v235, 31, v1
v_mfma_f32_16x16x32_bf16 v[212:215], a[216:219], a[240:243], v[212:215]
v_cmp_gt_u32 vcc, 16, v235
s_waitcnt lgkmcnt(10)
v_mfma_f32_32x32x16_bf16 v[64:79], a[12:15], a[160:163], v[64:79]
ds_read_b64_tr_b16 a[200:201], v4 offset:18432
ds_read_b64_tr_b16 a[202:203], v4 offset:18944
ds_read_b64_tr_b16 a[204:205], v7 offset:18432
v_cmp_gt_u32_e64 s[88:89], 20, v235
v_add_u32 v252, 0, v237
v_add_u32 v253, 16, v239
v_mfma_f32_32x32x16_bf16 v[80:95], a[12:15], a[164:167], v[80:95]
ds_read_b64_tr_b16 a[206:207], v7 offset:18944
ds_read_b64_tr_b16 a[208:209], v4 offset:26624
ds_read_b64_tr_b16 a[210:211], v4 offset:27136
v_cndmask_b32 v252, v253, v252, vcc
v_lshl_add_u32 v252, v252, 4, v238
v_cndmask_b32_e64 v231, v254, v252, s[88:89]
v_mfma_f32_32x32x16_bf16 v[96:111], a[12:15], a[168:171], v[96:111]
ds_read_b64_tr_b16 a[212:213], v7 offset:26624
ds_read_b64_tr_b16 a[214:215], v7 offset:27136
ds_read_b64_tr_b16 a[216:217], v10 offset:18432
v_add_u32 v252, 24, v237
v_add_u32 v253, 20, v239
v_cndmask_b32 v252, v253, v252, vcc
v_mfma_f32_32x32x16_bf16 v[112:127], a[12:15], a[172:175], v[112:127]
ds_read_b64_tr_b16 a[218:219], v10 offset:18944
v_lshl_add_u32 v252, v252, 4, v238
v_cndmask_b32_e64 v232, v254, v252, s[88:89]
v_cmp_gt_u32 vcc, 2, v1
v_cmp_gt_u32_e64 s[88:89], 4, v1
v_mov_b32 v252, s16
v_mov_b32 v253, s17
v_mfma_f32_16x16x32_bf16 v[212:215], a[176:179], a[240:243], v[212:215]
v_mov_b32 v254, s18
s_waitcnt lgkmcnt(10)
v_mfma_f32_32x32x16_bf16 v[128:143], a[180:183], a[0:3], 0
ds_read_b64_tr_b16 a[160:161], v4 offset:20480
ds_read_b64_tr_b16 a[162:163], v4 offset:20992
ds_read_b64_tr_b16 a[164:165], v7 offset:20480
v_and_b32 v255, 1, v1
v_cndmask_b32_e64 v253, v254, v253, s[88:89]
v_cndmask_b32 v252, v253, v252, vcc
v_mfma_f32_32x32x16_bf16 v[144:159], a[184:187], a[0:3], 0
ds_read_b64_tr_b16 a[166:167], v7 offset:20992
ds_read_b64_tr_b16 a[168:169], v4 offset:28672
ds_read_b64_tr_b16 a[170:171], v4 offset:29184
v_mad_u32_u24 v234, v255, s19, v252
s_cmp_ge_u32 s54, 2
s_cselect_b32 s61, 9600, 0
v_mfma_f32_32x32x16_bf16 v[160:175], a[188:191], a[0:3], 0
ds_read_b64_tr_b16 a[172:173], v7 offset:28672
ds_read_b64_tr_b16 a[174:175], v7 offset:29184
ds_read_b64_tr_b16 a[176:177], v10 offset:20480
buffer_load_dwordx4 v16, s[32:35], s81 offen lds
v_add_u32 v253, 0, v1
v_mfma_f32_32x32x16_bf16 v[176:191], a[192:195], a[0:3], 0
ds_read_b64_tr_b16 a[178:179], v10 offset:20992
buffer_load_dwordx4 v17, s[32:35], s81 offen offset:1024 lds
v_mul_u32_u24 v253, 205, v253
v_lshrrev_b32 v253, 13, v253
v_mad_u32_u24 v224, v253, s61, v2
v_add_u32 v253, 64, v1
v_mfma_f32_16x16x32_bf16 v[216:219], a[196:199], a[240:243], 0
v_mul_u32_u24 v253, 205, v253
s_waitcnt lgkmcnt(10)
v_mfma_f32_32x32x16_bf16 v[128:143], a[200:203], a[4:7], v[128:143]
ds_read_b64_tr_b16 a[180:181], v4 offset:22528
ds_read_b64_tr_b16 a[182:183], v4 offset:23040
ds_read_b64_tr_b16 a[184:185], v7 offset:22528
s_waitcnt vmcnt(6)
ds_read_b128 a[16:19], v60 offset:16384
v_lshrrev_b32 v253, 13, v253
v_mfma_f32_32x32x16_bf16 v[144:159], a[204:207], a[4:7], v[144:159]
ds_read_b64_tr_b16 a[186:187], v7 offset:23040
ds_read_b64_tr_b16 a[188:189], v4 offset:30720
ds_read_b64_tr_b16 a[190:191], v4 offset:31232
ds_read_b128 a[20:23], v61 offset:16384
buffer_load_dwordx4 v18, s[32:35], s81 offen offset:2048 lds
v_mfma_f32_32x32x16_bf16 v[160:175], a[208:211], a[4:7], v[160:175]
ds_read_b64_tr_b16 a[192:193], v7 offset:30720
ds_read_b64_tr_b16 a[194:195], v7 offset:31232
ds_read_b64_tr_b16 a[196:197], v10 offset:22528
ds_read_b128 a[24:27], v62 offset:16384
buffer_load_dwordx4 v19, s[32:35], s81 offen offset:3072 lds
v_mfma_f32_32x32x16_bf16 v[176:191], a[212:215], a[4:7], v[176:191]
ds_read_b64_tr_b16 a[198:199], v10 offset:23040
ds_read_b128 a[28:31], v63 offset:16384
v_mad_u32_u24 v225, v253, s61, v2
v_mul_u32_u24 v252, 38400, v45
v_xor_b32 v253, 1, v45
v_mul_u32_u24 v253, 3, v253
v_add_u32 v252, v252, v2
v_mfma_f32_16x16x32_bf16 v[216:219], a[216:219], a[240:243], v[216:219]
v_mad_u32_u24 v226, v253, s61, v252
s_waitcnt lgkmcnt(14)
v_mfma_f32_32x32x16_bf16 v[128:143], a[160:163], a[8:11], v[128:143]
s_waitcnt vmcnt(4)
s_barrier
ds_read_b64_tr_b16 a[200:201], v48 offset:0
ds_read_b64_tr_b16 a[202:203], v48 offset:512
ds_read_b64_tr_b16 a[204:205], v50 offset:0
v_add_u32 v253, 32, v1
v_mfma_f32_32x32x16_bf16 v[144:159], a[164:167], a[8:11], v[144:159]
ds_read_b64_tr_b16 a[206:207], v50 offset:512
ds_read_b64_tr_b16 a[208:209], v48 offset:8192
ds_read_b64_tr_b16 a[210:211], v48 offset:8704
buffer_load_dword v223, v198, s[24:27], s23 offen sc1
v_mul_u32_u24 v253, 205, v253
v_mfma_f32_32x32x16_bf16 v[160:175], a[168:171], a[8:11], v[160:175]
ds_read_b64_tr_b16 a[212:213], v50 offset:8192
ds_read_b64_tr_b16 a[214:215], v50 offset:8704
ds_read_b64_tr_b16 a[216:217], v5 offset:0
buffer_load_dword v223, v43, s[24:27], 0 offen sc1
v_lshrrev_b32 v253, 13, v253
v_mfma_f32_32x32x16_bf16 v[176:191], a[172:175], a[8:11], v[176:191]
ds_read_b64_tr_b16 a[218:219], v5 offset:512
s_add_u32 m0, s84, 32768
s_mov_b32 s83, 128
v_mad_u32_u24 v227, v253, s61, v2
v_add_u32 v227, 38400, v227
v_add_u32 v253, 96, v1
v_mul_u32_u24 v253, 205, v253
v_mfma_f32_16x16x32_bf16 v[216:219], a[176:179], a[240:243], v[216:219]
v_lshrrev_b32 v253, 13, v253
s_waitcnt lgkmcnt(11)
v_mfma_f32_32x32x16_bf16 v[128:143], a[180:183], a[12:15], v[128:143]
ds_read_b64_tr_b16 a[160:161], v48 offset:2048
ds_read_b64_tr_b16 a[162:163], v48 offset:2560
ds_read_b64_tr_b16 a[164:165], v50 offset:2048
buffer_load_dwordx4 v56, s[36:39], s83 offen lds
v_mad_u32_u24 v228, v253, s61, v2
v_mfma_f32_32x32x16_bf16 v[144:159], a[184:187], a[12:15], v[144:159]
ds_read_b64_tr_b16 a[166:167], v50 offset:2560
ds_read_b64_tr_b16 a[168:169], v48 offset:10240
ds_read_b64_tr_b16 a[170:171], v48 offset:10752
buffer_load_dwordx4 v57, s[36:39], s83 offen offset:1024 lds
v_add_u32 v228, 42496, v228
v_mfma_f32_32x32x16_bf16 v[160:175], a[188:191], a[12:15], v[160:175]
ds_read_b64_tr_b16 a[172:173], v50 offset:10240
ds_read_b64_tr_b16 a[174:175], v50 offset:10752
ds_read_b64_tr_b16 a[176:177], v5 offset:2048
v_add_u32 v247, 0x9e3779b9, v247
v_min_u32 v44, 1, v30
v_mfma_f32_32x32x16_bf16 v[176:191], a[192:195], a[12:15], v[176:191]
ds_read_b64_tr_b16 a[178:179], v5 offset:2560
buffer_load_dwordx4 v58, s[36:39], s83 offen offset:2048 lds
v_lshlrev_b32 v44, 30, v44
v_readfirstlane_b32 s56, v247
v_lshl_add_u32 v44, v45, 4, v44
s_mov_b32 s57, s56
v_mfma_f32_16x16x32_bf16 v[216:219], a[196:199], a[240:243], v[216:219]
s_waitcnt lgkmcnt(10)
v_mfma_f32_32x32x16_bf16 v[64:79], a[16:19], a[200:203], v[64:79]
ds_read_b64_tr_b16 a[180:181], v48 offset:4096
ds_read_b64_tr_b16 a[182:183], v48 offset:4608
ds_read_b64_tr_b16 a[184:185], v50 offset:4096
buffer_load_dwordx4 v59, s[36:39], s83 offen offset:3072 lds
v_mfma_f32_32x32x16_bf16 v[80:95], a[16:19], a[204:207], v[80:95]
ds_read_b64_tr_b16 a[186:187], v50 offset:4608
ds_read_b64_tr_b16 a[188:189], v48 offset:12288
ds_read_b64_tr_b16 a[190:191], v48 offset:12800
s_add_u32 m0, s84, 81920
s_mov_b32 s80, 245760
v_mfma_f32_32x32x16_bf16 v[96:111], a[16:19], a[208:211], v[96:111]
ds_read_b64_tr_b16 a[192:193], v50 offset:12288
ds_read_b64_tr_b16 a[194:195], v50 offset:12800
ds_read_b64_tr_b16 a[196:197], v5 offset:4096
buffer_load_dwordx4 v52, s[28:31], s80 offen lds
v_mfma_f32_32x32x16_bf16 v[112:127], a[16:19], a[212:215], v[112:127]
ds_read_b64_tr_b16 a[198:199], v5 offset:4608
v_mfma_f32_16x16x32_bf16 v[212:215], a[216:219], a[236:239], v[212:215]
s_waitcnt lgkmcnt(10)
v_mfma_f32_32x32x16_bf16 v[64:79], a[20:23], a[160:163], v[64:79]
ds_read_b64_tr_b16 a[200:201], v48 offset:6144
ds_read_b64_tr_b16 a[202:203], v48 offset:6656
ds_read_b64_tr_b16 a[204:205], v50 offset:6144
buffer_load_dwordx4 v53, s[28:31], s80 offen offset:1024 lds
v_mfma_f32_32x32x16_bf16 v[80:95], a[20:23], a[164:167], v[80:95]
ds_read_b64_tr_b16 a[206:207], v50 offset:6656
ds_read_b64_tr_b16 a[208:209], v48 offset:14336
ds_read_b64_tr_b16 a[210:211], v48 offset:14848
buffer_load_dwordx4 v54, s[28:31], s80 offen offset:2048 lds
v_mfma_f32_32x32x16_bf16 v[96:111], a[20:23], a[168:171], v[96:111]
ds_read_b64_tr_b16 a[212:213], v50 offset:14336
ds_read_b64_tr_b16 a[214:215], v50 offset:14848
ds_read_b64_tr_b16 a[216:217], v5 offset:6144
v_mfma_f32_32x32x16_bf16 v[112:127], a[20:23], a[172:175], v[112:127]
ds_read_b64_tr_b16 a[218:219], v5 offset:6656
buffer_load_dwordx4 v55, s[28:31], s80 offen offset:3072 lds
v_mfma_f32_16x16x32_bf16 v[212:215], a[176:179], a[236:239], v[212:215]
s_waitcnt lgkmcnt(10)
v_mfma_f32_32x32x16_bf16 v[64:79], a[24:27], a[180:183], v[64:79]
s_waitcnt vmcnt(10)
s_barrier
ds_read_b64_tr_b16 a[160:161], v29 offset:16384
ds_read_b64_tr_b16 a[162:163], v29 offset:16896
ds_read_b64_tr_b16 a[164:165], v6 offset:16384
v_mfma_f32_32x32x16_bf16 v[80:95], a[24:27], a[184:187], v[80:95]
ds_read_b64_tr_b16 a[166:167], v6 offset:16896
ds_read_b64_tr_b16 a[168:169], v29 offset:24576
ds_read_b64_tr_b16 a[170:171], v29 offset:25088
buffer_load_dwordx4 v[200:203], v46, s[36:39], s64 offen
v_mfma_f32_32x32x16_bf16 v[96:111], a[24:27], a[188:191], v[96:111]
ds_read_b64_tr_b16 a[172:173], v6 offset:24576
ds_read_b64_tr_b16 a[174:175], v6 offset:25088
ds_read_b64_tr_b16 a[176:177], v9 offset:16384
buffer_load_dwordx4 v[204:207], v46, s[36:39], s64 offen offset:512
v_mfma_f32_32x32x16_bf16 v[112:127], a[24:27], a[192:195], v[112:127]
ds_read_b64_tr_b16 a[178:179], v9 offset:16896
v_mfma_f32_16x16x32_bf16 v[212:215], a[196:199], a[236:239], v[212:215]
s_waitcnt lgkmcnt(10)
v_mfma_f32_32x32x16_bf16 v[64:79], a[28:31], a[200:203], v[64:79]
ds_read_b64_tr_b16 a[180:181], v29 offset:18432
ds_read_b64_tr_b16 a[182:183], v29 offset:18944
ds_read_b64_tr_b16 a[184:185], v6 offset:18432
buffer_load_dwordx4 v[208:211], v47, s[36:39], s64 offen offset:1024
v_mfma_f32_32x32x16_bf16 v[80:95], a[28:31], a[204:207], v[80:95]
ds_read_b64_tr_b16 a[186:187], v6 offset:18944
ds_read_b64_tr_b16 a[188:189], v29 offset:26624
ds_read_b64_tr_b16 a[190:191], v29 offset:27136
s_add_u32 m0, s84, 98304
s_mov_b32 s81, 196608
v_mfma_f32_32x32x16_bf16 v[96:111], a[28:31], a[208:211], v[96:111]
ds_read_b64_tr_b16 a[192:193], v6 offset:26624
ds_read_b64_tr_b16 a[194:195], v6 offset:27136
ds_read_b64_tr_b16 a[196:197], v9 offset:18432
buffer_load_dwordx4 v16, s[32:35], s81 offen lds
v_mfma_f32_32x32x16_bf16 v[112:127], a[28:31], a[212:215], v[112:127]
ds_read_b64_tr_b16 a[198:199], v9 offset:18944
v_mfma_f32_16x16x32_bf16 v[212:215], a[216:219], a[236:239], v[212:215]
s_waitcnt lgkmcnt(10)
v_mfma_f32_32x32x16_bf16 v[128:143], a[160:163], a[16:19], v[128:143]
ds_read_b64_tr_b16 a[200:201], v29 offset:20480
ds_read_b64_tr_b16 a[202:203], v29 offset:20992
ds_read_b64_tr_b16 a[204:205], v6 offset:20480
buffer_load_dwordx4 v17, s[32:35], s81 offen offset:1024 lds
v_mfma_f32_32x32x16_bf16 v[144:159], a[164:167], a[16:19], v[144:159]
ds_read_b64_tr_b16 a[206:207], v6 offset:20992
ds_read_b64_tr_b16 a[208:209], v29 offset:28672
ds_read_b64_tr_b16 a[210:211], v29 offset:29184
buffer_load_dwordx4 v18, s[32:35], s81 offen offset:2048 lds
v_mfma_f32_32x32x16_bf16 v[160:175], a[168:171], a[16:19], v[160:175]
ds_read_b64_tr_b16 a[212:213], v6 offset:28672
ds_read_b64_tr_b16 a[214:215], v6 offset:29184
ds_read_b64_tr_b16 a[216:217], v9 offset:20480
v_mfma_f32_32x32x16_bf16 v[176:191], a[172:175], a[16:19], v[176:191]
ds_read_b64_tr_b16 a[218:219], v9 offset:20992
buffer_load_dwordx4 v19, s[32:35], s81 offen offset:3072 lds
s_add_u32 m0, s84, 0
s_bfe_u32 s83, s55, 0x40004
s_mul_i32 s83, s83, 128
v_mfma_f32_16x16x32_bf16 v[216:219], a[176:179], a[236:239], v[216:219]
s_waitcnt lgkmcnt(10)
v_mfma_f32_32x32x16_bf16 v[128:143], a[180:183], a[20:23], v[128:143]
ds_read_b64_tr_b16 a[160:161], v29 offset:22528
ds_read_b64_tr_b16 a[162:163], v29 offset:23040
ds_read_b64_tr_b16 a[164:165], v6 offset:22528
s_waitcnt vmcnt(11)
ds_read_b128 a[32:35], v60 offset:32768
v_mfma_f32_32x32x16_bf16 v[144:159], a[184:187], a[20:23], v[144:159]
ds_read_b64_tr_b16 a[166:167], v6 offset:23040
ds_read_b64_tr_b16 a[168:169], v29 offset:30720
ds_read_b64_tr_b16 a[170:171], v29 offset:31232
ds_read_b128 a[36:39], v61 offset:32768
buffer_load_dwordx4 v56, s[36:39], s83 offen lds
v_mfma_f32_32x32x16_bf16 v[160:175], a[188:191], a[20:23], v[160:175]
ds_read_b64_tr_b16 a[172:173], v6 offset:30720
ds_read_b64_tr_b16 a[174:175], v6 offset:31232
ds_read_b64_tr_b16 a[176:177], v9 offset:22528
ds_read_b128 a[40:43], v62 offset:32768
buffer_load_dwordx4 v57, s[36:39], s83 offen offset:1024 lds
v_mfma_f32_32x32x16_bf16 v[176:191], a[192:195], a[20:23], v[176:191]
ds_read_b64_tr_b16 a[178:179], v9 offset:23040
ds_read_b128 a[44:47], v63 offset:32768
s_waitcnt vmcnt(8)
v_lshlrev_b32 v252, 16, v200
v_and_b32 v253, 0xffff0000, v200
v_add_f32 v236, v252, v253
v_mul_f32 v238, v252, v252
v_mfma_f32_16x16x32_bf16 v[216:219], a[196:199], a[236:239], v[216:219]
v_fmac_f32 v238, v253, v253
s_waitcnt lgkmcnt(14)
v_mfma_f32_32x32x16_bf16 v[128:143], a[200:203], a[24:27], v[128:143]
s_barrier
ds_read_b64_tr_b16 a[180:181], v48 offset:32768
ds_read_b64_tr_b16 a[182:183], v48 offset:33280
ds_read_b64_tr_b16 a[184:185], v50 offset:32768
v_lshlrev_b32 v252, 16, v201
v_mfma_f32_32x32x16_bf16 v[144:159], a[204:207], a[24:27], v[144:159]
ds_read_b64_tr_b16 a[186:187], v50 offset:33280
ds_read_b64_tr_b16 a[188:189], v48 offset:40960
ds_read_b64_tr_b16 a[190:191], v48 offset:41472
buffer_load_dwordx4 v58, s[36:39], s83 offen offset:2048 lds
v_and_b32 v253, 0xffff0000, v201
v_mfma_f32_32x32x16_bf16 v[160:175], a[208:211], a[24:27], v[160:175]
ds_read_b64_tr_b16 a[192:193], v50 offset:40960
ds_read_b64_tr_b16 a[194:195], v50 offset:41472
ds_read_b64_tr_b16 a[196:197], v5 offset:32768
buffer_load_dwordx4 v59, s[36:39], s83 offen offset:3072 lds
v_add_f32 v236, v236, v252
v_mfma_f32_32x32x16_bf16 v[176:191], a[212:215], a[24:27], v[176:191]
ds_read_b64_tr_b16 a[198:199], v5 offset:33280
s_add_u32 m0, s84, 114688
s_bfe_u32 s80, s55, 0x40004
s_mul_i32 s80, s80, 245760
v_fmac_f32 v238, v252, v252
v_add_f32 v236, v236, v253
v_fmac_f32 v238, v253, v253
v_mfma_f32_16x16x32_bf16 v[216:219], a[216:219], a[236:239], v[216:219]
v_lshlrev_b32 v252, 16, v202
s_waitcnt lgkmcnt(11)
v_mfma_f32_32x32x16_bf16 v[128:143], a[160:163], a[28:31], v[128:143]
ds_read_b64_tr_b16 a[200:201], v48 offset:34816
ds_read_b64_tr_b16 a[202:203], v48 offset:35328
ds_read_b64_tr_b16 a[204:205], v50 offset:34816
buffer_load_dwordx4 v52, s[28:31], s80 offen lds
v_and_b32 v253, 0xffff0000, v202
v_mfma_f32_32x32x16_bf16 v[144:159], a[164:167], a[28:31], v[144:159]
ds_read_b64_tr_b16 a[206:207], v50 offset:35328
ds_read_b64_tr_b16 a[208:209], v48 offset:43008
ds_read_b64_tr_b16 a[210:211], v48 offset:43520
buffer_load_dwordx4 v53, s[28:31], s80 offen offset:1024 lds
v_add_f32 v236, v236, v252
v_mfma_f32_32x32x16_bf16 v[160:175], a[168:171], a[28:31], v[160:175]
ds_read_b64_tr_b16 a[212:213], v50 offset:43008
ds_read_b64_tr_b16 a[214:215], v50 offset:43520
ds_read_b64_tr_b16 a[216:217], v5 offset:34816
v_fmac_f32 v238, v252, v252
v_add_f32 v236, v236, v253
v_fmac_f32 v238, v253, v253
v_mfma_f32_32x32x16_bf16 v[176:191], a[172:175], a[28:31], v[176:191]
ds_read_b64_tr_b16 a[218:219], v5 offset:35328
buffer_load_dwordx4 v54, s[28:31], s80 offen offset:2048 lds
v_lshlrev_b32 v252, 16, v203
v_and_b32 v253, 0xffff0000, v203
v_add_f32 v236, v236, v252
v_fmac_f32 v238, v252, v252
v_mfma_f32_16x16x32_bf16 v[216:219], a[176:179], a[236:239], v[216:219]
v_add_f32 v236, v236, v253
s_waitcnt lgkmcnt(10)
v_mfma_f32_32x32x16_bf16 v[64:79], a[32:35], a[180:183], v[64:79]
ds_read_b64_tr_b16 a[160:161], v48 offset:36864
ds_read_b64_tr_b16 a[162:163], v48 offset:37376
ds_read_b64_tr_b16 a[164:165], v50 offset:36864
buffer_load_dwordx4 v55, s[28:31], s80 offen offset:3072 lds
v_fmac_f32 v238, v253, v253
v_mfma_f32_32x32x16_bf16 v[80:95], a[32:35], a[184:187], v[80:95]
ds_read_b64_tr_b16 a[166:167], v50 offset:37376
ds_read_b64_tr_b16 a[168:169], v48 offset:45056
ds_read_b64_tr_b16 a[170:171], v48 offset:45568
s_add_u32 m0, s84, 16384
s_bfe_u32 s83, s55, 0x40008
s_mul_i32 s83, s83, 128
v_mfma_f32_32x32x16_bf16 v[96:111], a[32:35], a[188:191], v[96:111]
ds_read_b64_tr_b16 a[172:173], v50 offset:45056
ds_read_b64_tr_b16 a[174:175], v50 offset:45568
ds_read_b64_tr_b16 a[176:177], v5 offset:36864
buffer_load_dwordx4 v56, s[36:39], s83 offen lds
v_mfma_f32_32x32x16_bf16 v[112:127], a[32:35], a[192:195], v[112:127]
ds_read_b64_tr_b16 a[178:179], v5 offset:37376
s_waitcnt vmcnt(14)
v_lshlrev_b32 v252, 16, v204
v_and_b32 v253, 0xffff0000, v204
v_add_f32 v236, v236, v252
v_fmac_f32 v238, v252, v252
v_add_f32 v236, v236, v253
v_mfma_f32_16x16x32_bf16 v[212:215], a[196:199], a[244:247], v[212:215]
v_fmac_f32 v238, v253, v253
s_waitcnt lgkmcnt(10)
v_mfma_f32_32x32x16_bf16 v[64:79], a[36:39], a[200:203], v[64:79]
ds_read_b64_tr_b16 a[180:181], v48 offset:38912
ds_read_b64_tr_b16 a[182:183], v48 offset:39424
ds_read_b64_tr_b16 a[184:185], v50 offset:38912
buffer_load_dwordx4 v57, s[36:39], s83 offen offset:1024 lds
v_lshlrev_b32 v252, 16, v205
v_mfma_f32_32x32x16_bf16 v[80:95], a[36:39], a[204:207], v[80:95]
ds_read_b64_tr_b16 a[186:187], v50 offset:39424
ds_read_b64_tr_b16 a[188:189], v48 offset:47104
ds_read_b64_tr_b16 a[190:191], v48 offset:47616
buffer_load_dwordx4 v58, s[36:39], s83 offen offset:2048 lds
v_and_b32 v253, 0xffff0000, v205
v_mfma_f32_32x32x16_bf16 v[96:111], a[36:39], a[208:211], v[96:111]
ds_read_b64_tr_b16 a[192:193], v50 offset:47104
ds_read_b64_tr_b16 a[194:195], v50 offset:47616
ds_read_b64_tr_b16 a[196:197], v5 offset:38912
v_add_f32 v236, v236, v252
v_fmac_f32 v238, v252, v252
v_add_f32 v236, v236, v253
v_mfma_f32_32x32x16_bf16 v[112:127], a[36:39], a[212:215], v[112:127]
ds_read_b64_tr_b16 a[198:199], v5 offset:39424
buffer_load_dwordx4 v59, s[36:39], s83 offen offset:3072 lds
s_add_u32 m0, s84, 147456
v_fmac_f32 v238, v253, v253
v_lshlrev_b32 v252, 16, v206
v_and_b32 v253, 0xffff0000, v206
v_mfma_f32_16x16x32_bf16 v[212:215], a[216:219], a[244:247], v[212:215]
v_add_f32 v236, v236, v252
s_waitcnt lgkmcnt(10)
v_mfma_f32_32x32x16_bf16 v[64:79], a[40:43], a[160:163], v[64:79]
s_waitcnt vmcnt(12)
s_barrier
ds_read_b64_tr_b16 a[200:201], v29 offset:49152
ds_read_b64_tr_b16 a[202:203], v29 offset:49664
ds_read_b64_tr_b16 a[204:205], v6 offset:49152
v_fmac_f32 v238, v252, v252
v_mfma_f32_32x32x16_bf16 v[80:95], a[40:43], a[164:167], v[80:95]
ds_read_b64_tr_b16 a[206:207], v6 offset:49664
ds_read_b64_tr_b16 a[208:209], v29 offset:57344
ds_read_b64_tr_b16 a[210:211], v29 offset:57856
buffer_load_dwordx4 v32, s[48:51], s70 offen offset:0 lds
v_add_f32 v236, v236, v253
v_mfma_f32_32x32x16_bf16 v[96:111], a[40:43], a[168:171], v[96:111]
ds_read_b64_tr_b16 a[212:213], v6 offset:57344
ds_read_b64_tr_b16 a[214:215], v6 offset:57856
ds_read_b64_tr_b16 a[216:217], v9 offset:49152
buffer_load_dwordx4 v33, s[48:51], s70 offen offset:1024 lds
v_fmac_f32 v238, v253, v253
v_mfma_f32_32x32x16_bf16 v[112:127], a[40:43], a[172:175], v[112:127]
ds_read_b64_tr_b16 a[218:219], v9 offset:49664
v_lshlrev_b32 v252, 16, v207
v_and_b32 v253, 0xffff0000, v207
v_add_f32 v236, v236, v252
v_fmac_f32 v238, v252, v252
v_add_f32 v236, v236, v253
v_fmac_f32 v238, v253, v253
v_mfma_f32_16x16x32_bf16 v[212:215], a[176:179], a[244:247], v[212:215]
s_waitcnt lgkmcnt(10)
v_mfma_f32_32x32x16_bf16 v[64:79], a[44:47], a[180:183], v[64:79]
ds_read_b64_tr_b16 a[160:161], v29 offset:51200
ds_read_b64_tr_b16 a[162:163], v29 offset:51712
ds_read_b64_tr_b16 a[164:165], v6 offset:51200
buffer_load_dwordx4 v34, s[48:51], s70 offen offset:2048 lds
v_mfma_f32_32x32x16_bf16 v[80:95], a[44:47], a[184:187], v[80:95]
ds_read_b64_tr_b16 a[166:167], v6 offset:51712
ds_read_b64_tr_b16 a[168:169], v29 offset:59392
ds_read_b64_tr_b16 a[170:171], v29 offset:59904
buffer_load_dwordx4 v35, s[48:51], s70 offen offset:3072 lds
v_mfma_f32_32x32x16_bf16 v[96:111], a[44:47], a[188:191], v[96:111]
ds_read_b64_tr_b16 a[172:173], v6 offset:59392
ds_read_b64_tr_b16 a[174:175], v6 offset:59904
ds_read_b64_tr_b16 a[176:177], v9 offset:51200
s_add_u32 m0, s84, 131072
s_bfe_u32 s80, s55, 0x40008
s_mul_i32 s80, s80, 245760
v_mfma_f32_32x32x16_bf16 v[112:127], a[44:47], a[192:195], v[112:127]
ds_read_b64_tr_b16 a[178:179], v9 offset:51712
buffer_load_dwordx4 v52, s[28:31], s80 offen lds
v_lshlrev_b32 v252, 16, v208
v_and_b32 v253, 0xffff0000, v208
v_add_f32 v236, v236, v252
v_mfma_f32_16x16x32_bf16 v[212:215], a[196:199], a[244:247], v[212:215]
v_fmac_f32 v238, v252, v252
s_waitcnt lgkmcnt(10)
v_mfma_f32_32x32x16_bf16 v[128:143], a[200:203], a[32:35], v[128:143]
ds_read_b64_tr_b16 a[180:181], v29 offset:53248
ds_read_b64_tr_b16 a[182:183], v29 offset:53760
ds_read_b64_tr_b16 a[184:185], v6 offset:53248
buffer_load_dwordx4 v53, s[28:31], s80 offen offset:1024 lds
v_add_f32 v236, v236, v253
v_mfma_f32_32x32x16_bf16 v[144:159], a[204:207], a[32:35], v[144:159]
ds_read_b64_tr_b16 a[186:187], v6 offset:53760
ds_read_b64_tr_b16 a[188:189], v29 offset:61440
ds_read_b64_tr_b16 a[190:191], v29 offset:61952
v_fmac_f32 v238, v253, v253
v_lshlrev_b32 v252, 16, v209
v_and_b32 v253, 0xffff0000, v209
v_mfma_f32_32x32x16_bf16 v[160:175], a[208:211], a[32:35], v[160:175]
ds_read_b64_tr_b16 a[192:193], v6 offset:61440
ds_read_b64_tr_b16 a[194:195], v6 offset:61952
ds_read_b64_tr_b16 a[196:197], v9 offset:53248
buffer_load_dwordx4 v54, s[28:31], s80 offen offset:2048 lds
v_add_f32 v236, v236, v252
v_mfma_f32_32x32x16_bf16 v[176:191], a[212:215], a[32:35], v[176:191]
ds_read_b64_tr_b16 a[198:199], v9 offset:53760
buffer_load_dwordx4 v55, s[28:31], s80 offen offset:3072 lds
s_add_u32 m0, s84, 32768
s_bfe_u32 s83, s55, 0x4000c
s_mul_i32 s83, s83, 128
buffer_store_dwordx4 v[212:215], v42, s[24:27], s6 offen sc1
v_mfma_f32_16x16x32_bf16 v[216:219], a[216:219], a[244:247], v[216:219]
v_fmac_f32 v238, v252, v252
s_waitcnt lgkmcnt(10)
v_mfma_f32_32x32x16_bf16 v[128:143], a[160:163], a[36:39], v[128:143]
ds_read_b64_tr_b16 a[200:201], v29 offset:55296
ds_read_b64_tr_b16 a[202:203], v29 offset:55808
ds_read_b64_tr_b16 a[204:205], v6 offset:55296
s_waitcnt vmcnt(17)
ds_read_b128 a[48:51], v60 offset:0
v_add_f32 v236, v236, v253
v_mfma_f32_32x32x16_bf16 v[144:159], a[164:167], a[36:39], v[144:159]
ds_read_b64_tr_b16 a[206:207], v6 offset:55808
ds_read_b64_tr_b16 a[208:209], v29 offset:63488
ds_read_b64_tr_b16 a[210:211], v29 offset:64000
ds_read_b128 a[52:55], v61 offset:0
buffer_load_dwordx4 v56, s[36:39], s83 offen lds
v_mfma_f32_32x32x16_bf16 v[160:175], a[168:171], a[36:39], v[160:175]
ds_read_b64_tr_b16 a[212:213], v6 offset:63488
ds_read_b64_tr_b16 a[214:215], v6 offset:64000
ds_read_b64_tr_b16 a[216:217], v9 offset:55296
ds_read_b128 a[56:59], v62 offset:0
buffer_load_dwordx4 v57, s[36:39], s83 offen offset:1024 lds
v_mfma_f32_32x32x16_bf16 v[176:191], a[172:175], a[36:39], v[176:191]
ds_read_b64_tr_b16 a[218:219], v9 offset:55808
ds_read_b128 a[60:63], v63 offset:0
v_fmac_f32 v238, v253, v253
v_lshlrev_b32 v252, 16, v210
v_and_b32 v253, 0xffff0000, v210
v_add_f32 v236, v236, v252
v_fmac_f32 v238, v252, v252
v_mfma_f32_16x16x32_bf16 v[216:219], a[176:179], a[244:247], v[216:219]
v_add_f32 v236, v236, v253
s_waitcnt lgkmcnt(14)
v_mfma_f32_32x32x16_bf16 v[128:143], a[180:183], a[40:43], v[128:143]
s_waitcnt vmcnt(15)
s_barrier
ds_read_b64_tr_b16 a[160:161], v49 offset:0
ds_read_b64_tr_b16 a[162:163], v49 offset:512
buffer_load_dwordx4 v58, s[36:39], s83 offen offset:2048 lds
v_fmac_f32 v238, v253, v253
v_mfma_f32_32x32x16_bf16 v[144:159], a[184:187], a[40:43], v[144:159]
ds_read_b64_tr_b16 a[164:165], v51 offset:0
ds_read_b64_tr_b16 a[166:167], v51 offset:512
buffer_load_dwordx4 v59, s[36:39], s83 offen offset:3072 lds
s_add_u32 m0, s84, 49152
s_bfe_u32 s80, s55, 0x4000c
s_mul_i32 s80, s80, 245760
v_mfma_f32_32x32x16_bf16 v[160:175], a[188:191], a[40:43], v[160:175]
ds_read_b64_tr_b16 a[168:169], v49 offset:8192
ds_read_b64_tr_b16 a[170:171], v49 offset:8704
v_lshlrev_b32 v252, 16, v211
v_and_b32 v253, 0xffff0000, v211
v_add_f32 v236, v236, v252
v_fmac_f32 v238, v252, v252
v_add_f32 v236, v236, v253
v_mfma_f32_32x32x16_bf16 v[176:191], a[192:195], a[40:43], v[176:191]
ds_read_b64_tr_b16 a[172:173], v51 offset:8192
ds_read_b64_tr_b16 a[174:175], v51 offset:8704
buffer_load_dwordx4 v52, s[28:31], s80 offen lds
v_fmac_f32 v238, v253, v253
v_add_f32_dpp v236, v236, v236 row_ror:1 row_mask:0xf bank_mask:0xf
s_nop 0
v_add_f32_dpp v238, v238, v238 row_ror:1 row_mask:0xf bank_mask:0xf
v_mfma_f32_16x16x32_bf16 v[216:219], a[196:199], a[244:247], v[216:219]
v_add_f32_dpp v236, v236, v236 row_ror:2 row_mask:0xf bank_mask:0xf
s_waitcnt lgkmcnt(9)
v_mfma_f32_32x32x16_bf16 v[128:143], a[200:203], a[44:47], v[128:143]
ds_read_b64_tr_b16 a[180:181], v49 offset:2048
ds_read_b64_tr_b16 a[182:183], v49 offset:2560
buffer_load_dwordx4 v53, s[28:31], s80 offen offset:1024 lds
v_add_f32_dpp v238, v238, v238 row_ror:2 row_mask:0xf bank_mask:0xf
v_add_f32_dpp v236, v236, v236 row_ror:4 row_mask:0xf bank_mask:0xf
s_nop 0
v_add_f32_dpp v238, v238, v238 row_ror:4 row_mask:0xf bank_mask:0xf
v_mfma_f32_32x32x16_bf16 v[144:159], a[204:207], a[44:47], v[144:159]
ds_read_b64_tr_b16 a[184:185], v51 offset:2048
ds_read_b64_tr_b16 a[186:187], v51 offset:2560
buffer_load_dwordx4 v54, s[28:31], s80 offen offset:2048 lds
v_add_f32_dpp v236, v236, v236 row_ror:8 row_mask:0xf bank_mask:0xf
v_add_f32_dpp v238, v238, v238 row_ror:8 row_mask:0xf bank_mask:0xf
v_mov_b32 v252, v236
v_mfma_f32_32x32x16_bf16 v[160:175], a[208:211], a[44:47], v[160:175]
ds_read_b64_tr_b16 a[188:189], v49 offset:10240
ds_read_b64_tr_b16 a[190:191], v49 offset:10752
v_mov_b32 v253, v238
v_permlane16_swap_b32 v236, v252
s_nop 0
v_permlane16_swap_b32 v238, v253
v_add_f32 v236, v236, v252
v_add_f32 v238, v238, v253
v_mfma_f32_32x32x16_bf16 v[176:191], a[212:215], a[44:47], v[176:191]
ds_read_b64_tr_b16 a[192:193], v51 offset:10240
ds_read_b64_tr_b16 a[194:195], v51 offset:10752
buffer_load_dwordx4 v55, s[28:31], s80 offen offset:3072 lds
s_add_u32 m0, s84, 65536
s_bfe_u32 s81, s55, 0x40004
s_mul_i32 s81, s81, 196608
v_mfma_f32_16x16x32_bf16 v[216:219], a[216:219], a[244:247], v[216:219]
s_waitcnt vmcnt(8)
buffer_store_dword v247, v246, s[24:27], s4 offen offset:0 sc1
s_waitcnt lgkmcnt(8)
v_mfma_f32_32x32x16_bf16 v[64:79], a[48:51], a[160:163], v[64:79]
ds_read_b64_tr_b16 a[200:201], v49 offset:4096
ds_read_b64_tr_b16 a[202:203], v49 offset:4608
buffer_load_dwordx4 v16, s[32:35], s81 offen lds
v_mul_f32 v236, 0x3acccccd, v236
v_mul_f32 v238, 0x3acccccd, v238
v_fma_f32 v238, -v236, v236, v238
v_mfma_f32_32x32x16_bf16 v[80:95], a[48:51], a[164:167], v[80:95]
ds_read_b64_tr_b16 a[204:205], v51 offset:4096
ds_read_b64_tr_b16 a[206:207], v51 offset:4608
buffer_load_dwordx4 v17, s[32:35], s81 offen offset:1024 lds
v_max_f32 v238, 0, v238
v_cvt_pk_bf16_f32 v238, v238, v238
v_and_b32 v238, 0xffff0000, v238
v_mfma_f32_32x32x16_bf16 v[96:111], a[48:51], a[168:171], v[96:111]
ds_read_b64_tr_b16 a[208:209], v49 offset:12288
ds_read_b64_tr_b16 a[210:211], v49 offset:12800
v_add_f32 v238, 0x3727c5ac, v238
v_cvt_pk_bf16_f32 v238, v238, v238
v_and_b32 v238, 0xffff0000, v238
v_sqrt_f32 v238, v238
v_mfma_f32_32x32x16_bf16 v[112:127], a[48:51], a[172:175], v[112:127]
ds_read_b64_tr_b16 a[212:213], v51 offset:12288
ds_read_b64_tr_b16 a[214:215], v51 offset:12800
buffer_load_dwordx4 v18, s[32:35], s81 offen offset:2048 lds
s_add_u32 s87, s6, 5120
buffer_store_dwordx4 v[216:219], v42, s[24:27], s87 offen sc1
s_waitcnt lgkmcnt(8)
v_mfma_f32_32x32x16_bf16 v[64:79], a[52:55], a[180:183], v[64:79]
ds_read_b64_tr_b16 a[160:161], v49 offset:6144
ds_read_b64_tr_b16 a[162:163], v49 offset:6656
ds_read_b128 a[64:67], v60 offset:16384
buffer_load_dwordx4 v19, s[32:35], s81 offen offset:3072 lds
v_mfma_f32_32x32x16_bf16 v[80:95], a[52:55], a[184:187], v[80:95]
ds_read_b64_tr_b16 a[164:165], v51 offset:6144
ds_read_b64_tr_b16 a[166:167], v51 offset:6656
ds_read_b128 a[68:71], v61 offset:16384
s_add_u32 m0, s84, 0
s_bfe_u32 s83, s55, 0x40010
s_mul_i32 s83, s83, 128
v_mfma_f32_32x32x16_bf16 v[96:111], a[52:55], a[188:191], v[96:111]
ds_read_b64_tr_b16 a[168:169], v49 offset:14336
ds_read_b64_tr_b16 a[170:171], v49 offset:14848
ds_read_b128 a[72:75], v62 offset:16384
buffer_load_dwordx4 v56, s[36:39], s83 offen lds
v_mov_b32 v237, v247
v_mfma_f32_32x32x16_bf16 v[112:127], a[52:55], a[192:195], v[112:127]
ds_read_b64_tr_b16 a[172:173], v51 offset:14336
ds_read_b64_tr_b16 a[174:175], v51 offset:14848
ds_read_b128 a[76:79], v63 offset:16384
ds_read_b64_tr_b16 a[220:221], v36 offset:0
s_waitcnt lgkmcnt(13)
v_mfma_f32_32x32x16_bf16 v[64:79], a[56:59], a[200:203], v[64:79]
s_barrier
ds_read_b64_tr_b16 a[180:181], v49 offset:16384
ds_read_b64_tr_b16 a[182:183], v49 offset:16896
buffer_load_dwordx4 v57, s[36:39], s83 offen offset:1024 lds
v_mov_b32 v239, v247
v_mfma_f32_32x32x16_bf16 v[80:95], a[56:59], a[204:207], v[80:95]
ds_read_b64_tr_b16 a[184:185], v51 offset:16384
ds_read_b64_tr_b16 a[186:187], v51 offset:16896
ds_read_b64_tr_b16 a[222:223], v36 offset:512
ds_read_b64_tr_b16 a[224:225], v37 offset:0
ds_read_b64_tr_b16 a[226:227], v37 offset:512
ds_read_b64_tr_b16 a[228:229], v38 offset:0
v_mfma_f32_32x32x16_bf16 v[96:111], a[56:59], a[208:211], v[96:111]
ds_read_b64_tr_b16 a[188:189], v49 offset:24576
ds_read_b64_tr_b16 a[190:191], v49 offset:25088
buffer_load_dwordx4 v58, s[36:39], s83 offen offset:2048 lds
ds_read_b64_tr_b16 a[230:231], v38 offset:512
ds_read_b64_tr_b16 a[232:233], v39 offset:0
v_mfma_f32_32x32x16_bf16 v[112:127], a[56:59], a[212:215], v[112:127]
ds_read_b64_tr_b16 a[192:193], v51 offset:24576
ds_read_b64_tr_b16 a[194:195], v51 offset:25088
ds_read_b64_tr_b16 a[234:235], v39 offset:512
v_cvt_pk_bf16_f32 v236, v236, v238
v_mov_b32 v238, v236
s_waitcnt lgkmcnt(15)
v_mfma_f32_32x32x16_bf16 v[64:79], a[60:63], a[160:163], v[64:79]
ds_read_b64_tr_b16 a[200:201], v49 offset:18432
ds_read_b64_tr_b16 a[202:203], v49 offset:18944
buffer_load_dwordx4 v59, s[36:39], s83 offen offset:3072 lds
s_add_u32 m0, s84, 81920
s_bfe_u32 s80, s55, 0x40010
s_mul_i32 s80, s80, 245760
v_mfma_f32_32x32x16_bf16 v[80:95], a[60:63], a[164:167], v[80:95]
ds_read_b64_tr_b16 a[204:205], v51 offset:18432
ds_read_b64_tr_b16 a[206:207], v51 offset:18944
buffer_store_dwordx4 v[236:239], v44, s[24:27], s65 offen sc1
v_mfma_f32_32x32x16_bf16 v[96:111], a[60:63], a[168:171], v[96:111]
ds_read_b64_tr_b16 a[208:209], v49 offset:26624
ds_read_b64_tr_b16 a[210:211], v49 offset:27136
buffer_load_dwordx4 v52, s[28:31], s80 offen lds
s_waitcnt lgkmcnt(6)
buffer_store_dwordx4 a[220:223], v28, s[24:27], s73 offen sc1
v_mfma_f32_16x16x32_bf16 v[212:215], a[220:223], a[236:239], 0
v_mfma_f32_16x16x32_bf16 v[216:219], a[224:227], a[236:239], 0
v_mfma_f32_16x16x32_bf16 v[212:215], a[228:231], a[236:239], v[212:215]
v_mfma_f32_16x16x32_bf16 v[216:219], a[232:235], a[236:239], v[216:219]
v_mfma_f32_32x32x16_bf16 v[112:127], a[60:63], a[172:175], v[112:127]
ds_read_b64_tr_b16 a[212:213], v51 offset:26624
ds_read_b64_tr_b16 a[214:215], v51 offset:27136
v_mfma_f32_32x32x16_bf16 v[64:79], a[64:67], a[180:183], v[64:79]
ds_read_b64_tr_b16 a[160:161], v49 offset:20480
ds_read_b64_tr_b16 a[162:163], v49 offset:20992
buffer_load_dwordx4 v53, s[28:31], s80 offen offset:1024 lds
v_mfma_f32_32x32x16_bf16 v[80:95], a[64:67], a[184:187], v[80:95]
ds_read_b64_tr_b16 a[164:165], v51 offset:20480
ds_read_b64_tr_b16 a[166:167], v51 offset:20992
v_mfma_f32_32x32x16_bf16 v[96:111], a[64:67], a[188:191], v[96:111]
ds_read_b64_tr_b16 a[168:169], v49 offset:28672
ds_read_b64_tr_b16 a[170:171], v49 offset:29184
buffer_load_dwordx4 v54, s[28:31], s80 offen offset:2048 lds
buffer_store_dwordx4 v[212:215], v15, s[24:27], s77 offen offset:0 sc1
buffer_store_dwordx4 v[216:219], v15, s[24:27], s77 offen offset:128 sc1
v_mfma_f32_32x32x16_bf16 v[112:127], a[64:67], a[192:195], v[112:127]
ds_read_b64_tr_b16 a[172:173], v51 offset:28672
ds_read_b64_tr_b16 a[174:175], v51 offset:29184
buffer_store_dwordx4 a[224:227], v28, s[24:27], s74 offen sc1
s_waitcnt lgkmcnt(8)
v_mfma_f32_32x32x16_bf16 v[64:79], a[68:71], a[200:203], v[64:79]
ds_read_b64_tr_b16 a[180:181], v49 offset:22528
ds_read_b64_tr_b16 a[182:183], v49 offset:23040
s_waitcnt vmcnt(22)
ds_read_b128 a[80:83], v60 offset:32768
v_mfma_f32_32x32x16_bf16 v[80:95], a[68:71], a[204:207], v[80:95]
ds_read_b64_tr_b16 a[184:185], v51 offset:22528
ds_read_b64_tr_b16 a[186:187], v51 offset:23040
ds_read_b128 a[84:87], v61 offset:32768
buffer_load_dwordx4 v55, s[28:31], s80 offen offset:3072 lds
v_mfma_f32_32x32x16_bf16 v[96:111], a[68:71], a[208:211], v[96:111]
ds_read_b64_tr_b16 a[188:189], v49 offset:30720
ds_read_b64_tr_b16 a[190:191], v49 offset:31232
ds_read_b128 a[88:91], v62 offset:32768
v_mfma_f32_32x32x16_bf16 v[112:127], a[68:71], a[212:215], v[112:127]
ds_read_b64_tr_b16 a[192:193], v51 offset:30720
ds_read_b64_tr_b16 a[194:195], v51 offset:31232
ds_read_b128 a[92:95], v63 offset:32768
s_waitcnt lgkmcnt(12)
v_mfma_f32_32x32x16_bf16 v[64:79], a[72:75], a[160:163], v[64:79]
s_waitcnt vmcnt(19)
s_barrier
ds_read_b64_tr_b16 a[200:201], v48 offset:0
ds_read_b64_tr_b16 a[202:203], v48 offset:512
buffer_store_dwordx4 a[228:231], v28, s[24:27], s75 offen sc1
v_mfma_f32_32x32x16_bf16 v[80:95], a[72:75], a[164:167], v[80:95]
ds_read_b64_tr_b16 a[204:205], v50 offset:0
ds_read_b64_tr_b16 a[206:207], v50 offset:512
s_add_u32 m0, s84, 16384
s_bfe_u32 s83, s55, 0x40014
s_mul_i32 s83, s83, 128
v_mfma_f32_32x32x16_bf16 v[96:111], a[72:75], a[168:171], v[96:111]
ds_read_b64_tr_b16 a[208:209], v48 offset:8192
ds_read_b64_tr_b16 a[210:211], v48 offset:8704
buffer_load_dwordx4 v56, s[36:39], s83 offen lds
v_mfma_f32_32x32x16_bf16 v[112:127], a[72:75], a[172:175], v[112:127]
ds_read_b64_tr_b16 a[212:213], v50 offset:8192
ds_read_b64_tr_b16 a[214:215], v50 offset:8704
s_waitcnt lgkmcnt(9)
v_mfma_f32_32x32x16_bf16 v[64:79], a[76:79], a[180:183], v[64:79]
ds_read_b64_tr_b16 a[160:161], v48 offset:2048
ds_read_b64_tr_b16 a[162:163], v48 offset:2560
v_mfma_f32_32x32x16_bf16 v[80:95], a[76:79], a[184:187], v[80:95]
ds_read_b64_tr_b16 a[164:165], v50 offset:2048
ds_read_b64_tr_b16 a[166:167], v50 offset:2560
buffer_load_dwordx4 v57, s[36:39], s83 offen offset:1024 lds
buffer_store_dwordx4 a[232:235], v28, s[24:27], s76 offen sc1
v_mfma_f32_32x32x16_bf16 v[96:111], a[76:79], a[188:191], v[96:111]
ds_read_b64_tr_b16 a[168:169], v48 offset:10240
ds_read_b64_tr_b16 a[170:171], v48 offset:10752
v_mfma_f32_32x32x16_bf16 v[112:127], a[76:79], a[192:195], v[112:127]
ds_read_b64_tr_b16 a[172:173], v50 offset:10240
ds_read_b64_tr_b16 a[174:175], v50 offset:10752
buffer_load_dwordx4 v58, s[36:39], s83 offen offset:2048 lds
s_waitcnt lgkmcnt(8)
v_mfma_f32_32x32x16_bf16 v[64:79], a[80:83], a[200:203], v[64:79]
ds_read_b64_tr_b16 a[180:181], v48 offset:4096
ds_read_b64_tr_b16 a[182:183], v48 offset:4608
buffer_load_dword v222, v11, s[24:27], s69 offen offset:0 sc1
v_mfma_f32_32x32x16_bf16 v[80:95], a[80:83], a[204:207], v[80:95]
ds_read_b64_tr_b16 a[184:185], v50 offset:4096
ds_read_b64_tr_b16 a[186:187], v50 offset:4608
buffer_load_dwordx4 v59, s[36:39], s83 offen offset:3072 lds
v_mfma_f32_32x32x16_bf16 v[96:111], a[80:83], a[208:211], v[96:111]
ds_read_b64_tr_b16 a[188:189], v48 offset:12288
ds_read_b64_tr_b16 a[190:191], v48 offset:12800
s_add_u32 m0, s84, 98304
s_bfe_u32 s80, s55, 0x40014
s_mul_i32 s80, s80, 245760
v_mfma_f32_32x32x16_bf16 v[112:127], a[80:83], a[212:215], v[112:127]
ds_read_b64_tr_b16 a[192:193], v50 offset:12288
ds_read_b64_tr_b16 a[194:195], v50 offset:12800
buffer_load_dwordx4 v52, s[28:31], s80 offen lds
s_waitcnt lgkmcnt(8)
v_mfma_f32_32x32x16_bf16 v[64:79], a[84:87], a[160:163], v[64:79]
ds_read_b64_tr_b16 a[200:201], v48 offset:6144
ds_read_b64_tr_b16 a[202:203], v48 offset:6656
v_mfma_f32_32x32x16_bf16 v[80:95], a[84:87], a[164:167], v[80:95]
ds_read_b64_tr_b16 a[204:205], v50 offset:6144
ds_read_b64_tr_b16 a[206:207], v50 offset:6656
v_mfma_f32_32x32x16_bf16 v[96:111], a[84:87], a[168:171], v[96:111]
ds_read_b64_tr_b16 a[208:209], v48 offset:14336
ds_read_b64_tr_b16 a[210:211], v48 offset:14848
buffer_load_dwordx4 v53, s[28:31], s80 offen offset:1024 lds
v_mfma_f32_32x32x16_bf16 v[112:127], a[84:87], a[172:175], v[112:127]
ds_read_b64_tr_b16 a[212:213], v50 offset:14336
ds_read_b64_tr_b16 a[214:215], v50 offset:14848
s_waitcnt lgkmcnt(8)
v_mfma_f32_32x32x16_bf16 v[64:79], a[88:91], a[180:183], v[64:79]
s_waitcnt vmcnt(22)
s_barrier
ds_read_b64_tr_b16 a[160:161], v29 offset:16384
ds_read_b64_tr_b16 a[162:163], v29 offset:16896
buffer_load_dwordx4 v54, s[28:31], s80 offen offset:2048 lds
v_mfma_f32_32x32x16_bf16 v[80:95], a[88:91], a[184:187], v[80:95]
ds_read_b64_tr_b16 a[164:165], v6 offset:16384
ds_read_b64_tr_b16 a[166:167], v6 offset:16896
v_mfma_f32_32x32x16_bf16 v[96:111], a[88:91], a[188:191], v[96:111]
ds_read_b64_tr_b16 a[168:169], v29 offset:24576
ds_read_b64_tr_b16 a[170:171], v29 offset:25088
buffer_load_dwordx4 v55, s[28:31], s80 offen offset:3072 lds
v_mfma_f32_32x32x16_bf16 v[112:127], a[88:91], a[192:195], v[112:127]
ds_read_b64_tr_b16 a[172:173], v6 offset:24576
ds_read_b64_tr_b16 a[174:175], v6 offset:25088
s_add_u32 m0, s84, 32768
s_bfe_u32 s83, s55, 0x40018
s_mul_i32 s83, s83, 128
s_waitcnt lgkmcnt(8)
v_mfma_f32_32x32x16_bf16 v[64:79], a[92:95], a[200:203], v[64:79]
ds_read_b64_tr_b16 a[180:181], v29 offset:18432
ds_read_b64_tr_b16 a[182:183], v29 offset:18944
buffer_load_dwordx4 v56, s[36:39], s83 offen lds
v_mfma_f32_32x32x16_bf16 v[80:95], a[92:95], a[204:207], v[80:95]
ds_read_b64_tr_b16 a[184:185], v6 offset:18432
ds_read_b64_tr_b16 a[186:187], v6 offset:18944
v_mfma_f32_32x32x16_bf16 v[96:111], a[92:95], a[208:211], v[96:111]
ds_read_b64_tr_b16 a[188:189], v29 offset:26624
ds_read_b64_tr_b16 a[190:191], v29 offset:27136
v_mfma_f32_32x32x16_bf16 v[112:127], a[92:95], a[212:215], v[112:127]
ds_read_b64_tr_b16 a[192:193], v6 offset:26624
ds_read_b64_tr_b16 a[194:195], v6 offset:27136
buffer_load_dwordx4 v57, s[36:39], s83 offen offset:1024 lds
s_waitcnt lgkmcnt(8)
v_mfma_f32_32x32x16_bf16 v[128:143], a[160:163], a[48:51], v[128:143]
ds_read_b64_tr_b16 a[200:201], v29 offset:20480
ds_read_b64_tr_b16 a[202:203], v29 offset:20992
v_mfma_f32_32x32x16_bf16 v[144:159], a[164:167], a[48:51], v[144:159]
ds_read_b64_tr_b16 a[204:205], v6 offset:20480
ds_read_b64_tr_b16 a[206:207], v6 offset:20992
buffer_load_dwordx4 v58, s[36:39], s83 offen offset:2048 lds
v_mfma_f32_32x32x16_bf16 v[160:175], a[168:171], a[48:51], v[160:175]
ds_read_b64_tr_b16 a[208:209], v29 offset:28672
ds_read_b64_tr_b16 a[210:211], v29 offset:29184
v_mfma_f32_32x32x16_bf16 v[176:191], a[172:175], a[48:51], v[176:191]
ds_read_b64_tr_b16 a[212:213], v6 offset:28672
ds_read_b64_tr_b16 a[214:215], v6 offset:29184
buffer_load_dwordx4 v59, s[36:39], s83 offen offset:3072 lds
s_waitcnt lgkmcnt(8)
v_mfma_f32_32x32x16_bf16 v[128:143], a[180:183], a[52:55], v[128:143]
ds_read_b64_tr_b16 a[160:161], v29 offset:22528
ds_read_b64_tr_b16 a[162:163], v29 offset:23040
s_waitcnt vmcnt(24)
ds_read_b128 a[96:99], v60 offset:0
v_mfma_f32_32x32x16_bf16 v[144:159], a[184:187], a[52:55], v[144:159]
ds_read_b64_tr_b16 a[164:165], v6 offset:22528
ds_read_b64_tr_b16 a[166:167], v6 offset:23040
ds_read_b128 a[100:103], v61 offset:0
v_mfma_f32_32x32x16_bf16 v[160:175], a[188:191], a[52:55], v[160:175]
ds_read_b64_tr_b16 a[168:169], v29 offset:30720
ds_read_b64_tr_b16 a[170:171], v29 offset:31232
ds_read_b128 a[104:107], v62 offset:0
v_mfma_f32_32x32x16_bf16 v[176:191], a[192:195], a[52:55], v[176:191]
ds_read_b64_tr_b16 a[172:173], v6 offset:30720
ds_read_b64_tr_b16 a[174:175], v6 offset:31232
ds_read_b128 a[108:111], v63 offset:0
s_waitcnt lgkmcnt(12)
v_mfma_f32_32x32x16_bf16 v[128:143], a[200:203], a[56:59], v[128:143]
s_waitcnt vmcnt(11)
s_barrier
ds_read_b64_tr_b16 a[180:181], v48 offset:32768
ds_read_b64_tr_b16 a[182:183], v48 offset:33280
s_waitcnt vmcnt(9)
v_cmp_ne_u32 vcc, s56, v222
s_cbranch_vccnz L_sp5_slow
L_sp5_back:
v_mfma_f32_32x32x16_bf16 v[144:159], a[204:207], a[56:59], v[144:159]
ds_read_b64_tr_b16 a[184:185], v50 offset:32768
ds_read_b64_tr_b16 a[186:187], v50 offset:33280
s_add_u32 m0, s84, 114688
s_bfe_u32 s80, s55, 0x40018
s_mul_i32 s80, s80, 245760
buffer_store_dword v247, v43, s[24:27], 0 offen sc1
v_mfma_f32_32x32x16_bf16 v[160:175], a[208:211], a[56:59], v[160:175]
ds_read_b64_tr_b16 a[188:189], v48 offset:40960
ds_read_b64_tr_b16 a[190:191], v48 offset:41472
buffer_load_dwordx4 v52, s[28:31], s80 offen lds
buffer_load_dword v192, v14, s[24:27], s6 offen offset:0 sc1
v_mfma_f32_32x32x16_bf16 v[176:191], a[212:215], a[56:59], v[176:191]
ds_read_b64_tr_b16 a[192:193], v50 offset:40960
ds_read_b64_tr_b16 a[194:195], v50 offset:41472
buffer_load_dword v193, v14, s[24:27], s6 offen offset:512 sc1
v_lshrrev_b32 v235, 4, v30
s_waitcnt lgkmcnt(9)
v_mfma_f32_32x32x16_bf16 v[128:143], a[160:163], a[60:63], v[128:143]
ds_read_b64_tr_b16 a[200:201], v48 offset:34816
ds_read_b64_tr_b16 a[202:203], v48 offset:35328
buffer_load_dword v194, v14, s[24:27], s6 offen offset:1024 sc1
v_lshlrev_b32 v236, 2, v45
s_lshl_b32 s59, s54, 3
v_mfma_f32_32x32x16_bf16 v[144:159], a[164:167], a[60:63], v[144:159]
ds_read_b64_tr_b16 a[204:205], v50 offset:34816
ds_read_b64_tr_b16 a[206:207], v50 offset:35328
buffer_load_dwordx4 v53, s[28:31], s80 offen offset:1024 lds
buffer_load_dword v195, v14, s[24:27], s6 offen offset:1536 sc1
v_mfma_f32_32x32x16_bf16 v[160:175], a[168:171], a[60:63], v[160:175]
ds_read_b64_tr_b16 a[208:209], v48 offset:43008
ds_read_b64_tr_b16 a[210:211], v48 offset:43520
buffer_load_dword v196, v14, s[24:27], s6 offen offset:2048 sc1
v_sub_u32 v235, v235, v236
v_subrev_u32 v235, s59, v235
v_mfma_f32_32x32x16_bf16 v[176:191], a[172:175], a[60:63], v[176:191]
ds_read_b64_tr_b16 a[212:213], v50 offset:43008
ds_read_b64_tr_b16 a[214:215], v50 offset:43520
buffer_load_dwordx4 v54, s[28:31], s80 offen offset:2048 lds
v_mov_b32 v238, 0xff800000
s_waitcnt lgkmcnt(8)
v_mfma_f32_32x32x16_bf16 v[64:79], a[96:99], a[180:183], v[64:79]
ds_read_b64_tr_b16 a[160:161], v48 offset:36864
ds_read_b64_tr_b16 a[162:163], v48 offset:37376
buffer_load_dword v197, v14, s[24:27], s6 offen offset:2560 sc1
v_cmp_le_i32 vcc, 0, v235
v_cmp_le_i32_e64 s[88:89], 1, v235
v_mfma_f32_32x32x16_bf16 v[80:95], a[96:99], a[184:187], v[80:95]
ds_read_b64_tr_b16 a[164:165], v50 offset:36864
ds_read_b64_tr_b16 a[166:167], v50 offset:37376
buffer_load_dwordx4 v55, s[28:31], s80 offen offset:3072 lds
buffer_load_dword v198, v14, s[24:27], s6 offen offset:3072 sc1
v_mfma_f32_32x32x16_bf16 v[96:111], a[96:99], a[188:191], v[96:111]
ds_read_b64_tr_b16 a[168:169], v48 offset:45056
ds_read_b64_tr_b16 a[170:171], v48 offset:45568
s_add_u32 m0, s84, 0
s_bfe_u32 s83, s55, 0x4001c
s_mul_i32 s83, s83, 128
v_cndmask_b32_e64 v208, v238, 0, vcc
v_mfma_f32_32x32x16_bf16 v[112:127], a[96:99], a[192:195], v[112:127]
ds_read_b64_tr_b16 a[172:173], v50 offset:45056
ds_read_b64_tr_b16 a[174:175], v50 offset:45568
buffer_load_dwordx4 v56, s[36:39], s83 offen lds
v_cndmask_b32_e64 v204, 0, v238, vcc
s_waitcnt lgkmcnt(8)
v_mfma_f32_32x32x16_bf16 v[64:79], a[100:103], a[200:203], v[64:79]
ds_read_b64_tr_b16 a[180:181], v48 offset:38912
ds_read_b64_tr_b16 a[182:183], v48 offset:39424
s_waitcnt vmcnt(21)
ds_read_b128 a[112:115], v60 offset:16384
v_cndmask_b32_e64 v209, v238, 0, s[88:89]
v_mfma_f32_32x32x16_bf16 v[80:95], a[100:103], a[204:207], v[80:95]
ds_read_b64_tr_b16 a[184:185], v50 offset:38912
ds_read_b64_tr_b16 a[186:187], v50 offset:39424
ds_read_b128 a[116:119], v61 offset:16384
buffer_load_dword v199, v14, s[24:27], s6 offen offset:3584 sc1
v_mfma_f32_32x32x16_bf16 v[96:111], a[100:103], a[208:211], v[96:111]
ds_read_b64_tr_b16 a[188:189], v48 offset:47104
ds_read_b64_tr_b16 a[190:191], v48 offset:47616
ds_read_b128 a[120:123], v62 offset:16384
buffer_load_dwordx4 v57, s[36:39], s83 offen offset:1024 lds
v_mfma_f32_32x32x16_bf16 v[112:127], a[100:103], a[212:215], v[112:127]
ds_read_b64_tr_b16 a[192:193], v50 offset:47104
ds_read_b64_tr_b16 a[194:195], v50 offset:47616
ds_read_b128 a[124:127], v63 offset:16384
v_cndmask_b32_e64 v205, 0, v238, s[88:89]
s_waitcnt lgkmcnt(12)
v_mfma_f32_32x32x16_bf16 v[64:79], a[104:107], a[160:163], v[64:79]
s_waitcnt vmcnt(19)
s_barrier
ds_read_b64_tr_b16 a[200:201], v48 offset:49152
ds_read_b64_tr_b16 a[202:203], v48 offset:49664
buffer_load_dwordx4 v58, s[36:39], s83 offen offset:2048 lds
v_mfma_f32_32x32x16_bf16 v[80:95], a[104:107], a[164:167], v[80:95]
ds_read_b64_tr_b16 a[204:205], v50 offset:49152
ds_read_b64_tr_b16 a[206:207], v50 offset:49664
v_cmp_le_i32 vcc, 2, v235
v_cmp_le_i32_e64 s[88:89], 3, v235
s_nop 0
v_cndmask_b32_e64 v210, v238, 0, vcc
v_cndmask_b32_e64 v206, 0, v238, vcc
v_mfma_f32_32x32x16_bf16 v[96:111], a[104:107], a[168:171], v[96:111]
ds_read_b64_tr_b16 a[208:209], v48 offset:57344
ds_read_b64_tr_b16 a[210:211], v48 offset:57856
buffer_load_dwordx4 v59, s[36:39], s83 offen offset:3072 lds
v_cndmask_b32_e64 v211, v238, 0, s[88:89]
v_cndmask_b32_e64 v207, 0, v238, s[88:89]
buffer_load_dwordx2 v[220:221], v31, s[24:27], s66 offen offset:0 sc1
v_mfma_f32_32x32x16_bf16 v[112:127], a[104:107], a[172:175], v[112:127]
ds_read_b64_tr_b16 a[212:213], v50 offset:57344
ds_read_b64_tr_b16 a[214:215], v50 offset:57856
s_add_u32 m0, s84, 131072
s_bfe_u32 s80, s55, 0x4001c
s_mul_i32 s80, s80, 245760
s_waitcnt lgkmcnt(9)
v_mfma_f32_32x32x16_bf16 v[64:79], a[108:111], a[180:183], v[64:79]
ds_read_b64_tr_b16 a[160:161], v48 offset:51200
ds_read_b64_tr_b16 a[162:163], v48 offset:51712
buffer_load_dwordx4 v52, s[28:31], s80 offen lds
s_lshr_b32 s59, s84, 2
s_add_u32 s59, s59, 155648
v_mfma_f32_32x32x16_bf16 v[80:95], a[108:111], a[184:187], v[80:95]
ds_read_b64_tr_b16 a[164:165], v50 offset:51200
ds_read_b64_tr_b16 a[166:167], v50 offset:51712
v_add_u32 v236, s59, v2
ds_write_b128 v236, v[204:207]
ds_write_b128 v236, v[208:211] offset:4096
v_mfma_f32_32x32x16_bf16 v[96:111], a[108:111], a[188:191], v[96:111]
ds_read_b64_tr_b16 a[168:169], v48 offset:59392
ds_read_b64_tr_b16 a[170:171], v48 offset:59904
v_mfma_f32_32x32x16_bf16 v[112:127], a[108:111], a[192:195], v[112:127]
ds_read_b64_tr_b16 a[172:173], v50 offset:59392
ds_read_b64_tr_b16 a[174:175], v50 offset:59904
buffer_load_dwordx4 v53, s[28:31], s80 offen offset:1024 lds
s_waitcnt lgkmcnt(10)
v_mfma_f32_32x32x16_bf16 v[64:79], a[112:115], a[200:203], v[64:79]
ds_read_b64_tr_b16 a[180:181], v48 offset:53248
ds_read_b64_tr_b16 a[182:183], v48 offset:53760
v_mfma_f32_32x32x16_bf16 v[80:95], a[112:115], a[204:207], v[80:95]
ds_read_b64_tr_b16 a[184:185], v50 offset:53248
ds_read_b64_tr_b16 a[186:187], v50 offset:53760
buffer_load_dwordx4 v54, s[28:31], s80 offen offset:2048 lds
v_mfma_f32_32x32x16_bf16 v[96:111], a[112:115], a[208:211], v[96:111]
ds_read_b64_tr_b16 a[188:189], v48 offset:61440
ds_read_b64_tr_b16 a[190:191], v48 offset:61952
v_mfma_f32_32x32x16_bf16 v[112:127], a[112:115], a[212:215], v[112:127]
ds_read_b64_tr_b16 a[192:193], v50 offset:61440
ds_read_b64_tr_b16 a[194:195], v50 offset:61952
buffer_load_dwordx4 v55, s[28:31], s80 offen offset:3072 lds
s_waitcnt lgkmcnt(8)
v_mfma_f32_32x32x16_bf16 v[64:79], a[116:119], a[160:163], v[64:79]
ds_read_b64_tr_b16 a[200:201], v48 offset:55296
ds_read_b64_tr_b16 a[202:203], v48 offset:55808
s_waitcnt vmcnt(22)
ds_read_b128 a[128:131], v60 offset:32768
v_lshlrev_b32 v212, 3, v1
v_mfma_f32_32x32x16_bf16 v[80:95], a[116:119], a[164:167], v[80:95]
ds_read_b64_tr_b16 a[204:205], v50 offset:55296
ds_read_b64_tr_b16 a[206:207], v50 offset:55808
ds_read_b128 a[132:135], v61 offset:32768
v_add_u32 v212, 147456, v212
s_lshl_b32 s60, s54, 9
v_mfma_f32_32x32x16_bf16 v[96:111], a[116:119], a[168:171], v[96:111]
ds_read_b64_tr_b16 a[208:209], v48 offset:63488
ds_read_b64_tr_b16 a[210:211], v48 offset:64000
ds_read_b128 a[136:139], v62 offset:32768
v_add_u32 v213, s60, v212
v_mfma_f32_32x32x16_bf16 v[112:127], a[116:119], a[172:175], v[112:127]
ds_read_b64_tr_b16 a[212:213], v50 offset:63488
ds_read_b64_tr_b16 a[214:215], v50 offset:64000
ds_read_b128 a[140:143], v63 offset:32768
s_waitcnt lgkmcnt(12)
v_mfma_f32_32x32x16_bf16 v[64:79], a[120:123], a[180:183], v[64:79]
s_waitcnt vmcnt(11)
s_barrier
ds_read_b64_tr_b16 a[160:161], v49 offset:0
ds_read_b64_tr_b16 a[162:163], v49 offset:512
s_waitcnt vmcnt(8)
v_add_f32 v192, v192, v197
v_mfma_f32_32x32x16_bf16 v[80:95], a[120:123], a[184:187], v[80:95]
ds_read_b64_tr_b16 a[164:165], v51 offset:0
ds_read_b64_tr_b16 a[166:167], v51 offset:512
s_add_u32 m0, s84, 49152
s_bfe_u32 s81, s55, 0x40008
s_mul_i32 s81, s81, 196608
v_add_f32 v193, v193, v198
v_mfma_f32_32x32x16_bf16 v[96:111], a[120:123], a[188:191], v[96:111]
ds_read_b64_tr_b16 a[168:169], v49 offset:8192
ds_read_b64_tr_b16 a[170:171], v49 offset:8704
buffer_load_dwordx4 v16, s[32:35], s81 offen lds
v_add_f32 v194, v194, v199
v_add_f32 v192, v192, v193
v_mfma_f32_32x32x16_bf16 v[112:127], a[120:123], a[192:195], v[112:127]
ds_read_b64_tr_b16 a[172:173], v51 offset:8192
ds_read_b64_tr_b16 a[174:175], v51 offset:8704
v_add_f32 v194, v194, v195
v_add_f32 v192, v192, v196
v_add_f32 v192, v192, v194
s_waitcnt lgkmcnt(9)
v_mfma_f32_32x32x16_bf16 v[64:79], a[124:127], a[200:203], v[64:79]
ds_read_b64_tr_b16 a[180:181], v49 offset:2048
ds_read_b64_tr_b16 a[182:183], v49 offset:2560
v_cvt_pk_bf16_f32 v193, v192, v192
v_and_b32 v193, 0xffff0000, v193
v_sub_f32 v193, v192, v193
v_cvt_pk_bf16_f32 v194, v192, v193
v_mfma_f32_32x32x16_bf16 v[80:95], a[124:127], a[204:207], v[80:95]
ds_read_b64_tr_b16 a[184:185], v51 offset:2048
ds_read_b64_tr_b16 a[186:187], v51 offset:2560
buffer_load_dwordx4 v17, s[32:35], s81 offen offset:1024 lds
v_and_b32 v196, 0xffff0000, v194
v_sub_f32 v193, v193, v196
v_mfma_f32_32x32x16_bf16 v[96:111], a[124:127], a[208:211], v[96:111]
ds_read_b64_tr_b16 a[188:189], v49 offset:10240
ds_read_b64_tr_b16 a[190:191], v49 offset:10752
v_cvt_pk_bf16_f32 v195, v193, 0
ds_write_b64 v213, v[194:195] offset:0
v_mfma_f32_32x32x16_bf16 v[112:127], a[124:127], a[212:215], v[112:127]
ds_read_b64_tr_b16 a[192:193], v51 offset:10240
ds_read_b64_tr_b16 a[194:195], v51 offset:10752
buffer_load_dwordx4 v18, s[32:35], s81 offen offset:2048 lds
s_waitcnt lgkmcnt(9)
v_mfma_f32_32x32x16_bf16 v[64:79], a[128:131], a[160:163], v[64:79]
ds_read_b64_tr_b16 a[200:201], v49 offset:4096
ds_read_b64_tr_b16 a[202:203], v49 offset:4608
v_mfma_f32_32x32x16_bf16 v[80:95], a[128:131], a[164:167], v[80:95]
ds_read_b64_tr_b16 a[204:205], v51 offset:4096
ds_read_b64_tr_b16 a[206:207], v51 offset:4608
buffer_load_dwordx4 v19, s[32:35], s81 offen offset:3072 lds
v_mfma_f32_32x32x16_bf16 v[96:111], a[128:131], a[168:171], v[96:111]
ds_read_b64_tr_b16 a[208:209], v49 offset:12288
ds_read_b64_tr_b16 a[210:211], v49 offset:12800
s_add_u32 m0, s84, 65536
s_bfe_u32 s81, s55, 0x4000c
s_mul_i32 s81, s81, 196608
s_waitcnt vmcnt(8)
v_cmp_ne_u32 vcc, s56, v221
s_cbranch_vccnz L_sp4_slow
L_sp4_back:
v_mfma_f32_32x32x16_bf16 v[112:127], a[128:131], a[172:175], v[112:127]
ds_read_b64_tr_b16 a[212:213], v51 offset:12288
ds_read_b64_tr_b16 a[214:215], v51 offset:12800
buffer_load_dwordx4 v16, s[32:35], s81 offen lds
v_and_b32 v235, 0xffff0000, v220
v_and_b32 v23, 0xffff, v220
s_waitcnt lgkmcnt(8)
v_mfma_f32_32x32x16_bf16 v[64:79], a[132:135], a[180:183], v[64:79]
ds_read_b64_tr_b16 a[160:161], v49 offset:6144
ds_read_b64_tr_b16 a[162:163], v49 offset:6656
ds_read_b128 a[144:147], v60 offset:0
v_rcp_f32 v236, v235
v_mfma_f32_32x32x16_bf16 v[80:95], a[132:135], a[184:187], v[80:95]
ds_read_b64_tr_b16 a[164:165], v51 offset:6144
ds_read_b64_tr_b16 a[166:167], v51 offset:6656
ds_read_b128 a[148:151], v61 offset:0
v_xor_b32 v23, 0x8000, v23
v_mul_f32 v26, v235, v235
v_lshl_or_b32 v22, v23, 16, v23
v_mfma_f32_32x32x16_bf16 v[96:111], a[132:135], a[188:191], v[96:111]
ds_read_b64_tr_b16 a[168:169], v49 offset:14336
ds_read_b64_tr_b16 a[170:171], v49 offset:14848
ds_read_b128 a[152:155], v62 offset:0
buffer_load_dwordx4 v17, s[32:35], s81 offen offset:1024 lds
v_mul_f32 v237, s8, v236
v_mfma_f32_32x32x16_bf16 v[112:127], a[132:135], a[192:195], v[112:127]
ds_read_b64_tr_b16 a[172:173], v51 offset:14336
ds_read_b64_tr_b16 a[174:175], v51 offset:14848
ds_read_b128 a[156:159], v63 offset:0
v_mul_f32 v24, 0xc0135761, v236
v_mul_f32 v25, v236, v236
s_waitcnt lgkmcnt(12)
v_mfma_f32_32x32x16_bf16 v[64:79], a[136:139], a[200:203], v[64:79]
s_waitcnt vmcnt(6)
s_barrier
ds_read_b64_tr_b16 a[180:181], v49 offset:16384
ds_read_b64_tr_b16 a[182:183], v49 offset:16896
buffer_load_dwordx4 v18, s[32:35], s81 offen offset:2048 lds
s_lshr_b32 s59, s84, 5
v_mfma_f32_32x32x16_bf16 v[80:95], a[136:139], a[204:207], v[80:95]
ds_read_b64_tr_b16 a[184:185], v51 offset:16384
ds_read_b64_tr_b16 a[186:187], v51 offset:16896
ds_read_b64 a[240:241], v212 offset:0
ds_read_b64 a[242:243], v212 offset:512
ds_read_b64 a[244:245], v212 offset:1024
ds_read_b64 a[246:247], v212 offset:1536
v_mfma_f32_32x32x16_bf16 v[96:111], a[136:139], a[208:211], v[96:111]
ds_read_b64_tr_b16 a[188:189], v49 offset:24576
ds_read_b64_tr_b16 a[190:191], v49 offset:25088
buffer_load_dwordx4 v19, s[32:35], s81 offen offset:3072 lds
s_add_u32 s59, s59, 153600
v_lshrrev_b32 v235, 2, v30
v_add_u32 v235, s59, v235
v_mfma_f32_32x32x16_bf16 v[112:127], a[136:139], a[212:215], v[112:127]
ds_read_b64_tr_b16 a[192:193], v51 offset:24576
ds_read_b64_tr_b16 a[194:195], v51 offset:25088
s_add_u32 m0, s84, 81920
s_bfe_u32 s81, s55, 0x40010
s_mul_i32 s81, s81, 196608
s_waitcnt lgkmcnt(13)
v_mfma_f32_32x32x16_bf16 v[64:79], a[140:143], a[160:163], v[64:79]
ds_read_b64_tr_b16 a[200:201], v49 offset:18432
ds_read_b64_tr_b16 a[202:203], v49 offset:18944
buffer_load_dwordx4 v16, s[32:35], s81 offen lds
ds_write_b32 v235, v237
v_mul_f32 v25, v25, v236
buffer_load_dword v222, v2, s[24:27], s68 offen offset:0 sc1
v_mfma_f32_32x32x16_bf16 v[80:95], a[140:143], a[164:167], v[80:95]
ds_read_b64_tr_b16 a[204:205], v51 offset:18432
ds_read_b64_tr_b16 a[206:207], v51 offset:18944
v_lshlrev_b32 v235, 4, v45
v_add_u32 v235, s59, v235
v_mul_f32 v25, 0xbdd2d3e8, v25
ds_read_b128 v[32:35], v235 offset:0
v_mfma_f32_32x32x16_bf16 v[96:111], a[140:143], a[168:171], v[96:111]
ds_read_b64_tr_b16 a[208:209], v49 offset:26624
ds_read_b64_tr_b16 a[210:211], v49 offset:27136
ds_read_b128 v[36:39], v235 offset:32
ds_read_b128 v[40:43], v235 offset:64
ds_read_b128 v[44:47], v235 offset:96
v_mfma_f32_32x32x16_bf16 v[112:127], a[140:143], a[172:175], v[112:127]
ds_read_b64_tr_b16 a[212:213], v51 offset:26624
ds_read_b64_tr_b16 a[214:215], v51 offset:27136
buffer_load_dwordx4 v17, s[32:35], s81 offen offset:1024 lds
s_cmp_ge_u32 s53, 10
s_cselect_b64 vcc, -1, 0
s_waitcnt lgkmcnt(13)
v_mfma_f32_32x32x16_bf16 v[64:79], a[144:147], a[180:183], v[64:79]
ds_read_b64_tr_b16 a[160:161], v49 offset:20480
ds_read_b64_tr_b16 a[162:163], v49 offset:20992
s_waitcnt lgkmcnt(4)
v_cndmask_b32 v32, v237, v32, vcc
v_cndmask_b32 v33, v237, v33, vcc
v_cndmask_b32 v34, v237, v34, vcc
v_cndmask_b32 v35, v237, v35, vcc
v_mfma_f32_32x32x16_bf16 v[80:95], a[144:147], a[184:187], v[80:95]
ds_read_b64_tr_b16 a[164:165], v51 offset:20480
ds_read_b64_tr_b16 a[166:167], v51 offset:20992
buffer_load_dwordx4 v18, s[32:35], s81 offen offset:2048 lds
v_cndmask_b32 v36, v237, v36, vcc
v_cndmask_b32 v37, v237, v37, vcc
v_cndmask_b32 v38, v237, v38, vcc
v_mfma_f32_32x32x16_bf16 v[96:111], a[144:147], a[188:191], v[96:111]
ds_read_b64_tr_b16 a[168:169], v49 offset:28672
ds_read_b64_tr_b16 a[170:171], v49 offset:29184
v_cndmask_b32 v39, v237, v39, vcc
v_cndmask_b32 v40, v237, v40, vcc
v_cndmask_b32 v41, v237, v41, vcc
v_cndmask_b32 v42, v237, v42, vcc
v_cndmask_b32 v43, v237, v43, vcc
v_mfma_f32_32x32x16_bf16 v[112:127], a[144:147], a[192:195], v[112:127]
ds_read_b64_tr_b16 a[172:173], v51 offset:28672
ds_read_b64_tr_b16 a[174:175], v51 offset:29184
buffer_load_dwordx4 v19, s[32:35], s81 offen offset:3072 lds
v_cndmask_b32 v44, v237, v44, vcc
v_cndmask_b32 v45, v237, v45, vcc
s_waitcnt lgkmcnt(8)
v_mfma_f32_32x32x16_bf16 v[64:79], a[148:151], a[200:203], v[64:79]
ds_read_b64_tr_b16 a[180:181], v49 offset:22528
ds_read_b64_tr_b16 a[182:183], v49 offset:23040
s_add_u32 m0, s84, 98304
s_bfe_u32 s81, s55, 0x40014
s_mul_i32 s81, s81, 196608
v_cndmask_b32 v46, v237, v46, vcc
v_cndmask_b32 v47, v237, v47, vcc
v_mfma_f32_32x32x16_bf16 v[80:95], a[148:151], a[204:207], v[80:95]
ds_read_b64_tr_b16 a[184:185], v51 offset:22528
ds_read_b64_tr_b16 a[186:187], v51 offset:23040
buffer_load_dwordx4 v16, s[32:35], s81 offen lds
v_mfma_f32_32x32x16_bf16 v[96:111], a[148:151], a[208:211], v[96:111]
ds_read_b64_tr_b16 a[188:189], v49 offset:30720
ds_read_b64_tr_b16 a[190:191], v49 offset:31232
v_mfma_f32_32x32x16_bf16 v[112:127], a[148:151], a[212:215], v[112:127]
ds_read_b64_tr_b16 a[192:193], v51 offset:30720
ds_read_b64_tr_b16 a[194:195], v51 offset:31232
s_waitcnt lgkmcnt(8)
v_mfma_f32_32x32x16_bf16 v[64:79], a[152:155], a[160:163], v[64:79]
s_waitcnt vmcnt(10)
s_barrier
ds_read_b64_tr_b16 a[200:201], v29 offset:0
ds_read_b64_tr_b16 a[202:203], v29 offset:512
buffer_load_dwordx4 v17, s[32:35], s81 offen offset:1024 lds
v_mfma_f32_32x32x16_bf16 v[80:95], a[152:155], a[164:167], v[80:95]
ds_read_b64_tr_b16 a[204:205], v6 offset:0
ds_read_b64_tr_b16 a[206:207], v6 offset:512
v_mfma_f32_32x32x16_bf16 v[96:111], a[152:155], a[168:171], v[96:111]
ds_read_b64_tr_b16 a[208:209], v29 offset:8192
ds_read_b64_tr_b16 a[210:211], v29 offset:8704
buffer_load_dwordx4 v18, s[32:35], s81 offen offset:2048 lds
v_mfma_f32_32x32x16_bf16 v[112:127], a[152:155], a[172:175], v[112:127]
ds_read_b64_tr_b16 a[212:213], v6 offset:8192
ds_read_b64_tr_b16 a[214:215], v6 offset:8704
s_waitcnt lgkmcnt(8)
v_mfma_f32_32x32x16_bf16 v[64:79], a[156:159], a[180:183], v[64:79]
ds_read_b64_tr_b16 a[160:161], v29 offset:2048
ds_read_b64_tr_b16 a[162:163], v29 offset:2560
v_mfma_f32_32x32x8_bf16 v[64:79], v[22:23], a[240:241], v[64:79]
buffer_load_dwordx4 v19, s[32:35], s81 offen offset:3072 lds
v_mfma_f32_32x32x16_bf16 v[80:95], a[156:159], a[184:187], v[80:95]
ds_read_b64_tr_b16 a[164:165], v6 offset:2048
ds_read_b64_tr_b16 a[166:167], v6 offset:2560
v_mfma_f32_32x32x8_bf16 v[80:95], v[22:23], a[242:243], v[80:95]
s_add_u32 m0, s84, 114688
s_bfe_u32 s81, s55, 0x40018
s_mul_i32 s81, s81, 196608
v_mfma_f32_32x32x16_bf16 v[96:111], a[156:159], a[188:191], v[96:111]
ds_read_b64_tr_b16 a[168:169], v29 offset:10240
ds_read_b64_tr_b16 a[170:171], v29 offset:10752
v_mfma_f32_32x32x8_bf16 v[96:111], v[22:23], a[244:245], v[96:111]
buffer_load_dwordx4 v16, s[32:35], s81 offen lds
v_mfma_f32_32x32x16_bf16 v[112:127], a[156:159], a[192:195], v[112:127]
ds_read_b64_tr_b16 a[172:173], v6 offset:10240
ds_read_b64_tr_b16 a[174:175], v6 offset:10752
v_mfma_f32_32x32x8_bf16 v[112:127], v[22:23], a[246:247], v[112:127]
s_nop 0
L_gua:
s_waitcnt lgkmcnt(8)
v_mfma_f32_32x32x16_bf16 v[128:143], a[200:203], a[64:67], v[128:143]
ds_read_b64_tr_b16 a[180:181], v29 offset:4096
ds_read_b64_tr_b16 a[182:183], v29 offset:4608
v_mfma_f32_32x32x16_bf16 v[144:159], a[204:207], a[64:67], v[144:159]
ds_read_b64_tr_b16 a[184:185], v6 offset:4096
ds_read_b64_tr_b16 a[186:187], v6 offset:4608
buffer_load_dwordx4 v17, s[32:35], s81 offen offset:1024 lds
s_cmp_eq_u32 s54, 0
s_cselect_b32 s62, 0, 1073741824
v_or_b32 v255, s62, v246
v_mfma_f32_32x32x16_bf16 v[160:175], a[208:211], a[64:67], v[160:175]
ds_read_b64_tr_b16 a[188:189], v29 offset:12288
ds_read_b64_tr_b16 a[190:191], v29 offset:12800
v_mfma_f32_32x32x16_bf16 v[176:191], a[212:215], a[64:67], v[176:191]
ds_read_b64_tr_b16 a[192:193], v6 offset:12288
ds_read_b64_tr_b16 a[194:195], v6 offset:12800
buffer_load_dwordx4 v18, s[32:35], s81 offen offset:2048 lds
v_mul_f32 v64, v32, v64
s_waitcnt lgkmcnt(8)
v_mfma_f32_32x32x16_bf16 v[128:143], a[160:163], a[68:71], v[128:143]
ds_read_b64_tr_b16 a[200:201], v29 offset:6144
ds_read_b64_tr_b16 a[202:203], v29 offset:6656
s_waitcnt vmcnt(10)
v_cmp_ne_u32 vcc, s56, v222
s_cbranch_vccnz L_sp3_slow
L_sp3_back:
v_mul_f32 v65, v33, v65
v_mfma_f32_32x32x16_bf16 v[144:159], a[164:167], a[68:71], v[144:159]
ds_read_b64_tr_b16 a[204:205], v6 offset:6144
ds_read_b64_tr_b16 a[206:207], v6 offset:6656
buffer_load_dwordx4 v19, s[32:35], s81 offen offset:3072 lds
v_mul_f32 v66, v34, v66
v_mul_f32 v67, v35, v67
s_load_dwordx16 s[64:79], s[90:91], 128
s_load_dwordx4 s[20:23], s[90:91], 208
s_load_dwordx4 s[28:31], s[90:91], 224
s_load_dwordx4 s[48:51], s[90:91], 240
v_mfma_f32_32x32x16_bf16 v[160:175], a[168:171], a[68:71], v[160:175]
ds_read_b64_tr_b16 a[208:209], v29 offset:14336
ds_read_b64_tr_b16 a[210:211], v29 offset:14848
s_add_u32 m0, s84, 131072
s_bfe_u32 s81, s55, 0x4001c
s_mul_i32 s81, s81, 196608
v_mul_f32 v68, v36, v68
v_mfma_f32_32x32x16_bf16 v[176:191], a[172:175], a[68:71], v[176:191]
ds_read_b64_tr_b16 a[212:213], v6 offset:14336
ds_read_b64_tr_b16 a[214:215], v6 offset:14848
v_mul_f32 v69, v37, v69
v_mul_f32 v70, v38, v70
v_mul_f32 v71, v39, v71
s_waitcnt lgkmcnt(8)
v_mfma_f32_32x32x16_bf16 v[128:143], a[180:183], a[72:75], v[128:143]
s_barrier
ds_read_b64_tr_b16 a[160:161], v29 offset:16384
ds_read_b64_tr_b16 a[162:163], v29 offset:16896
v_cvt_pk_bf16_f32 v192, v64, v65
v_cvt_pk_bf16_f32 v193, v66, v67
v_mfma_f32_32x32x16_bf16 v[144:159], a[184:187], a[72:75], v[144:159]
ds_read_b64_tr_b16 a[164:165], v6 offset:16384
ds_read_b64_tr_b16 a[166:167], v6 offset:16896
buffer_load_dwordx4 v16, s[32:35], s81 offen lds
buffer_load_dword v48, v14, s[24:27], s87 offen offset:0 sc1
v_mfma_f32_32x32x16_bf16 v[160:175], a[188:191], a[72:75], v[160:175]
ds_read_b64_tr_b16 a[168:169], v29 offset:24576
ds_read_b64_tr_b16 a[170:171], v29 offset:25088
buffer_load_dword v49, v14, s[24:27], s87 offen offset:512 sc1
v_cvt_pk_bf16_f32 v194, v68, v69
v_cvt_pk_bf16_f32 v195, v70, v71
v_mfma_f32_32x32x16_bf16 v[176:191], a[192:195], a[72:75], v[176:191]
ds_read_b64_tr_b16 a[172:173], v6 offset:24576
ds_read_b64_tr_b16 a[174:175], v6 offset:25088
buffer_load_dwordx4 v17, s[32:35], s81 offen offset:1024 lds
s_waitcnt lgkmcnt(0)
v_mfma_f32_32x32x16_bf16 v[128:143], a[200:203], a[76:79], v[128:143]
ds_read_b64_tr_b16 a[180:181], v29 offset:18432
ds_read_b64_tr_b16 a[182:183], v29 offset:18944
buffer_load_dword v50, v14, s[24:27], s87 offen offset:1024 sc1
buffer_store_dwordx4 v[192:195], v27, s[44:47], s9 offen sc1
v_mfma_f32_32x32x16_bf16 v[144:159], a[204:207], a[76:79], v[144:159]
ds_read_b64_tr_b16 a[184:185], v6 offset:18432
ds_read_b64_tr_b16 a[186:187], v6 offset:18944
buffer_load_dwordx4 v18, s[32:35], s81 offen offset:2048 lds
buffer_load_dword v51, v14, s[24:27], s87 offen offset:1536 sc1
v_mfma_f32_32x32x16_bf16 v[160:175], a[208:211], a[76:79], v[160:175]
ds_read_b64_tr_b16 a[188:189], v29 offset:26624
ds_read_b64_tr_b16 a[190:191], v29 offset:27136
buffer_load_dword v52, v14, s[24:27], s87 offen offset:2048 sc1
v_mul_f32 v72, v40, v72
v_mul_f32 v73, v41, v73
v_mfma_f32_32x32x16_bf16 v[176:191], a[212:215], a[76:79], v[176:191]
ds_read_b64_tr_b16 a[192:193], v6 offset:26624
ds_read_b64_tr_b16 a[194:195], v6 offset:27136
buffer_load_dwordx4 v19, s[32:35], s81 offen offset:3072 lds
s_add_u32 m0, s85, 0
v_mfma_f32_32x32x16_bf16 v[128:143], a[160:163], a[80:83], v[128:143]
ds_read_b64_tr_b16 a[200:201], v29 offset:20480
ds_read_b64_tr_b16 a[202:203], v29 offset:20992
buffer_load_dword v53, v14, s[24:27], s87 offen offset:2560 sc1
v_mul_f32 v74, v42, v74
v_mul_f32 v75, v43, v75
v_mfma_f32_32x32x16_bf16 v[144:159], a[164:167], a[80:83], v[144:159]
ds_read_b64_tr_b16 a[204:205], v6 offset:20480
ds_read_b64_tr_b16 a[206:207], v6 offset:20992
buffer_load_dwordx4 v13, s[24:27], 0 offen sc1 lds
buffer_load_dword v54, v14, s[24:27], s87 offen offset:3072 sc1
v_mfma_f32_32x32x16_bf16 v[160:175], a[168:171], a[80:83], v[160:175]
ds_read_b64_tr_b16 a[208:209], v29 offset:28672
ds_read_b64_tr_b16 a[210:211], v29 offset:29184
buffer_load_dword v55, v14, s[24:27], s87 offen offset:3584 sc1
v_mul_f32 v76, v44, v76
v_mul_f32 v77, v45, v77
v_mfma_f32_32x32x16_bf16 v[176:191], a[172:175], a[80:83], v[176:191]
ds_read_b64_tr_b16 a[212:213], v6 offset:28672
ds_read_b64_tr_b16 a[214:215], v6 offset:29184
buffer_load_dwordx4 v13, s[24:27], 0 offen offset:1024 sc1 lds
v_mul_f32 v78, v46, v78
s_waitcnt lgkmcnt(8)
v_mfma_f32_32x32x16_bf16 v[128:143], a[180:183], a[84:87], v[128:143]
ds_read_b64_tr_b16 a[160:161], v29 offset:22528
ds_read_b64_tr_b16 a[162:163], v29 offset:23040
s_add_u32 m0, s85, 8192
s_bfe_u32 s82, s55, 0x40000
s_mul_i32 s82, s82, 8192
v_mul_f32 v79, v47, v79
v_mfma_f32_32x32x16_bf16 v[144:159], a[184:187], a[84:87], v[144:159]
ds_read_b64_tr_b16 a[164:165], v6 offset:22528
ds_read_b64_tr_b16 a[166:167], v6 offset:23040
buffer_load_dword v58, v14, s[24:27], s7 offen offset:0 sc1
v_cvt_pk_bf16_f32 v196, v72, v73
v_cvt_pk_bf16_f32 v197, v74, v75
v_mfma_f32_32x32x16_bf16 v[160:175], a[188:191], a[84:87], v[160:175]
ds_read_b64_tr_b16 a[168:169], v29 offset:30720
ds_read_b64_tr_b16 a[170:171], v29 offset:31232
buffer_load_dwordx4 v13, s[24:27], s82 offen sc1 lds
buffer_load_dword v59, v14, s[24:27], s7 offen offset:256 sc1
v_mfma_f32_32x32x16_bf16 v[176:191], a[192:195], a[84:87], v[176:191]
ds_read_b64_tr_b16 a[172:173], v6 offset:30720
ds_read_b64_tr_b16 a[174:175], v6 offset:31232
buffer_load_dword v60, v14, s[24:27], s7 offen offset:512 sc1
v_cvt_pk_bf16_f32 v198, v76, v77
s_waitcnt lgkmcnt(8)
v_mfma_f32_32x32x16_bf16 v[128:143], a[200:203], a[88:91], v[128:143]
s_waitcnt vmcnt(27)
s_barrier
ds_read_b64_tr_b16 a[180:181], v29 offset:32768
ds_read_b64_tr_b16 a[182:183], v29 offset:33280
buffer_load_dwordx4 v13, s[24:27], s82 offen offset:1024 sc1 lds
v_mfma_f32_32x32x16_bf16 v[144:159], a[204:207], a[88:91], v[144:159]
ds_read_b64_tr_b16 a[184:185], v6 offset:32768
ds_read_b64_tr_b16 a[186:187], v6 offset:33280
s_add_u32 m0, s85, 16384
s_mov_b32 s82, 8192
buffer_load_dword v61, v14, s[24:27], s7 offen offset:768 sc1
v_mfma_f32_32x32x16_bf16 v[160:175], a[208:211], a[88:91], v[160:175]
ds_read_b64_tr_b16 a[188:189], v29 offset:40960
ds_read_b64_tr_b16 a[190:191], v29 offset:41472
buffer_load_dword v62, v14, s[24:27], s7 offen offset:1024 sc1
v_cvt_pk_bf16_f32 v199, v78, v79
s_add_u32 s58, s9, s11
v_mfma_f32_32x32x16_bf16 v[176:191], a[212:215], a[88:91], v[176:191]
ds_read_b64_tr_b16 a[192:193], v6 offset:40960
ds_read_b64_tr_b16 a[194:195], v6 offset:41472
buffer_load_dwordx4 v13, s[24:27], s82 offen sc1 lds
s_waitcnt lgkmcnt(8)
v_mfma_f32_32x32x16_bf16 v[128:143], a[160:163], a[92:95], v[128:143]
ds_read_b64_tr_b16 a[200:201], v29 offset:34816
ds_read_b64_tr_b16 a[202:203], v29 offset:35328
buffer_load_dword v63, v14, s[24:27], s7 offen offset:1280 sc1
buffer_store_dwordx4 v[196:199], v27, s[44:47], s58 offen sc1
v_mfma_f32_32x32x16_bf16 v[144:159], a[164:167], a[92:95], v[144:159]
ds_read_b64_tr_b16 a[204:205], v6 offset:34816
ds_read_b64_tr_b16 a[206:207], v6 offset:35328
buffer_load_dwordx4 v13, s[24:27], s82 offen offset:1024 sc1 lds
buffer_load_dword v208, v14, s[24:27], s7 offen offset:1536 sc1
v_mfma_f32_32x32x16_bf16 v[160:175], a[168:171], a[92:95], v[160:175]
ds_read_b64_tr_b16 a[208:209], v29 offset:43008
ds_read_b64_tr_b16 a[210:211], v29 offset:43520
s_add_u32 m0, s85, 24576
s_bfe_u32 s82, s55, 0x40004
s_mul_i32 s82, s82, 8192
v_mul_f32 v80, v32, v80
v_mfma_f32_32x32x16_bf16 v[176:191], a[172:175], a[92:95], v[176:191]
ds_read_b64_tr_b16 a[212:213], v6 offset:43008
ds_read_b64_tr_b16 a[214:215], v6 offset:43520
buffer_load_dword v209, v14, s[24:27], s7 offen offset:1792 sc1
v_mul_f32 v81, v33, v81
s_waitcnt lgkmcnt(8)
v_mfma_f32_32x32x16_bf16 v[128:143], a[180:183], a[96:99], v[128:143]
ds_read_b64_tr_b16 a[160:161], v29 offset:36864
ds_read_b64_tr_b16 a[162:163], v29 offset:37376
buffer_load_dwordx4 v13, s[24:27], s82 offen sc1 lds
buffer_load_dword v210, v14, s[24:27], s7 offen offset:2048 sc1
v_mfma_f32_32x32x16_bf16 v[144:159], a[184:187], a[96:99], v[144:159]
ds_read_b64_tr_b16 a[164:165], v6 offset:36864
ds_read_b64_tr_b16 a[166:167], v6 offset:37376
buffer_load_dword v211, v14, s[24:27], s7 offen offset:2304 sc1
v_mul_f32 v82, v34, v82
v_mul_f32 v83, v35, v83
v_mfma_f32_32x32x16_bf16 v[160:175], a[188:191], a[96:99], v[160:175]
ds_read_b64_tr_b16 a[168:169], v29 offset:45056
ds_read_b64_tr_b16 a[170:171], v29 offset:45568
v_mul_f32 v84, v36, v84
v_mul_f32 v85, v37, v85
v_mul_f32 v86, v38, v86
v_mul_f32 v87, v39, v87
v_mfma_f32_32x32x16_bf16 v[176:191], a[192:195], a[96:99], v[176:191]
ds_read_b64_tr_b16 a[172:173], v6 offset:45056
ds_read_b64_tr_b16 a[174:175], v6 offset:45568
buffer_load_dwordx4 v13, s[24:27], s82 offen offset:1024 sc1 lds
v_cvt_pk_bf16_f32 v200, v80, v81
s_waitcnt lgkmcnt(8)
v_mfma_f32_32x32x16_bf16 v[128:143], a[200:203], a[100:103], v[128:143]
ds_read_b64_tr_b16 a[180:181], v29 offset:38912
ds_read_b64_tr_b16 a[182:183], v29 offset:39424
s_add_u32 m0, s85, 32768
s_bfe_u32 s82, s55, 0x40008
s_mul_i32 s82, s82, 8192
v_cvt_pk_bf16_f32 v201, v82, v83
v_mfma_f32_32x32x16_bf16 v[144:159], a[204:207], a[100:103], v[144:159]
ds_read_b64_tr_b16 a[184:185], v6 offset:38912
ds_read_b64_tr_b16 a[186:187], v6 offset:39424
buffer_load_dwordx4 v13, s[24:27], s82 offen sc1 lds
v_cvt_pk_bf16_f32 v202, v84, v85
v_cvt_pk_bf16_f32 v203, v86, v87
v_mfma_f32_32x32x16_bf16 v[160:175], a[208:211], a[100:103], v[160:175]
ds_read_b64_tr_b16 a[188:189], v29 offset:47104
ds_read_b64_tr_b16 a[190:191], v29 offset:47616
s_add_u32 s9, s9, s10
buffer_store_dwordx4 v[200:203], v27, s[44:47], s9 offen sc1
v_mul_f32 v88, v40, v88
v_mfma_f32_32x32x16_bf16 v[176:191], a[212:215], a[100:103], v[176:191]
ds_read_b64_tr_b16 a[192:193], v6 offset:47104
ds_read_b64_tr_b16 a[194:195], v6 offset:47616
v_mul_f32 v89, v41, v89
v_mul_f32 v90, v42, v90
v_mul_f32 v91, v43, v91
s_waitcnt lgkmcnt(8)
v_mfma_f32_32x32x16_bf16 v[128:143], a[160:163], a[104:107], v[128:143]
s_waitcnt vmcnt(38)
s_barrier
ds_read_b64_tr_b16 a[200:201], v29 offset:49152
ds_read_b64_tr_b16 a[202:203], v29 offset:49664
buffer_load_dwordx4 v13, s[24:27], s82 offen offset:1024 sc1 lds
v_mfma_f32_32x32x16_bf16 v[144:159], a[164:167], a[104:107], v[144:159]
ds_read_b64_tr_b16 a[204:205], v6 offset:49152
ds_read_b64_tr_b16 a[206:207], v6 offset:49664
s_add_u32 m0, s85, 40960
s_bfe_u32 s82, s55, 0x4000c
s_mul_i32 s82, s82, 8192
v_mul_f32 v92, v44, v92
v_mfma_f32_32x32x16_bf16 v[160:175], a[168:171], a[104:107], v[160:175]
ds_read_b64_tr_b16 a[208:209], v29 offset:57344
ds_read_b64_tr_b16 a[210:211], v29 offset:57856
v_mul_f32 v93, v45, v93
v_mul_f32 v94, v46, v94
v_mul_f32 v95, v47, v95
v_cvt_pk_bf16_f32 v204, v88, v89
v_mfma_f32_32x32x16_bf16 v[176:191], a[172:175], a[104:107], v[176:191]
ds_read_b64_tr_b16 a[212:213], v6 offset:57344
ds_read_b64_tr_b16 a[214:215], v6 offset:57856
buffer_load_dwordx4 v13, s[24:27], s82 offen sc1 lds
v_cvt_pk_bf16_f32 v205, v90, v91
s_waitcnt lgkmcnt(8)
v_mfma_f32_32x32x16_bf16 v[128:143], a[180:183], a[108:111], v[128:143]
ds_read_b64_tr_b16 a[160:161], v29 offset:51200
ds_read_b64_tr_b16 a[162:163], v29 offset:51712
v_cvt_pk_bf16_f32 v206, v92, v93
v_cvt_pk_bf16_f32 v207, v94, v95
s_add_u32 s58, s9, s11
v_mfma_f32_32x32x16_bf16 v[144:159], a[184:187], a[108:111], v[144:159]
ds_read_b64_tr_b16 a[164:165], v6 offset:51200
ds_read_b64_tr_b16 a[166:167], v6 offset:51712
buffer_load_dwordx4 v13, s[24:27], s82 offen offset:1024 sc1 lds
buffer_store_dwordx4 v[204:207], v27, s[44:47], s58 offen sc1
v_mfma_f32_32x32x16_bf16 v[160:175], a[188:191], a[108:111], v[160:175]
ds_read_b64_tr_b16 a[168:169], v29 offset:59392
ds_read_b64_tr_b16 a[170:171], v29 offset:59904
s_add_u32 m0, s85, 49152
s_bfe_u32 s82, s55, 0x40010
s_mul_i32 s82, s82, 8192
v_mul_f32 v96, v32, v96
v_mfma_f32_32x32x16_bf16 v[176:191], a[192:195], a[108:111], v[176:191]
ds_read_b64_tr_b16 a[172:173], v6 offset:59392
ds_read_b64_tr_b16 a[174:175], v6 offset:59904
v_mul_f32 v97, v33, v97
v_mul_f32 v98, v34, v98
v_mul_f32 v99, v35, v99
s_waitcnt lgkmcnt(8)
v_mfma_f32_32x32x16_bf16 v[128:143], a[200:203], a[112:115], v[128:143]
ds_read_b64_tr_b16 a[180:181], v29 offset:53248
ds_read_b64_tr_b16 a[182:183], v29 offset:53760
buffer_load_dwordx4 v13, s[24:27], s82 offen sc1 lds
v_mul_f32 v100, v36, v100
v_mul_f32 v101, v37, v101
v_mfma_f32_32x32x16_bf16 v[144:159], a[204:207], a[112:115], v[144:159]
ds_read_b64_tr_b16 a[184:185], v6 offset:53248
ds_read_b64_tr_b16 a[186:187], v6 offset:53760
v_mul_f32 v102, v38, v102
v_mul_f32 v103, v39, v103
v_cvt_pk_bf16_f32 v192, v96, v97
v_cvt_pk_bf16_f32 v193, v98, v99
v_mfma_f32_32x32x16_bf16 v[160:175], a[208:211], a[112:115], v[160:175]
ds_read_b64_tr_b16 a[188:189], v29 offset:61440
ds_read_b64_tr_b16 a[190:191], v29 offset:61952
buffer_load_dwordx4 v13, s[24:27], s82 offen offset:1024 sc1 lds
v_cvt_pk_bf16_f32 v194, v100, v101
v_cvt_pk_bf16_f32 v195, v102, v103
v_mfma_f32_32x32x16_bf16 v[176:191], a[212:215], a[112:115], v[176:191]
ds_read_b64_tr_b16 a[192:193], v6 offset:61440
ds_read_b64_tr_b16 a[194:195], v6 offset:61952
s_add_u32 m0, s85, 57344
s_bfe_u32 s82, s55, 0x40014
s_mul_i32 s82, s82, 8192
s_waitcnt lgkmcnt(8)
v_mfma_f32_32x32x16_bf16 v[128:143], a[160:163], a[116:119], v[128:143]
ds_read_b64_tr_b16 a[200:201], v29 offset:55296
ds_read_b64_tr_b16 a[202:203], v29 offset:55808
s_add_u32 s9, s9, s10
buffer_store_dwordx4 v[192:195], v27, s[44:47], s9 offen sc1
v_mul_f32 v104, v40, v104
v_mfma_f32_32x32x16_bf16 v[144:159], a[164:167], a[116:119], v[144:159]
ds_read_b64_tr_b16 a[204:205], v6 offset:55296
ds_read_b64_tr_b16 a[206:207], v6 offset:55808
buffer_load_dwordx4 v13, s[24:27], s82 offen sc1 lds
v_mul_f32 v105, v41, v105
v_mul_f32 v106, v42, v106
v_mfma_f32_32x32x16_bf16 v[160:175], a[168:171], a[116:119], v[160:175]
ds_read_b64_tr_b16 a[208:209], v29 offset:63488
ds_read_b64_tr_b16 a[210:211], v29 offset:64000
v_mul_f32 v107, v43, v107
v_mul_f32 v108, v44, v108
v_mul_f32 v109, v45, v109
v_mul_f32 v110, v46, v110
v_mfma_f32_32x32x16_bf16 v[176:191], a[172:175], a[116:119], v[176:191]
ds_read_b64_tr_b16 a[212:213], v6 offset:63488
ds_read_b64_tr_b16 a[214:215], v6 offset:64000
buffer_load_dwordx4 v13, s[24:27], s82 offen offset:1024 sc1 lds
v_mul_f32 v111, v47, v111
s_waitcnt lgkmcnt(8)
v_mfma_f32_32x32x16_bf16 v[128:143], a[180:183], a[120:123], v[128:143]
s_waitcnt vmcnt(43)
s_barrier
ds_read_b64_tr_b16 a[160:161], v4 offset:0
ds_read_b64_tr_b16 a[162:163], v4 offset:512
v_cvt_pk_bf16_f32 v196, v104, v105
v_cvt_pk_bf16_f32 v197, v106, v107
v_mfma_f32_32x32x16_bf16 v[144:159], a[184:187], a[120:123], v[144:159]
ds_read_b64_tr_b16 a[164:165], v7 offset:0
ds_read_b64_tr_b16 a[166:167], v7 offset:512
s_add_u32 m0, s85, 65536
s_bfe_u32 s82, s55, 0x40018
s_mul_i32 s82, s82, 8192
v_cvt_pk_bf16_f32 v198, v108, v109
v_mfma_f32_32x32x16_bf16 v[160:175], a[188:191], a[120:123], v[160:175]
ds_read_b64_tr_b16 a[168:169], v4 offset:8192
ds_read_b64_tr_b16 a[170:171], v4 offset:8704
buffer_load_dwordx4 v13, s[24:27], s82 offen sc1 lds
v_cvt_pk_bf16_f32 v199, v110, v111
s_add_u32 s58, s9, s11
v_mfma_f32_32x32x16_bf16 v[176:191], a[192:195], a[120:123], v[176:191]
ds_read_b64_tr_b16 a[172:173], v7 offset:8192
ds_read_b64_tr_b16 a[174:175], v7 offset:8704
buffer_store_dwordx4 v[196:199], v27, s[44:47], s58 offen sc1
v_mul_f32 v112, v32, v112
s_waitcnt lgkmcnt(8)
v_mfma_f32_32x32x16_bf16 v[128:143], a[200:203], a[124:127], v[128:143]
ds_read_b64_tr_b16 a[180:181], v4 offset:2048
ds_read_b64_tr_b16 a[182:183], v4 offset:2560
v_mul_f32 v113, v33, v113
v_mul_f32 v114, v34, v114
v_mul_f32 v115, v35, v115
v_mul_f32 v116, v36, v116
v_mfma_f32_32x32x16_bf16 v[144:159], a[204:207], a[124:127], v[144:159]
ds_read_b64_tr_b16 a[184:185], v7 offset:2048
ds_read_b64_tr_b16 a[186:187], v7 offset:2560
buffer_load_dwordx4 v13, s[24:27], s82 offen offset:1024 sc1 lds
v_mul_f32 v117, v37, v117
v_mul_f32 v118, v38, v118
v_mfma_f32_32x32x16_bf16 v[160:175], a[208:211], a[124:127], v[160:175]
ds_read_b64_tr_b16 a[188:189], v4 offset:10240
ds_read_b64_tr_b16 a[190:191], v4 offset:10752
s_add_u32 m0, s85, 73728
s_bfe_u32 s82, s55, 0x4001c
s_mul_i32 s82, s82, 8192
v_mul_f32 v119, v39, v119
v_mfma_f32_32x32x16_bf16 v[176:191], a[212:215], a[124:127], v[176:191]
ds_read_b64_tr_b16 a[192:193], v7 offset:10240
ds_read_b64_tr_b16 a[194:195], v7 offset:10752
v_cvt_pk_bf16_f32 v200, v112, v113
v_cvt_pk_bf16_f32 v201, v114, v115
v_cvt_pk_bf16_f32 v202, v116, v117
s_waitcnt lgkmcnt(8)
v_mfma_f32_32x32x16_bf16 v[128:143], a[160:163], a[128:131], v[128:143]
ds_read_b64_tr_b16 a[200:201], v4 offset:4096
ds_read_b64_tr_b16 a[202:203], v4 offset:4608
buffer_load_dwordx4 v13, s[24:27], s82 offen sc1 lds
v_cvt_pk_bf16_f32 v203, v118, v119
s_add_u32 s9, s9, s10
v_mfma_f32_32x32x16_bf16 v[144:159], a[164:167], a[128:131], v[144:159]
ds_read_b64_tr_b16 a[204:205], v7 offset:4096
ds_read_b64_tr_b16 a[206:207], v7 offset:4608
buffer_store_dwordx4 v[200:203], v27, s[44:47], s9 offen sc1
v_mul_f32 v120, v40, v120
v_mul_f32 v121, v41, v121
v_mfma_f32_32x32x16_bf16 v[160:175], a[168:171], a[128:131], v[160:175]
ds_read_b64_tr_b16 a[208:209], v4 offset:12288
ds_read_b64_tr_b16 a[210:211], v4 offset:12800
buffer_load_dwordx4 v13, s[24:27], s82 offen offset:1024 sc1 lds
v_mul_f32 v122, v42, v122
v_mul_f32 v123, v43, v123
v_mfma_f32_32x32x16_bf16 v[176:191], a[172:175], a[128:131], v[176:191]
ds_read_b64_tr_b16 a[212:213], v7 offset:12288
ds_read_b64_tr_b16 a[214:215], v7 offset:12800
v_mul_f32 v124, v44, v124
v_mul_f32 v125, v45, v125
v_mul_f32 v126, v46, v126
s_waitcnt lgkmcnt(8)
v_mfma_f32_32x32x16_bf16 v[128:143], a[180:183], a[132:135], v[128:143]
ds_read_b64_tr_b16 a[160:161], v4 offset:6144
ds_read_b64_tr_b16 a[162:163], v4 offset:6656
v_mul_f32 v127, v47, v127
v_cvt_pk_bf16_f32 v204, v120, v121
v_cvt_pk_bf16_f32 v205, v122, v123
v_cvt_pk_bf16_f32 v206, v124, v125
buffer_load_dwordx4 a[248:251], v3, s[36:39], s79 offen
v_mfma_f32_32x32x16_bf16 v[144:159], a[184:187], a[132:135], v[144:159]
ds_read_b64_tr_b16 a[164:165], v7 offset:6144
ds_read_b64_tr_b16 a[166:167], v7 offset:6656
v_cvt_pk_bf16_f32 v207, v126, v127
s_add_u32 s58, s9, s11
buffer_store_dwordx4 v[204:207], v27, s[44:47], s58 offen sc1
v_mfma_f32_32x32x16_bf16 v[160:175], a[188:191], a[132:135], v[160:175]
ds_read_b64_tr_b16 a[168:169], v4 offset:14336
ds_read_b64_tr_b16 a[170:171], v4 offset:14848
s_waitcnt vmcnt(37)
v_add_f32 v48, v48, v53
v_add_f32 v49, v49, v54
v_add_f32 v50, v50, v55
v_mfma_f32_32x32x16_bf16 v[176:191], a[192:195], a[132:135], v[176:191]
ds_read_b64_tr_b16 a[172:173], v7 offset:14336
ds_read_b64_tr_b16 a[174:175], v7 offset:14848
v_add_f32 v48, v48, v49
v_add_f32 v50, v50, v51
v_add_f32 v48, v48, v52
s_waitcnt lgkmcnt(8)
v_mfma_f32_32x32x16_bf16 v[128:143], a[200:203], a[136:139], v[128:143]
s_barrier
ds_read_b64_tr_b16 a[180:181], v4 offset:16384
ds_read_b64_tr_b16 a[182:183], v4 offset:16896
v_add_f32 v48, v48, v50
v_cvt_pk_bf16_f32 v49, v48, v48
buffer_load_dwordx4 a[252:255], v3, s[36:39], s79 offen offset:64
v_mfma_f32_32x32x16_bf16 v[144:159], a[204:207], a[136:139], v[144:159]
ds_read_b64_tr_b16 a[184:185], v7 offset:16384
ds_read_b64_tr_b16 a[186:187], v7 offset:16896
v_and_b32 v49, 0xffff0000, v49
v_sub_f32 v49, v48, v49
v_cvt_pk_bf16_f32 v50, v48, v49
v_and_b32 v52, 0xffff0000, v50
v_mfma_f32_32x32x16_bf16 v[160:175], a[208:211], a[136:139], v[160:175]
ds_read_b64_tr_b16 a[188:189], v4 offset:24576
ds_read_b64_tr_b16 a[190:191], v4 offset:25088
v_sub_f32 v49, v49, v52
v_cvt_pk_bf16_f32 v51, v49, 0
ds_write_b64 v213, v[50:51] offset:2048
v_mfma_f32_32x32x16_bf16 v[176:191], a[212:215], a[136:139], v[176:191]
ds_read_b64_tr_b16 a[192:193], v7 offset:24576
ds_read_b64_tr_b16 a[194:195], v7 offset:25088
s_waitcnt vmcnt(21)
v_add_f32 v58, v58, v63
v_add_f32 v59, v59, v208
s_waitcnt lgkmcnt(9)
v_mfma_f32_32x32x16_bf16 v[128:143], a[160:163], a[140:143], v[128:143]
ds_read_b64_tr_b16 a[200:201], v4 offset:18432
ds_read_b64_tr_b16 a[202:203], v4 offset:18944
v_add_f32 v60, v60, v209
v_add_f32 v61, v61, v210
v_add_f32 v62, v62, v211
v_add_f32 v58, v58, v59
buffer_load_dwordx2 v[20:21], v245, s[36:39], s79 offen offset:128
v_mfma_f32_32x32x16_bf16 v[144:159], a[164:167], a[140:143], v[144:159]
ds_read_b64_tr_b16 a[204:205], v7 offset:18432
ds_read_b64_tr_b16 a[206:207], v7 offset:18944
v_add_f32 v60, v60, v61
v_add_f32 v58, v58, v62
v_add_f32 v58, v58, v60
v_cvt_pk_bf16_f32 v59, v58, v58
v_mfma_f32_32x32x16_bf16 v[160:175], a[168:171], a[140:143], v[160:175]
ds_read_b64_tr_b16 a[208:209], v4 offset:26624
ds_read_b64_tr_b16 a[210:211], v4 offset:27136
v_and_b32 v59, 0xffff0000, v59
v_sub_f32 v59, v58, v59
v_cvt_pk_bf16_f32 v60, v58, v59
v_and_b32 v62, 0xffff0000, v60
v_mfma_f32_32x32x16_bf16 v[176:191], a[172:175], a[140:143], v[176:191]
ds_read_b64_tr_b16 a[212:213], v7 offset:26624
ds_read_b64_tr_b16 a[214:215], v7 offset:27136
v_sub_f32 v59, v59, v62
v_cvt_pk_bf16_f32 v61, v59, 0
ds_write_b64 v213, v[60:61] offset:4096
s_waitcnt lgkmcnt(9)
v_mfma_f32_32x32x16_bf16 v[128:143], a[180:183], a[144:147], v[128:143]
ds_read_b64_tr_b16 a[160:161], v4 offset:20480
ds_read_b64_tr_b16 a[162:163], v4 offset:20992
v_add_u32 v241, s21, v240
v_add_u32 v242, s22, v240
v_add_u32 v243, s23, v240
v_add_u32 v240, s20, v240
v_mfma_f32_32x32x16_bf16 v[144:159], a[184:187], a[144:147], v[144:159]
ds_read_b64_tr_b16 a[164:165], v7 offset:20480
ds_read_b64_tr_b16 a[166:167], v7 offset:20992
v_add_u32 v235, 155648, v2
ds_read_b128 v[32:35], v235 offset:0
ds_read_b128 v[36:39], v235 offset:1024
buffer_load_dwordx4 a[220:223], v2, s[24:27], s73 offen offset:0 sc1
v_mfma_f32_32x32x16_bf16 v[160:175], a[188:191], a[144:147], v[160:175]
ds_read_b64_tr_b16 a[168:169], v4 offset:28672
ds_read_b64_tr_b16 a[170:171], v4 offset:29184
ds_read_b128 v[40:43], v235 offset:2048
ds_read_b128 v[44:47], v235 offset:3072
ds_read_b128 v[48:51], v235 offset:4096
v_mfma_f32_32x32x16_bf16 v[176:191], a[192:195], a[144:147], v[176:191]
ds_read_b64_tr_b16 a[172:173], v7 offset:28672
ds_read_b64_tr_b16 a[174:175], v7 offset:29184
ds_read_b128 v[52:55], v235 offset:5120
ds_read_b128 v[56:59], v235 offset:6144
buffer_load_dwordx4 a[224:227], v2, s[24:27], s73 offen offset:1024 sc1
s_waitcnt lgkmcnt(15)
v_mfma_f32_32x32x16_bf16 v[128:143], a[200:203], a[148:151], v[128:143]
ds_read_b64_tr_b16 a[180:181], v4 offset:22528
ds_read_b64_tr_b16 a[182:183], v4 offset:23040
ds_read_b128 v[60:63], v235 offset:7168
v_mfma_f32_32x32x16_bf16 v[144:159], a[204:207], a[148:151], v[144:159]
ds_read_b64_tr_b16 a[184:185], v7 offset:22528
ds_read_b64_tr_b16 a[186:187], v7 offset:23040
buffer_load_dwordx4 a[228:231], v2, s[24:27], s73 offen offset:2048 sc1
v_mfma_f32_32x32x16_bf16 v[160:175], a[208:211], a[148:151], v[160:175]
ds_read_b64_tr_b16 a[188:189], v4 offset:30720
ds_read_b64_tr_b16 a[190:191], v4 offset:31232
v_mfma_f32_32x32x16_bf16 v[176:191], a[212:215], a[148:151], v[176:191]
ds_read_b64_tr_b16 a[192:193], v7 offset:30720
ds_read_b64_tr_b16 a[194:195], v7 offset:31232
s_waitcnt lgkmcnt(11)
v_mfma_f32_32x32x16_bf16 v[128:143], a[160:163], a[152:155], v[128:143]
s_waitcnt vmcnt(5)
s_barrier
ds_read_b128 a[200:203], v2 offset:0
buffer_store_dword v247, v255, s[24:27], s4 offen offset:128 sc1
buffer_load_dwordx4 a[232:235], v2, s[24:27], s73 offen offset:3072 sc1
v_mfma_f32_32x32x16_bf16 v[144:159], a[164:167], a[152:155], v[144:159]
ds_read_b128 a[204:207], v2 offset:1024
ds_read_b64 a[240:241], v212 offset:2048
ds_read_b64 a[242:243], v212 offset:2560
ds_read_b64 a[244:245], v212 offset:3072
ds_read_b64 a[246:247], v212 offset:3584
v_mfma_f32_32x32x16_bf16 v[160:175], a[168:171], a[152:155], v[160:175]
s_add_u32 s73, s73, 4096
buffer_load_dwordx4 a[236:239], v2, s[24:27], s73 offen offset:0 sc1
v_mfma_f32_32x32x16_bf16 v[176:191], a[172:175], a[152:155], v[176:191]
s_waitcnt lgkmcnt(6)
v_mfma_f32_32x32x16_bf16 v[128:143], a[180:183], a[156:159], v[128:143]
ds_read_b128 a[160:163], v2 offset:2048
s_waitcnt lgkmcnt(1)
v_mfma_f32_32x32x8_bf16 v[128:143], a[240:241], v[22:23], v[128:143]
v_mfma_f32_32x32x16_bf16 v[144:159], a[184:187], a[156:159], v[144:159]
ds_read_b128 a[164:167], v2 offset:3072
v_mfma_f32_32x32x8_bf16 v[144:159], a[242:243], v[22:23], v[144:159]
buffer_load_dwordx4 a[176:179], v2, s[24:27], s73 offen offset:1024 sc1
v_mfma_f32_32x32x16_bf16 v[160:175], a[188:191], a[156:159], v[160:175]
v_mfma_f32_32x32x8_bf16 v[160:175], a[244:245], v[22:23], v[160:175]
v_mfma_f32_32x32x16_bf16 v[176:191], a[192:195], a[156:159], v[176:191]
v_mfma_f32_32x32x8_bf16 v[176:191], a[246:247], v[22:23], v[176:191]
buffer_load_dwordx4 a[196:199], v2, s[24:27], s73 offen offset:2048 sc1
v_mfma_f32_32x32x16_bf16 v[64:79], a[200:203], a[0:3], 0
ds_read_b128 a[180:183], v2 offset:4096
ds_read_b64 a[240:241], v212 offset:4096
ds_read_b64 a[242:243], v212 offset:4608
ds_read_b64 a[244:245], v212 offset:5120
ds_read_b64 a[246:247], v212 offset:5632
v_mfma_f32_32x32x16_bf16 v[80:95], a[204:207], a[0:3], 0
ds_read_b128 a[184:187], v2 offset:5120
s_waitcnt lgkmcnt(6)
v_mfma_f32_32x32x16_bf16 v[64:79], a[160:163], a[4:7], v[64:79]
ds_read_b128 a[200:203], v2 offset:6144
buffer_load_dwordx4 a[216:219], v2, s[24:27], s73 offen offset:3072 sc1
v_mul_f32 v208, v128, v128
v_mul_f32 v209, v129, v129
v_mul_f32 v210, v130, v130
v_mfma_f32_32x32x16_bf16 v[80:95], a[164:167], a[4:7], v[80:95]
ds_read_b128 a[204:207], v2 offset:7168
v_mul_f32 v211, v131, v131
v_fma_f32 v208, v208, v25, v24
v_fma_f32 v209, v209, v25, v24
v_fma_f32 v210, v210, v25, v24
s_waitcnt lgkmcnt(2)
v_mfma_f32_32x32x16_bf16 v[64:79], a[180:183], a[8:11], v[64:79]
ds_read_b128 a[160:163], v2 offset:8192
v_mfma_f32_32x32x8_bf16 v[64:79], a[240:241], v[22:23], v[64:79]
s_barrier
v_fma_f32 v211, v211, v25, v24
v_mul_f32 v208, v208, v128
v_mfma_f32_32x32x16_bf16 v[80:95], a[184:187], a[8:11], v[80:95]
ds_read_b128 a[164:167], v2 offset:9216
v_mfma_f32_32x32x8_bf16 v[80:95], a[242:243], v[22:23], v[80:95]
s_add_u32 s73, s73, 4096
buffer_load_dwordx4 v[108:111], v2, s[24:27], s73 offen offset:0 sc1
s_waitcnt lgkmcnt(2)
v_mfma_f32_32x32x16_bf16 v[64:79], a[200:203], a[12:15], v[64:79]
ds_read_b128 a[180:183], v2 offset:10240
v_mfma_f32_32x32x8_bf16 v[64:79], a[244:245], v[22:23], v[64:79]
v_mul_f32 v209, v209, v129
v_mul_f32 v210, v210, v130
v_mul_f32 v211, v211, v131
v_mfma_f32_32x32x16_bf16 v[80:95], a[204:207], a[12:15], v[80:95]
ds_read_b128 a[184:187], v2 offset:11264
v_mfma_f32_32x32x8_bf16 v[80:95], a[246:247], v[22:23], v[80:95]
buffer_load_dwordx4 v[112:115], v2, s[24:27], s73 offen offset:1024 sc1
s_waitcnt lgkmcnt(2)
v_mfma_f32_32x32x16_bf16 v[64:79], a[160:163], a[16:19], v[64:79]
ds_read_b128 a[200:203], v2 offset:12288
v_exp_f32 v208, v208
v_mul_f32 v160, v128, v160
v_exp_f32 v209, v209
v_mfma_f32_32x32x16_bf16 v[80:95], a[164:167], a[16:19], v[80:95]
ds_read_b128 a[204:207], v2 offset:13312
buffer_load_dwordx4 v[116:119], v2, s[24:27], s73 offen offset:2048 sc1
v_mul_f32 v161, v129, v161
s_waitcnt lgkmcnt(2)
v_mfma_f32_32x32x16_bf16 v[64:79], a[180:183], a[20:23], v[64:79]
ds_read_b128 a[160:163], v2 offset:14336
v_exp_f32 v210, v210
v_mul_f32 v162, v130, v162
v_exp_f32 v211, v211
v_mfma_f32_32x32x16_bf16 v[80:95], a[184:187], a[20:23], v[80:95]
ds_read_b128 a[164:167], v2 offset:15360
v_mul_f32 v163, v131, v163
v_fma_f32 v208, v208, v26, v26
v_fma_f32 v209, v209, v26, v26
v_fma_f32 v210, v210, v26, v26
s_waitcnt lgkmcnt(2)
v_mfma_f32_32x32x16_bf16 v[64:79], a[200:203], a[24:27], v[64:79]
ds_read_b128 a[180:183], v2 offset:16384
buffer_load_dwordx4 v[120:123], v2, s[24:27], s73 offen offset:3072 sc1
v_fma_f32 v211, v211, v26, v26
v_rcp_f32 v208, v208
v_mfma_f32_32x32x16_bf16 v[80:95], a[204:207], a[24:27], v[80:95]
ds_read_b128 a[184:187], v2 offset:17408
v_rcp_f32 v209, v209
v_rcp_f32 v210, v210
s_waitcnt lgkmcnt(2)
v_mfma_f32_32x32x16_bf16 v[64:79], a[160:163], a[28:31], v[64:79]
ds_read_b128 a[200:203], v2 offset:18432
s_add_u32 s73, s73, 4096
buffer_load_dwordx4 v[124:127], v2, s[24:27], s73 offen offset:0 sc1
v_rcp_f32 v211, v211
v_mfma_f32_32x32x16_bf16 v[80:95], a[164:167], a[28:31], v[80:95]
ds_read_b128 a[204:207], v2 offset:19456
v_mul_f32 v160, v160, v208
v_mul_f32 v161, v161, v209
v_mul_f32 v162, v162, v210
v_mul_f32 v163, v163, v211
s_waitcnt lgkmcnt(2)
v_mfma_f32_32x32x16_bf16 v[64:79], a[180:183], a[32:35], v[64:79]
ds_read_b128 a[160:163], v2 offset:20480
v_cvt_pk_bf16_f32 v192, v160, v161
v_cvt_pk_bf16_f32 v193, v162, v163
v_mul_f32 v208, v132, v132
v_mul_f32 v209, v133, v133
v_mul_f32 v210, v134, v134
v_mfma_f32_32x32x16_bf16 v[80:95], a[184:187], a[32:35], v[80:95]
ds_read_b128 a[164:167], v2 offset:21504
buffer_load_dwordx4 a[168:171], v2, s[24:27], s73 offen offset:1024 sc1
v_mul_f32 v211, v135, v135
v_fma_f32 v208, v208, v25, v24
s_waitcnt lgkmcnt(2)
v_mfma_f32_32x32x16_bf16 v[64:79], a[200:203], a[36:39], v[64:79]
ds_read_b128 a[180:183], v2 offset:22528
v_fma_f32 v209, v209, v25, v24
v_fma_f32 v210, v210, v25, v24
v_fma_f32 v211, v211, v25, v24
v_mul_f32 v208, v208, v132
v_mul_f32 v209, v209, v133
v_mfma_f32_32x32x16_bf16 v[80:95], a[204:207], a[36:39], v[80:95]
ds_read_b128 a[184:187], v2 offset:23552
buffer_load_dwordx4 a[172:175], v2, s[24:27], s73 offen offset:2048 sc1
v_mul_f32 v210, v210, v134
v_mul_f32 v211, v211, v135
s_waitcnt lgkmcnt(2)
v_mfma_f32_32x32x16_bf16 v[64:79], a[160:163], a[40:43], v[64:79]
ds_read_b128 a[200:203], v2 offset:24576
v_exp_f32 v208, v208
v_mul_f32 v164, v132, v164
v_exp_f32 v209, v209
v_mfma_f32_32x32x16_bf16 v[80:95], a[164:167], a[40:43], v[80:95]
ds_read_b128 a[204:207], v2 offset:25600
v_mul_f32 v165, v133, v165
v_exp_f32 v210, v210
v_mul_f32 v166, v134, v166
s_waitcnt lgkmcnt(2)
v_mfma_f32_32x32x16_bf16 v[64:79], a[180:183], a[44:47], v[64:79]
ds_read_b128 a[160:163], v2 offset:26624
buffer_load_dwordx4 a[188:191], v2, s[24:27], s73 offen offset:3072 sc1
v_exp_f32 v211, v211
v_mul_f32 v167, v135, v167
v_mfma_f32_32x32x16_bf16 v[80:95], a[184:187], a[44:47], v[80:95]
ds_read_b128 a[164:167], v2 offset:27648
v_fma_f32 v208, v208, v26, v26
v_fma_f32 v209, v209, v26, v26
v_fma_f32 v210, v210, v26, v26
v_fma_f32 v211, v211, v26, v26
s_waitcnt lgkmcnt(2)
v_mfma_f32_32x32x16_bf16 v[64:79], a[200:203], a[48:51], v[64:79]
ds_read_b128 a[180:183], v2 offset:28672
s_add_u32 s73, s73, 4096
buffer_load_dwordx4 a[192:195], v2, s[24:27], s73 offen offset:0 sc1
v_rcp_f32 v208, v208
v_mfma_f32_32x32x16_bf16 v[80:95], a[204:207], a[48:51], v[80:95]
ds_read_b128 a[184:187], v2 offset:29696
v_rcp_f32 v209, v209
v_rcp_f32 v210, v210
s_waitcnt lgkmcnt(2)
v_mfma_f32_32x32x16_bf16 v[64:79], a[160:163], a[52:55], v[64:79]
ds_read_b128 a[200:203], v2 offset:30720
v_rcp_f32 v211, v211
v_mul_f32 v164, v164, v208
v_mul_f32 v165, v165, v209
v_mul_f32 v166, v166, v210
v_mfma_f32_32x32x16_bf16 v[80:95], a[164:167], a[52:55], v[80:95]
ds_read_b128 a[204:207], v2 offset:31744
buffer_load_dwordx4 a[208:211], v2, s[24:27], s73 offen offset:1024 sc1
v_mul_f32 v167, v167, v211
v_cvt_pk_bf16_f32 v194, v164, v165
s_waitcnt lgkmcnt(2)
v_mfma_f32_32x32x16_bf16 v[64:79], a[180:183], a[56:59], v[64:79]
ds_read_b128 a[160:163], v2 offset:32768
v_cvt_pk_bf16_f32 v195, v166, v167
buffer_store_dwordx4 v[192:195], v2, s[24:27], s13 offen offset:0 sc1
v_mul_f32 v208, v136, v136
v_mul_f32 v209, v137, v137
v_mfma_f32_32x32x16_bf16 v[80:95], a[184:187], a[56:59], v[80:95]
ds_read_b128 a[164:167], v2 offset:33792
buffer_load_dwordx4 a[212:215], v2, s[24:27], s73 offen offset:2048 sc1
v_mul_f32 v210, v138, v138
v_mul_f32 v211, v139, v139
s_waitcnt lgkmcnt(2)
v_mfma_f32_32x32x16_bf16 v[64:79], a[200:203], a[60:63], v[64:79]
ds_read_b128 a[180:183], v2 offset:34816
v_fma_f32 v208, v208, v25, v24
v_fma_f32 v209, v209, v25, v24
v_fma_f32 v210, v210, v25, v24
v_fma_f32 v211, v211, v25, v24
v_mul_f32 v208, v208, v136
v_mfma_f32_32x32x16_bf16 v[80:95], a[204:207], a[60:63], v[80:95]
ds_read_b128 a[184:187], v2 offset:35840
v_mul_f32 v209, v209, v137
v_mul_f32 v210, v210, v138
v_mul_f32 v211, v211, v139
s_waitcnt lgkmcnt(2)
v_mfma_f32_32x32x16_bf16 v[64:79], a[160:163], a[64:67], v[64:79]
ds_read_b128 a[200:203], v2 offset:36864
buffer_load_dword v222, v234, s[24:27], 0 offen offset:128 sc1
buffer_load_dwordx4 a[0:3], v2, s[24:27], s73 offen offset:3072 sc1
v_mfma_f32_32x32x16_bf16 v[80:95], a[164:167], a[64:67], v[80:95]
ds_read_b128 a[204:207], v2 offset:37888
v_exp_f32 v208, v208
v_mul_f32 v168, v136, v168
s_waitcnt lgkmcnt(2)
v_mfma_f32_32x32x16_bf16 v[64:79], a[180:183], a[68:71], v[64:79]
ds_read_b128 a[160:163], v2 offset:38912
s_add_u32 s73, s73, 4096
buffer_load_dwordx4 a[4:7], v2, s[24:27], s73 offen offset:0 sc1
v_exp_f32 v209, v209
v_mfma_f32_32x32x16_bf16 v[80:95], a[184:187], a[68:71], v[80:95]
ds_read_b128 a[164:167], v2 offset:39936
v_mul_f32 v169, v137, v169
v_exp_f32 v210, v210
v_mul_f32 v170, v138, v170
s_waitcnt lgkmcnt(2)
v_mfma_f32_32x32x16_bf16 v[64:79], a[200:203], a[72:75], v[64:79]
s_barrier
ds_read_b128 a[180:183], v2 offset:40960
v_exp_f32 v211, v211
v_mul_f32 v171, v139, v171
v_mfma_f32_32x32x16_bf16 v[80:95], a[204:207], a[72:75], v[80:95]
ds_read_b128 a[184:187], v2 offset:41984
buffer_load_dwordx4 a[8:11], v2, s[24:27], s73 offen offset:1024 sc1
v_fma_f32 v208, v208, v26, v26
v_fma_f32 v209, v209, v26, v26
s_waitcnt lgkmcnt(2)
v_mfma_f32_32x32x16_bf16 v[64:79], a[160:163], a[76:79], v[64:79]
ds_read_b128 a[200:203], v2 offset:43008
v_fma_f32 v210, v210, v26, v26
v_fma_f32 v211, v211, v26, v26
v_rcp_f32 v208, v208
v_mfma_f32_32x32x16_bf16 v[80:95], a[164:167], a[76:79], v[80:95]
ds_read_b128 a[204:207], v2 offset:44032
buffer_load_dwordx4 a[12:15], v2, s[24:27], s73 offen offset:2048 sc1
v_rcp_f32 v209, v209
s_waitcnt lgkmcnt(2)
v_mfma_f32_32x32x16_bf16 v[64:79], a[180:183], a[80:83], v[64:79]
ds_read_b128 a[160:163], v2 offset:45056
v_rcp_f32 v210, v210
v_rcp_f32 v211, v211
v_mul_f32 v168, v168, v208
v_mfma_f32_32x32x16_bf16 v[80:95], a[184:187], a[80:83], v[80:95]
ds_read_b128 a[164:167], v2 offset:46080
v_mul_f32 v169, v169, v209
v_mul_f32 v170, v170, v210
v_mul_f32 v171, v171, v211
v_cvt_pk_bf16_f32 v196, v168, v169
s_waitcnt lgkmcnt(2)
v_mfma_f32_32x32x16_bf16 v[64:79], a[200:203], a[84:87], v[64:79]
ds_read_b128 a[180:183], v2 offset:47104
buffer_load_dwordx4 a[16:19], v2, s[24:27], s73 offen offset:3072 sc1
v_cvt_pk_bf16_f32 v197, v170, v171
v_mul_f32 v208, v140, v140
v_mul_f32 v209, v141, v141
v_mfma_f32_32x32x16_bf16 v[80:95], a[204:207], a[84:87], v[80:95]
ds_read_b128 a[184:187], v2 offset:48128
v_mul_f32 v210, v142, v142
v_mul_f32 v211, v143, v143
v_fma_f32 v208, v208, v25, v24
v_fma_f32 v209, v209, v25, v24
s_waitcnt lgkmcnt(2)
v_mfma_f32_32x32x16_bf16 v[64:79], a[160:163], a[88:91], v[64:79]
ds_read_b128 a[200:203], v2 offset:49152
s_add_u32 s73, s73, 4096
buffer_load_dwordx4 a[20:23], v2, s[24:27], s73 offen offset:0 sc1
v_fma_f32 v210, v210, v25, v24
v_fma_f32 v211, v211, v25, v24
v_mfma_f32_32x32x16_bf16 v[80:95], a[164:167], a[88:91], v[80:95]
ds_read_b128 a[204:207], v2 offset:50176
v_mul_f32 v208, v208, v140
v_mul_f32 v209, v209, v141
v_mul_f32 v210, v210, v142
v_mul_f32 v211, v211, v143
s_waitcnt lgkmcnt(2)
v_mfma_f32_32x32x16_bf16 v[64:79], a[180:183], a[92:95], v[64:79]
ds_read_b128 a[160:163], v2 offset:51200
v_exp_f32 v208, v208
v_mul_f32 v172, v140, v172
v_exp_f32 v209, v209
v_mfma_f32_32x32x16_bf16 v[80:95], a[184:187], a[92:95], v[80:95]
ds_read_b128 a[164:167], v2 offset:52224
buffer_load_dwordx4 a[24:27], v2, s[24:27], s73 offen offset:1024 sc1
v_mul_f32 v173, v141, v173
s_waitcnt lgkmcnt(2)
v_mfma_f32_32x32x16_bf16 v[64:79], a[200:203], a[96:99], v[64:79]
ds_read_b128 a[180:183], v2 offset:53248
v_exp_f32 v210, v210
v_mul_f32 v174, v142, v174
v_exp_f32 v211, v211
v_mfma_f32_32x32x16_bf16 v[80:95], a[204:207], a[96:99], v[80:95]
ds_read_b128 a[184:187], v2 offset:54272
buffer_load_dwordx4 a[28:31], v2, s[24:27], s73 offen offset:2048 sc1
v_mul_f32 v175, v143, v175
v_fma_f32 v208, v208, v26, v26
s_waitcnt lgkmcnt(2)
v_mfma_f32_32x32x16_bf16 v[64:79], a[160:163], a[100:103], v[64:79]
ds_read_b128 a[200:203], v2 offset:55296
s_waitcnt vmcnt(8)
v_cmp_ne_u32 vcc, s56, v222
s_cbranch_vccnz L_sp6_slow
L_sp6_back:
v_fma_f32 v209, v209, v26, v26
v_fma_f32 v210, v210, v26, v26
v_mfma_f32_32x32x16_bf16 v[80:95], a[164:167], a[100:103], v[80:95]
ds_read_b128 a[204:207], v2 offset:56320
v_fma_f32 v211, v211, v26, v26
v_rcp_f32 v208, v208
s_waitcnt lgkmcnt(2)
v_mfma_f32_32x32x16_bf16 v[64:79], a[180:183], a[104:107], v[64:79]
ds_read_b128 a[160:163], v2 offset:57344
buffer_load_dwordx4 v[96:99], v2, s[24:27], s71 offen sc1
v_rcp_f32 v209, v209
v_mfma_f32_32x32x16_bf16 v[80:95], a[184:187], a[104:107], v[80:95]
ds_read_b128 a[164:167], v2 offset:58368
v_rcp_f32 v210, v210
v_rcp_f32 v211, v211
s_waitcnt lgkmcnt(2)
v_mfma_f32_32x32x16_bf16 v[64:79], a[200:203], a[108:111], v[64:79]
ds_read_b128 a[180:183], v2 offset:59392
buffer_load_dwordx2 v[100:101], v233, s[24:27], s71 offen offset:1024 sc1
v_mul_f32 v172, v172, v208
v_mul_f32 v173, v173, v209
v_mul_f32 v174, v174, v210
v_mfma_f32_32x32x16_bf16 v[80:95], a[204:207], a[108:111], v[80:95]
ds_read_b128 a[184:187], v2 offset:60416
v_mul_f32 v175, v175, v211
v_cvt_pk_bf16_f32 v198, v172, v173
v_cvt_pk_bf16_f32 v199, v174, v175
s_waitcnt lgkmcnt(2)
v_mfma_f32_32x32x16_bf16 v[64:79], a[160:163], a[112:115], v[64:79]
ds_read_b128 a[200:203], v2 offset:61440
buffer_store_dwordx4 v[196:199], v2, s[24:27], s13 offen offset:1024 sc1
v_mul_f32 v208, v144, v144
v_mul_f32 v209, v145, v145
v_mul_f32 v210, v146, v146
v_mfma_f32_32x32x16_bf16 v[80:95], a[164:167], a[112:115], v[80:95]
ds_read_b128 a[204:207], v2 offset:62464
buffer_load_dwordx4 v[102:105], v2, s[24:27], s71 offen offset:1536 sc1
v_mul_f32 v211, v147, v147
v_fma_f32 v208, v208, v25, v24
s_waitcnt lgkmcnt(2)
v_mfma_f32_32x32x16_bf16 v[64:79], a[180:183], a[116:119], v[64:79]
ds_read_b128 a[160:163], v2 offset:63488
v_fma_f32 v209, v209, v25, v24
v_fma_f32 v210, v210, v25, v24
v_fma_f32 v211, v211, v25, v24
v_mul_f32 v208, v208, v144
v_mul_f32 v209, v209, v145
v_mfma_f32_32x32x16_bf16 v[80:95], a[184:187], a[116:119], v[80:95]
ds_read_b128 a[164:167], v2 offset:64512
buffer_load_dwordx2 v[106:107], v233, s[24:27], s71 offen offset:1032 sc1
s_mov_b32 s46, s68
s_add_u32 m0, s67, 0
s_waitcnt lgkmcnt(2)
v_mfma_f32_32x32x16_bf16 v[64:79], a[200:203], a[120:123], v[64:79]
ds_read_b128 a[180:183], v12 offset:0
v_mul_f32 v210, v210, v146
v_mul_f32 v211, v211, v147
v_exp_f32 v208, v208
v_mul_f32 v176, v144, v176
v_mfma_f32_32x32x16_bf16 v[80:95], a[204:207], a[120:123], v[80:95]
ds_read_b128 a[184:187], v12 offset:1024
v_exp_f32 v209, v209
v_mul_f32 v177, v145, v177
s_waitcnt lgkmcnt(2)
v_mfma_f32_32x32x16_bf16 v[64:79], a[160:163], a[124:127], v[64:79]
ds_read_b128 a[200:203], v12 offset:2048
buffer_load_dwordx4 v224, s[44:47], s64 offen offset:0 sc1 lds
v_exp_f32 v210, v210
v_mul_f32 v178, v146, v178
v_mfma_f32_32x32x16_bf16 v[80:95], a[164:167], a[124:127], v[80:95]
ds_read_b128 a[204:207], v12 offset:3072
v_exp_f32 v211, v211
v_mul_f32 v179, v147, v179
v_fma_f32 v208, v208, v26, v26
s_waitcnt lgkmcnt(2)
v_mfma_f32_32x32x16_bf16 v[64:79], a[180:183], a[128:131], v[64:79]
ds_read_b128 a[160:163], v12 offset:4096
buffer_load_dwordx4 v225, s[44:47], s64 offen offset:1024 sc1 lds
v_fma_f32 v209, v209, v26, v26
v_fma_f32 v210, v210, v26, v26
v_fma_f32 v211, v211, v26, v26
v_mfma_f32_32x32x16_bf16 v[80:95], a[184:187], a[128:131], v[80:95]
ds_read_b128 a[164:167], v12 offset:5120
v_rcp_f32 v208, v208
v_rcp_f32 v209, v209
s_waitcnt lgkmcnt(2)
v_mfma_f32_32x32x16_bf16 v[64:79], a[200:203], a[132:135], v[64:79]
ds_read_b128 a[180:183], v12 offset:6144
v_rcp_f32 v210, v210
v_rcp_f32 v211, v211
v_mul_f32 v176, v176, v208
v_mfma_f32_32x32x16_bf16 v[80:95], a[204:207], a[132:135], v[80:95]
ds_read_b128 a[184:187], v12 offset:7168
buffer_load_dwordx4 v226, s[44:47], s64 offen offset:2048 sc1 lds
v_mul_f32 v177, v177, v209
v_mul_f32 v178, v178, v210
s_waitcnt lgkmcnt(2)
v_mfma_f32_32x32x16_bf16 v[64:79], a[160:163], a[136:139], v[64:79]
ds_read_b128 a[200:203], v12 offset:8192
v_mul_f32 v179, v179, v211
v_cvt_pk_bf16_f32 v200, v176, v177
v_cvt_pk_bf16_f32 v201, v178, v179
v_mul_f32 v208, v148, v148
v_mul_f32 v209, v149, v149
v_mfma_f32_32x32x16_bf16 v[80:95], a[164:167], a[136:139], v[80:95]
ds_read_b128 a[204:207], v12 offset:9216
buffer_load_dwordx4 v227, s[44:47], s64 offen offset:3072 sc1 lds
s_add_u32 m0, s67, 4096
v_mul_f32 v210, v150, v150
s_waitcnt lgkmcnt(2)
v_mfma_f32_32x32x16_bf16 v[64:79], a[180:183], a[140:143], v[64:79]
ds_read_b128 a[160:163], v12 offset:10240
v_mul_f32 v211, v151, v151
v_fma_f32 v208, v208, v25, v24
v_fma_f32 v209, v209, v25, v24
v_fma_f32 v210, v210, v25, v24
v_fma_f32 v211, v211, v25, v24
v_mfma_f32_32x32x16_bf16 v[80:95], a[184:187], a[140:143], v[80:95]
ds_read_b128 a[164:167], v12 offset:11264
v_mul_f32 v208, v208, v148
v_mul_f32 v209, v209, v149
v_mul_f32 v210, v210, v150
v_mul_f32 v211, v211, v151
s_waitcnt lgkmcnt(2)
v_mfma_f32_32x32x16_bf16 v[64:79], a[200:203], a[144:147], v[64:79]
ds_read_b128 a[180:183], v12 offset:12288
buffer_load_dwordx4 v228, s[44:47], s64 offen offset:0 sc1 lds
s_mov_b32 s46, s69
s_add_u32 m0, s67, 5120
v_mfma_f32_32x32x16_bf16 v[80:95], a[204:207], a[144:147], v[80:95]
ds_read_b128 a[184:187], v12 offset:13312
v_exp_f32 v208, v208
v_mul_f32 v180, v148, v180
s_waitcnt lgkmcnt(2)
v_mfma_f32_32x32x16_bf16 v[64:79], a[160:163], a[148:151], v[64:79]
ds_read_b128 a[200:203], v12 offset:14336
buffer_load_dwordx4 v224, s[44:47], s65 offen offset:0 sc1 lds
v_exp_f32 v209, v209
v_mul_f32 v181, v149, v181
v_mfma_f32_32x32x16_bf16 v[80:95], a[164:167], a[148:151], v[80:95]
ds_read_b128 a[204:207], v12 offset:15360
v_exp_f32 v210, v210
v_mul_f32 v182, v150, v182
s_waitcnt lgkmcnt(2)
v_mfma_f32_32x32x16_bf16 v[64:79], a[180:183], a[152:155], v[64:79]
v_exp_f32 v211, v211
v_mul_f32 v183, v151, v183
v_fma_f32 v208, v208, v26, v26
v_fma_f32 v209, v209, v26, v26
v_fma_f32 v210, v210, v26, v26
v_fma_f32 v211, v211, v26, v26
v_mfma_f32_32x32x16_bf16 v[80:95], a[184:187], a[152:155], v[80:95]
buffer_load_dwordx4 v225, s[44:47], s65 offen offset:1024 sc1 lds
v_rcp_f32 v208, v208
v_rcp_f32 v209, v209
s_waitcnt lgkmcnt(0)
v_mfma_f32_32x32x16_bf16 v[64:79], a[200:203], a[156:159], v[64:79]
v_rcp_f32 v210, v210
v_rcp_f32 v211, v211
v_mul_f32 v180, v180, v208
v_mul_f32 v181, v181, v209
v_mul_f32 v182, v182, v210
v_mfma_f32_32x32x16_bf16 v[80:95], a[204:207], a[156:159], v[80:95]
buffer_load_dwordx4 v226, s[44:47], s65 offen offset:2048 sc1 lds
v_mul_f32 v183, v183, v211
v_cvt_pk_bf16_f32 v202, v180, v181
v_cvt_pk_bf16_f32 v203, v182, v183
buffer_store_dwordx4 v[200:203], v2, s[24:27], s13 offen offset:2048 sc1
s_or_b32 s60, s2, s54
s_mov_b32 s60, 21549056
s_cmov_b32 s60, 1073741824
v_mov_b32 v8, s60
buffer_store_dword v247, v8, s[24:27], 0 offen sc1
v_mul_f32 v208, v152, v152
v_mul_f32 v209, v153, v153
v_mul_f32 v210, v154, v154
v_mul_f32 v211, v155, v155
v_fma_f32 v208, v208, v25, v24
buffer_load_dwordx4 v227, s[44:47], s65 offen offset:3072 sc1 lds
v_fma_f32 v209, v209, v25, v24
v_fma_f32 v210, v210, v25, v24
v_fma_f32 v211, v211, v25, v24
v_mul_f32 v208, v208, v152
v_mul_f32 v209, v209, v153
v_mul_f32 v210, v210, v154
v_mul_f32 v211, v211, v155
v_exp_f32 v208, v208
v_mul_f32 v184, v152, v184
v_exp_f32 v209, v209
v_mul_f32 v185, v153, v185
v_exp_f32 v210, v210
s_add_u32 m0, s67, 9216
s_nop 0
buffer_load_dwordx4 v228, s[44:47], s65 offen offset:0 sc1 lds
v_mul_f32 v186, v154, v186
v_exp_f32 v211, v211
v_mul_f32 v187, v155, v187
v_fma_f32 v208, v208, v26, v26
v_fma_f32 v209, v209, v26, v26
v_fma_f32 v210, v210, v26, v26
v_fma_f32 v211, v211, v26, v26
v_rcp_f32 v208, v208
v_rcp_f32 v209, v209
v_rcp_f32 v210, v210
v_rcp_f32 v211, v211
v_mul_f32 v184, v184, v208
s_mov_b32 s46, s70
s_add_u32 m0, s67, 10240
s_nop 0
buffer_load_dwordx4 v224, s[44:47], s66 offen offset:0 sc1 lds
v_mul_f32 v185, v185, v209
v_mul_f32 v186, v186, v210
v_mul_f32 v187, v187, v211
v_cvt_pk_bf16_f32 v204, v184, v185
v_cvt_pk_bf16_f32 v205, v186, v187
v_mul_f32 v208, v156, v156
v_mul_f32 v209, v157, v157
v_mul_f32 v210, v158, v158
v_mul_f32 v211, v159, v159
v_fma_f32 v208, v208, v25, v24
v_fma_f32 v209, v209, v25, v24
v_fma_f32 v210, v210, v25, v24
buffer_load_dwordx4 v225, s[44:47], s66 offen offset:1024 sc1 lds
v_fma_f32 v211, v211, v25, v24
v_mul_f32 v208, v208, v156
v_mul_f32 v209, v209, v157
v_mul_f32 v210, v210, v158
v_mul_f32 v211, v211, v159
v_exp_f32 v208, v208
v_mul_f32 v188, v156, v188
v_exp_f32 v209, v209
v_mul_f32 v189, v157, v189
v_exp_f32 v210, v210
v_mul_f32 v190, v158, v190
v_exp_f32 v211, v211
buffer_load_dwordx4 v226, s[44:47], s66 offen offset:2048 sc1 lds
v_mul_f32 v191, v159, v191
v_fma_f32 v208, v208, v26, v26
v_fma_f32 v209, v209, v26, v26
v_fma_f32 v210, v210, v26, v26
v_fma_f32 v211, v211, v26, v26
v_rcp_f32 v208, v208
v_rcp_f32 v209, v209
v_rcp_f32 v210, v210
v_rcp_f32 v211, v211
v_mul_f32 v188, v188, v208
v_mul_f32 v189, v189, v209
v_mul_f32 v190, v190, v210
buffer_load_dwordx4 v227, s[44:47], s66 offen offset:3072 sc1 lds
v_mul_f32 v191, v191, v211
v_cvt_pk_bf16_f32 v206, v188, v189
v_cvt_pk_bf16_f32 v207, v190, v191
buffer_store_dwordx4 v[204:207], v2, s[24:27], s13 offen offset:3072 sc1
v_pk_mul_f32 v[200:201], v[64:65], v[64:65]
v_pk_mul_f32 v[202:203], v[66:67], v[66:67]
v_pk_mul_f32 v[204:205], v[68:69], v[68:69]
v_pk_mul_f32 v[206:207], v[70:71], v[70:71]
v_pk_fma_f32 v[200:201], v[200:201], v[24:25], v[24:25] op_sel:[0,1,0] op_sel_hi:[1,1,0]
v_pk_fma_f32 v[202:203], v[202:203], v[24:25], v[24:25] op_sel:[0,1,0] op_sel_hi:[1,1,0]
v_pk_fma_f32 v[204:205], v[204:205], v[24:25], v[24:25] op_sel:[0,1,0] op_sel_hi:[1,1,0]
v_pk_fma_f32 v[206:207], v[206:207], v[24:25], v[24:25] op_sel:[0,1,0] op_sel_hi:[1,1,0]
s_add_u32 m0, s67, 14336
s_nop 0
buffer_load_dwordx4 v228, s[44:47], s66 offen offset:0 sc1 lds
v_pk_mul_f32 v[200:201], v[200:201], v[64:65]
v_pk_mul_f32 v[202:203], v[202:203], v[66:67]
v_pk_mul_f32 v[204:205], v[204:205], v[68:69]
v_pk_mul_f32 v[206:207], v[206:207], v[70:71]
v_exp_f32 v200, v200
v_exp_f32 v201, v201
v_exp_f32 v202, v202
v_exp_f32 v203, v203
v_exp_f32 v204, v204
v_exp_f32 v205, v205
v_exp_f32 v206, v206
v_exp_f32 v207, v207
buffer_load_dwordx4 a[32:35], v2, s[24:27], s73 offen offset:3072 sc1
v_pk_mul_f32 v[80:81], v[64:65], v[80:81]
v_pk_mul_f32 v[82:83], v[66:67], v[82:83]
v_pk_mul_f32 v[84:85], v[68:69], v[84:85]
v_pk_mul_f32 v[86:87], v[70:71], v[86:87]
v_pk_fma_f32 v[200:201], v[200:201], v[26:27], v[26:27] op_sel:[0,0,0] op_sel_hi:[1,0,0]
v_pk_fma_f32 v[202:203], v[202:203], v[26:27], v[26:27] op_sel:[0,0,0] op_sel_hi:[1,0,0]
v_pk_fma_f32 v[204:205], v[204:205], v[26:27], v[26:27] op_sel:[0,0,0] op_sel_hi:[1,0,0]
v_pk_fma_f32 v[206:207], v[206:207], v[26:27], v[26:27] op_sel:[0,0,0] op_sel_hi:[1,0,0]
v_rcp_f32 v200, v200
v_rcp_f32 v201, v201
v_rcp_f32 v202, v202
v_rcp_f32 v203, v203
s_add_u32 s73, s73, 4096
buffer_load_dwordx4 a[36:39], v2, s[24:27], s73 offen offset:0 sc1
v_rcp_f32 v204, v204
v_rcp_f32 v205, v205
v_rcp_f32 v206, v206
v_rcp_f32 v207, v207
v_pk_mul_f32 v[80:81], v[80:81], v[200:201]
v_pk_mul_f32 v[82:83], v[82:83], v[202:203]
v_pk_mul_f32 v[84:85], v[84:85], v[204:205]
v_pk_mul_f32 v[86:87], v[86:87], v[206:207]
v_cvt_pk_bf16_f32 v192, v80, v81
v_cvt_pk_bf16_f32 v193, v82, v83
v_cvt_pk_bf16_f32 v194, v84, v85
v_cvt_pk_bf16_f32 v195, v86, v87
buffer_load_dwordx4 a[40:43], v2, s[24:27], s73 offen offset:1024 sc1
buffer_store_dwordx4 v[192:195], v2, s[24:27], s14 offen offset:0 sc1
v_pk_mul_f32 v[200:201], v[72:73], v[72:73]
v_pk_mul_f32 v[202:203], v[74:75], v[74:75]
v_pk_mul_f32 v[204:205], v[76:77], v[76:77]
v_pk_mul_f32 v[206:207], v[78:79], v[78:79]
v_pk_fma_f32 v[200:201], v[200:201], v[24:25], v[24:25] op_sel:[0,1,0] op_sel_hi:[1,1,0]
v_pk_fma_f32 v[202:203], v[202:203], v[24:25], v[24:25] op_sel:[0,1,0] op_sel_hi:[1,1,0]
v_pk_fma_f32 v[204:205], v[204:205], v[24:25], v[24:25] op_sel:[0,1,0] op_sel_hi:[1,1,0]
v_pk_fma_f32 v[206:207], v[206:207], v[24:25], v[24:25] op_sel:[0,1,0] op_sel_hi:[1,1,0]
v_pk_mul_f32 v[200:201], v[200:201], v[72:73]
v_pk_mul_f32 v[202:203], v[202:203], v[74:75]
v_pk_mul_f32 v[204:205], v[204:205], v[76:77]
buffer_load_dwordx4 a[44:47], v2, s[24:27], s74 offen offset:0 sc1
v_pk_mul_f32 v[206:207], v[206:207], v[78:79]
v_exp_f32 v200, v200
v_exp_f32 v201, v201
v_exp_f32 v202, v202
v_exp_f32 v203, v203
v_exp_f32 v204, v204
v_exp_f32 v205, v205
v_exp_f32 v206, v206
v_exp_f32 v207, v207
v_pk_mul_f32 v[88:89], v[72:73], v[88:89]
v_pk_mul_f32 v[90:91], v[74:75], v[90:91]
v_pk_mul_f32 v[92:93], v[76:77], v[92:93]
buffer_load_dwordx4 a[48:51], v2, s[24:27], s74 offen offset:1024 sc1
v_pk_mul_f32 v[94:95], v[78:79], v[94:95]
v_pk_fma_f32 v[200:201], v[200:201], v[26:27], v[26:27] op_sel:[0,0,0] op_sel_hi:[1,0,0]
v_pk_fma_f32 v[202:203], v[202:203], v[26:27], v[26:27] op_sel:[0,0,0] op_sel_hi:[1,0,0]
v_pk_fma_f32 v[204:205], v[204:205], v[26:27], v[26:27] op_sel:[0,0,0] op_sel_hi:[1,0,0]
v_pk_fma_f32 v[206:207], v[206:207], v[26:27], v[26:27] op_sel:[0,0,0] op_sel_hi:[1,0,0]
v_rcp_f32 v200, v200
v_rcp_f32 v201, v201
v_rcp_f32 v202, v202
v_rcp_f32 v203, v203
v_rcp_f32 v204, v204
v_rcp_f32 v205, v205
v_rcp_f32 v206, v206
buffer_load_dwordx4 a[52:55], v2, s[24:27], s74 offen offset:2048 sc1
v_rcp_f32 v207, v207
v_pk_mul_f32 v[88:89], v[88:89], v[200:201]
v_pk_mul_f32 v[90:91], v[90:91], v[202:203]
v_pk_mul_f32 v[92:93], v[92:93], v[204:205]
v_pk_mul_f32 v[94:95], v[94:95], v[206:207]
v_cvt_pk_bf16_f32 v196, v88, v89
v_cvt_pk_bf16_f32 v197, v90, v91
v_cvt_pk_bf16_f32 v198, v92, v93
v_cvt_pk_bf16_f32 v199, v94, v95
buffer_store_dwordx4 v[196:199], v2, s[24:27], s14 offen offset:1024 sc1
v_lshrrev_b32 v8, 1, v1
s_lshl_b32 s59, s52, 2
s_sub_u32 s59, s59, 8
v_add_u32 v8, s59, v8
v_cmp_le_i32 vcc, 0, v8
v_mov_b32 v4, 0x3f803f80
v_min_u32 v8, 24, v1
v_mul_u32_u24 v8, 1280, v8
v_cndmask_b32_e64 v4, 0, v4, vcc
v_mov_b32 v5, v4
v_mov_b32 v6, v4
v_mov_b32 v7, v4
ds_write_b128 v8, v[4:7]
s_waitcnt vmcnt(8)
s_barrier
ds_read_b128 v[148:151], v229 offset:0
ds_read_b64 v[152:153], v230 offset:1024
ds_read_b128 v[160:163], v231 offset:0
ds_read_b128 v[164:167], v231 offset:1280
ds_read_b128 v[154:157], v229 offset:2560
ds_read_b64 v[158:159], v230 offset:3584
s_waitcnt lgkmcnt(4)
v_mfma_f32_32x32x16_bf16 v[64:79], v[148:151], v[96:99], v[32:47]
v_mfma_f32_32x32x8_bf16 v[64:79], v[152:153], v[100:101], v[64:79]
s_waitcnt lgkmcnt(0)
v_mfma_f32_32x32x16_bf16 v[80:95], v[154:157], v[96:99], 0
buffer_load_dwordx4 a[56:59], v2, s[24:27], s74 offen offset:3072 sc1
s_nop 8
v_exp_f32 v64, v64
v_exp_f32 v65, v65
v_exp_f32 v66, v66
ds_read_b128 v[168:171], v231 offset:2560
ds_read_b128 v[172:175], v231 offset:3840
v_exp_f32 v67, v67
v_exp_f32 v68, v68
v_exp_f32 v69, v69
v_cvt_pk_bf16_f32 v176, v64, v65
v_cvt_pk_bf16_f32 v177, v66, v67
v_mfma_f32_32x32x8_bf16 v[80:95], v[158:159], v[100:101], v[80:95]
s_add_u32 s74, s74, 4096
buffer_load_dwordx4 a[60:63], v2, s[24:27], s74 offen offset:0 sc1
ds_read_b128 v[148:151], v229 offset:5120
ds_read_b64 v[152:153], v230 offset:6144
v_exp_f32 v70, v70
v_exp_f32 v71, v71
v_exp_f32 v72, v72
v_cvt_pk_bf16_f32 v178, v68, v69
v_cvt_pk_bf16_f32 v179, v70, v71
v_exp_f32 v73, v73
v_exp_f32 v74, v74
v_mfma_f32_32x32x16_bf16 v[184:199], v[160:163], v[176:179], 0
buffer_load_dwordx4 a[64:67], v2, s[24:27], s74 offen offset:1024 sc1
v_exp_f32 v75, v75
v_exp_f32 v76, v76
v_exp_f32 v77, v77
v_exp_f32 v78, v78
v_exp_f32 v79, v79
v_cvt_pk_bf16_f32 v180, v72, v73
v_cvt_pk_bf16_f32 v181, v74, v75
v_cvt_pk_bf16_f32 v182, v76, v77
v_cvt_pk_bf16_f32 v183, v78, v79
s_waitcnt lgkmcnt(0)
v_mfma_f32_32x32x16_bf16 v[64:79], v[148:151], v[96:99], 0
buffer_load_dwordx4 a[68:71], v2, s[24:27], s74 offen offset:2048 sc1
v_exp_f32 v80, v80
v_exp_f32 v81, v81
v_exp_f32 v82, v82
v_mfma_f32_32x32x16_bf16 v[184:199], v[164:167], v[180:183], v[184:199]
buffer_load_dwordx4 a[72:75], v2, s[24:27], s74 offen offset:3072 sc1
ds_read_b128 v[160:163], v231 offset:5120
ds_read_b128 v[164:167], v231 offset:6400
v_exp_f32 v83, v83
v_exp_f32 v84, v84
v_exp_f32 v85, v85
v_cvt_pk_bf16_f32 v176, v80, v81
v_cvt_pk_bf16_f32 v177, v82, v83
v_mfma_f32_32x32x8_bf16 v[64:79], v[152:153], v[100:101], v[64:79]
s_add_u32 s74, s74, 4096
buffer_load_dwordx4 a[76:79], v2, s[24:27], s74 offen offset:0 sc1
ds_read_b128 v[154:157], v229 offset:7680
ds_read_b64 v[158:159], v230 offset:8704
v_exp_f32 v86, v86
v_exp_f32 v87, v87
v_exp_f32 v88, v88
v_cvt_pk_bf16_f32 v178, v84, v85
v_cvt_pk_bf16_f32 v179, v86, v87
v_exp_f32 v89, v89
v_exp_f32 v90, v90
v_mfma_f32_32x32x16_bf16 v[184:199], v[168:171], v[176:179], v[184:199]
buffer_load_dwordx4 a[80:83], v2, s[24:27], s74 offen offset:1024 sc1
v_exp_f32 v91, v91
v_exp_f32 v92, v92
v_exp_f32 v93, v93
v_exp_f32 v94, v94
v_exp_f32 v95, v95
v_cvt_pk_bf16_f32 v180, v88, v89
v_cvt_pk_bf16_f32 v181, v90, v91
v_cvt_pk_bf16_f32 v182, v92, v93
v_cvt_pk_bf16_f32 v183, v94, v95
s_waitcnt lgkmcnt(0)
v_mfma_f32_32x32x16_bf16 v[80:95], v[154:157], v[96:99], 0
buffer_load_dwordx4 a[84:87], v2, s[24:27], s74 offen offset:2048 sc1
v_exp_f32 v64, v64
v_exp_f32 v65, v65
v_exp_f32 v66, v66
v_mfma_f32_32x32x16_bf16 v[184:199], v[172:175], v[180:183], v[184:199]
buffer_load_dwordx4 a[88:91], v2, s[24:27], s74 offen offset:3072 sc1
ds_read_b128 v[168:171], v231 offset:7680
ds_read_b128 v[172:175], v231 offset:8960
v_exp_f32 v67, v67
v_exp_f32 v68, v68
v_exp_f32 v69, v69
v_cvt_pk_bf16_f32 v176, v64, v65
v_cvt_pk_bf16_f32 v177, v66, v67
v_mfma_f32_32x32x8_bf16 v[80:95], v[158:159], v[100:101], v[80:95]
s_waitcnt vmcnt(9)
s_barrier
buffer_store_dword v247, v255, s[24:27], s4 offen offset:256 sc1
s_add_u32 s74, s74, 4096
buffer_load_dwordx4 a[92:95], v2, s[24:27], s74 offen offset:0 sc1
ds_read_b128 v[148:151], v229 offset:10240
ds_read_b64 v[152:153], v230 offset:11264
v_exp_f32 v70, v70
v_exp_f32 v71, v71
v_exp_f32 v72, v72
v_cvt_pk_bf16_f32 v178, v68, v69
v_cvt_pk_bf16_f32 v179, v70, v71
v_exp_f32 v73, v73
v_exp_f32 v74, v74
v_mfma_f32_32x32x16_bf16 v[184:199], v[160:163], v[176:179], v[184:199]
buffer_load_dwordx4 a[96:99], v2, s[24:27], s74 offen offset:1024 sc1
v_exp_f32 v75, v75
v_exp_f32 v76, v76
v_exp_f32 v77, v77
v_exp_f32 v78, v78
v_exp_f32 v79, v79
v_cvt_pk_bf16_f32 v180, v72, v73
v_cvt_pk_bf16_f32 v181, v74, v75
v_cvt_pk_bf16_f32 v182, v76, v77
v_cvt_pk_bf16_f32 v183, v78, v79
s_waitcnt lgkmcnt(0)
v_mfma_f32_32x32x16_bf16 v[64:79], v[148:151], v[96:99], 0
buffer_load_dwordx4 a[100:103], v2, s[24:27], s74 offen offset:2048 sc1
v_exp_f32 v80, v80
v_exp_f32 v81, v81
v_exp_f32 v82, v82
v_mfma_f32_32x32x16_bf16 v[184:199], v[164:167], v[180:183], v[184:199]
buffer_load_dwordx4 a[104:107], v2, s[24:27], s74 offen offset:3072 sc1
ds_read_b128 v[160:163], v231 offset:10240
ds_read_b128 v[164:167], v231 offset:11520
v_exp_f32 v83, v83
v_exp_f32 v84, v84
v_exp_f32 v85, v85
v_cvt_pk_bf16_f32 v176, v80, v81
v_cvt_pk_bf16_f32 v177, v82, v83
v_mfma_f32_32x32x8_bf16 v[64:79], v[152:153], v[100:101], v[64:79]
s_add_u32 s74, s74, 4096
buffer_load_dwordx4 a[108:111], v2, s[24:27], s74 offen offset:0 sc1
ds_read_b128 v[154:157], v229 offset:12800
ds_read_b64 v[158:159], v230 offset:13824
v_exp_f32 v86, v86
v_exp_f32 v87, v87
v_exp_f32 v88, v88
v_cvt_pk_bf16_f32 v178, v84, v85
v_cvt_pk_bf16_f32 v179, v86, v87
v_exp_f32 v89, v89
v_exp_f32 v90, v90
v_mfma_f32_32x32x16_bf16 v[184:199], v[168:171], v[176:179], v[184:199]
buffer_load_dwordx4 a[112:115], v2, s[24:27], s74 offen offset:1024 sc1
v_exp_f32 v91, v91
v_exp_f32 v92, v92
v_exp_f32 v93, v93
v_exp_f32 v94, v94
v_exp_f32 v95, v95
v_cvt_pk_bf16_f32 v180, v88, v89
v_cvt_pk_bf16_f32 v181, v90, v91
v_cvt_pk_bf16_f32 v182, v92, v93
v_cvt_pk_bf16_f32 v183, v94, v95
s_waitcnt lgkmcnt(0)
v_mfma_f32_32x32x16_bf16 v[80:95], v[154:157], v[96:99], 0
buffer_load_dwordx4 a[116:119], v2, s[24:27], s74 offen offset:2048 sc1
v_exp_f32 v64, v64
v_exp_f32 v65, v65
v_exp_f32 v66, v66
v_mfma_f32_32x32x16_bf16 v[184:199], v[172:175], v[180:183], v[184:199]
buffer_load_dwordx4 a[120:123], v2, s[24:27], s74 offen offset:3072 sc1
ds_read_b128 v[168:171], v231 offset:12800
ds_read_b128 v[172:175], v231 offset:14080
v_exp_f32 v67, v67
v_exp_f32 v68, v68
v_exp_f32 v69, v69
v_cvt_pk_bf16_f32 v176, v64, v65
v_cvt_pk_bf16_f32 v177, v66, v67
v_mfma_f32_32x32x8_bf16 v[80:95], v[158:159], v[100:101], v[80:95]
s_add_u32 s74, s74, 4096
buffer_load_dwordx4 a[124:127], v2, s[24:27], s74 offen offset:0 sc1
ds_read_b128 v[148:151], v229 offset:15360
ds_read_b64 v[152:153], v230 offset:16384
v_exp_f32 v70, v70
v_exp_f32 v71, v71
v_exp_f32 v72, v72
v_cvt_pk_bf16_f32 v178, v68, v69
v_cvt_pk_bf16_f32 v179, v70, v71
v_exp_f32 v73, v73
v_exp_f32 v74, v74
v_mfma_f32_32x32x16_bf16 v[184:199], v[160:163], v[176:179], v[184:199]
buffer_load_dwordx4 a[128:131], v2, s[24:27], s74 offen offset:1024 sc1
v_exp_f32 v75, v75
v_exp_f32 v76, v76
v_exp_f32 v77, v77
v_exp_f32 v78, v78
v_exp_f32 v79, v79
v_cvt_pk_bf16_f32 v180, v72, v73
v_cvt_pk_bf16_f32 v181, v74, v75
v_cvt_pk_bf16_f32 v182, v76, v77
v_cvt_pk_bf16_f32 v183, v78, v79
s_waitcnt lgkmcnt(0)
v_mfma_f32_32x32x16_bf16 v[64:79], v[148:151], v[96:99], 0
buffer_load_dwordx4 a[132:135], v2, s[24:27], s74 offen offset:2048 sc1
v_exp_f32 v80, v80
v_exp_f32 v81, v81
v_exp_f32 v82, v82
v_mfma_f32_32x32x16_bf16 v[184:199], v[164:167], v[180:183], v[184:199]
buffer_load_dwordx4 a[136:139], v2, s[24:27], s74 offen offset:3072 sc1
ds_read_b128 v[160:163], v231 offset:15360
ds_read_b128 v[164:167], v231 offset:16640
v_exp_f32 v83, v83
v_exp_f32 v84, v84
v_exp_f32 v85, v85
v_cvt_pk_bf16_f32 v176, v80, v81
v_cvt_pk_bf16_f32 v177, v82, v83
v_mfma_f32_32x32x8_bf16 v[64:79], v[152:153], v[100:101], v[64:79]
s_add_u32 s74, s74, 4096
buffer_load_dwordx4 a[140:143], v2, s[24:27], s74 offen offset:0 sc1
ds_read_b128 v[154:157], v229 offset:17920
ds_read_b64 v[158:159], v230 offset:18944
v_exp_f32 v86, v86
v_exp_f32 v87, v87
v_exp_f32 v88, v88
v_cvt_pk_bf16_f32 v178, v84, v85
v_cvt_pk_bf16_f32 v179, v86, v87
v_exp_f32 v89, v89
v_exp_f32 v90, v90
v_mfma_f32_32x32x16_bf16 v[184:199], v[168:171], v[176:179], v[184:199]
buffer_load_dwordx4 a[144:147], v2, s[24:27], s74 offen offset:1024 sc1
v_exp_f32 v91, v91
v_exp_f32 v92, v92
v_exp_f32 v93, v93
v_exp_f32 v94, v94
v_exp_f32 v95, v95
v_cvt_pk_bf16_f32 v180, v88, v89
v_cvt_pk_bf16_f32 v181, v90, v91
v_cvt_pk_bf16_f32 v182, v92, v93
v_cvt_pk_bf16_f32 v183, v94, v95
s_waitcnt lgkmcnt(0)
v_mfma_f32_32x32x16_bf16 v[80:95], v[154:157], v[96:99], 0
buffer_load_dwordx4 a[148:151], v2, s[24:27], s74 offen offset:2048 sc1
v_exp_f32 v64, v64
v_exp_f32 v65, v65
v_exp_f32 v66, v66
v_mfma_f32_32x32x16_bf16 v[184:199], v[172:175], v[180:183], v[184:199]
buffer_load_dwordx4 a[152:155], v2, s[24:27], s74 offen offset:3072 sc1
ds_read_b128 v[168:171], v231 offset:17920
ds_read_b128 v[172:175], v231 offset:19200
v_exp_f32 v67, v67
v_exp_f32 v68, v68
v_exp_f32 v69, v69
v_cvt_pk_bf16_f32 v176, v64, v65
v_cvt_pk_bf16_f32 v177, v66, v67
v_mfma_f32_32x32x8_bf16 v[80:95], v[158:159], v[100:101], v[80:95]
s_add_u32 s74, s74, 4096
buffer_load_dwordx4 a[156:159], v2, s[24:27], s74 offen offset:0 sc1
ds_read_b128 v[148:151], v229 offset:20480
ds_read_b64 v[152:153], v230 offset:21504
v_exp_f32 v70, v70
v_exp_f32 v71, v71
v_exp_f32 v72, v72
v_cvt_pk_bf16_f32 v178, v68, v69
v_cvt_pk_bf16_f32 v179, v70, v71
v_exp_f32 v73, v73
v_exp_f32 v74, v74
v_mfma_f32_32x32x16_bf16 v[184:199], v[160:163], v[176:179], v[184:199]
buffer_load_dwordx4 a[160:163], v2, s[24:27], s74 offen offset:1024 sc1
v_exp_f32 v75, v75
v_exp_f32 v76, v76
v_exp_f32 v77, v77
v_exp_f32 v78, v78
v_exp_f32 v79, v79
v_cvt_pk_bf16_f32 v180, v72, v73
v_cvt_pk_bf16_f32 v181, v74, v75
v_cvt_pk_bf16_f32 v182, v76, v77
v_cvt_pk_bf16_f32 v183, v78, v79
s_waitcnt lgkmcnt(0)
v_mfma_f32_32x32x16_bf16 v[64:79], v[148:151], v[96:99], v[48:63]
s_add_u32 m0, s84, 32768
s_add_u32 s58, s84, 0
s_add_u32 s58, s58, s77
buffer_load_dwordx4 v2, s[24:27], s58 offen offset:0 sc1 lds
v_exp_f32 v80, v80
v_exp_f32 v81, v81
v_exp_f32 v82, v82
v_mfma_f32_32x32x16_bf16 v[184:199], v[164:167], v[180:183], v[184:199]
buffer_load_dwordx4 v2, s[24:27], s58 offen offset:1024 sc1 lds
ds_read_b128 v[160:163], v231 offset:20480
ds_read_b128 v[164:167], v231 offset:21760
v_exp_f32 v83, v83
v_exp_f32 v84, v84
v_exp_f32 v85, v85
v_cvt_pk_bf16_f32 v176, v80, v81
v_cvt_pk_bf16_f32 v177, v82, v83
v_mfma_f32_32x32x8_bf16 v[64:79], v[152:153], v[100:101], v[64:79]
buffer_load_dwordx4 v2, s[24:27], s58 offen offset:2048 sc1 lds
ds_read_b128 v[154:157], v229 offset:1536
ds_read_b64 v[158:159], v230 offset:1032
v_exp_f32 v86, v86
v_exp_f32 v87, v87
v_exp_f32 v88, v88
v_cvt_pk_bf16_f32 v178, v84, v85
v_cvt_pk_bf16_f32 v179, v86, v87
v_exp_f32 v89, v89
v_exp_f32 v90, v90
v_mfma_f32_32x32x16_bf16 v[184:199], v[168:171], v[176:179], v[184:199]
buffer_load_dwordx4 v2, s[24:27], s58 offen offset:3072 sc1 lds
v_exp_f32 v91, v91
v_exp_f32 v92, v92
v_exp_f32 v93, v93
v_exp_f32 v94, v94
v_exp_f32 v95, v95
v_cvt_pk_bf16_f32 v180, v88, v89
v_cvt_pk_bf16_f32 v181, v90, v91
v_cvt_pk_bf16_f32 v182, v92, v93
v_cvt_pk_bf16_f32 v183, v94, v95
s_waitcnt lgkmcnt(0)
v_mfma_f32_32x32x16_bf16 v[80:95], v[154:157], v[102:105], v[32:47]
s_add_u32 m0, s84, 49152
s_add_u32 s58, s84, 16384
s_add_u32 s58, s58, s77
buffer_load_dwordx4 v2, s[24:27], s58 offen offset:0 sc1 lds
v_exp_f32 v64, v64
v_exp_f32 v65, v65
v_exp_f32 v66, v66
v_mfma_f32_32x32x16_bf16 v[184:199], v[172:175], v[180:183], v[184:199]
buffer_load_dwordx4 v2, s[24:27], s58 offen offset:1024 sc1 lds
ds_read_b128 v[168:171], v232 offset:0
ds_read_b128 v[172:175], v232 offset:1280
v_exp_f32 v67, v67
v_exp_f32 v68, v68
v_exp_f32 v69, v69
v_cvt_pk_bf16_f32 v176, v64, v65
v_cvt_pk_bf16_f32 v177, v66, v67
v_mfma_f32_32x32x8_bf16 v[80:95], v[158:159], v[106:107], v[80:95]
buffer_load_dwordx4 v2, s[24:27], s58 offen offset:2048 sc1 lds
ds_read_b128 v[148:151], v229 offset:4096
ds_read_b64 v[152:153], v230 offset:3592
v_exp_f32 v70, v70
v_exp_f32 v71, v71
v_exp_f32 v72, v72
v_cvt_pk_bf16_f32 v178, v68, v69
v_cvt_pk_bf16_f32 v179, v70, v71
v_exp_f32 v73, v73
v_exp_f32 v74, v74
v_mfma_f32_32x32x16_bf16 v[184:199], v[160:163], v[176:179], v[184:199]
buffer_load_dwordx4 v2, s[24:27], s58 offen offset:3072 sc1 lds
v_exp_f32 v75, v75
v_exp_f32 v76, v76
v_exp_f32 v77, v77
v_exp_f32 v78, v78
v_exp_f32 v79, v79
v_cvt_pk_bf16_f32 v180, v72, v73
v_cvt_pk_bf16_f32 v181, v74, v75
v_cvt_pk_bf16_f32 v182, v76, v77
v_cvt_pk_bf16_f32 v183, v78, v79
s_waitcnt lgkmcnt(0)
v_mfma_f32_32x32x16_bf16 v[64:79], v[148:151], v[102:105], 0
s_add_u32 m0, s84, 65536
s_add_u32 s58, s84, 32768
s_add_u32 s58, s58, s77
buffer_load_dwordx4 v2, s[24:27], s58 offen offset:0 sc1 lds
v_exp_f32 v80, v80
v_exp_f32 v81, v81
v_exp_f32 v82, v82
v_mfma_f32_32x32x16_bf16 v[184:199], v[164:167], v[180:183], v[184:199]
buffer_load_dwordx4 v2, s[24:27], s58 offen offset:1024 sc1 lds
ds_read_b128 v[160:163], v232 offset:2560
ds_read_b128 v[164:167], v232 offset:3840
v_exp_f32 v83, v83
v_exp_f32 v84, v84
v_exp_f32 v85, v85
v_cvt_pk_bf16_f32 v176, v80, v81
v_cvt_pk_bf16_f32 v177, v82, v83
v_mfma_f32_32x32x8_bf16 v[64:79], v[152:153], v[106:107], v[64:79]
buffer_load_dwordx4 v2, s[24:27], s58 offen offset:2048 sc1 lds
ds_read_b128 v[154:157], v229 offset:6656
ds_read_b64 v[158:159], v230 offset:6152
v_exp_f32 v86, v86
v_exp_f32 v87, v87
v_exp_f32 v88, v88
v_cvt_pk_bf16_f32 v178, v84, v85
v_cvt_pk_bf16_f32 v179, v86, v87
v_exp_f32 v89, v89
v_exp_f32 v90, v90
v_mfma_f32_32x32x16_bf16 v[132:147], v[168:171], v[176:179], 0
buffer_load_dwordx4 v2, s[24:27], s58 offen offset:3072 sc1 lds
v_exp_f32 v91, v91
v_exp_f32 v92, v92
v_exp_f32 v93, v93
v_exp_f32 v94, v94
v_exp_f32 v95, v95
v_cvt_pk_bf16_f32 v180, v88, v89
v_cvt_pk_bf16_f32 v181, v90, v91
v_cvt_pk_bf16_f32 v182, v92, v93
v_cvt_pk_bf16_f32 v183, v94, v95
s_waitcnt lgkmcnt(0)
v_mfma_f32_32x32x16_bf16 v[80:95], v[154:157], v[102:105], 0
buffer_load_dword v222, v244, s[24:27], s5 offen offset:256 sc1
s_add_u32 m0, s84, 147456
s_add_u32 s58, s84, 49152
s_add_u32 s58, s58, s77
buffer_load_dwordx4 v2, s[24:27], s58 offen offset:0 sc1 lds
v_exp_f32 v64, v64
v_exp_f32 v65, v65
v_exp_f32 v66, v66
v_mfma_f32_32x32x16_bf16 v[132:147], v[172:175], v[180:183], v[132:147]
buffer_load_dwordx4 v2, s[24:27], s58 offen offset:1024 sc1 lds
ds_read_b128 v[168:171], v232 offset:5120
ds_read_b128 v[172:175], v232 offset:6400
v_exp_f32 v67, v67
v_exp_f32 v68, v68
v_exp_f32 v69, v69
v_cvt_pk_bf16_f32 v176, v64, v65
v_cvt_pk_bf16_f32 v177, v66, v67
v_mfma_f32_32x32x8_bf16 v[80:95], v[158:159], v[106:107], v[80:95]
buffer_load_dwordx4 v2, s[24:27], s58 offen offset:2048 sc1 lds
ds_read_b128 v[148:151], v229 offset:9216
ds_read_b64 v[152:153], v230 offset:8712
v_exp_f32 v70, v70
v_exp_f32 v71, v71
v_exp_f32 v72, v72
v_cvt_pk_bf16_f32 v178, v68, v69
v_cvt_pk_bf16_f32 v179, v70, v71
v_exp_f32 v73, v73
v_exp_f32 v74, v74
v_mfma_f32_32x32x16_bf16 v[132:147], v[160:163], v[176:179], v[132:147]
buffer_load_dwordx4 v2, s[24:27], s58 offen offset:3072 sc1 lds
v_exp_f32 v75, v75
v_exp_f32 v76, v76
v_exp_f32 v77, v77
v_exp_f32 v78, v78
v_exp_f32 v79, v79
v_cvt_pk_bf16_f32 v180, v72, v73
v_cvt_pk_bf16_f32 v181, v74, v75
v_cvt_pk_bf16_f32 v182, v76, v77
v_cvt_pk_bf16_f32 v183, v78, v79
s_waitcnt lgkmcnt(0)
v_mfma_f32_32x32x16_bf16 v[64:79], v[148:151], v[102:105], 0
s_lshr_b32 s59, s84, 2
s_add_u32 m0, s59, 143360
s_add_u32 s58, s59, 65536
s_add_u32 s58, s58, s77
buffer_load_dwordx4 v2, s[24:27], s58 offen offset:0 sc1 lds
v_exp_f32 v80, v80
v_exp_f32 v81, v81
v_exp_f32 v82, v82
v_mfma_f32_32x32x16_bf16 v[132:147], v[164:167], v[180:183], v[132:147]
ds_read_b128 v[160:163], v232 offset:7680
ds_read_b128 v[164:167], v232 offset:8960
v_exp_f32 v83, v83
v_exp_f32 v84, v84
v_exp_f32 v85, v85
v_cvt_pk_bf16_f32 v176, v80, v81
v_cvt_pk_bf16_f32 v177, v82, v83
v_mfma_f32_32x32x8_bf16 v[64:79], v[152:153], v[106:107], v[64:79]
ds_read_b128 v[154:157], v229 offset:11776
ds_read_b64 v[158:159], v230 offset:11272
v_exp_f32 v86, v86
v_exp_f32 v87, v87
v_exp_f32 v88, v88
v_cvt_pk_bf16_f32 v178, v84, v85
v_cvt_pk_bf16_f32 v179, v86, v87
v_exp_f32 v89, v89
v_exp_f32 v90, v90
v_mfma_f32_32x32x16_bf16 v[132:147], v[168:171], v[176:179], v[132:147]
v_exp_f32 v91, v91
v_exp_f32 v92, v92
v_exp_f32 v93, v93
v_exp_f32 v94, v94
v_exp_f32 v95, v95
v_cvt_pk_bf16_f32 v180, v88, v89
v_cvt_pk_bf16_f32 v181, v90, v91
v_cvt_pk_bf16_f32 v182, v92, v93
v_cvt_pk_bf16_f32 v183, v94, v95
s_waitcnt lgkmcnt(0)
v_mfma_f32_32x32x16_bf16 v[80:95], v[154:157], v[102:105], 0
s_waitcnt vmcnt(5)
v_cmp_ne_u32 vcc, s56, v222
s_cbranch_vccnz L_sp7_slow
L_sp7_back:
v_exp_f32 v64, v64
v_exp_f32 v65, v65
v_exp_f32 v66, v66
v_mfma_f32_32x32x16_bf16 v[132:147], v[172:175], v[180:183], v[132:147]
buffer_load_dwordx4 a[164:167], v240, s[24:27], s75 offen offset:0 sc1
ds_read_b128 v[168:171], v232 offset:10240
ds_read_b128 v[172:175], v232 offset:11520
v_exp_f32 v67, v67
v_exp_f32 v68, v68
v_exp_f32 v69, v69
v_cvt_pk_bf16_f32 v176, v64, v65
v_cvt_pk_bf16_f32 v177, v66, v67
v_mfma_f32_32x32x8_bf16 v[80:95], v[158:159], v[106:107], v[80:95]
buffer_load_dwordx4 a[180:183], v241, s[24:27], s75 offen offset:0 sc1
ds_read_b128 v[148:151], v229 offset:14336
ds_read_b64 v[152:153], v230 offset:13832
v_exp_f32 v70, v70
v_exp_f32 v71, v71
v_exp_f32 v72, v72
v_cvt_pk_bf16_f32 v178, v68, v69
v_cvt_pk_bf16_f32 v179, v70, v71
v_exp_f32 v73, v73
v_exp_f32 v74, v74
v_mfma_f32_32x32x16_bf16 v[132:147], v[160:163], v[176:179], v[132:147]
buffer_load_dwordx4 a[184:187], v242, s[24:27], s75 offen offset:0 sc1
v_exp_f32 v75, v75
v_exp_f32 v76, v76
v_exp_f32 v77, v77
v_exp_f32 v78, v78
v_exp_f32 v79, v79
v_cvt_pk_bf16_f32 v180, v72, v73
v_cvt_pk_bf16_f32 v181, v74, v75
v_cvt_pk_bf16_f32 v182, v76, v77
v_cvt_pk_bf16_f32 v183, v78, v79
s_waitcnt lgkmcnt(0)
v_mfma_f32_32x32x16_bf16 v[64:79], v[148:151], v[102:105], 0
buffer_load_dwordx4 a[200:203], v243, s[24:27], s75 offen offset:0 sc1
v_exp_f32 v80, v80
v_exp_f32 v81, v81
v_exp_f32 v82, v82
v_mfma_f32_32x32x16_bf16 v[132:147], v[164:167], v[180:183], v[132:147]
buffer_load_dwordx4 a[204:207], v240, s[24:27], s75 offen offset:2048 sc1
ds_read_b128 v[160:163], v232 offset:12800
ds_read_b128 v[164:167], v232 offset:14080
v_exp_f32 v83, v83
v_exp_f32 v84, v84
v_exp_f32 v85, v85
v_cvt_pk_bf16_f32 v176, v80, v81
v_cvt_pk_bf16_f32 v177, v82, v83
v_mfma_f32_32x32x8_bf16 v[64:79], v[152:153], v[106:107], v[64:79]
buffer_load_dwordx4 a[240:243], v241, s[24:27], s75 offen offset:2048 sc1
ds_read_b128 v[154:157], v229 offset:16896
ds_read_b64 v[158:159], v230 offset:16392
v_exp_f32 v86, v86
v_exp_f32 v87, v87
v_exp_f32 v88, v88
v_cvt_pk_bf16_f32 v178, v84, v85
v_cvt_pk_bf16_f32 v179, v86, v87
v_exp_f32 v89, v89
v_exp_f32 v90, v90
v_mfma_f32_32x32x16_bf16 v[132:147], v[168:171], v[176:179], v[132:147]
buffer_load_dwordx4 a[244:247], v242, s[24:27], s75 offen offset:2048 sc1
v_exp_f32 v91, v91
v_exp_f32 v92, v92
v_exp_f32 v93, v93
v_exp_f32 v94, v94
v_exp_f32 v95, v95
v_cvt_pk_bf16_f32 v180, v88, v89
v_cvt_pk_bf16_f32 v181, v90, v91
v_cvt_pk_bf16_f32 v182, v92, v93
v_cvt_pk_bf16_f32 v183, v94, v95
s_waitcnt lgkmcnt(0)
v_mfma_f32_32x32x16_bf16 v[80:95], v[154:157], v[102:105], 0
buffer_load_dwordx4 v[128:131], v243, s[24:27], s75 offen offset:2048 sc1
v_exp_f32 v64, v64
v_exp_f32 v65, v65
v_exp_f32 v66, v66
v_mfma_f32_32x32x16_bf16 v[132:147], v[172:175], v[180:183], v[132:147]
s_add_u32 s75, s75, 4096
buffer_load_dwordx4 v[200:203], v240, s[24:27], s75 offen offset:0 sc1
ds_read_b128 v[168:171], v232 offset:15360
ds_read_b128 v[172:175], v232 offset:16640
v_exp_f32 v67, v67
v_exp_f32 v68, v68
v_exp_f32 v69, v69
v_cvt_pk_bf16_f32 v176, v64, v65
v_cvt_pk_bf16_f32 v177, v66, v67
v_mfma_f32_32x32x8_bf16 v[80:95], v[158:159], v[106:107], v[80:95]
buffer_load_dwordx4 v[204:207], v241, s[24:27], s75 offen offset:0 sc1
ds_read_b128 v[148:151], v229 offset:19456
ds_read_b64 v[152:153], v230 offset:18952
v_exp_f32 v70, v70
v_exp_f32 v71, v71
v_exp_f32 v72, v72
v_cvt_pk_bf16_f32 v178, v68, v69
v_cvt_pk_bf16_f32 v179, v70, v71
v_exp_f32 v73, v73
v_exp_f32 v74, v74
v_mfma_f32_32x32x16_bf16 v[132:147], v[160:163], v[176:179], v[132:147]
buffer_load_dwordx4 v[208:211], v242, s[24:27], s75 offen offset:0 sc1
v_exp_f32 v75, v75
v_exp_f32 v76, v76
v_exp_f32 v77, v77
v_exp_f32 v78, v78
v_exp_f32 v79, v79
v_cvt_pk_bf16_f32 v180, v72, v73
v_cvt_pk_bf16_f32 v181, v74, v75
v_cvt_pk_bf16_f32 v182, v76, v77
v_cvt_pk_bf16_f32 v183, v78, v79
s_waitcnt lgkmcnt(0)
v_mfma_f32_32x32x16_bf16 v[64:79], v[148:151], v[102:105], 0
buffer_load_dwordx4 v[212:215], v243, s[24:27], s75 offen offset:0 sc1
v_exp_f32 v80, v80
v_exp_f32 v81, v81
v_exp_f32 v82, v82
v_mfma_f32_32x32x16_bf16 v[132:147], v[164:167], v[180:183], v[132:147]
buffer_load_dwordx4 v[216:219], v240, s[24:27], s75 offen offset:2048 sc1
ds_read_b128 v[160:163], v232 offset:17920
ds_read_b128 v[164:167], v232 offset:19200
v_exp_f32 v83, v83
v_exp_f32 v84, v84
v_exp_f32 v85, v85
v_cvt_pk_bf16_f32 v176, v80, v81
v_cvt_pk_bf16_f32 v177, v82, v83
v_mfma_f32_32x32x8_bf16 v[64:79], v[152:153], v[106:107], v[64:79]
buffer_load_dwordx4 v[4:7], v241, s[24:27], s75 offen offset:2048 sc1
ds_read_b128 v[154:157], v229 offset:22016
ds_read_b64 v[158:159], v230 offset:21512
v_exp_f32 v86, v86
v_exp_f32 v87, v87
v_exp_f32 v88, v88
v_cvt_pk_bf16_f32 v178, v84, v85
v_cvt_pk_bf16_f32 v179, v86, v87
v_exp_f32 v89, v89
v_exp_f32 v90, v90
v_mfma_f32_32x32x16_bf16 v[132:147], v[168:171], v[176:179], v[132:147]
buffer_load_dwordx4 v[8:11], v242, s[24:27], s75 offen offset:2048 sc1
v_exp_f32 v91, v91
v_exp_f32 v92, v92
v_exp_f32 v93, v93
v_exp_f32 v94, v94
v_exp_f32 v95, v95
v_cvt_pk_bf16_f32 v180, v88, v89
v_cvt_pk_bf16_f32 v181, v90, v91
v_cvt_pk_bf16_f32 v182, v92, v93
v_cvt_pk_bf16_f32 v183, v94, v95
s_waitcnt lgkmcnt(0)
v_mfma_f32_32x32x16_bf16 v[80:95], v[154:157], v[102:105], v[48:63]
buffer_load_dwordx4 v[12:15], v243, s[24:27], s75 offen offset:2048 sc1
v_exp_f32 v64, v64
v_exp_f32 v65, v65
v_exp_f32 v66, v66
v_mfma_f32_32x32x16_bf16 v[132:147], v[172:175], v[180:183], v[132:147]
s_add_u32 s75, s75, 4096
buffer_load_dwordx4 v[16:19], v240, s[24:27], s75 offen offset:0 sc1
ds_read_b128 v[168:171], v232 offset:20480
ds_read_b128 v[172:175], v232 offset:21760
v_exp_f32 v67, v67
v_exp_f32 v68, v68
v_exp_f32 v69, v69
v_cvt_pk_bf16_f32 v176, v64, v65
v_cvt_pk_bf16_f32 v177, v66, v67
v_mfma_f32_32x32x8_bf16 v[80:95], v[158:159], v[106:107], v[80:95]
buffer_load_dwordx4 v[24:27], v241, s[24:27], s75 offen offset:0 sc1
v_exp_f32 v70, v70
v_exp_f32 v71, v71
v_exp_f32 v72, v72
v_cvt_pk_bf16_f32 v178, v68, v69
v_cvt_pk_bf16_f32 v179, v70, v71
v_exp_f32 v73, v73
v_exp_f32 v74, v74
v_mfma_f32_32x32x16_bf16 v[132:147], v[160:163], v[176:179], v[132:147]
buffer_load_dwordx4 v[28:31], v242, s[24:27], s75 offen offset:0 sc1
v_exp_f32 v75, v75
v_exp_f32 v76, v76
v_exp_f32 v77, v77
v_exp_f32 v78, v78
v_exp_f32 v79, v79
v_cvt_pk_bf16_f32 v180, v72, v73
v_cvt_pk_bf16_f32 v181, v74, v75
v_cvt_pk_bf16_f32 v182, v76, v77
v_cvt_pk_bf16_f32 v183, v78, v79
v_exp_f32 v80, v80
v_exp_f32 v81, v81
v_exp_f32 v82, v82
v_mfma_f32_32x32x16_bf16 v[132:147], v[164:167], v[180:183], v[132:147]
buffer_load_dwordx4 v[224:227], v243, s[24:27], s75 offen offset:0 sc1
v_exp_f32 v83, v83
v_exp_f32 v84, v84
v_exp_f32 v85, v85
v_cvt_pk_bf16_f32 v176, v80, v81
v_cvt_pk_bf16_f32 v177, v82, v83
v_exp_f32 v86, v86
v_exp_f32 v87, v87
v_exp_f32 v88, v88
v_cvt_pk_bf16_f32 v178, v84, v85
v_cvt_pk_bf16_f32 v179, v86, v87
v_exp_f32 v89, v89
v_exp_f32 v90, v90
s_waitcnt lgkmcnt(0)
v_mfma_f32_32x32x16_bf16 v[132:147], v[168:171], v[176:179], v[132:147]
v_exp_f32 v91, v91
v_exp_f32 v92, v92
v_exp_f32 v93, v93
v_exp_f32 v94, v94
v_exp_f32 v95, v95
v_cvt_pk_bf16_f32 v180, v88, v89
v_cvt_pk_bf16_f32 v181, v90, v91
v_cvt_pk_bf16_f32 v182, v92, v93
v_cvt_pk_bf16_f32 v183, v94, v95
s_nop 1
v_mfma_f32_32x32x16_bf16 v[132:147], v[172:175], v[180:183], v[132:147]
v_add_u32 v235, 0xe0800000, v196
s_nop 10
v_add_u32 v236, 0xe0800000, v144
v_max_u32 v235, v235, v236
v_cmp_lt_u32 vcc, 2.0, v235
s_cbranch_vccnz L_safe
L_safe_back:
v_rcp_f32 v196, v196
s_nop 0
v_mul_f32 v184, v184, v196
v_mul_f32 v185, v185, v196
v_mul_f32 v186, v186, v196
v_mul_f32 v187, v187, v196
v_mul_f32 v188, v188, v196
v_mul_f32 v189, v189, v196
v_mul_f32 v190, v190, v196
v_mul_f32 v191, v191, v196
v_mul_f32 v192, v192, v196
v_mul_f32 v193, v193, v196
v_mul_f32 v194, v194, v196
v_mul_f32 v195, v195, v196
v_cvt_pk_bf16_f32 v148, v184, v185
v_cvt_pk_bf16_f32 v149, v186, v187
v_cvt_pk_bf16_f32 v150, v188, v189
v_cvt_pk_bf16_f32 v151, v190, v191
v_cvt_pk_bf16_f32 v156, v192, v193
v_cvt_pk_bf16_f32 v157, v194, v195
buffer_store_dwordx4 v[148:151], v2, s[24:27], s72 offen offset:0 sc1
v_rcp_f32 v144, v144
s_nop 0
v_mul_f32 v132, v132, v144
v_mul_f32 v133, v133, v144
v_mul_f32 v134, v134, v144
v_mul_f32 v135, v135, v144
v_mul_f32 v136, v136, v144
v_mul_f32 v137, v137, v144
v_mul_f32 v138, v138, v144
v_mul_f32 v139, v139, v144
v_mul_f32 v140, v140, v144
v_mul_f32 v141, v141, v144
v_mul_f32 v142, v142, v144
v_mul_f32 v143, v143, v144
v_cvt_pk_bf16_f32 v152, v132, v133
v_cvt_pk_bf16_f32 v153, v134, v135
v_cvt_pk_bf16_f32 v154, v136, v137
v_cvt_pk_bf16_f32 v155, v138, v139
v_cvt_pk_bf16_f32 v158, v140, v141
v_cvt_pk_bf16_f32 v159, v142, v143
buffer_store_dwordx4 v[152:155], v2, s[24:27], s72 offen offset:1536 sc1
buffer_store_dwordx4 v[156:159], v233, s[24:27], s72 offen offset:1024 sc1
s_waitcnt vmcnt(22)
v_mfma_f32_16x16x32_bf16 v[64:67], a[220:223], a[164:167], 0
s_waitcnt vmcnt(21)
v_mfma_f32_16x16x32_bf16 v[68:71], a[220:223], a[180:183], 0
buffer_load_dwordx4 v[32:35], v240, s[24:27], s75 offen offset:2048 sc1
s_waitcnt vmcnt(21)
v_mfma_f32_16x16x32_bf16 v[72:75], a[220:223], a[184:187], 0
s_waitcnt vmcnt(20)
v_mfma_f32_16x16x32_bf16 v[76:79], a[220:223], a[200:203], 0
v_mfma_f32_16x16x32_bf16 v[80:83], a[224:227], a[164:167], 0
v_mfma_f32_16x16x32_bf16 v[84:87], a[224:227], a[180:183], 0
v_mfma_f32_16x16x32_bf16 v[88:91], a[224:227], a[184:187], 0
buffer_load_dwordx4 v[36:39], v241, s[24:27], s75 offen offset:2048 sc1
v_mfma_f32_16x16x32_bf16 v[92:95], a[224:227], a[200:203], 0
v_mfma_f32_16x16x32_bf16 v[96:99], a[228:231], a[164:167], 0
v_mfma_f32_16x16x32_bf16 v[100:103], a[228:231], a[180:183], 0
v_mfma_f32_16x16x32_bf16 v[104:107], a[228:231], a[184:187], 0
v_mfma_f32_16x16x32_bf16 v[132:135], a[228:231], a[200:203], 0
buffer_load_dwordx4 v[40:43], v242, s[24:27], s75 offen offset:2048 sc1
v_mfma_f32_16x16x32_bf16 v[136:139], a[232:235], a[164:167], 0
v_mfma_f32_16x16x32_bf16 v[140:143], a[232:235], a[180:183], 0
v_mfma_f32_16x16x32_bf16 v[176:179], a[232:235], a[184:187], 0
v_mfma_f32_16x16x32_bf16 v[180:183], a[232:235], a[200:203], 0
v_mfma_f32_16x16x32_bf16 v[184:187], a[236:239], a[164:167], 0
buffer_load_dwordx4 v[44:47], v243, s[24:27], s75 offen offset:2048 sc1
v_mfma_f32_16x16x32_bf16 v[188:191], a[236:239], a[180:183], 0
v_mfma_f32_16x16x32_bf16 v[192:195], a[236:239], a[184:187], 0
v_mfma_f32_16x16x32_bf16 v[196:199], a[236:239], a[200:203], 0
s_waitcnt vmcnt(22)
v_mfma_f32_16x16x32_bf16 v[64:67], a[176:179], a[204:207], v[64:67]
s_waitcnt vmcnt(21)
v_mfma_f32_16x16x32_bf16 v[68:71], a[176:179], a[240:243], v[68:71]
buffer_load_dwordx4 v[48:51], v240, s[24:27], s76 offen offset:0 sc1
s_waitcnt vmcnt(21)
v_mfma_f32_16x16x32_bf16 v[72:75], a[176:179], a[244:247], v[72:75]
s_waitcnt vmcnt(20)
v_mfma_f32_16x16x32_bf16 v[76:79], a[176:179], v[128:131], v[76:79]
v_mfma_f32_16x16x32_bf16 v[80:83], a[196:199], a[204:207], v[80:83]
v_mfma_f32_16x16x32_bf16 v[84:87], a[196:199], a[240:243], v[84:87]
v_mfma_f32_16x16x32_bf16 v[88:91], a[196:199], a[244:247], v[88:91]
buffer_load_dwordx4 v[52:55], v241, s[24:27], s76 offen offset:0 sc1
v_mfma_f32_16x16x32_bf16 v[92:95], a[196:199], v[128:131], v[92:95]
v_mfma_f32_16x16x32_bf16 v[96:99], a[216:219], a[204:207], v[96:99]
v_mfma_f32_16x16x32_bf16 v[100:103], a[216:219], a[240:243], v[100:103]
v_mfma_f32_16x16x32_bf16 v[104:107], a[216:219], a[244:247], v[104:107]
v_mfma_f32_16x16x32_bf16 v[132:135], a[216:219], v[128:131], v[132:135]
buffer_load_dwordx4 v[56:59], v242, s[24:27], s76 offen offset:0 sc1
v_mfma_f32_16x16x32_bf16 v[136:139], v[108:111], a[204:207], v[136:139]
v_mfma_f32_16x16x32_bf16 v[140:143], v[108:111], a[240:243], v[140:143]
v_mfma_f32_16x16x32_bf16 v[176:179], v[108:111], a[244:247], v[176:179]
v_mfma_f32_16x16x32_bf16 v[180:183], v[108:111], v[128:131], v[180:183]
v_mfma_f32_16x16x32_bf16 v[184:187], v[112:115], a[204:207], v[184:187]
buffer_load_dwordx4 v[60:63], v243, s[24:27], s76 offen offset:0 sc1
v_mfma_f32_16x16x32_bf16 v[188:191], v[112:115], a[240:243], v[188:191]
v_mfma_f32_16x16x32_bf16 v[192:195], v[112:115], a[244:247], v[192:195]
v_mfma_f32_16x16x32_bf16 v[196:199], v[112:115], v[128:131], v[196:199]
s_waitcnt vmcnt(22)
v_mfma_f32_16x16x32_bf16 v[64:67], v[116:119], v[200:203], v[64:67]
s_waitcnt vmcnt(8)
s_barrier
buffer_store_dword v247, v255, s[24:27], s4 offen offset:384 sc1
v_add_u32 v229, s48, v2
v_mfma_f32_16x16x32_bf16 v[68:71], v[116:119], v[204:207], v[68:71]
buffer_load_dwordx4 v[160:163], v240, s[24:27], s76 offen offset:2048 sc1
v_mfma_f32_16x16x32_bf16 v[72:75], v[116:119], v[208:211], v[72:75]
v_add_u32 v230, s49, v2
v_mfma_f32_16x16x32_bf16 v[76:79], v[116:119], v[212:215], v[76:79]
v_add_u32 v231, s50, v2
v_mfma_f32_16x16x32_bf16 v[80:83], v[120:123], v[200:203], v[80:83]
v_add_u32 v232, s51, v2
v_mfma_f32_16x16x32_bf16 v[84:87], v[120:123], v[204:207], v[84:87]
v_add_u32 v248, s28, v2
v_mfma_f32_16x16x32_bf16 v[88:91], v[120:123], v[208:211], v[88:91]
buffer_load_dwordx4 v[164:167], v241, s[24:27], s76 offen offset:2048 sc1
v_mfma_f32_16x16x32_bf16 v[92:95], v[120:123], v[212:215], v[92:95]
v_add_u32 v249, s29, v2
v_mfma_f32_16x16x32_bf16 v[96:99], v[124:127], v[200:203], v[96:99]
v_add_u32 v250, s30, v2
v_mfma_f32_16x16x32_bf16 v[100:103], v[124:127], v[204:207], v[100:103]
v_add_u32 v251, s31, v2
v_mfma_f32_16x16x32_bf16 v[104:107], v[124:127], v[208:211], v[104:107]
v_mfma_f32_16x16x32_bf16 v[132:135], v[124:127], v[212:215], v[132:135]
buffer_load_dwordx4 v[168:171], v242, s[24:27], s76 offen offset:2048 sc1
v_mfma_f32_16x16x32_bf16 v[136:139], a[168:171], v[200:203], v[136:139]
v_mfma_f32_16x16x32_bf16 v[140:143], a[168:171], v[204:207], v[140:143]
v_mfma_f32_16x16x32_bf16 v[176:179], a[168:171], v[208:211], v[176:179]
v_mfma_f32_16x16x32_bf16 v[180:183], a[168:171], v[212:215], v[180:183]
v_mfma_f32_16x16x32_bf16 v[184:187], a[172:175], v[200:203], v[184:187]
buffer_load_dwordx4 v[172:175], v243, s[24:27], s76 offen offset:2048 sc1
v_mfma_f32_16x16x32_bf16 v[188:191], a[172:175], v[204:207], v[188:191]
v_mfma_f32_16x16x32_bf16 v[192:195], a[172:175], v[208:211], v[192:195]
v_mfma_f32_16x16x32_bf16 v[196:199], a[172:175], v[212:215], v[196:199]
v_mfma_f32_16x16x32_bf16 v[64:67], a[188:191], v[216:219], v[64:67]
v_mfma_f32_16x16x32_bf16 v[68:71], a[188:191], v[4:7], v[68:71]
s_add_u32 s76, s76, 4096
buffer_load_dwordx4 v[236:239], v240, s[24:27], s76 offen offset:0 sc1
v_mfma_f32_16x16x32_bf16 v[72:75], a[188:191], v[8:11], v[72:75]
v_mfma_f32_16x16x32_bf16 v[76:79], a[188:191], v[12:15], v[76:79]
v_mfma_f32_16x16x32_bf16 v[80:83], a[192:195], v[216:219], v[80:83]
v_mfma_f32_16x16x32_bf16 v[84:87], a[192:195], v[4:7], v[84:87]
v_mfma_f32_16x16x32_bf16 v[88:91], a[192:195], v[8:11], v[88:91]
buffer_load_dwordx4 a[220:223], v241, s[24:27], s76 offen offset:0 sc1
v_mfma_f32_16x16x32_bf16 v[92:95], a[192:195], v[12:15], v[92:95]
v_mfma_f32_16x16x32_bf16 v[96:99], a[208:211], v[216:219], v[96:99]
v_mfma_f32_16x16x32_bf16 v[100:103], a[208:211], v[4:7], v[100:103]
v_mfma_f32_16x16x32_bf16 v[104:107], a[208:211], v[8:11], v[104:107]
v_mfma_f32_16x16x32_bf16 v[132:135], a[208:211], v[12:15], v[132:135]
buffer_load_dwordx4 a[224:227], v242, s[24:27], s76 offen offset:0 sc1
v_mfma_f32_16x16x32_bf16 v[136:139], a[212:215], v[216:219], v[136:139]
v_mfma_f32_16x16x32_bf16 v[140:143], a[212:215], v[4:7], v[140:143]
v_mfma_f32_16x16x32_bf16 v[176:179], a[212:215], v[8:11], v[176:179]
v_mfma_f32_16x16x32_bf16 v[180:183], a[212:215], v[12:15], v[180:183]
v_mfma_f32_16x16x32_bf16 v[184:187], a[0:3], v[216:219], v[184:187]
buffer_load_dwordx4 a[228:231], v243, s[24:27], s76 offen offset:0 sc1
v_mfma_f32_16x16x32_bf16 v[188:191], a[0:3], v[4:7], v[188:191]
v_mfma_f32_16x16x32_bf16 v[192:195], a[0:3], v[8:11], v[192:195]
v_mfma_f32_16x16x32_bf16 v[196:199], a[0:3], v[12:15], v[196:199]
v_mfma_f32_16x16x32_bf16 v[64:67], a[4:7], v[16:19], v[64:67]
v_mfma_f32_16x16x32_bf16 v[68:71], a[4:7], v[24:27], v[68:71]
buffer_load_dwordx4 a[232:235], v240, s[24:27], s76 offen offset:2048 sc1
v_mfma_f32_16x16x32_bf16 v[72:75], a[4:7], v[28:31], v[72:75]
v_mfma_f32_16x16x32_bf16 v[76:79], a[4:7], v[224:227], v[76:79]
v_mfma_f32_16x16x32_bf16 v[80:83], a[8:11], v[16:19], v[80:83]
v_mfma_f32_16x16x32_bf16 v[84:87], a[8:11], v[24:27], v[84:87]
v_mfma_f32_16x16x32_bf16 v[88:91], a[8:11], v[28:31], v[88:91]
buffer_load_dwordx4 a[164:167], v241, s[24:27], s76 offen offset:2048 sc1
v_mfma_f32_16x16x32_bf16 v[92:95], a[8:11], v[224:227], v[92:95]
v_mfma_f32_16x16x32_bf16 v[96:99], a[12:15], v[16:19], v[96:99]
v_mfma_f32_16x16x32_bf16 v[100:103], a[12:15], v[24:27], v[100:103]
v_mfma_f32_16x16x32_bf16 v[104:107], a[12:15], v[28:31], v[104:107]
v_mfma_f32_16x16x32_bf16 v[132:135], a[12:15], v[224:227], v[132:135]
buffer_load_dwordx4 a[180:183], v242, s[24:27], s76 offen offset:2048 sc1
v_mfma_f32_16x16x32_bf16 v[136:139], a[16:19], v[16:19], v[136:139]
v_mfma_f32_16x16x32_bf16 v[140:143], a[16:19], v[24:27], v[140:143]
v_mfma_f32_16x16x32_bf16 v[176:179], a[16:19], v[28:31], v[176:179]
v_mfma_f32_16x16x32_bf16 v[180:183], a[16:19], v[224:227], v[180:183]
v_mfma_f32_16x16x32_bf16 v[184:187], a[20:23], v[16:19], v[184:187]
buffer_load_dwordx4 a[184:187], v243, s[24:27], s76 offen offset:2048 sc1
v_mfma_f32_16x16x32_bf16 v[188:191], a[20:23], v[24:27], v[188:191]
v_mfma_f32_16x16x32_bf16 v[192:195], a[20:23], v[28:31], v[192:195]
v_mfma_f32_16x16x32_bf16 v[196:199], a[20:23], v[224:227], v[196:199]
s_waitcnt vmcnt(20)
v_mfma_f32_16x16x32_bf16 v[64:67], a[24:27], v[32:35], v[64:67]
s_waitcnt vmcnt(19)
v_mfma_f32_16x16x32_bf16 v[68:71], a[24:27], v[36:39], v[68:71]
s_add_u32 s76, s76, 4096
buffer_load_dwordx4 a[236:239], v240, s[24:27], s76 offen offset:0 sc1
s_waitcnt vmcnt(19)
v_mfma_f32_16x16x32_bf16 v[72:75], a[24:27], v[40:43], v[72:75]
s_waitcnt vmcnt(18)
v_mfma_f32_16x16x32_bf16 v[76:79], a[24:27], v[44:47], v[76:79]
v_mfma_f32_16x16x32_bf16 v[80:83], a[28:31], v[32:35], v[80:83]
v_mfma_f32_16x16x32_bf16 v[84:87], a[28:31], v[36:39], v[84:87]
v_mfma_f32_16x16x32_bf16 v[88:91], a[28:31], v[40:43], v[88:91]
buffer_load_dwordx4 a[200:203], v241, s[24:27], s76 offen offset:0 sc1
v_mfma_f32_16x16x32_bf16 v[92:95], a[28:31], v[44:47], v[92:95]
v_mfma_f32_16x16x32_bf16 v[96:99], a[32:35], v[32:35], v[96:99]
v_mfma_f32_16x16x32_bf16 v[100:103], a[32:35], v[36:39], v[100:103]
v_mfma_f32_16x16x32_bf16 v[104:107], a[32:35], v[40:43], v[104:107]
v_mfma_f32_16x16x32_bf16 v[132:135], a[32:35], v[44:47], v[132:135]
buffer_load_dwordx4 a[176:179], v242, s[24:27], s76 offen offset:0 sc1
v_mfma_f32_16x16x32_bf16 v[136:139], a[36:39], v[32:35], v[136:139]
v_mfma_f32_16x16x32_bf16 v[140:143], a[36:39], v[36:39], v[140:143]
v_mfma_f32_16x16x32_bf16 v[176:179], a[36:39], v[40:43], v[176:179]
v_mfma_f32_16x16x32_bf16 v[180:183], a[36:39], v[44:47], v[180:183]
v_mfma_f32_16x16x32_bf16 v[184:187], a[40:43], v[32:35], v[184:187]
buffer_load_dwordx4 a[196:199], v243, s[24:27], s76 offen offset:0 sc1
v_mfma_f32_16x16x32_bf16 v[188:191], a[40:43], v[36:39], v[188:191]
v_mfma_f32_16x16x32_bf16 v[192:195], a[40:43], v[40:43], v[192:195]
v_mfma_f32_16x16x32_bf16 v[196:199], a[40:43], v[44:47], v[196:199]
s_waitcnt vmcnt(20)
v_mfma_f32_16x16x32_bf16 v[64:67], a[44:47], v[48:51], v[64:67]
s_waitcnt vmcnt(19)
v_mfma_f32_16x16x32_bf16 v[68:71], a[44:47], v[52:55], v[68:71]
buffer_load_dwordx4 a[216:219], v240, s[24:27], s76 offen offset:2048 sc1
s_waitcnt vmcnt(19)
v_mfma_f32_16x16x32_bf16 v[72:75], a[44:47], v[56:59], v[72:75]
s_waitcnt vmcnt(18)
v_mfma_f32_16x16x32_bf16 v[76:79], a[44:47], v[60:63], v[76:79]
v_mfma_f32_16x16x32_bf16 v[80:83], a[48:51], v[48:51], v[80:83]
v_mfma_f32_16x16x32_bf16 v[84:87], a[48:51], v[52:55], v[84:87]
v_mfma_f32_16x16x32_bf16 v[88:91], a[48:51], v[56:59], v[88:91]
buffer_load_dwordx4 v[108:111], v241, s[24:27], s76 offen offset:2048 sc1
v_mfma_f32_16x16x32_bf16 v[92:95], a[48:51], v[60:63], v[92:95]
v_mfma_f32_16x16x32_bf16 v[96:99], a[52:55], v[48:51], v[96:99]
v_mfma_f32_16x16x32_bf16 v[100:103], a[52:55], v[52:55], v[100:103]
v_mfma_f32_16x16x32_bf16 v[104:107], a[52:55], v[56:59], v[104:107]
v_mfma_f32_16x16x32_bf16 v[132:135], a[52:55], v[60:63], v[132:135]
buffer_load_dwordx4 a[204:207], v242, s[24:27], s76 offen offset:2048 sc1
v_mfma_f32_16x16x32_bf16 v[136:139], a[56:59], v[48:51], v[136:139]
v_mfma_f32_16x16x32_bf16 v[140:143], a[56:59], v[52:55], v[140:143]
v_mfma_f32_16x16x32_bf16 v[176:179], a[56:59], v[56:59], v[176:179]
v_mfma_f32_16x16x32_bf16 v[180:183], a[56:59], v[60:63], v[180:183]
v_mfma_f32_16x16x32_bf16 v[184:187], a[60:63], v[48:51], v[184:187]
buffer_load_dwordx4 a[240:243], v243, s[24:27], s76 offen offset:2048 sc1
v_mfma_f32_16x16x32_bf16 v[188:191], a[60:63], v[52:55], v[188:191]
v_mfma_f32_16x16x32_bf16 v[192:195], a[60:63], v[56:59], v[192:195]
v_mfma_f32_16x16x32_bf16 v[196:199], a[60:63], v[60:63], v[196:199]
s_waitcnt vmcnt(19)
v_mfma_f32_16x16x32_bf16 v[64:67], a[64:67], v[160:163], v[64:67]
v_accvgpr_read_b32 v113, a248
s_waitcnt vmcnt(18)
v_mfma_f32_16x16x32_bf16 v[68:71], a[64:67], v[164:167], v[68:71]
s_add_u32 m0, s84, 0
s_add_u32 s58, s84, 69632
s_add_u32 s58, s58, s77
buffer_load_dwordx4 v2, s[24:27], s58 offen offset:0 sc1 lds
s_waitcnt vmcnt(18)
v_mfma_f32_16x16x32_bf16 v[72:75], a[64:67], v[168:171], v[72:75]
v_lshlrev_b32 v112, 16, v113
s_waitcnt vmcnt(17)
v_mfma_f32_16x16x32_bf16 v[76:79], a[64:67], v[172:175], v[76:79]
v_and_b32 v113, 0xffff0000, v113
v_mfma_f32_16x16x32_bf16 v[80:83], a[68:71], v[160:163], v[80:83]
v_accvgpr_read_b32 v115, a249
v_mfma_f32_16x16x32_bf16 v[84:87], a[68:71], v[164:167], v[84:87]
v_lshlrev_b32 v114, 16, v115
v_mfma_f32_16x16x32_bf16 v[88:91], a[68:71], v[168:171], v[88:91]
buffer_load_dwordx4 v2, s[24:27], s58 offen offset:1024 sc1 lds
v_mfma_f32_16x16x32_bf16 v[92:95], a[68:71], v[172:175], v[92:95]
v_and_b32 v115, 0xffff0000, v115
v_mfma_f32_16x16x32_bf16 v[96:99], a[72:75], v[160:163], v[96:99]
v_accvgpr_read_b32 v129, a250
v_mfma_f32_16x16x32_bf16 v[100:103], a[72:75], v[164:167], v[100:103]
v_lshlrev_b32 v128, 16, v129
v_mfma_f32_16x16x32_bf16 v[104:107], a[72:75], v[168:171], v[104:107]
v_and_b32 v129, 0xffff0000, v129
v_mfma_f32_16x16x32_bf16 v[132:135], a[72:75], v[172:175], v[132:135]
buffer_load_dwordx4 v2, s[24:27], s58 offen offset:2048 sc1 lds
v_mfma_f32_16x16x32_bf16 v[136:139], a[76:79], v[160:163], v[136:139]
v_accvgpr_read_b32 v131, a251
v_mfma_f32_16x16x32_bf16 v[140:143], a[76:79], v[164:167], v[140:143]
v_lshlrev_b32 v130, 16, v131
v_mfma_f32_16x16x32_bf16 v[176:179], a[76:79], v[168:171], v[176:179]
v_and_b32 v131, 0xffff0000, v131
v_mfma_f32_16x16x32_bf16 v[180:183], a[76:79], v[172:175], v[180:183]
v_accvgpr_read_b32 v149, a252
v_mfma_f32_16x16x32_bf16 v[184:187], a[80:83], v[160:163], v[184:187]
buffer_load_dwordx4 v2, s[24:27], s58 offen offset:3072 sc1 lds
v_mfma_f32_16x16x32_bf16 v[188:191], a[80:83], v[164:167], v[188:191]
v_lshlrev_b32 v148, 16, v149
v_mfma_f32_16x16x32_bf16 v[192:195], a[80:83], v[168:171], v[192:195]
v_and_b32 v149, 0xffff0000, v149
v_mfma_f32_16x16x32_bf16 v[196:199], a[80:83], v[172:175], v[196:199]
v_accvgpr_read_b32 v151, a253
s_waitcnt vmcnt(19)
v_mfma_f32_16x16x32_bf16 v[64:67], a[84:87], v[236:239], v[64:67]
buffer_load_dword v222, v244, s[24:27], s5 offen offset:384 sc1
v_lshlrev_b32 v150, 16, v151
s_waitcnt vmcnt(19)
v_mfma_f32_16x16x32_bf16 v[68:71], a[84:87], a[220:223], v[68:71]
s_add_u32 m0, s84, 16384
s_add_u32 s58, s84, 86016
s_add_u32 s58, s58, s77
buffer_load_dwordx4 v2, s[24:27], s58 offen offset:0 sc1 lds
s_waitcnt vmcnt(19)
v_mfma_f32_16x16x32_bf16 v[72:75], a[84:87], a[224:227], v[72:75]
v_and_b32 v151, 0xffff0000, v151
s_waitcnt vmcnt(18)
v_mfma_f32_16x16x32_bf16 v[76:79], a[84:87], a[228:231], v[76:79]
v_accvgpr_read_b32 v153, a254
v_mfma_f32_16x16x32_bf16 v[80:83], a[88:91], v[236:239], v[80:83]
v_lshlrev_b32 v152, 16, v153
v_mfma_f32_16x16x32_bf16 v[84:87], a[88:91], a[220:223], v[84:87]
v_and_b32 v153, 0xffff0000, v153
v_mfma_f32_16x16x32_bf16 v[88:91], a[88:91], a[224:227], v[88:91]
buffer_load_dwordx4 v2, s[24:27], s58 offen offset:1024 sc1 lds
v_mfma_f32_16x16x32_bf16 v[92:95], a[88:91], a[228:231], v[92:95]
v_accvgpr_read_b32 v155, a255
v_mfma_f32_16x16x32_bf16 v[96:99], a[92:95], v[236:239], v[96:99]
v_lshlrev_b32 v154, 16, v155
v_mfma_f32_16x16x32_bf16 v[100:103], a[92:95], a[220:223], v[100:103]
v_and_b32 v155, 0xffff0000, v155
v_mfma_f32_16x16x32_bf16 v[104:107], a[92:95], a[224:227], v[104:107]
v_lshlrev_b32 v156, 16, v20
v_mfma_f32_16x16x32_bf16 v[132:135], a[92:95], a[228:231], v[132:135]
buffer_load_dwordx4 v2, s[24:27], s58 offen offset:2048 sc1 lds
v_mfma_f32_16x16x32_bf16 v[136:139], a[96:99], v[236:239], v[136:139]
v_and_b32 v157, 0xffff0000, v20
v_mfma_f32_16x16x32_bf16 v[140:143], a[96:99], a[220:223], v[140:143]
v_lshlrev_b32 v158, 16, v21
v_mfma_f32_16x16x32_bf16 v[176:179], a[96:99], a[224:227], v[176:179]
v_and_b32 v159, 0xffff0000, v21
v_mfma_f32_16x16x32_bf16 v[180:183], a[96:99], a[228:231], v[180:183]
v_permlane16_swap_b32 v112, v128
v_mfma_f32_16x16x32_bf16 v[184:187], a[100:103], v[236:239], v[184:187]
buffer_load_dwordx4 v2, s[24:27], s58 offen offset:3072 sc1 lds
v_mfma_f32_16x16x32_bf16 v[188:191], a[100:103], a[220:223], v[188:191]
v_permlane16_swap_b32 v113, v129
v_mfma_f32_16x16x32_bf16 v[192:195], a[100:103], a[224:227], v[192:195]
v_permlane16_swap_b32 v114, v130
v_mfma_f32_16x16x32_bf16 v[196:199], a[100:103], a[228:231], v[196:199]
v_permlane16_swap_b32 v115, v131
s_waitcnt vmcnt(18)
v_mfma_f32_16x16x32_bf16 v[72:75], a[104:107], a[180:183], v[72:75]
v_permlane16_swap_b32 v148, v152
s_waitcnt vmcnt(17)
v_mfma_f32_16x16x32_bf16 v[76:79], a[104:107], a[184:187], v[76:79]
v_mfma_f32_16x16x32_bf16 v[88:91], a[108:111], a[180:183], v[88:91]
v_permlane16_swap_b32 v149, v153
v_mfma_f32_16x16x32_bf16 v[92:95], a[108:111], a[184:187], v[92:95]
v_permlane16_swap_b32 v150, v154
v_mfma_f32_16x16x32_bf16 v[104:107], a[112:115], a[180:183], v[104:107]
v_permlane16_swap_b32 v151, v155
v_mfma_f32_16x16x32_bf16 v[132:135], a[112:115], a[184:187], v[132:135]
v_mfma_f32_16x16x32_bf16 v[176:179], a[116:119], a[180:183], v[176:179]
v_mfma_f32_16x16x32_bf16 v[180:183], a[116:119], a[184:187], v[180:183]
v_mfma_f32_16x16x32_bf16 v[192:195], a[120:123], a[180:183], v[192:195]
v_mfma_f32_16x16x32_bf16 v[196:199], a[120:123], a[184:187], v[196:199]
s_waitcnt vmcnt(14)
v_mfma_f32_16x16x32_bf16 v[72:75], a[124:127], a[176:179], v[72:75]
s_waitcnt vmcnt(13)
v_mfma_f32_16x16x32_bf16 v[76:79], a[124:127], a[196:199], v[76:79]
v_mfma_f32_16x16x32_bf16 v[88:91], a[128:131], a[176:179], v[88:91]
v_mfma_f32_16x16x32_bf16 v[92:95], a[128:131], a[196:199], v[92:95]
v_mfma_f32_16x16x32_bf16 v[104:107], a[132:135], a[176:179], v[104:107]
v_mfma_f32_16x16x32_bf16 v[132:135], a[132:135], a[196:199], v[132:135]
v_mfma_f32_16x16x32_bf16 v[176:179], a[136:139], a[176:179], v[176:179]
v_mfma_f32_16x16x32_bf16 v[180:183], a[136:139], a[196:199], v[180:183]
v_mfma_f32_16x16x32_bf16 v[192:195], a[140:143], a[176:179], v[192:195]
v_mfma_f32_16x16x32_bf16 v[196:199], a[140:143], a[196:199], v[196:199]
s_waitcnt vmcnt(10)
v_mfma_f32_16x16x32_bf16 v[72:75], a[144:147], a[204:207], v[72:75]
s_waitcnt vmcnt(4)
v_cmp_ne_u32 vcc, s56, v222
s_cbranch_vccnz L_sp8_slow
L_sp8_back:
v_mfma_f32_16x16x32_bf16 v[76:79], a[144:147], a[240:243], v[76:79]
buffer_load_dwordx4 a[244:247], v240, s[24:27], s78 offen offset:0 sc1
v_mfma_f32_16x16x32_bf16 v[88:91], a[148:151], a[204:207], v[88:91]
v_mfma_f32_16x16x32_bf16 v[92:95], a[148:151], a[240:243], v[92:95]
v_mfma_f32_16x16x32_bf16 v[104:107], a[152:155], a[204:207], v[104:107]
v_mfma_f32_16x16x32_bf16 v[132:135], a[152:155], a[240:243], v[132:135]
v_mfma_f32_16x16x32_bf16 v[176:179], a[156:159], a[204:207], v[176:179]
buffer_load_dwordx4 v[144:147], v241, s[24:27], s78 offen offset:0 sc1
v_mfma_f32_16x16x32_bf16 v[180:183], a[156:159], a[240:243], v[180:183]
v_mfma_f32_16x16x32_bf16 v[192:195], a[160:163], a[204:207], v[192:195]
v_mfma_f32_16x16x32_bf16 v[196:199], a[160:163], a[240:243], v[196:199]
v_mfma_f32_16x16x32_bf16 v[68:71], a[104:107], a[164:167], v[68:71]
v_mfma_f32_16x16x32_bf16 v[64:67], a[104:107], a[232:235], v[64:67]
buffer_load_dwordx4 v[116:119], v240, s[24:27], s78 offen offset:2048 sc1
v_mfma_f32_16x16x32_bf16 v[84:87], a[108:111], a[164:167], v[84:87]
ds_write_b128 v249, v[72:75] offset:0
v_mfma_f32_16x16x32_bf16 v[80:83], a[108:111], a[232:235], v[80:83]
v_mfma_f32_16x16x32_bf16 v[100:103], a[112:115], a[164:167], v[100:103]
ds_write_b128 v250, v[76:79] offset:0
v_mfma_f32_16x16x32_bf16 v[96:99], a[112:115], a[232:235], v[96:99]
v_mfma_f32_16x16x32_bf16 v[140:143], a[116:119], a[164:167], v[140:143]
buffer_load_dwordx4 v[120:123], v241, s[24:27], s78 offen offset:2048 sc1
v_mfma_f32_16x16x32_bf16 v[136:139], a[116:119], a[232:235], v[136:139]
v_mfma_f32_16x16x32_bf16 v[188:191], a[120:123], a[164:167], v[188:191]
ds_write_b128 v249, v[88:91] offset:1024
v_mfma_f32_16x16x32_bf16 v[184:187], a[120:123], a[232:235], v[184:187]
v_mfma_f32_16x16x32_bf16 v[68:71], a[124:127], a[200:203], v[68:71]
ds_write_b128 v250, v[92:95] offset:1024
v_mfma_f32_16x16x32_bf16 v[64:67], a[124:127], a[236:239], v[64:67]
s_add_u32 s78, s78, 4096
buffer_load_dwordx4 v[124:127], v240, s[24:27], s78 offen offset:0 sc1
v_mfma_f32_16x16x32_bf16 v[84:87], a[128:131], a[200:203], v[84:87]
ds_write_b128 v249, v[104:107] offset:2048
v_mfma_f32_16x16x32_bf16 v[80:83], a[128:131], a[236:239], v[80:83]
v_mfma_f32_16x16x32_bf16 v[100:103], a[132:135], a[200:203], v[100:103]
ds_write_b128 v250, v[132:135] offset:2048
v_mfma_f32_16x16x32_bf16 v[96:99], a[132:135], a[236:239], v[96:99]
v_mfma_f32_16x16x32_bf16 v[140:143], a[136:139], a[200:203], v[140:143]
buffer_load_dwordx4 a[168:171], v241, s[24:27], s78 offen offset:0 sc1
v_mfma_f32_16x16x32_bf16 v[136:139], a[136:139], a[236:239], v[136:139]
v_mfma_f32_16x16x32_bf16 v[188:191], a[140:143], a[200:203], v[188:191]
ds_write_b128 v249, v[176:179] offset:3072
v_mfma_f32_16x16x32_bf16 v[184:187], a[140:143], a[236:239], v[184:187]
v_mfma_f32_16x16x32_bf16 v[68:71], a[144:147], v[108:111], v[68:71]
ds_write_b128 v250, v[180:183] offset:3072
v_mfma_f32_16x16x32_bf16 v[64:67], a[144:147], a[216:219], v[64:67]
buffer_load_dwordx4 v[200:203], v240, s[24:27], s78 offen offset:2048 sc1
v_mfma_f32_16x16x32_bf16 v[84:87], a[148:151], v[108:111], v[84:87]
ds_write_b128 v249, v[192:195] offset:4096
ds_write_b128 v250, v[196:199] offset:4096
s_waitcnt vmcnt(7) lgkmcnt(0)
s_barrier
v_mfma_f32_16x16x32_bf16 v[80:83], a[148:151], a[216:219], v[80:83]
ds_read_b128 v[204:207], v229 offset:0
v_mfma_f32_16x16x32_bf16 v[100:103], a[152:155], v[108:111], v[100:103]
ds_read_b128 v[208:211], v229 offset:1024
v_mfma_f32_16x16x32_bf16 v[96:99], a[152:155], a[216:219], v[96:99]
ds_read_b128 a[172:175], v229 offset:2048
v_mfma_f32_16x16x32_bf16 v[140:143], a[156:159], v[108:111], v[140:143]
buffer_load_dwordx4 v[212:215], v241, s[24:27], s78 offen offset:2048 sc1
ds_read_b128 a[188:191], v229 offset:3072
v_mfma_f32_16x16x32_bf16 v[136:139], a[156:159], a[216:219], v[136:139]
ds_read_b128 a[192:195], v229 offset:4096
v_mfma_f32_16x16x32_bf16 v[188:191], a[160:163], v[108:111], v[188:191]
ds_read_b128 a[208:211], v229 offset:5120
v_mfma_f32_16x16x32_bf16 v[184:187], a[160:163], a[216:219], v[184:187]
s_waitcnt vmcnt(6) lgkmcnt(4)
v_mfma_f32_16x16x32_bf16 v[68:71], v[204:207], v[144:147], v[68:71]
ds_read_b128 a[212:215], v229 offset:6144
s_add_u32 s78, s78, 4096
buffer_load_dwordx4 v[216:219], v240, s[24:27], s78 offen offset:0 sc1
v_mfma_f32_16x16x32_bf16 v[64:67], v[204:207], a[244:247], v[64:67]
ds_read_b128 v[72:75], v251 offset:5120
ds_read_b128 v[76:79], v251 offset:10240
v_mfma_f32_16x16x32_bf16 v[84:87], v[208:211], v[144:147], v[84:87]
ds_read_b128 v[4:7], v229 offset:7168
buffer_load_dwordx4 v[8:11], v241, s[24:27], s78 offen offset:0 sc1
v_mfma_f32_16x16x32_bf16 v[80:83], v[208:211], a[244:247], v[80:83]
ds_read_b128 v[88:91], v251 offset:6144
ds_read_b128 v[92:95], v251 offset:11264
s_waitcnt lgkmcnt(8)
v_mfma_f32_16x16x32_bf16 v[100:103], a[172:175], v[144:147], v[100:103]
ds_read_b128 a[0:3], v229 offset:8192
buffer_load_dwordx4 v[12:15], v240, s[24:27], s78 offen offset:2048 sc1
v_mfma_f32_16x16x32_bf16 v[96:99], a[172:175], a[244:247], v[96:99]
ds_read_b128 v[104:107], v251 offset:7168
ds_read_b128 v[132:135], v251 offset:12288
v_mfma_f32_16x16x32_bf16 v[140:143], a[188:191], v[144:147], v[140:143]
ds_read_b128 a[4:7], v229 offset:9216
buffer_load_dwordx4 a[8:11], v241, s[24:27], s78 offen offset:2048 sc1
v_mfma_f32_16x16x32_bf16 v[136:139], a[188:191], a[244:247], v[136:139]
ds_read_b128 v[176:179], v251 offset:8192
ds_read_b128 v[180:183], v251 offset:13312
s_waitcnt lgkmcnt(12)
v_mfma_f32_16x16x32_bf16 v[188:191], a[192:195], v[144:147], v[188:191]
ds_read_b128 a[12:15], v229 offset:10240
s_add_u32 s78, s78, 4096
buffer_load_dwordx4 a[16:19], v240, s[24:27], s78 offen offset:0 sc1
v_mfma_f32_16x16x32_bf16 v[184:187], a[192:195], a[244:247], v[184:187]
ds_read_b128 v[192:195], v251 offset:9216
ds_read_b128 v[196:199], v251 offset:14336
s_waitcnt vmcnt(9)
v_mfma_f32_16x16x32_bf16 v[68:71], a[208:211], v[120:123], v[68:71]
ds_read_b128 v[16:19], v229 offset:11264
buffer_load_dwordx4 v[24:27], v241, s[24:27], s78 offen offset:0 sc1
v_mfma_f32_16x16x32_bf16 v[64:67], a[208:211], v[116:119], v[64:67]
s_waitcnt lgkmcnt(12)
v_mfma_f32_16x16x32_bf16 v[84:87], a[212:215], v[120:123], v[84:87]
ds_read_b128 v[28:31], v229 offset:12288
buffer_load_dwordx4 a[20:23], v240, s[24:27], s78 offen offset:2048 sc1
v_mfma_f32_16x16x32_bf16 v[80:83], a[212:215], v[116:119], v[80:83]
v_mfma_f32_16x16x32_bf16 v[100:103], v[4:7], v[120:123], v[100:103]
ds_read_b128 v[224:227], v229 offset:13312
buffer_load_dwordx4 a[24:27], v241, s[24:27], s78 offen offset:2048 sc1
v_mfma_f32_16x16x32_bf16 v[96:99], v[4:7], v[116:119], v[96:99]
v_add_f32 v72, v72, v76
v_add_f32 v73, v73, v77
s_waitcnt lgkmcnt(8)
v_mfma_f32_16x16x32_bf16 v[140:143], a[0:3], v[120:123], v[140:143]
ds_read_b128 a[28:31], v230 offset:0
s_add_u32 s78, s78, 4096
buffer_load_dwordx4 a[32:35], v240, s[24:27], s78 offen offset:0 sc1
v_mfma_f32_16x16x32_bf16 v[136:139], a[0:3], v[116:119], v[136:139]
v_add_f32 v74, v74, v78
v_add_f32 v75, v75, v79
v_mfma_f32_16x16x32_bf16 v[188:191], a[4:7], v[120:123], v[188:191]
ds_read_b128 a[36:39], v230 offset:1024
buffer_load_dwordx4 v[32:35], v241, s[24:27], s78 offen offset:0 sc1
v_mfma_f32_16x16x32_bf16 v[184:187], a[4:7], v[116:119], v[184:187]
v_add_f32 v88, v88, v92
v_add_f32 v89, v89, v93
s_waitcnt vmcnt(12) lgkmcnt(4)
v_mfma_f32_16x16x32_bf16 v[68:71], a[12:15], a[168:171], v[68:71]
ds_read_b128 v[36:39], v230 offset:2048
buffer_load_dwordx4 v[40:43], v240, s[24:27], s78 offen offset:2048 sc1
v_mfma_f32_16x16x32_bf16 v[64:67], a[12:15], v[124:127], v[64:67]
v_add_f32 v90, v90, v94
v_add_f32 v91, v91, v95
v_mfma_f32_16x16x32_bf16 v[84:87], v[16:19], a[168:171], v[84:87]
ds_read_b128 a[40:43], v230 offset:3072
buffer_load_dwordx4 v[44:47], v241, s[24:27], s78 offen offset:2048 sc1
v_mfma_f32_16x16x32_bf16 v[80:83], v[16:19], v[124:127], v[80:83]
v_add_f32 v104, v104, v132
v_add_f32 v105, v105, v133
s_waitcnt lgkmcnt(4)
v_mfma_f32_16x16x32_bf16 v[100:103], v[28:31], a[168:171], v[100:103]
ds_read_b128 a[44:47], v231 offset:0
v_mfma_f32_16x16x32_bf16 v[96:99], v[28:31], v[124:127], v[96:99]
v_add_f32 v106, v106, v134
v_add_f32 v107, v107, v135
v_mfma_f32_16x16x32_bf16 v[140:143], v[224:227], a[168:171], v[140:143]
ds_read_b128 a[48:51], v231 offset:1024
v_mfma_f32_16x16x32_bf16 v[136:139], v[224:227], v[124:127], v[136:139]
v_add_f32 v176, v176, v180
v_add_f32 v177, v177, v181
s_waitcnt lgkmcnt(4)
v_mfma_f32_16x16x32_bf16 v[188:191], a[28:31], a[168:171], v[188:191]
ds_read_b128 a[52:55], v231 offset:2048
v_mfma_f32_16x16x32_bf16 v[184:187], a[28:31], v[124:127], v[184:187]
v_add_f32 v178, v178, v182
v_add_f32 v179, v179, v183
s_waitcnt vmcnt(12)
v_mfma_f32_16x16x32_bf16 v[68:71], a[36:39], v[212:215], v[68:71]
ds_read_b128 a[56:59], v231 offset:3072
v_mfma_f32_16x16x32_bf16 v[64:67], a[36:39], v[200:203], v[64:67]
v_add_f32 v192, v192, v196
v_add_f32 v193, v193, v197
s_waitcnt lgkmcnt(4)
v_mfma_f32_16x16x32_bf16 v[84:87], v[36:39], v[212:215], v[84:87]
ds_read_b128 v[48:51], v231 offset:4096
v_mfma_f32_16x16x32_bf16 v[80:83], v[36:39], v[200:203], v[80:83]
v_add_f32 v194, v194, v198
v_add_f32 v195, v195, v199
v_mfma_f32_16x16x32_bf16 v[100:103], a[40:43], v[212:215], v[100:103]
ds_read_b128 v[52:55], v231 offset:5120
v_mfma_f32_16x16x32_bf16 v[96:99], a[40:43], v[200:203], v[96:99]
v_add_f32 v72, v72, v112
v_add_f32 v73, v73, v113
s_waitcnt lgkmcnt(4)
v_mfma_f32_16x16x32_bf16 v[140:143], a[44:47], v[212:215], v[140:143]
ds_read_b128 v[56:59], v231 offset:6144
v_mfma_f32_16x16x32_bf16 v[136:139], a[44:47], v[200:203], v[136:139]
v_add_f32 v74, v74, v114
v_add_f32 v75, v75, v115
v_mfma_f32_16x16x32_bf16 v[188:191], a[48:51], v[212:215], v[188:191]
ds_read_b128 a[60:63], v231 offset:7168
v_mfma_f32_16x16x32_bf16 v[184:187], a[48:51], v[200:203], v[184:187]
v_add_f32 v88, v88, v128
v_add_f32 v89, v89, v129
s_waitcnt vmcnt(10) lgkmcnt(4)
v_mfma_f32_16x16x32_bf16 v[68:71], a[52:55], v[8:11], v[68:71]
ds_read_b128 v[60:63], v231 offset:8192
v_mfma_f32_16x16x32_bf16 v[64:67], a[52:55], v[216:219], v[64:67]
v_add_f32 v90, v90, v130
v_add_f32 v91, v91, v131
v_mfma_f32_16x16x32_bf16 v[84:87], a[56:59], v[8:11], v[84:87]
ds_read_b128 a[64:67], v231 offset:9216
v_mfma_f32_16x16x32_bf16 v[80:83], a[56:59], v[216:219], v[80:83]
v_add_f32 v104, v104, v148
v_add_f32 v105, v105, v149
s_waitcnt lgkmcnt(4)
v_mfma_f32_16x16x32_bf16 v[100:103], v[48:51], v[8:11], v[100:103]
ds_read_b128 a[68:71], v231 offset:10240
v_mfma_f32_16x16x32_bf16 v[96:99], v[48:51], v[216:219], v[96:99]
v_add_f32 v106, v106, v150
v_add_f32 v107, v107, v151
v_mfma_f32_16x16x32_bf16 v[140:143], v[52:55], v[8:11], v[140:143]
ds_read_b128 a[72:75], v231 offset:11264
v_mfma_f32_16x16x32_bf16 v[136:139], v[52:55], v[216:219], v[136:139]
v_add_f32 v176, v176, v152
v_add_f32 v177, v177, v153
s_waitcnt lgkmcnt(4)
v_mfma_f32_16x16x32_bf16 v[188:191], v[56:59], v[8:11], v[188:191]
ds_read_b128 v[204:207], v231 offset:12288
v_mfma_f32_16x16x32_bf16 v[184:187], v[56:59], v[216:219], v[184:187]
v_add_f32 v178, v178, v154
v_add_f32 v179, v179, v155
s_waitcnt vmcnt(8)
v_mfma_f32_16x16x32_bf16 v[68:71], a[60:63], a[8:11], v[68:71]
ds_read_b128 v[208:211], v231 offset:13312
v_mfma_f32_16x16x32_bf16 v[64:67], a[60:63], v[12:15], v[64:67]
v_add_f32 v192, v192, v156
v_add_f32 v193, v193, v157
s_waitcnt lgkmcnt(4)
v_mfma_f32_16x16x32_bf16 v[84:87], v[60:63], a[8:11], v[84:87]
ds_read_b128 a[172:175], v231 offset:14336
v_mfma_f32_16x16x32_bf16 v[80:83], v[60:63], v[12:15], v[80:83]
v_add_f32 v194, v194, v158
v_add_f32 v195, v195, v159
v_mfma_f32_16x16x32_bf16 v[100:103], a[64:67], a[8:11], v[100:103]
ds_read_b128 a[188:191], v231 offset:15360
v_mfma_f32_16x16x32_bf16 v[96:99], a[64:67], v[12:15], v[96:99]
s_waitcnt lgkmcnt(4)
v_mfma_f32_16x16x32_bf16 v[140:143], a[68:71], a[8:11], v[140:143]
ds_read_b128 a[192:195], v231 offset:16384
v_mfma_f32_16x16x32_bf16 v[188:191], a[72:75], a[8:11], v[188:191]
ds_read_b128 a[208:211], v231 offset:17408
s_waitcnt vmcnt(6) lgkmcnt(4)
v_mfma_f32_16x16x32_bf16 v[68:71], v[204:207], v[24:27], v[68:71]
ds_read_b128 a[212:215], v231 offset:18432
v_mfma_f32_16x16x32_bf16 v[84:87], v[208:211], v[24:27], v[84:87]
ds_read_b128 v[4:7], v231 offset:19456
s_waitcnt lgkmcnt(4)
v_mfma_f32_16x16x32_bf16 v[100:103], a[172:175], v[24:27], v[100:103]
ds_read_b128 a[0:3], v231 offset:20480
v_mfma_f32_16x16x32_bf16 v[140:143], a[188:191], v[24:27], v[140:143]
ds_read_b128 a[4:7], v231 offset:21504
s_waitcnt lgkmcnt(4)
v_mfma_f32_16x16x32_bf16 v[188:191], a[192:195], v[24:27], v[188:191]
ds_read_b128 a[12:15], v231 offset:22528
s_waitcnt vmcnt(4)
v_mfma_f32_16x16x32_bf16 v[68:71], a[208:211], a[24:27], v[68:71]
ds_read_b128 v[16:19], v231 offset:23552
s_waitcnt lgkmcnt(4)
v_mfma_f32_16x16x32_bf16 v[84:87], a[212:215], a[24:27], v[84:87]
ds_read_b128 v[28:31], v231 offset:24576
v_mfma_f32_16x16x32_bf16 v[100:103], v[4:7], a[24:27], v[100:103]
ds_read_b128 v[224:227], v231 offset:25600
s_waitcnt lgkmcnt(4)
v_mfma_f32_16x16x32_bf16 v[140:143], a[0:3], a[24:27], v[140:143]
ds_read_b128 a[28:31], v231 offset:26624
v_mfma_f32_16x16x32_bf16 v[188:191], a[4:7], a[24:27], v[188:191]
ds_read_b128 a[36:39], v231 offset:27648
s_waitcnt vmcnt(2) lgkmcnt(4)
v_mfma_f32_16x16x32_bf16 v[68:71], a[12:15], v[32:35], v[68:71]
ds_read_b128 v[36:39], v231 offset:28672
v_mfma_f32_16x16x32_bf16 v[84:87], v[16:19], v[32:35], v[84:87]
ds_read_b128 a[40:43], v231 offset:29696
s_waitcnt lgkmcnt(4)
v_mfma_f32_16x16x32_bf16 v[100:103], v[28:31], v[32:35], v[100:103]
ds_read_b128 a[44:47], v232 offset:0
v_mfma_f32_16x16x32_bf16 v[140:143], v[224:227], v[32:35], v[140:143]
ds_read_b128 a[48:51], v232 offset:1024
s_waitcnt lgkmcnt(4)
v_mfma_f32_16x16x32_bf16 v[188:191], a[28:31], v[32:35], v[188:191]
s_waitcnt vmcnt(0)
v_mfma_f32_16x16x32_bf16 v[68:71], a[36:39], v[44:47], v[68:71]
s_waitcnt lgkmcnt(2)
v_mfma_f32_16x16x32_bf16 v[84:87], v[36:39], v[44:47], v[84:87]
v_mfma_f32_16x16x32_bf16 v[100:103], a[40:43], v[44:47], v[100:103]
s_waitcnt lgkmcnt(0)
v_mfma_f32_16x16x32_bf16 v[140:143], a[44:47], v[44:47], v[140:143]
v_mfma_f32_16x16x32_bf16 v[188:191], a[48:51], v[44:47], v[188:191]
v_mfma_f32_16x16x32_bf16 v[136:139], a[68:71], v[12:15], v[136:139]
v_mfma_f32_16x16x32_bf16 v[184:187], a[72:75], v[12:15], v[184:187]
ds_write_b128 v248, v[68:71] offset:0
s_nop 0
ds_write_b128 v248, v[84:87] offset:1024
v_mfma_f32_16x16x32_bf16 v[64:67], v[204:207], a[16:19], v[64:67]
ds_write_b128 v248, v[100:103] offset:2048
ds_write_b128 v248, v[140:143] offset:3072
v_mfma_f32_16x16x32_bf16 v[80:83], v[208:211], a[16:19], v[80:83]
ds_write_b128 v248, v[188:191] offset:4096
v_mfma_f32_16x16x32_bf16 v[96:99], a[172:175], a[16:19], v[96:99]
v_mfma_f32_16x16x32_bf16 v[136:139], a[188:191], a[16:19], v[136:139]
s_waitcnt lgkmcnt(0)
s_barrier
ds_read_b128 v[68:71], v251 offset:0
v_mfma_f32_16x16x32_bf16 v[184:187], a[192:195], a[16:19], v[184:187]
ds_read_b128 v[84:87], v251 offset:1024
ds_read_b128 v[100:103], v251 offset:2048
v_mfma_f32_16x16x32_bf16 v[64:67], a[208:211], a[20:23], v[64:67]
ds_read_b128 v[140:143], v251 offset:3072
ds_read_b128 v[188:191], v251 offset:4096
v_mfma_f32_16x16x32_bf16 v[80:83], a[212:215], a[20:23], v[80:83]
v_mfma_f32_16x16x32_bf16 v[96:99], v[4:7], a[20:23], v[96:99]
s_waitcnt lgkmcnt(4)
v_add_f32 v72, v72, v68
v_add_f32 v73, v73, v69
v_mfma_f32_16x16x32_bf16 v[136:139], a[0:3], a[20:23], v[136:139]
v_add_f32 v74, v74, v70
v_add_f32 v75, v75, v71
v_mfma_f32_16x16x32_bf16 v[184:187], a[4:7], a[20:23], v[184:187]
s_waitcnt lgkmcnt(3)
v_add_f32 v88, v88, v84
v_add_f32 v89, v89, v85
v_mfma_f32_16x16x32_bf16 v[64:67], a[12:15], a[32:35], v[64:67]
v_add_f32 v90, v90, v86
v_add_f32 v91, v91, v87
v_mfma_f32_16x16x32_bf16 v[80:83], v[16:19], a[32:35], v[80:83]
s_waitcnt lgkmcnt(2)
v_add_f32 v104, v104, v100
v_add_f32 v105, v105, v101
v_mfma_f32_16x16x32_bf16 v[96:99], v[28:31], a[32:35], v[96:99]
v_add_f32 v106, v106, v102
v_add_f32 v107, v107, v103
v_mfma_f32_16x16x32_bf16 v[136:139], v[224:227], a[32:35], v[136:139]
s_waitcnt lgkmcnt(1)
v_add_f32 v176, v176, v140
v_add_f32 v177, v177, v141
v_mfma_f32_16x16x32_bf16 v[184:187], a[28:31], a[32:35], v[184:187]
v_add_f32 v178, v178, v142
v_add_f32 v179, v179, v143
v_mfma_f32_16x16x32_bf16 v[64:67], a[36:39], v[40:43], v[64:67]
s_waitcnt lgkmcnt(0)
v_add_f32 v192, v192, v188
v_add_f32 v193, v193, v189
v_mfma_f32_16x16x32_bf16 v[80:83], v[36:39], v[40:43], v[80:83]
v_add_f32 v194, v194, v190
v_add_f32 v195, v195, v191
v_mfma_f32_16x16x32_bf16 v[96:99], a[40:43], v[40:43], v[96:99]
v_mfma_f32_16x16x32_bf16 v[136:139], a[44:47], v[40:43], v[136:139]
v_mfma_f32_16x16x32_bf16 v[184:187], a[48:51], v[40:43], v[184:187]
v_add_f32 v64, v64, v72
v_add_f32 v65, v65, v73
v_add_f32 v66, v66, v74
v_add_f32 v67, v67, v75
v_cvt_pk_bf16_f32 v76, v64, v65
v_cvt_pk_bf16_f32 v77, v66, v67
v_add_f32 v80, v80, v88
v_add_f32 v81, v81, v89
v_add_f32 v82, v82, v90
v_add_f32 v83, v83, v91
v_cvt_pk_bf16_f32 v78, v80, v81
v_cvt_pk_bf16_f32 v79, v82, v83
v_add_f32 v96, v96, v104
v_add_f32 v97, v97, v105
v_add_f32 v98, v98, v106
v_add_f32 v99, v99, v107
v_cvt_pk_bf16_f32 v92, v96, v97
v_cvt_pk_bf16_f32 v93, v98, v99
v_permlane16_swap_b32 v76, v78
v_permlane16_swap_b32 v77, v79
buffer_store_dwordx4 v[76:79], v3, s[40:43], s79 offen offset:0
v_add_f32 v136, v136, v176
v_add_f32 v137, v137, v177
v_add_f32 v138, v138, v178
v_add_f32 v139, v139, v179
v_cvt_pk_bf16_f32 v94, v136, v137
v_cvt_pk_bf16_f32 v95, v138, v139
v_add_f32 v184, v184, v192
v_add_f32 v185, v185, v193
v_add_f32 v186, v186, v194
v_add_f32 v187, v187, v195
v_cvt_pk_bf16_f32 v132, v184, v185
v_cvt_pk_bf16_f32 v133, v186, v187
v_permlane16_swap_b32 v92, v94
v_permlane16_swap_b32 v93, v95
buffer_store_dwordx4 v[92:95], v3, s[40:43], s79 offen offset:64
buffer_store_dwordx2 v[132:133], v245, s[40:43], s79 offen offset:128
L_end:
s_endpgm
L_sp1_slow:
s_mov_b32 s86, 0
L_sp1_loop:
s_sleep 8
buffer_load_dwordx2 v[220:221], v31, s[24:27], s66 offen offset:0 sc1
s_waitcnt vmcnt(0)
v_cmp_ne_u32 vcc, s56, v221
s_cbranch_vccz L_sp1_back
s_add_u32 s86, s86, 1
s_cmp_lt_u32 s86, 262144
s_cbranch_scc1 L_sp1_loop
s_branch L_sp1_back
L_sp2_slow:
s_mov_b32 s86, 0
L_sp2_loop:
s_sleep 8
buffer_load_dword v222, v11, s[24:27], s69 offen offset:0 sc1
s_waitcnt vmcnt(0)
v_cmp_ne_u32 vcc, s56, v222
s_cbranch_vccz L_sp2_back
s_add_u32 s86, s86, 1
s_cmp_lt_u32 s86, 262144
s_cbranch_scc1 L_sp2_loop
s_branch L_sp2_back
L_sp3_slow:
s_mov_b32 s86, 0
L_sp3_loop:
s_sleep 8
buffer_load_dword v222, v2, s[24:27], s68 offen offset:0 sc1
s_waitcnt vmcnt(0)
v_cmp_ne_u32 vcc, s56, v222
s_cbranch_vccz L_sp3_back
s_add_u32 s86, s86, 1
s_cmp_lt_u32 s86, 262144
s_cbranch_scc1 L_sp3_loop
s_branch L_sp3_back
L_sp4_slow:
s_mov_b32 s86, 0
L_sp4_loop:
s_sleep 8
buffer_load_dwordx2 v[220:221], v31, s[24:27], s66 offen offset:0 sc1
s_waitcnt vmcnt(0)
v_cmp_ne_u32 vcc, s56, v221
s_cbranch_vccz L_sp4_back
s_add_u32 s86, s86, 1
s_cmp_lt_u32 s86, 262144
s_cbranch_scc1 L_sp4_loop
s_branch L_sp4_back
L_sp5_slow:
s_mov_b32 s86, 0
L_sp5_loop:
s_sleep 8
buffer_load_dword v222, v11, s[24:27], s69 offen offset:0 sc1
s_waitcnt vmcnt(0)
v_cmp_ne_u32 vcc, s56, v222
s_cbranch_vccz L_sp5_back
s_add_u32 s86, s86, 1
s_cmp_lt_u32 s86, 262144
s_cbranch_scc1 L_sp5_loop
s_branch L_sp5_back
L_sp6_slow:
s_mov_b32 s86, 0
L_sp6_loop:
s_sleep 8
buffer_load_dword v222, v234, s[24:27], 0 offen offset:128 sc1
s_waitcnt vmcnt(0)
v_cmp_ne_u32 vcc, s56, v222
s_cbranch_vccz L_sp6_back
s_add_u32 s86, s86, 1
s_cmp_lt_u32 s86, 262144
s_cbranch_scc1 L_sp6_loop
s_branch L_sp6_back
L_sp7_slow:
s_mov_b32 s86, 0
L_sp7_loop:
s_sleep 8
buffer_load_dword v222, v244, s[24:27], s5 offen offset:256 sc1
s_waitcnt vmcnt(0)
v_cmp_ne_u32 vcc, s56, v222
s_cbranch_vccz L_sp7_back
s_add_u32 s86, s86, 1
s_cmp_lt_u32 s86, 262144
s_cbranch_scc1 L_sp7_loop
s_branch L_sp7_back
L_safe:
s_lshl_b32 s60, s52, 2
s_add_u32 s60, s60, s54
s_sub_u32 s60, 8, s60
s_max_i32 s60, s60, 0
s_mov_b32 s61, s60
v_mov_b32 v239, 0xff800000
L_sf00:
s_mul_i32 s62, s61, 2560
v_add_u32 v235, s62, v229
v_add_u32 v236, s62, v230
v_add_u32 v237, s62, v231
ds_read_b128 v[148:151], v235 offset:0
ds_read_b64 v[152:153], v236 offset:1024
ds_read_b128 v[160:163], v237
ds_read_b128 v[164:167], v237 offset:1280
s_waitcnt lgkmcnt(0)
s_cmp_eq_u32 s61, 0
s_cbranch_scc1 L_sf00a
s_cmp_eq_u32 s61, 8
s_cbranch_scc1 L_sf00b
v_mfma_f32_32x32x16_bf16 v[64:79], v[148:151], v[96:99], 0
s_branch L_sf00c
L_sf00a:
s_nop 15
v_mfma_f32_32x32x16_bf16 v[64:79], v[148:151], v[96:99], v[32:47]
s_branch L_sf00c
L_sf00b:
s_nop 15
v_mfma_f32_32x32x16_bf16 v[64:79], v[148:151], v[96:99], v[48:63]
L_sf00c:
v_mfma_f32_32x32x8_bf16 v[64:79], v[152:153], v[100:101], v[64:79]
s_nop 15
v_max3_f32 v239, v239, v64, v65
v_max3_f32 v239, v239, v66, v67
v_max3_f32 v239, v239, v68, v69
v_max3_f32 v239, v239, v70, v71
v_max3_f32 v239, v239, v72, v73
v_max3_f32 v239, v239, v74, v75
v_max3_f32 v239, v239, v76, v77
v_max3_f32 v239, v239, v78, v79
s_add_u32 s61, s61, 1
s_cmp_lt_u32 s61, 9
s_cbranch_scc1 L_sf00
v_mov_b32 v235, v239
s_nop 1
v_permlane32_swap_b32 v239, v235
v_max_f32 v239, v239, v235
s_mov_b32 s61, s60
v_mov_b32 v184, 0
v_mov_b32 v185, 0
v_mov_b32 v186, 0
v_mov_b32 v187, 0
v_mov_b32 v188, 0
v_mov_b32 v189, 0
v_mov_b32 v190, 0
v_mov_b32 v191, 0
v_mov_b32 v192, 0
v_mov_b32 v193, 0
v_mov_b32 v194, 0
v_mov_b32 v195, 0
v_mov_b32 v196, 0
v_mov_b32 v197, 0
v_mov_b32 v198, 0
v_mov_b32 v199, 0
L_sf01:
s_mul_i32 s62, s61, 2560
v_add_u32 v235, s62, v229
v_add_u32 v236, s62, v230
v_add_u32 v237, s62, v231
ds_read_b128 v[148:151], v235 offset:0
ds_read_b64 v[152:153], v236 offset:1024
ds_read_b128 v[160:163], v237
ds_read_b128 v[164:167], v237 offset:1280
s_waitcnt lgkmcnt(0)
s_cmp_eq_u32 s61, 0
s_cbranch_scc1 L_sf01a
s_cmp_eq_u32 s61, 8
s_cbranch_scc1 L_sf01b
v_mfma_f32_32x32x16_bf16 v[64:79], v[148:151], v[96:99], 0
s_branch L_sf01c
L_sf01a:
s_nop 15
v_mfma_f32_32x32x16_bf16 v[64:79], v[148:151], v[96:99], v[32:47]
s_branch L_sf01c
L_sf01b:
s_nop 15
v_mfma_f32_32x32x16_bf16 v[64:79], v[148:151], v[96:99], v[48:63]
L_sf01c:
v_mfma_f32_32x32x8_bf16 v[64:79], v[152:153], v[100:101], v[64:79]
s_nop 15
v_sub_f32 v64, v64, v239
v_sub_f32 v65, v65, v239
v_sub_f32 v66, v66, v239
v_sub_f32 v67, v67, v239
v_sub_f32 v68, v68, v239
v_sub_f32 v69, v69, v239
v_sub_f32 v70, v70, v239
v_sub_f32 v71, v71, v239
v_sub_f32 v72, v72, v239
v_sub_f32 v73, v73, v239
v_sub_f32 v74, v74, v239
v_sub_f32 v75, v75, v239
v_sub_f32 v76, v76, v239
v_sub_f32 v77, v77, v239
v_sub_f32 v78, v78, v239
v_sub_f32 v79, v79, v239
v_exp_f32 v64, v64
v_exp_f32 v65, v65
v_exp_f32 v66, v66
v_exp_f32 v67, v67
v_exp_f32 v68, v68
v_exp_f32 v69, v69
v_exp_f32 v70, v70
v_exp_f32 v71, v71
v_exp_f32 v72, v72
v_exp_f32 v73, v73
v_exp_f32 v74, v74
v_exp_f32 v75, v75
v_exp_f32 v76, v76
v_exp_f32 v77, v77
v_exp_f32 v78, v78
v_exp_f32 v79, v79
v_cvt_pk_bf16_f32 v176, v64, v65
v_cvt_pk_bf16_f32 v177, v66, v67
v_cvt_pk_bf16_f32 v178, v68, v69
v_cvt_pk_bf16_f32 v179, v70, v71
v_cvt_pk_bf16_f32 v180, v72, v73
v_cvt_pk_bf16_f32 v181, v74, v75
v_cvt_pk_bf16_f32 v182, v76, v77
v_cvt_pk_bf16_f32 v183, v78, v79
v_mfma_f32_32x32x16_bf16 v[184:199], v[160:163], v[176:179], v[184:199]
s_nop 0
v_mfma_f32_32x32x16_bf16 v[184:199], v[164:167], v[180:183], v[184:199]
s_nop 15
s_add_u32 s61, s61, 1
s_cmp_lt_u32 s61, 9
s_cbranch_scc1 L_sf01
s_mov_b32 s61, s60
v_mov_b32 v239, 0xff800000
L_sf10:
s_mul_i32 s62, s61, 2560
v_add_u32 v235, s62, v229
v_add_u32 v236, s62, v230
v_add_u32 v237, s62, v232
ds_read_b128 v[148:151], v235 offset:1536
ds_read_b64 v[152:153], v236 offset:1032
ds_read_b128 v[160:163], v237
ds_read_b128 v[164:167], v237 offset:1280
s_waitcnt lgkmcnt(0)
s_cmp_eq_u32 s61, 0
s_cbranch_scc1 L_sf10a
s_cmp_eq_u32 s61, 8
s_cbranch_scc1 L_sf10b
v_mfma_f32_32x32x16_bf16 v[64:79], v[148:151], v[102:105], 0
s_branch L_sf10c
L_sf10a:
s_nop 15
v_mfma_f32_32x32x16_bf16 v[64:79], v[148:151], v[102:105], v[32:47]
s_branch L_sf10c
L_sf10b:
s_nop 15
v_mfma_f32_32x32x16_bf16 v[64:79], v[148:151], v[102:105], v[48:63]
L_sf10c:
v_mfma_f32_32x32x8_bf16 v[64:79], v[152:153], v[106:107], v[64:79]
s_nop 15
v_max3_f32 v239, v239, v64, v65
v_max3_f32 v239, v239, v66, v67
v_max3_f32 v239, v239, v68, v69
v_max3_f32 v239, v239, v70, v71
v_max3_f32 v239, v239, v72, v73
v_max3_f32 v239, v239, v74, v75
v_max3_f32 v239, v239, v76, v77
v_max3_f32 v239, v239, v78, v79
s_add_u32 s61, s61, 1
s_cmp_lt_u32 s61, 9
s_cbranch_scc1 L_sf10
v_mov_b32 v235, v239
s_nop 1
v_permlane32_swap_b32 v239, v235
v_max_f32 v239, v239, v235
s_mov_b32 s61, s60
v_mov_b32 v132, 0
v_mov_b32 v133, 0
v_mov_b32 v134, 0
v_mov_b32 v135, 0
v_mov_b32 v136, 0
v_mov_b32 v137, 0
v_mov_b32 v138, 0
v_mov_b32 v139, 0
v_mov_b32 v140, 0
v_mov_b32 v141, 0
v_mov_b32 v142, 0
v_mov_b32 v143, 0
v_mov_b32 v144, 0
v_mov_b32 v145, 0
v_mov_b32 v146, 0
v_mov_b32 v147, 0
L_sf11:
s_mul_i32 s62, s61, 2560
v_add_u32 v235, s62, v229
v_add_u32 v236, s62, v230
v_add_u32 v237, s62, v232
ds_read_b128 v[148:151], v235 offset:1536
ds_read_b64 v[152:153], v236 offset:1032
ds_read_b128 v[160:163], v237
ds_read_b128 v[164:167], v237 offset:1280
s_waitcnt lgkmcnt(0)
s_cmp_eq_u32 s61, 0
s_cbranch_scc1 L_sf11a
s_cmp_eq_u32 s61, 8
s_cbranch_scc1 L_sf11b
v_mfma_f32_32x32x16_bf16 v[64:79], v[148:151], v[102:105], 0
s_branch L_sf11c
L_sf11a:
s_nop 15
v_mfma_f32_32x32x16_bf16 v[64:79], v[148:151], v[102:105], v[32:47]
s_branch L_sf11c
L_sf11b:
s_nop 15
v_mfma_f32_32x32x16_bf16 v[64:79], v[148:151], v[102:105], v[48:63]
L_sf11c:
v_mfma_f32_32x32x8_bf16 v[64:79], v[152:153], v[106:107], v[64:79]
s_nop 15
v_sub_f32 v64, v64, v239
v_sub_f32 v65, v65, v239
v_sub_f32 v66, v66, v239
v_sub_f32 v67, v67, v239
v_sub_f32 v68, v68, v239
v_sub_f32 v69, v69, v239
v_sub_f32 v70, v70, v239
v_sub_f32 v71, v71, v239
v_sub_f32 v72, v72, v239
v_sub_f32 v73, v73, v239
v_sub_f32 v74, v74, v239
v_sub_f32 v75, v75, v239
v_sub_f32 v76, v76, v239
v_sub_f32 v77, v77, v239
v_sub_f32 v78, v78, v239
v_sub_f32 v79, v79, v239
v_exp_f32 v64, v64
v_exp_f32 v65, v65
v_exp_f32 v66, v66
v_exp_f32 v67, v67
v_exp_f32 v68, v68
v_exp_f32 v69, v69
v_exp_f32 v70, v70
v_exp_f32 v71, v71
v_exp_f32 v72, v72
v_exp_f32 v73, v73
v_exp_f32 v74, v74
v_exp_f32 v75, v75
v_exp_f32 v76, v76
v_exp_f32 v77, v77
v_exp_f32 v78, v78
v_exp_f32 v79, v79
v_cvt_pk_bf16_f32 v176, v64, v65
v_cvt_pk_bf16_f32 v177, v66, v67
v_cvt_pk_bf16_f32 v178, v68, v69
v_cvt_pk_bf16_f32 v179, v70, v71
v_cvt_pk_bf16_f32 v180, v72, v73
v_cvt_pk_bf16_f32 v181, v74, v75
v_cvt_pk_bf16_f32 v182, v76, v77
v_cvt_pk_bf16_f32 v183, v78, v79
v_mfma_f32_32x32x16_bf16 v[132:147], v[160:163], v[176:179], v[132:147]
s_nop 0
v_mfma_f32_32x32x16_bf16 v[132:147], v[164:167], v[180:183], v[132:147]
s_nop 15
s_add_u32 s61, s61, 1
s_cmp_lt_u32 s61, 9
s_cbranch_scc1 L_sf11
s_nop 15
s_branch L_safe_back
L_sp8_slow:
s_mov_b32 s86, 0
L_sp8_loop:
s_sleep 8
buffer_load_dword v222, v244, s[24:27], s5 offen offset:384 sc1
s_waitcnt vmcnt(0)
v_cmp_ne_u32 vcc, s56, v222
s_cbranch_vccz L_sp8_back
s_add_u32 s86, s86, 1
s_cmp_lt_u32 s86, 262144
s_cbranch_scc1 L_sp8_loop
s_branch L_sp8_back
.p2align 8
.type wave_params,@object
wave_params:
.long 0,21287424,21287424,21282816,21282816,21286912,0,1966080,1280,16777216,16778240,16779264,16780288,0,0,1073741824,21286912,21286912,20873216,21200896,1051011932,0,2048,1024,512,7864320,7868416,19562496,21286912,21292032,21292032,0,2621440,2621440,2621440,81920,0,0,0,0,7962624,16777216,16807936,7864320,7876608,17022976,7962624,0,4294967295,0,0,21286912,0,256,139264,139520,97280,117760,138240,81920,32768,47104,51200,147456
.long 2560,21287456,21291520,1073741824,21283840,21286916,1024768,1966080,1280,18301952,18646016,18647040,18648064,0,0,1073741824,21286916,21286912,20873344,21241856,1051011932,40960,2048,1024,512,8003584,8007680,19564544,21286912,21292032,21292032,0,2621440,2621440,2703360,97280,0,21553152,21553152,40960,8101888,16838656,16869376,7888896,7901184,17022976,7983104,20480,4294967295,0,0,21286912,256,0,139520,139264,81920,133120,122880,97280,149504,143360,0,30720
.long 5120,21287488,21295616,1073741824,21284864,21286920,123136,819200,1280,17389568,17390592,17734656,17735680,0,0,1073741824,21286920,21286912,20873472,21203456,1051011932,81920,2048,1024,512,8142848,8146944,19566592,21286912,21297152,21297152,0,5242880,5242880,5242880,112640,0,0,0,81920,8241152,16900096,16930816,7913472,7925760,17022976,7962624,40960,4294967295,0,0,21286912,139264,139520,0,256,128000,87040,107520,112640,32768,47104,51200,147456
.long 7680,21287520,21299712,1073741824,21285888,21286924,788096,1966080,3072,20250624,20332544,20252672,20334592,21223424,0,0,21286924,21286912,20873600,21244416,1051011932,122880,2048,1024,512,8282112,8286208,19568640,21286912,21297152,21297152,0,5242880,5242880,5324800,128000,0,21553152,21553152,122880,8380416,16961536,16992256,7938048,7950336,17022976,7983104,61440,4294967295,0,0,21286912,139520,139264,256,0,112640,102400,92160,128000,149504,143360,0,30720
.long 40960,21291520,21287424,21282832,21282816,21291008,128,1966080,1280,16781312,17125376,17126400,17127424,0,0,1073741824,21291008,21286912,20914176,21211136,1051011932,32768,2048,1024,512,7888896,7892992,19890176,21287936,21293056,21293056,0,2631680,2631680,2631680,81920,0,0,0,10240,7972864,18169856,18200576,7864320,7876608,18415616,7962624,640,4294967295,0,0,21291008,0,256,139264,139520,97280,117760,138240,81920,32768,47104,51200,147456
.long 43520,21291552,21291520,1073741824,21283840,21291012,1024896,1966080,1280,18649088,18650112,18994176,18995200,0,0,1073741824,21291012,21286912,20914304,21252096,1051011932,73728,2048,1024,512,8028160,8032256,19892224,21287936,21293056,21293056,0,2631680,2631680,2713600,97280,0,21553152,21553152,51200,8112128,18231296,18262016,7888896,7901184,18415616,7983104,21120,4294967295,0,0,21291008,256,0,139520,139264,81920,133120,122880,97280,149504,143360,0,30720
.long 46080,21291584,21295616,1073741824,21284864,21291016,123264,819200,1280,17736704,17737728,17738752,18082816,0,0,1073741824,21291016,21286912,20914432,21213696,1051011932,114688,2048,1024,512,8167424,8171520,19894272,21287936,21298176,21298176,0,5245440,5245440,5245440,112640,0,0,0,92160,8251392,18292736,18323456,7913472,7925760,18415616,7962624,41600,4294967295,0,0,21291008,139264,139520,0,256,128000,87040,107520,112640,32768,47104,51200,147456
.long 48640,21291616,21299712,1073741824,21285888,21291020,886400,1966080,3072,20254720,20336640,20256768,20338688,21223680,0,0,21291020,21286912,20914560,21254656,1051011932,155648,2048,1024,512,8306688,8310784,19896320,21287936,21298176,21298176,0,5245440,5245440,5327360,128000,0,21553152,21553152,133120,8390656,18354176,18384896,7938048,7950336,18415616,7983104,62080,4294967295,0,0,21291008,139520,139264,256,0,112640,102400,92160,128000,149504,143360,0,30720
.long 81920,21295616,21287424,21282848,21282816,21295104,256,1966080,1280,17128448,17129472,17473536,17474560,0,0,1073741824,21295104,21286912,20955136,21221376,1065353216,2646016,2048,1024,512,7913472,7917568,20217856,21288960,21294080,21294080,0,2641920,2641920,2641920,81920,0,0,0,20480,7983104,16777216,16807936,8142848,8155136,17022976,8241152,81920,4294967295,0,0,21295104,0,256,139264,139520,97280,117760,138240,81920,32768,47104,51200,147456
.long 84480,21295648,21291520,1073741824,21283840,21295108,1025024,1966080,1280,18996224,18997248,18998272,19342336,0,0,1073741824,21295108,21286912,20955264,21262336,1065353216,2686976,2048,1024,512,8052736,8056832,20219904,21288960,21294080,21294080,0,2641920,2641920,2723840,97280,0,21553152,21553152,61440,8122368,16838656,16869376,8167424,8179712,17022976,8261632,102400,4294967295,0,0,21295104,256,0,139520,139264,81920,133120,122880,97280,149504,143360,0,30720
.long 87040,21295680,21295616,1073741824,21284864,21295112,123392,819200,1280,18083840,18084864,18085888,18086912,0,0,1073741824,21295112,21286912,20955392,21223936,1065353216,2727936,2048,1024,512,8192000,8196096,20221952,21288960,21299200,21299200,0,5248000,5248000,5248000,112640,0,0,0,102400,8261632,16900096,16930816,8192000,8204288,17022976,8241152,122880,4294967295,0,0,21295104,139264,139520,0,256,128000,87040,107520,112640,32768,47104,51200,147456
.long 89600,21295712,21299712,1073741824,21285888,21295116,984704,1966080,3072,20258816,20340736,20260864,20342784,21223936,0,0,21295116,21286912,20955520,21264896,1065353216,2768896,2048,1024,512,8331264,8335360,20224000,21288960,21299200,21299200,0,5248000,5248000,5329920,128000,0,21553152,21553152,143360,8400896,16961536,16992256,8216576,8228864,17022976,8261632,143360,4294967295,0,0,21295104,139520,139264,256,0,112640,102400,92160,128000,149504,143360,0,30720
.long 122880,21299712,21287424,21282864,21282816,21299200,384,1966080,1280,17475584,17476608,17477632,17821696,0,0,1073741824,21299200,21286912,20996096,21231616,1065353216,5246976,512,20480,10240,7938048,7942144,20545536,21289984,21295104,21295104,1024,2652160,2652160,2652160,81920,0,0,0,30720,7993344,18169856,18200576,8142848,8155136,18415616,8241152,82560,4294967295,0,0,21299200,0,256,139264,139520,97280,117760,138240,81920,32768,47104,51200,147456
.long 125440,21299744,21291520,1073741824,21283840,21299204,1025152,1966080,1280,19343360,19344384,19345408,19346432,0,0,1073741824,21299204,21286912,20996224,21272576,1065353216,5287936,512,20480,10240,8077312,8081408,20547584,21289984,21295104,21295104,1024,2652160,2652160,2734080,97280,0,21553152,21553152,71680,8132608,18231296,18262016,8167424,8179712,18415616,8261632,103040,4294967295,0,0,21299200,256,0,139520,139264,81920,133120,122880,97280,149504,143360,0,30720
.long 128000,21299776,21295616,1073741824,21284864,21299208,123520,819200,1280,18430976,18432000,18433024,18434048,0,0,1073741824,21299208,21286912,20996352,21234176,1065353216,5328896,512,20480,10240,8216576,8220672,20549632,21289984,21300224,21300224,1024,5250560,5250560,5250560,112640,0,0,0,112640,8271872,18292736,18323456,8192000,8204288,18415616,8241152,123520,4294967295,0,0,21299200,139264,139520,0,256,128000,87040,107520,112640,32768,47104,51200,147456
.long 130560,21299808,21299712,1073741824,21285888,21299212,1083008,1966080,3072,20262912,20344832,20264960,20346880,21224192,0,0,21299212,21286912,20996480,21275136,1065353216,5369856,512,20480,10240,8355840,8359936,20551680,21289984,21300224,21300224,1024,5250560,5250560,5332480,128000,0,21553152,21553152,153600,8411136,18354176,18384896,8216576,8228864,18415616,8261632,144000,4294967295,0,0,21299200,139520,139264,256,0,112640,102400,92160,128000,149504,143360,0,30720
.long 1310720,21418496,21418496,21282880,21282816,21417984,512,1966080,1280,17822720,17823744,17824768,17825792,0,0,1073741824,21417984,21417984,21037056,21200896,1051011932,1310720,2048,1024,512,12320768,12324864,19562496,21417984,21390336,21406720,0,3604480,3686400,3768320,81920,21553152,21553152,21553152,1310720,12419072,16777216,16807936,12320768,12333056,17022976,12419072,1310720,4294967295,0,0,21417984,0,256,139264,139520,97280,117760,138240,81920,32768,47104,51200,147456
.long 1313280,21418528,21422592,1073741824,21283840,21417988,1064960,1966080,1280,16910336,16911360,16912384,16913408,0,0,1073741824,21417988,21417984,21037184,21241856,1051011932,1351680,2048,1024,512,12460032,12464128,19564544,21417984,21406720,21423104,0,3850240,3932160,4014080,97280,21553152,21553152,21553152,1351680,12558336,16838656,16869376,12345344,12357632,17022976,12439552,1331200,4294967295,0,0,21417984,256,0,139520,139264,81920,133120,122880,97280,149504,143360,0,30720
.long 1315840,21418560,21426688,1073741824,21284864,21417992,123648,819200,1280,18435072,18779136,18780160,18781184,0,0,1073741824,21417992,21417984,21037312,21203456,1051011932,1392640,2048,1024,512,12599296,12603392,19566592,21417984,21395456,21411840,0,6225920,6307840,6389760,112640,21553152,21553152,21553152,1392640,12697600,16900096,16930816,12369920,12382208,17022976,12419072,1351680,4294967295,0,0,21417984,139264,139520,0,256,128000,87040,107520,112640,32768,47104,51200,147456
.long 1318400,21418592,21430784,1073741824,21285888,21417996,1181312,1966080,3072,20267008,20348928,20269056,20350976,21224448,0,0,21417996,21417984,21037440,21244416,1051011932,1433600,2048,1024,512,12738560,12742656,19568640,21417984,21411840,21428224,0,6471680,6553600,6635520,128000,21553152,21553152,21553152,1433600,12836864,16961536,16992256,12394496,12406784,17022976,12439552,1372160,4294967295,0,0,21417984,139520,139264,256,0,112640,102400,92160,128000,149504,143360,0,30720
.long 1351680,21422592,21418496,21282896,21282816,21422080,640,1966080,1280,18169856,18170880,18171904,18172928,0,0,1073741824,21422080,21417984,21078016,21211136,1051011932,1343488,2048,1024,512,12345344,12349440,19890176,21419008,21391360,21407744,0,3614720,3696640,3778560,81920,21553152,21553152,21553152,1320960,12429312,18169856,18200576,12320768,12333056,18415616,12419072,1311360,4294967295,0,0,21422080,0,256,139264,139520,97280,117760,138240,81920,32768,47104,51200,147456
.long 1354240,21422624,21422592,1073741824,21283840,21422084,1065088,1966080,1280,16914432,17258496,17259520,17260544,0,0,1073741824,21422084,21417984,21078144,21252096,1051011932,1384448,2048,1024,512,12484608,12488704,19892224,21419008,21407744,21424128,0,3860480,3942400,4024320,97280,21553152,21553152,21553152,1361920,12568576,18231296,18262016,12345344,12357632,18415616,12439552,1331840,4294967295,0,0,21422080,256,0,139520,139264,81920,133120,122880,97280,149504,143360,0,30720
.long 1356800,21422656,21426688,1073741824,21284864,21422088,123776,819200,1280,18782208,18783232,19127296,19128320,0,0,1073741824,21422088,21417984,21078272,21213696,1051011932,1425408,2048,1024,512,12623872,12627968,19894272,21419008,21396480,21412864,0,6228480,6310400,6392320,112640,21553152,21553152,21553152,1402880,12707840,18292736,18323456,12369920,12382208,18415616,12419072,1352320,4294967295,0,0,21422080,139264,139520,0,256,128000,87040,107520,112640,32768,47104,51200,147456
.long 1359360,21422688,21430784,1073741824,21285888,21422092,1279616,1966080,3072,20271104,20353024,20273152,20355072,21224704,0,0,21422092,21417984,21078400,21254656,1051011932,1466368,2048,1024,512,12763136,12767232,19896320,21419008,21412864,21429248,0,6474240,6556160,6638080,128000,21553152,21553152,21553152,1443840,12847104,18354176,18384896,12394496,12406784,18415616,12439552,1372800,4294967295,0,0,21422080,139520,139264,256,0,112640,102400,92160,128000,149504,143360,0,30720
.long 1392640,21426688,21418496,21282912,21282816,21426176,768,1966080,1280,18173952,18518016,18519040,18520064,0,0,1073741824,21426176,21417984,21118976,21221376,1065353216,3956736,2048,1024,512,12369920,12374016,20217856,21420032,21392384,21408768,0,3624960,3706880,3788800,81920,21553152,21553152,21553152,1331200,12439552,16777216,16807936,12599296,12611584,17022976,12697600,1392640,4294967295,0,0,21426176,0,256,139264,139520,97280,117760,138240,81920,32768,47104,51200,147456
.long 1395200,21426720,21422592,1073741824,21283840,21426180,1065216,1966080,1280,17261568,17262592,17606656,17607680,0,0,1073741824,21426180,21417984,21119104,21262336,1065353216,3997696,2048,1024,512,12509184,12513280,20219904,21420032,21408768,21425152,0,3870720,3952640,4034560,97280,21553152,21553152,21553152,1372160,12578816,16838656,16869376,12623872,12636160,17022976,12718080,1413120,4294967295,0,0,21426176,256,0,139520,139264,81920,133120,122880,97280,149504,143360,0,30720
.long 1397760,21426752,21426688,1073741824,21284864,21426184,123904,819200,1280,19129344,19130368,19131392,19475456,0,0,1073741824,21426184,21417984,21119232,21223936,1065353216,4038656,2048,1024,512,12648448,12652544,20221952,21420032,21397504,21413888,0,6231040,6312960,6394880,112640,21553152,21553152,21553152,1413120,12718080,16900096,16930816,12648448,12660736,17022976,12697600,1433600,4294967295,0,0,21426176,139264,139520,0,256,128000,87040,107520,112640,32768,47104,51200,147456
.long 1400320,21426784,21430784,1073741824,21285888,21426188,1377920,1966080,3072,20275200,20357120,20277248,20359168,21224960,0,0,21426188,21417984,21119360,21264896,1065353216,4079616,2048,1024,512,12787712,12791808,20224000,21420032,21413888,21430272,0,6476800,6558720,6640640,128000,21553152,21553152,21553152,1454080,12857344,16961536,16992256,12673024,12685312,17022976,12718080,1454080,4294967295,0,0,21426176,139520,139264,256,0,112640,102400,92160,128000,149504,143360,0,30720
.long 1433600,21430784,21418496,21282928,21282816,21430272,896,1966080,1280,18521088,18522112,18866176,18867200,0,0,1073741824,21430272,21417984,21159936,21231616,1065353216,6557696,512,20480,10240,12394496,12398592,20545536,21421056,21393408,21409792,1024,3635200,3717120,3799040,81920,21553152,21553152,21553152,1341440,12449792,18169856,18200576,12599296,12611584,18415616,12697600,1393280,4294967295,0,0,21430272,0,256,139264,139520,97280,117760,138240,81920,32768,47104,51200,147456
.long 1436160,21430816,21422592,1073741824,21283840,21430276,1065344,1966080,1280,17608704,17609728,17610752,17954816,0,0,1073741824,21430276,21417984,21160064,21272576,1065353216,6598656,512,20480,10240,12533760,12537856,20547584,21421056,21409792,21426176,1024,3880960,3962880,4044800,97280,21553152,21553152,21553152,1382400,12589056,18231296,18262016,12623872,12636160,18415616,12718080,1413760,4294967295,0,0,21430272,256,0,139520,139264,81920,133120,122880,97280,149504,143360,0,30720
.long 1438720,21430848,21426688,1073741824,21284864,21430280,124032,819200,1280,19476480,19477504,19478528,19479552,0,0,1073741824,21430280,21417984,21160192,21234176,1065353216,6639616,512,20480,10240,12673024,12677120,20549632,21421056,21398528,21414912,1024,6233600,6315520,6397440,112640,21553152,21553152,21553152,1423360,12728320,18292736,18323456,12648448,12660736,18415616,12697600,1434240,4294967295,0,0,21430272,139264,139520,0,256,128000,87040,107520,112640,32768,47104,51200,147456
.long 1441280,21430880,21430784,1073741824,21285888,21430284,1476224,1966080,3072,20279296,20361216,20281344,20363264,21225216,0,0,21430284,21417984,21160320,21275136,1065353216,6680576,512,20480,10240,12812288,12816384,20551680,21421056,21414912,21431296,1024,6479360,6561280,6643200,128000,21553152,21553152,21553152,1464320,12867584,18354176,18384896,12673024,12685312,18415616,12718080,1454720,4294967295,0,0,21430272,139520,139264,256,0,112640,102400,92160,128000,149504,143360,0,30720
.long 10240,21288448,21287424,21282944,21282816,21287936,1024,1966080,1280,18868224,18869248,18870272,19214336,0,0,1073741824,21287936,21286912,20883456,21201024,1051011932,8192,2048,1024,512,7872512,7870464,19644416,21286912,21292032,21292032,0,2624000,2624000,2624000,81920,0,0,0,2560,7965184,17125376,17156096,7864320,7876608,17371136,7962624,160,4294967295,0,0,21287936,0,256,139264,139520,97280,117760,138240,81920,32768,47104,51200,147456
.long 12800,21288480,21291520,1073741824,21283840,21287940,1065472,1966080,1280,17955840,17956864,17957888,17958912,0,0,1073741824,21287940,21286912,20883584,21241984,1051011932,49152,2048,1024,512,8011776,8009728,19646464,21286912,21292032,21292032,0,2624000,2624000,2705920,97280,0,21553152,21553152,43520,8104448,17186816,17217536,7888896,7901184,17371136,7983104,20640,4294967295,0,0,21287936,256,0,139520,139264,81920,133120,122880,97280,149504,143360,0,30720
.long 15360,21288512,21295616,1073741824,21284864,21287944,163840,819200,1280,17043456,17044480,17045504,17046528,0,0,1073741824,21287944,21286912,20883712,21203584,1051011932,90112,2048,1024,512,8151040,8148992,19648512,21286912,21297152,21297152,0,5243520,5243520,5243520,112640,0,0,0,84480,8243712,17248256,17278976,7913472,7925760,17371136,7962624,41120,4294967295,0,0,21287936,139264,139520,0,256,128000,87040,107520,112640,32768,47104,51200,147456
.long 17920,21288544,21299712,1073741824,21285888,21287948,1574528,1966080,3072,20283392,20365312,20285440,20367360,21225472,0,0,21287948,21286912,20883840,21244544,1051011932,131072,2048,1024,512,8290304,8288256,19650560,21286912,21297152,21297152,0,5243520,5243520,5325440,128000,0,21553152,21553152,125440,8382976,17309696,17340416,7938048,7950336,17371136,7983104,61600,4294967295,0,0,21287936,139520,139264,256,0,112640,102400,92160,128000,149504,143360,0,30720
.long 51200,21292544,21287424,21282960,21282816,21292032,1152,1966080,1280,19215360,19216384,19217408,19218432,0,0,1073741824,21292032,21286912,20924416,21211264,1065353216,2621440,2048,1024,512,7897088,7895040,19972096,21287936,21293056,21293056,0,2634240,2634240,2634240,81920,0,0,0,12800,7975424,18518016,18548736,7864320,7876608,18763776,7962624,800,4294967295,0,0,21292032,0,256,139264,139520,97280,117760,138240,81920,32768,47104,51200,147456
.long 53760,21292576,21291520,1073741824,21283840,21292036,1065600,1966080,1280,18302976,18304000,18305024,18306048,0,0,1073741824,21292036,21286912,20924544,21252224,1065353216,2662400,2048,1024,512,8036352,8034304,19974144,21287936,21293056,21293056,0,2634240,2634240,2716160,97280,0,21553152,21553152,53760,8114688,18579456,18610176,7888896,7901184,18763776,7983104,21280,4294967295,0,0,21292032,256,0,139520,139264,81920,133120,122880,97280,149504,143360,0,30720
.long 56320,21292608,21295616,1073741824,21284864,21292040,163968,819200,1280,17047552,17391616,17392640,17393664,0,0,1073741824,21292040,21286912,20924672,21213824,1065353216,2703360,2048,1024,512,8175616,8173568,19976192,21287936,21298176,21298176,0,5246080,5246080,5246080,112640,0,0,0,94720,8253952,18640896,18671616,7913472,7925760,18763776,7962624,41760,4294967295,0,0,21292032,139264,139520,0,256,128000,87040,107520,112640,32768,47104,51200,147456
.long 58880,21292640,21299712,1073741824,21285888,21292044,1672832,1966080,3072,20287488,20369408,20289536,20371456,21225728,0,0,21292044,21286912,20924800,21254784,1065353216,2744320,2048,1024,512,8314880,8312832,19978240,21287936,21298176,21298176,0,5246080,5246080,5328000,128000,0,21553152,21553152,135680,8393216,18702336,18733056,7938048,7950336,18763776,7983104,62240,4294967295,0,0,21292032,139520,139264,256,0,112640,102400,92160,128000,149504,143360,0,30720
.long 92160,21296640,21287424,21282976,21282816,21296128,40960,1966080,1280,16782336,16783360,16784384,16785408,0,0,1073741824,21296128,21286912,20965376,21221504,1065353216,2654208,2048,1024,512,7921664,7919616,20299776,21288960,21294080,21294080,1024,2644480,2644480,2644480,81920,0,0,0,23040,7985664,17125376,17156096,8142848,8155136,17371136,8241152,82080,4294967295,0,0,21296128,0,256,139264,139520,97280,117760,138240,81920,32768,47104,51200,147456
.long 94720,21296672,21291520,1073741824,21283840,21296132,1065728,1966080,1280,18307072,18651136,18652160,18653184,0,0,1073741824,21296132,21286912,20965504,21262464,1065353216,2695168,2048,1024,512,8060928,8058880,20301824,21288960,21294080,21294080,1024,2644480,2644480,2726400,97280,0,21553152,21553152,64000,8124928,17186816,17217536,8167424,8179712,17371136,8261632,102560,4294967295,0,0,21296128,256,0,139520,139264,81920,133120,122880,97280,149504,143360,0,30720
.long 97280,21296704,21295616,1073741824,21284864,21296136,164096,819200,1280,17394688,17395712,17739776,17740800,0,0,1073741824,21296136,21286912,20965632,21224064,1065353216,2736128,2048,1024,512,8200192,8198144,20303872,21288960,21299200,21299200,1024,5248640,5248640,5248640,112640,0,0,0,104960,8264192,17248256,17278976,8192000,8204288,17371136,8241152,123040,4294967295,0,0,21296128,139264,139520,0,256,128000,87040,107520,112640,32768,47104,51200,147456
.long 99840,21296736,21299712,1073741824,21285888,21296140,1771136,1966080,3072,20291584,20373504,20293632,20375552,21225984,0,0,21296140,21286912,20965760,21265024,1065353216,2777088,2048,1024,512,8339456,8337408,20305920,21288960,21299200,21299200,1024,5248640,5248640,5330560,128000,0,21553152,21553152,145920,8403456,17309696,17340416,8216576,8228864,17371136,8261632,143520,4294967295,0,0,21296128,139520,139264,256,0,112640,102400,92160,128000,149504,143360,0,30720
.long 133120,21300736,21287424,21282992,21282816,21300224,41088,1966080,1280,16786432,17130496,17131520,17132544,0,0,1073741824,21300224,21286912,21006336,21231744,1065353216,5249024,512,20480,10240,7946240,7944192,20627456,21291008,21296128,21296128,0,2654720,2654720,2654720,81920,0,0,0,33280,7995904,18518016,18548736,8142848,8155136,18763776,8241152,82720,4294967295,0,0,21300224,0,256,139264,139520,97280,117760,138240,81920,32768,47104,51200,147456
.long 135680,21300768,21291520,1073741824,21283840,21300228,1065856,1966080,1280,18654208,18655232,18999296,19000320,0,0,1073741824,21300228,21286912,21006464,21272704,1065353216,5289984,512,20480,10240,8085504,8083456,20629504,21291008,21296128,21296128,0,2654720,2654720,2736640,97280,0,21553152,21553152,74240,8135168,18579456,18610176,8167424,8179712,18763776,8261632,103200,4294967295,0,0,21300224,256,0,139520,139264,81920,133120,122880,97280,149504,143360,0,30720
.long 138240,21300800,21295616,1073741824,21284864,21300232,164224,819200,1280,17741824,17742848,17743872,18087936,0,0,1073741824,21300232,21286912,21006592,21234304,1065353216,5330944,512,20480,10240,8224768,8222720,20631552,21291008,21301248,21301248,0,5251200,5251200,5251200,112640,0,0,0,115200,8274432,18640896,18671616,8192000,8204288,18763776,8241152,123680,4294967295,0,0,21300224,139264,139520,0,256,128000,87040,107520,112640,32768,47104,51200,147456
.long 140800,21300832,21299712,1073741824,21285888,21300236,1869440,1966080,3072,20295680,20377600,20297728,20379648,21226240,0,0,21300236,21286912,21006720,21275264,1065353216,5371904,512,20480,10240,8364032,8361984,20633600,21291008,21301248,21301248,0,5251200,5251200,5333120,128000,0,21553152,21553152,156160,8413696,18702336,18733056,8216576,8228864,18763776,8261632,144160,4294967295,0,0,21300224,139520,139264,256,0,112640,102400,92160,128000,149504,143360,0,30720
.long 1320960,21419520,21418496,21283008,21282816,21419008,41216,1966080,1280,17133568,17134592,17478656,17479680,0,0,1073741824,21419008,21417984,21047296,21201024,1051011932,1318912,2048,1024,512,12328960,12326912,19644416,21417984,21390336,21406720,0,3607040,3688960,3770880,81920,21553152,21553152,21553152,1313280,12421632,17125376,17156096,12320768,12333056,17371136,12419072,1310880,4294967295,0,0,21419008,0,256,139264,139520,97280,117760,138240,81920,32768,47104,51200,147456
.long 1323520,21419552,21422592,1073741824,21283840,21419012,1065984,1966080,1280,19001344,19002368,19003392,19347456,0,0,1073741824,21419012,21417984,21047424,21241984,1051011932,1359872,2048,1024,512,12468224,12466176,19646464,21417984,21406720,21423104,0,3852800,3934720,4016640,97280,21553152,21553152,21553152,1354240,12560896,17186816,17217536,12345344,12357632,17371136,12439552,1331360,4294967295,0,0,21419008,256,0,139520,139264,81920,133120,122880,97280,149504,143360,0,30720
.long 1326080,21419584,21426688,1073741824,21284864,21419016,164352,819200,1280,18088960,18089984,18091008,18092032,0,0,1073741824,21419016,21417984,21047552,21203584,1051011932,1400832,2048,1024,512,12607488,12605440,19648512,21417984,21395456,21411840,0,6226560,6308480,6390400,112640,21553152,21553152,21553152,1395200,12700160,17248256,17278976,12369920,12382208,17371136,12419072,1351840,4294967295,0,0,21419008,139264,139520,0,256,128000,87040,107520,112640,32768,47104,51200,147456
.long 1328640,21419616,21430784,1073741824,21285888,21419020,2048,1966080,3072,20381696,20463616,20383744,20465664,21226496,0,0,21419020,21417984,21047680,21244544,1051011932,1441792,2048,1024,512,12746752,12744704,19650560,21417984,21411840,21428224,0,6472320,6554240,6636160,128000,21553152,21553152,21553152,1436160,12839424,17309696,17340416,12394496,12406784,17371136,12439552,1372320,4294967295,0,0,21419008,139520,139264,256,0,112640,102400,92160,128000,149504,143360,0,30720
.long 1361920,21423616,21418496,21283024,21282816,21423104,41344,1966080,1280,17480704,17481728,17482752,17826816,0,0,1073741824,21423104,21417984,21088256,21211264,1065353216,3932160,2048,1024,512,12353536,12351488,19972096,21419008,21391360,21407744,0,3617280,3699200,3781120,81920,21553152,21553152,21553152,1323520,12431872,18518016,18548736,12320768,12333056,18763776,12419072,1311520,4294967295,0,0,21423104,0,256,139264,139520,97280,117760,138240,81920,32768,47104,51200,147456
.long 1364480,21423648,21422592,1073741824,21283840,21423108,1066112,1966080,1280,19348480,19349504,19350528,19351552,0,0,1073741824,21423108,21417984,21088384,21252224,1065353216,3973120,2048,1024,512,12492800,12490752,19974144,21419008,21407744,21424128,0,3863040,3944960,4026880,97280,21553152,21553152,21553152,1364480,12571136,18579456,18610176,12345344,12357632,18763776,12439552,1332000,4294967295,0,0,21423104,256,0,139520,139264,81920,133120,122880,97280,149504,143360,0,30720
.long 1367040,21423680,21426688,1073741824,21284864,21423112,164480,819200,1280,18436096,18437120,18438144,18439168,0,0,1073741824,21423112,21417984,21088512,21213824,1065353216,4014080,2048,1024,512,12632064,12630016,19976192,21419008,21396480,21412864,0,6229120,6311040,6392960,112640,21553152,21553152,21553152,1405440,12710400,18640896,18671616,12369920,12382208,18763776,12419072,1352480,4294967295,0,0,21423104,139264,139520,0,256,128000,87040,107520,112640,32768,47104,51200,147456
.long 1369600,21423712,21430784,1073741824,21285888,21423116,100352,1966080,3072,20385792,20467712,20387840,20469760,21226752,0,0,21423116,21417984,21088640,21254784,1065353216,4055040,2048,1024,512,12771328,12769280,19978240,21419008,21412864,21429248,0,6474880,6556800,6638720,128000,21553152,21553152,21553152,1446400,12849664,18702336,18733056,12394496,12406784,18763776,12439552,1372960,4294967295,0,0,21423104,139520,139264,256,0,112640,102400,92160,128000,149504,143360,0,30720
.long 1402880,21427712,21418496,21283040,21282816,21427200,41472,1966080,1280,17827840,17828864,17829888,17830912,0,0,1073741824,21427200,21417984,21129216,21221504,1065353216,3964928,2048,1024,512,12378112,12376064,20299776,21420032,21392384,21408768,1024,3627520,3709440,3791360,81920,21553152,21553152,21553152,1333760,12442112,17125376,17156096,12599296,12611584,17371136,12697600,1392800,4294967295,0,0,21427200,0,256,139264,139520,97280,117760,138240,81920,32768,47104,51200,147456
.long 1405440,21427744,21422592,1073741824,21283840,21427204,1105920,1966080,1280,16915456,16916480,16917504,16918528,0,0,1073741824,21427204,21417984,21129344,21262464,1065353216,4005888,2048,1024,512,12517376,12515328,20301824,21420032,21408768,21425152,1024,3873280,3955200,4037120,97280,21553152,21553152,21553152,1374720,12581376,17186816,17217536,12623872,12636160,17371136,12718080,1413280,4294967295,0,0,21427200,256,0,139520,139264,81920,133120,122880,97280,149504,143360,0,30720
.long 1408000,21427776,21426688,1073741824,21284864,21427208,164608,819200,1280,18440192,18784256,18785280,18786304,0,0,1073741824,21427208,21417984,21129472,21224064,1065353216,4046848,2048,1024,512,12656640,12654592,20303872,21420032,21397504,21413888,1024,6231680,6313600,6395520,112640,21553152,21553152,21553152,1415680,12720640,17248256,17278976,12648448,12660736,17371136,12697600,1433760,4294967295,0,0,21427200,139264,139520,0,256,128000,87040,107520,112640,32768,47104,51200,147456
.long 1410560,21427808,21430784,1073741824,21285888,21427212,198656,1966080,3072,20389888,20471808,20391936,20473856,21227008,0,0,21427212,21417984,21129600,21265024,1065353216,4087808,2048,1024,512,12795904,12793856,20305920,21420032,21413888,21430272,1024,6477440,6559360,6641280,128000,21553152,21553152,21553152,1456640,12859904,17309696,17340416,12673024,12685312,17371136,12718080,1454240,4294967295,0,0,21427200,139520,139264,256,0,112640,102400,92160,128000,149504,143360,0,30720
.long 1443840,21431808,21418496,21283056,21282816,21431296,41600,1966080,1280,18174976,18176000,18177024,18178048,0,0,1073741824,21431296,21417984,21170176,21231744,1065353216,6559744,512,20480,10240,12402688,12400640,20627456,21422080,21394432,21410816,0,3637760,3719680,3801600,81920,21553152,21553152,21553152,1344000,12452352,18518016,18548736,12599296,12611584,18763776,12697600,1393440,4294967295,0,0,21431296,0,256,139264,139520,97280,117760,138240,81920,32768,47104,51200,147456
.long 1446400,21431840,21422592,1073741824,21283840,21431300,1106048,1966080,1280,16919552,17263616,17264640,17265664,0,0,1073741824,21431300,21417984,21170304,21272704,1065353216,6600704,512,20480,10240,12541952,12539904,20629504,21422080,21410816,21427200,0,3883520,3965440,4047360,97280,21553152,21553152,21553152,1384960,12591616,18579456,18610176,12623872,12636160,18763776,12718080,1413920,4294967295,0,0,21431296,256,0,139520,139264,81920,133120,122880,97280,149504,143360,0,30720
.long 1448960,21431872,21426688,1073741824,21284864,21431304,164736,819200,1280,18787328,18788352,19132416,19133440,0,0,1073741824,21431304,21417984,21170432,21234304,1065353216,6641664,512,20480,10240,12681216,12679168,20631552,21422080,21399552,21415936,0,6234240,6316160,6398080,112640,21553152,21553152,21553152,1425920,12730880,18640896,18671616,12648448,12660736,18763776,12697600,1434400,4294967295,0,0,21431296,139264,139520,0,256,128000,87040,107520,112640,32768,47104,51200,147456
.long 1451520,21431904,21430784,1073741824,21285888,21431308,296960,1966080,3072,20393984,20475904,20396032,20477952,21227264,0,0,21431308,21417984,21170560,21275264,1065353216,6682624,512,20480,10240,12820480,12818432,20633600,21422080,21415936,21432320,0,6480000,6561920,6643840,128000,21553152,21553152,21553152,1466880,12870144,18702336,18733056,12673024,12685312,18763776,12718080,1454880,4294967295,0,0,21431296,139520,139264,256,0,112640,102400,92160,128000,149504,143360,0,30720
.long 20480,21289472,21287424,21283072,21282816,21288960,41728,1966080,1280,18179072,18523136,18524160,18525184,0,0,1073741824,21288960,21286912,20893696,21206016,1051011932,16384,2048,1024,512,7876608,7880704,19726336,21286912,21292032,21292032,0,2626560,2626560,2626560,81920,0,0,0,5120,7967744,17473536,17504256,7864320,7876608,17719296,7962624,320,4294967295,0,0,21288960,0,256,139264,139520,97280,117760,138240,81920,32768,47104,51200,147456
.long 23040,21289504,21291520,1073741824,21283840,21288964,1106176,1966080,1280,17266688,17267712,17611776,17612800,0,0,1073741824,21288964,21286912,20893824,21246976,1051011932,57344,2048,1024,512,8015872,8019968,19728384,21286912,21292032,21292032,0,2626560,2626560,2708480,97280,0,21553152,21553152,46080,8107008,17534976,17565696,7888896,7901184,17719296,7983104,20800,4294967295,0,0,21288960,256,0,139520,139264,81920,133120,122880,97280,149504,143360,0,30720
.long 25600,21289536,21295616,1073741824,21284864,21288968,164864,819200,1280,19134464,19135488,19136512,19480576,0,0,1073741824,21288968,21286912,20893952,21208576,1051011932,98304,2048,1024,512,8155136,8159232,19730432,21286912,21297152,21297152,0,5244160,5244160,5244160,112640,0,0,0,87040,8246272,17596416,17627136,7913472,7925760,17719296,7962624,41280,4294967295,0,0,21288960,139264,139520,0,256,128000,87040,107520,112640,32768,47104,51200,147456
.long 28160,21289568,21299712,1073741824,21285888,21288972,395264,1966080,3072,20398080,20480000,20400128,20482048,21227520,0,0,21288972,21286912,20894080,21249536,1051011932,139264,2048,1024,512,8294400,8298496,19732480,21286912,21297152,21297152,0,5244160,5244160,5326080,128000,0,21553152,21553152,128000,8385536,17657856,17688576,7938048,7950336,17719296,7983104,61760,4294967295,0,0,21288960,139520,139264,256,0,112640,102400,92160,128000,149504,143360,0,30720
.long 61440,21293568,21287424,21283088,21282816,21293056,41856,1966080,1280,18526208,18527232,18871296,18872320,0,0,1073741824,21293056,21286912,20934656,21216256,1065353216,2629632,2048,1024,512,7901184,7905280,20054016,21287936,21293056,21293056,1024,2636800,2636800,2636800,81920,0,0,0,15360,7977984,18866176,18896896,7864320,7876608,19111936,7962624,960,4294967295,0,0,21293056,0,256,139264,139520,97280,117760,138240,81920,32768,47104,51200,147456
.long 64000,21293600,21291520,1073741824,21283840,21293060,1106304,1966080,1280,17613824,17614848,17615872,17959936,0,0,1073741824,21293060,21286912,20934784,21257216,1065353216,2670592,2048,1024,512,8040448,8044544,20056064,21287936,21293056,21293056,1024,2636800,2636800,2718720,97280,0,21553152,21553152,56320,8117248,18927616,18958336,7888896,7901184,19111936,7983104,21440,4294967295,0,0,21293056,256,0,139520,139264,81920,133120,122880,97280,149504,143360,0,30720
.long 66560,21293632,21295616,1073741824,21284864,21293064,164992,819200,1280,19481600,19482624,19483648,19484672,0,0,1073741824,21293064,21286912,20934912,21218816,1065353216,2711552,2048,1024,512,8179712,8183808,20058112,21287936,21298176,21298176,1024,5246720,5246720,5246720,112640,0,0,0,97280,8256512,18989056,19019776,7913472,7925760,19111936,7962624,41920,4294967295,0,0,21293056,139264,139520,0,256,128000,87040,107520,112640,32768,47104,51200,147456
.long 69120,21293664,21299712,1073741824,21285888,21293068,493568,1966080,3072,20402176,20484096,20404224,20486144,21227776,0,0,21293068,21286912,20935040,21259776,1065353216,2752512,2048,1024,512,8318976,8323072,20060160,21287936,21298176,21298176,1024,5246720,5246720,5328640,128000,0,21553152,21553152,138240,8395776,19050496,19081216,7938048,7950336,19111936,7983104,62400,4294967295,0,0,21293056,139520,139264,256,0,112640,102400,92160,128000,149504,143360,0,30720
.long 102400,21297664,21287424,21283104,21282816,21297152,41984,1966080,1280,18873344,18874368,18875392,19219456,0,0,1073741824,21297152,21286912,20975616,21226496,1065353216,5242880,512,20480,10240,7925760,7929856,20381696,21289984,21295104,21295104,0,2647040,2647040,2647040,81920,0,0,0,25600,7988224,17473536,17504256,8142848,8155136,17719296,8241152,82240,4294967295,0,0,21297152,0,256,139264,139520,97280,117760,138240,81920,32768,47104,51200,147456
.long 104960,21297696,21291520,1073741824,21283840,21297156,1106432,1966080,1280,17960960,17961984,17963008,17964032,0,0,1073741824,21297156,21286912,20975744,21267456,1065353216,5283840,512,20480,10240,8065024,8069120,20383744,21289984,21295104,21295104,0,2647040,2647040,2728960,97280,0,21553152,21553152,66560,8127488,17534976,17565696,8167424,8179712,17719296,8261632,102720,4294967295,0,0,21297152,256,0,139520,139264,81920,133120,122880,97280,149504,143360,0,30720
.long 107520,21297728,21295616,1073741824,21284864,21297160,204800,819200,1280,17048576,17049600,17050624,17051648,0,0,1073741824,21297160,21286912,20975872,21229056,1065353216,5324800,512,20480,10240,8204288,8208384,20385792,21289984,21300224,21300224,0,5249280,5249280,5249280,112640,0,0,0,107520,8266752,17596416,17627136,8192000,8204288,17719296,8241152,123200,4294967295,0,0,21297152,139264,139520,0,256,128000,87040,107520,112640,32768,47104,51200,147456
.long 110080,21297760,21299712,1073741824,21285888,21297164,591872,1966080,3072,20406272,20488192,20408320,20490240,21228032,0,0,21297164,21286912,20976000,21270016,1065353216,5365760,512,20480,10240,8343552,8347648,20387840,21289984,21300224,21300224,0,5249280,5249280,5331200,128000,0,21553152,21553152,148480,8406016,17657856,17688576,8216576,8228864,17719296,8261632,143680,4294967295,0,0,21297152,139520,139264,256,0,112640,102400,92160,128000,149504,143360,0,30720
.long 143360,21301760,21287424,21283120,21282816,21301248,42112,1966080,1280,19220480,19221504,19222528,19223552,0,0,1073741824,21301248,21286912,21016576,21236736,1065353216,5251072,512,20480,10240,7950336,7954432,20709376,21291008,21296128,21296128,0,2657280,2657280,2657280,81920,0,0,0,35840,7998464,18866176,18896896,8142848,8155136,19111936,8241152,82880,4294967295,0,0,21301248,0,256,139264,139520,97280,117760,138240,81920,32768,47104,51200,147456
.long 145920,21301792,21291520,1073741824,21283840,21301252,1106560,1966080,1280,18308096,18309120,18310144,18311168,0,0,1073741824,21301252,21286912,21016704,21277696,1065353216,5292032,512,20480,10240,8089600,8093696,20711424,21291008,21296128,21296128,0,2657280,2657280,2739200,97280,0,21553152,21553152,76800,8137728,18927616,18958336,8167424,8179712,19111936,8261632,103360,4294967295,0,0,21301248,256,0,139520,139264,81920,133120,122880,97280,149504,143360,0,30720
.long 148480,21301824,21295616,1073741824,21284864,21301256,204928,819200,1280,17052672,17396736,17397760,17398784,0,0,1073741824,21301256,21286912,21016832,21239296,1065353216,5332992,512,20480,10240,8228864,8232960,20713472,21291008,21301248,21301248,0,5251840,5251840,5251840,112640,0,0,0,117760,8276992,18989056,19019776,8192000,8204288,19111936,8241152,123840,4294967295,0,0,21301248,139264,139520,0,256,128000,87040,107520,112640,32768,47104,51200,147456
.long 151040,21301856,21299712,1073741824,21285888,21301260,690176,1966080,3072,20410368,20492288,20412416,20494336,21228288,0,0,21301260,21286912,21016960,21280256,1065353216,5373952,512,20480,10240,8368128,8372224,20715520,21291008,21301248,21301248,0,5251840,5251840,5333760,128000,0,21553152,21553152,158720,8416256,19050496,19081216,8216576,8228864,19111936,8261632,144320,4294967295,0,0,21301248,139520,139264,256,0,112640,102400,92160,128000,149504,143360,0,30720
.long 1331200,21420544,21418496,21283136,21282816,21420032,81920,1966080,1280,16787456,16788480,16789504,16790528,0,0,1073741824,21420032,21417984,21057536,21206016,1051011932,1327104,2048,1024,512,12333056,12337152,19726336,21417984,21390336,21406720,0,3609600,3691520,3773440,81920,21553152,21553152,21553152,1315840,12424192,17473536,17504256,12320768,12333056,17719296,12419072,1311040,4294967295,0,0,21420032,0,256,139264,139520,97280,117760,138240,81920,32768,47104,51200,147456
.long 1333760,21420576,21422592,1073741824,21283840,21420036,1106688,1966080,1280,18312192,18656256,18657280,18658304,0,0,1073741824,21420036,21417984,21057664,21246976,1051011932,1368064,2048,1024,512,12472320,12476416,19728384,21417984,21406720,21423104,0,3855360,3937280,4019200,97280,21553152,21553152,21553152,1356800,12563456,17534976,17565696,12345344,12357632,17719296,12439552,1331520,4294967295,0,0,21420032,256,0,139520,139264,81920,133120,122880,97280,149504,143360,0,30720
.long 1336320,21420608,21426688,1073741824,21284864,21420040,205056,819200,1280,17399808,17400832,17744896,17745920,0,0,1073741824,21420040,21417984,21057792,21208576,1051011932,1409024,2048,1024,512,12611584,12615680,19730432,21417984,21395456,21411840,0,6227200,6309120,6391040,112640,21553152,21553152,21553152,1397760,12702720,17596416,17627136,12369920,12382208,17719296,12419072,1352000,4294967295,0,0,21420032,139264,139520,0,256,128000,87040,107520,112640,32768,47104,51200,147456
.long 1338880,21420640,21430784,1073741824,21285888,21420044,788480,1966080,3072,20414464,20496384,20416512,20498432,21228544,0,0,21420044,21417984,21057920,21249536,1051011932,1449984,2048,1024,512,12750848,12754944,19732480,21417984,21411840,21428224,0,6472960,6554880,6636800,128000,21553152,21553152,21553152,1438720,12841984,17657856,17688576,12394496,12406784,17719296,12439552,1372480,4294967295,0,0,21420032,139520,139264,256,0,112640,102400,92160,128000,149504,143360,0,30720
.long 1372160,21424640,21418496,21283152,21282816,21424128,82048,1966080,1280,16791552,17135616,17136640,17137664,0,0,1073741824,21424128,21417984,21098496,21216256,1065353216,3940352,2048,1024,512,12357632,12361728,20054016,21419008,21391360,21407744,1024,3619840,3701760,3783680,81920,21553152,21553152,21553152,1326080,12434432,18866176,18896896,12320768,12333056,19111936,12419072,1311680,4294967295,0,0,21424128,0,256,139264,139520,97280,117760,138240,81920,32768,47104,51200,147456
.long 1374720,21424672,21422592,1073741824,21283840,21424132,1106816,1966080,1280,18659328,18660352,19004416,19005440,0,0,1073741824,21424132,21417984,21098624,21257216,1065353216,3981312,2048,1024,512,12496896,12500992,20056064,21419008,21407744,21424128,1024,3865600,3947520,4029440,97280,21553152,21553152,21553152,1367040,12573696,18927616,18958336,12345344,12357632,19111936,12439552,1332160,4294967295,0,0,21424128,256,0,139520,139264,81920,133120,122880,97280,149504,143360,0,30720
.long 1377280,21424704,21426688,1073741824,21284864,21424136,205184,819200,1280,17746944,17747968,17748992,18093056,0,0,1073741824,21424136,21417984,21098752,21218816,1065353216,4022272,2048,1024,512,12636160,12640256,20058112,21419008,21396480,21412864,1024,6229760,6311680,6393600,112640,21553152,21553152,21553152,1408000,12712960,18989056,19019776,12369920,12382208,19111936,12419072,1352640,4294967295,0,0,21424128,139264,139520,0,256,128000,87040,107520,112640,32768,47104,51200,147456
.long 1379840,21424736,21430784,1073741824,21285888,21424140,886784,1966080,3072,20418560,20500480,20420608,20502528,21228800,0,0,21424140,21417984,21098880,21259776,1065353216,4063232,2048,1024,512,12775424,12779520,20060160,21419008,21412864,21429248,1024,6475520,6557440,6639360,128000,21553152,21553152,21553152,1448960,12852224,19050496,19081216,12394496,12406784,19111936,12439552,1373120,4294967295,0,0,21424128,139520,139264,256,0,112640,102400,92160,128000,149504,143360,0,30720
.long 1413120,21428736,21418496,21283168,21282816,21428224,82176,1966080,1280,17138688,17139712,17483776,17484800,0,0,1073741824,21428224,21417984,21139456,21226496,1065353216,6553600,512,20480,10240,12382208,12386304,20381696,21421056,21393408,21409792,0,3630080,3712000,3793920,81920,21553152,21553152,21553152,1336320,12444672,17473536,17504256,12599296,12611584,17719296,12697600,1392960,4294967295,0,0,21428224,0,256,139264,139520,97280,117760,138240,81920,32768,47104,51200,147456
.long 1415680,21428768,21422592,1073741824,21283840,21428228,1106944,1966080,1280,19006464,19007488,19008512,19352576,0,0,1073741824,21428228,21417984,21139584,21267456,1065353216,6594560,512,20480,10240,12521472,12525568,20383744,21421056,21409792,21426176,0,3875840,3957760,4039680,97280,21553152,21553152,21553152,1377280,12583936,17534976,17565696,12623872,12636160,17719296,12718080,1413440,4294967295,0,0,21428224,256,0,139520,139264,81920,133120,122880,97280,149504,143360,0,30720
.long 1418240,21428800,21426688,1073741824,21284864,21428232,205312,819200,1280,18094080,18095104,18096128,18097152,0,0,1073741824,21428232,21417984,21139712,21229056,1065353216,6635520,512,20480,10240,12660736,12664832,20385792,21421056,21398528,21414912,0,6232320,6314240,6396160,112640,21553152,21553152,21553152,1418240,12723200,17596416,17627136,12648448,12660736,17719296,12697600,1433920,4294967295,0,0,21428224,139264,139520,0,256,128000,87040,107520,112640,32768,47104,51200,147456
.long 1420800,21428832,21430784,1073741824,21285888,21428236,985088,1966080,3072,20422656,20504576,20424704,20506624,21229056,0,0,21428236,21417984,21139840,21270016,1065353216,6676480,512,20480,10240,12800000,12804096,20387840,21421056,21414912,21431296,0,6478080,6560000,6641920,128000,21553152,21553152,21553152,1459200,12862464,17657856,17688576,12673024,12685312,17719296,12718080,1454400,4294967295,0,0,21428224,139520,139264,256,0,112640,102400,92160,128000,149504,143360,0,30720
.long 1454080,21432832,21418496,21283184,21282816,21432320,82304,1966080,1280,17485824,17486848,17487872,17831936,0,0,1073741824,21432320,21417984,21180416,21236736,1065353216,6561792,512,20480,10240,12406784,12410880,20709376,21422080,21394432,21410816,0,3640320,3722240,3804160,81920,21553152,21553152,21553152,1346560,12454912,18866176,18896896,12599296,12611584,19111936,12697600,1393600,4294967295,0,0,21432320,0,256,139264,139520,97280,117760,138240,81920,32768,47104,51200,147456
.long 1456640,21432864,21422592,1073741824,21283840,21432324,1107072,1966080,1280,19353600,19354624,19355648,19356672,0,0,1073741824,21432324,21417984,21180544,21277696,1065353216,6602752,512,20480,10240,12546048,12550144,20711424,21422080,21410816,21427200,0,3886080,3968000,4049920,97280,21553152,21553152,21553152,1387520,12594176,18927616,18958336,12623872,12636160,19111936,12718080,1414080,4294967295,0,0,21432320,256,0,139520,139264,81920,133120,122880,97280,149504,143360,0,30720
.long 1459200,21432896,21426688,1073741824,21284864,21432328,205440,819200,1280,18441216,18442240,18443264,18444288,0,0,1073741824,21432328,21417984,21180672,21239296,1065353216,6643712,512,20480,10240,12685312,12689408,20713472,21422080,21399552,21415936,0,6234880,6316800,6398720,112640,21553152,21553152,21553152,1428480,12733440,18989056,19019776,12648448,12660736,19111936,12697600,1434560,4294967295,0,0,21432320,139264,139520,0,256,128000,87040,107520,112640,32768,47104,51200,147456
.long 1461760,21432928,21430784,1073741824,21285888,21432332,1083392,1966080,3072,20426752,20508672,20428800,20510720,21229312,0,0,21432332,21417984,21180800,21280256,1065353216,6684672,512,20480,10240,12824576,12828672,20715520,21422080,21415936,21432320,0,6480640,6562560,6644480,128000,21553152,21553152,21553152,1469440,12872704,19050496,19081216,12673024,12685312,19111936,12718080,1455040,4294967295,0,0,21432320,139520,139264,256,0,112640,102400,92160,128000,149504,143360,0,30720
.long 30720,21290496,21287424,21283200,21282816,21289984,82432,1966080,1280,17832960,17833984,17835008,17836032,0,0,1073741824,21289984,21286912,20903936,21206144,1051011932,24576,2048,1024,512,7884800,7882752,19808256,21286912,21292032,21292032,1024,2629120,2629120,2629120,81920,0,0,0,7680,7970304,17821696,17852416,7864320,7876608,18067456,7962624,480,4294967295,0,0,21289984,0,256,139264,139520,97280,117760,138240,81920,32768,47104,51200,147456
.long 33280,21290528,21291520,1073741824,21283840,21289988,1146880,1966080,1280,16920576,16921600,16922624,16923648,0,0,1073741824,21289988,21286912,20904064,21247104,1051011932,65536,2048,1024,512,8024064,8022016,19810304,21286912,21292032,21292032,1024,2629120,2629120,2711040,97280,0,21553152,21553152,48640,8109568,17883136,17913856,7888896,7901184,18067456,7983104,20960,4294967295,0,0,21289984,256,0,139520,139264,81920,133120,122880,97280,149504,143360,0,30720
.long 35840,21290560,21295616,1073741824,21284864,21289992,205568,819200,1280,18445312,18789376,18790400,18791424,0,0,1073741824,21289992,21286912,20904192,21208704,1051011932,106496,2048,1024,512,8163328,8161280,19812352,21286912,21297152,21297152,1024,5244800,5244800,5244800,112640,0,0,0,89600,8248832,17944576,17975296,7913472,7925760,18067456,7962624,41440,4294967295,0,0,21289984,139264,139520,0,256,128000,87040,107520,112640,32768,47104,51200,147456
.long 38400,21290592,21299712,1073741824,21285888,21289996,1181696,1966080,3072,20430848,20512768,20432896,20514816,21229568,0,0,21289996,21286912,20904320,21249664,1051011932,147456,2048,1024,512,8302592,8300544,19814400,21286912,21297152,21297152,1024,5244800,5244800,5326720,128000,0,21553152,21553152,130560,8388096,18006016,18036736,7938048,7950336,18067456,7983104,61920,4294967295,0,0,21289984,139520,139264,256,0,112640,102400,92160,128000,149504,143360,0,30720
.long 71680,21294592,21287424,21283216,21282816,21294080,82560,1966080,1280,18180096,18181120,18182144,18183168,0,0,1073741824,21294080,21286912,20944896,21216384,1065353216,2637824,2048,1024,512,7909376,7907328,20135936,21288960,21294080,21294080,0,2639360,2639360,2639360,81920,0,0,0,17920,7980544,19214336,19245056,7864320,7876608,19460096,7962624,1120,4294967295,0,0,21294080,0,256,139264,139520,97280,117760,138240,81920,32768,47104,51200,147456
.long 74240,21294624,21291520,1073741824,21283840,21294084,1147008,1966080,1280,16924672,17268736,17269760,17270784,0,0,1073741824,21294084,21286912,20945024,21257344,1065353216,2678784,2048,1024,512,8048640,8046592,20137984,21288960,21294080,21294080,0,2639360,2639360,2721280,97280,0,21553152,21553152,58880,8119808,19275776,19306496,7888896,7901184,19460096,7983104,21600,4294967295,0,0,21294080,256,0,139520,139264,81920,133120,122880,97280,149504,143360,0,30720
.long 76800,21294656,21295616,1073741824,21284864,21294088,205696,819200,1280,18792448,18793472,19137536,19138560,0,0,1073741824,21294088,21286912,20945152,21218944,1065353216,2719744,2048,1024,512,8187904,8185856,20140032,21288960,21299200,21299200,0,5247360,5247360,5247360,112640,0,0,0,99840,8259072,19337216,19367936,7913472,7925760,19460096,7962624,42080,4294967295,0,0,21294080,139264,139520,0,256,128000,87040,107520,112640,32768,47104,51200,147456
.long 79360,21294688,21299712,1073741824,21285888,21294092,1280000,1966080,3072,20434944,20516864,20436992,20518912,21229824,0,0,21294092,21286912,20945280,21259904,1065353216,2760704,2048,1024,512,8327168,8325120,20142080,21288960,21299200,21299200,0,5247360,5247360,5329280,128000,0,21553152,21553152,140800,8398336,19398656,19429376,7938048,7950336,19460096,7983104,62560,4294967295,0,0,21294080,139520,139264,256,0,112640,102400,92160,128000,149504,143360,0,30720
.long 112640,21298688,21287424,21283232,21282816,21298176,82688,1966080,1280,18184192,18528256,18529280,18530304,0,0,1073741824,21298176,21286912,20985856,21226624,1065353216,5244928,512,20480,10240,7933952,7931904,20463616,21289984,21295104,21295104,0,2649600,2649600,2649600,81920,0,0,0,28160,7990784,17821696,17852416,8142848,8155136,18067456,8241152,82400,4294967295,0,0,21298176,0,256,139264,139520,97280,117760,138240,81920,32768,47104,51200,147456
.long 115200,21298720,21291520,1073741824,21283840,21298180,1147136,1966080,1280,17271808,17272832,17616896,17617920,0,0,1073741824,21298180,21286912,20985984,21267584,1065353216,5285888,512,20480,10240,8073216,8071168,20465664,21289984,21295104,21295104,0,2649600,2649600,2731520,97280,0,21553152,21553152,69120,8130048,17883136,17913856,8167424,8179712,18067456,8261632,102880,4294967295,0,0,21298176,256,0,139520,139264,81920,133120,122880,97280,149504,143360,0,30720
.long 117760,21298752,21295616,1073741824,21284864,21298184,205824,819200,1280,19139584,19140608,19141632,19485696,0,0,1073741824,21298184,21286912,20986112,21229184,1065353216,5326848,512,20480,10240,8212480,8210432,20467712,21289984,21300224,21300224,0,5249920,5249920,5249920,112640,0,0,0,110080,8269312,17944576,17975296,8192000,8204288,18067456,8241152,123360,4294967295,0,0,21298176,139264,139520,0,256,128000,87040,107520,112640,32768,47104,51200,147456
.long 120320,21298784,21299712,1073741824,21285888,21298188,1378304,1966080,3072,20439040,20520960,20441088,20523008,21230080,0,0,21298188,21286912,20986240,21270144,1065353216,5367808,512,20480,10240,8351744,8349696,20469760,21289984,21300224,21300224,0,5249920,5249920,5331840,128000,0,21553152,21553152,151040,8408576,18006016,18036736,8216576,8228864,18067456,8261632,143840,4294967295,0,0,21298176,139520,139264,256,0,112640,102400,92160,128000,149504,143360,0,30720
.long 153600,21302784,21287424,21283248,21282816,21302272,82816,1966080,1280,18531328,18532352,18876416,18877440,0,0,1073741824,21302272,21286912,21026816,21236864,1065353216,7864320,512,20480,10240,7958528,7956480,20791296,21291008,21296128,21296128,0,2659840,2659840,2659840,81920,0,0,0,38400,8001024,19214336,19245056,8142848,8155136,19460096,8241152,83040,4294967295,0,0,21302272,0,256,139264,139520,97280,117760,138240,81920,32768,47104,51200,147456
.long 156160,21302816,21291520,1073741824,21283840,21302276,1147264,1966080,1280,17618944,17619968,17620992,17965056,0,0,1073741824,21302276,21286912,21026944,21277824,1065353216,7905280,512,20480,10240,8097792,8095744,20793344,21291008,21296128,21296128,0,2659840,2659840,2741760,97280,0,21553152,21553152,79360,8140288,19275776,19306496,8167424,8179712,19460096,8261632,103520,4294967295,0,0,21302272,256,0,139520,139264,81920,133120,122880,97280,149504,143360,0,30720
.long 158720,21302848,21295616,1073741824,21284864,21302280,205952,819200,1280,19486720,19487744,19488768,19489792,0,0,1073741824,21302280,21286912,21027072,21239424,1065353216,7946240,512,20480,10240,8237056,8235008,20795392,21291008,21301248,21301248,0,5252480,5252480,5252480,112640,0,0,0,120320,8279552,19337216,19367936,8192000,8204288,19460096,8241152,124000,4294967295,0,0,21302272,139264,139520,0,256,128000,87040,107520,112640,32768,47104,51200,147456
.long 161280,21302880,21299712,1073741824,21285888,21302284,1476608,1966080,3072,20443136,20525056,20445184,20527104,21230336,0,0,21302284,21286912,21027200,21280384,1065353216,7987200,512,20480,10240,8376320,8374272,20797440,21291008,21301248,21301248,0,5252480,5252480,5334400,128000,0,21553152,21553152,161280,8418816,19398656,19429376,8216576,8228864,19460096,8261632,144480,4294967295,0,0,21302272,139520,139264,256,0,112640,102400,92160,128000,149504,143360,0,30720
.long 1341440,21421568,21418496,21283264,21282816,21421056,82944,1966080,1280,18878464,18879488,18880512,19224576,0,0,1073741824,21421056,21417984,21067776,21206144,1051011932,1335296,2048,1024,512,12341248,12339200,19808256,21417984,21390336,21406720,1024,3612160,3694080,3776000,81920,21553152,21553152,21553152,1318400,12426752,17821696,17852416,12320768,12333056,18067456,12419072,1311200,4294967295,0,0,21421056,0,256,139264,139520,97280,117760,138240,81920,32768,47104,51200,147456
.long 1344000,21421600,21422592,1073741824,21283840,21421060,1147392,1966080,1280,17966080,17967104,17968128,17969152,0,0,1073741824,21421060,21417984,21067904,21247104,1051011932,1376256,2048,1024,512,12480512,12478464,19810304,21417984,21406720,21423104,1024,3857920,3939840,4021760,97280,21553152,21553152,21553152,1359360,12566016,17883136,17913856,12345344,12357632,18067456,12439552,1331680,4294967295,0,0,21421056,256,0,139520,139264,81920,133120,122880,97280,149504,143360,0,30720
.long 1346560,21421632,21426688,1073741824,21284864,21421064,245760,819200,1280,17053696,17054720,17055744,17056768,0,0,1073741824,21421064,21417984,21068032,21208704,1051011932,1417216,2048,1024,512,12619776,12617728,19812352,21417984,21395456,21411840,1024,6227840,6309760,6391680,112640,21553152,21553152,21553152,1400320,12705280,17944576,17975296,12369920,12382208,18067456,12419072,1352160,4294967295,0,0,21421056,139264,139520,0,256,128000,87040,107520,112640,32768,47104,51200,147456
.long 1349120,21421664,21430784,1073741824,21285888,21421068,1574912,1966080,3072,20447232,20529152,20449280,20531200,21230592,0,0,21421068,21417984,21068160,21249664,1051011932,1458176,2048,1024,512,12759040,12756992,19814400,21417984,21411840,21428224,1024,6473600,6555520,6637440,128000,21553152,21553152,21553152,1441280,12844544,18006016,18036736,12394496,12406784,18067456,12439552,1372640,4294967295,0,0,21421056,139520,139264,256,0,112640,102400,92160,128000,149504,143360,0,30720
.long 1382400,21425664,21418496,21283280,21282816,21425152,83072,1966080,1280,19225600,19226624,19227648,19228672,0,0,1073741824,21425152,21417984,21108736,21216384,1065353216,3948544,2048,1024,512,12365824,12363776,20135936,21420032,21392384,21408768,0,3622400,3704320,3786240,81920,21553152,21553152,21553152,1328640,12436992,19214336,19245056,12320768,12333056,19460096,12419072,1311840,4294967295,0,0,21425152,0,256,139264,139520,97280,117760,138240,81920,32768,47104,51200,147456
.long 1384960,21425696,21422592,1073741824,21283840,21425156,1147520,1966080,1280,18313216,18314240,18315264,18316288,0,0,1073741824,21425156,21417984,21108864,21257344,1065353216,3989504,2048,1024,512,12505088,12503040,20137984,21420032,21408768,21425152,0,3868160,3950080,4032000,97280,21553152,21553152,21553152,1369600,12576256,19275776,19306496,12345344,12357632,19460096,12439552,1332320,4294967295,0,0,21425152,256,0,139520,139264,81920,133120,122880,97280,149504,143360,0,30720
.long 1387520,21425728,21426688,1073741824,21284864,21425160,245888,819200,1280,17057792,17401856,17402880,17403904,0,0,1073741824,21425160,21417984,21108992,21218944,1065353216,4030464,2048,1024,512,12644352,12642304,20140032,21420032,21397504,21413888,0,6230400,6312320,6394240,112640,21553152,21553152,21553152,1410560,12715520,19337216,19367936,12369920,12382208,19460096,12419072,1352800,4294967295,0,0,21425152,139264,139520,0,256,128000,87040,107520,112640,32768,47104,51200,147456
.long 1390080,21425760,21430784,1073741824,21285888,21425164,1673216,1966080,3072,20451328,20533248,20453376,20535296,21230848,0,0,21425164,21417984,21109120,21259904,1065353216,4071424,2048,1024,512,12783616,12781568,20142080,21420032,21413888,21430272,0,6476160,6558080,6640000,128000,21553152,21553152,21553152,1451520,12854784,19398656,19429376,12394496,12406784,19460096,12439552,1373280,4294967295,0,0,21425152,139520,139264,256,0,112640,102400,92160,128000,149504,143360,0,30720
.long 1423360,21429760,21418496,21283296,21282816,21429248,122880,1966080,1280,16792576,16793600,16794624,16795648,0,0,1073741824,21429248,21417984,21149696,21226624,1065353216,6555648,512,20480,10240,12390400,12388352,20463616,21421056,21393408,21409792,0,3632640,3714560,3796480,81920,21553152,21553152,21553152,1338880,12447232,17821696,17852416,12599296,12611584,18067456,12697600,1393120,4294967295,0,0,21429248,0,256,139264,139520,97280,117760,138240,81920,32768,47104,51200,147456
.long 1425920,21429792,21422592,1073741824,21283840,21429252,1147648,1966080,1280,18317312,18661376,18662400,18663424,0,0,1073741824,21429252,21417984,21149824,21267584,1065353216,6596608,512,20480,10240,12529664,12527616,20465664,21421056,21409792,21426176,0,3878400,3960320,4042240,97280,21553152,21553152,21553152,1379840,12586496,17883136,17913856,12623872,12636160,18067456,12718080,1413600,4294967295,0,0,21429248,256,0,139520,139264,81920,133120,122880,97280,149504,143360,0,30720
.long 1428480,21429824,21426688,1073741824,21284864,21429256,246016,819200,1280,17404928,17405952,17750016,17751040,0,0,1073741824,21429256,21417984,21149952,21229184,1065353216,6637568,512,20480,10240,12668928,12666880,20467712,21421056,21398528,21414912,0,6232960,6314880,6396800,112640,21553152,21553152,21553152,1420800,12725760,17944576,17975296,12648448,12660736,18067456,12697600,1434080,4294967295,0,0,21429248,139264,139520,0,256,128000,87040,107520,112640,32768,47104,51200,147456
.long 1431040,21429856,21430784,1073741824,21285888,21429260,1771520,1966080,3072,20455424,20537344,20457472,20539392,21231104,0,0,21429260,21417984,21150080,21270144,1065353216,6678528,512,20480,10240,12808192,12806144,20469760,21421056,21414912,21431296,0,6478720,6560640,6642560,128000,21553152,21553152,21553152,1461760,12865024,18006016,18036736,12673024,12685312,18067456,12718080,1454560,4294967295,0,0,21429248,139520,139264,256,0,112640,102400,92160,128000,149504,143360,0,30720
.long 1464320,21433856,21418496,21283312,21282816,21433344,123008,1966080,1280,16796672,17140736,17141760,17142784,0,0,1073741824,21433344,21417984,21190656,21236864,1065353216,9175040,512,20480,10240,12414976,12412928,20791296,21422080,21394432,21410816,0,3642880,3724800,3806720,81920,21553152,21553152,21553152,1349120,12457472,19214336,19245056,12599296,12611584,19460096,12697600,1393760,4294967295,0,0,21433344,0,256,139264,139520,97280,117760,138240,81920,32768,47104,51200,147456
.long 1466880,21433888,21422592,1073741824,21283840,21433348,1147776,1966080,1280,18664448,18665472,19009536,19010560,0,0,1073741824,21433348,21417984,21190784,21277824,1065353216,9216000,512,20480,10240,12554240,12552192,20793344,21422080,21410816,21427200,0,3888640,3970560,4052480,97280,21553152,21553152,21553152,1390080,12596736,19275776,19306496,12623872,12636160,19460096,12718080,1414240,4294967295,0,0,21433344,256,0,139520,139264,81920,133120,122880,97280,149504,143360,0,30720
.long 1469440,21433920,21426688,1073741824,21284864,21433352,246144,819200,1280,17752064,17753088,17754112,18098176,0,0,1073741824,21433352,21417984,21190912,21239424,1065353216,9256960,512,20480,10240,12693504,12691456,20795392,21422080,21399552,21415936,0,6235520,6317440,6399360,112640,21553152,21553152,21553152,1431040,12736000,19337216,19367936,12648448,12660736,19460096,12697600,1434720,4294967295,0,0,21433344,139264,139520,0,256,128000,87040,107520,112640,32768,47104,51200,147456
.long 1472000,21433952,21430784,1073741824,21285888,21433356,1869824,1966080,3072,20459520,20541440,20461568,20543488,21231360,0,0,21433356,21417984,21191040,21280384,1065353216,9297920,512,20480,10240,12832768,12830720,20797440,21422080,21415936,21432320,0,6481280,6563200,6645120,128000,21553152,21553152,21553152,1472000,12875264,19398656,19429376,12673024,12685312,19460096,12718080,1455200,4294967295,0,0,21433344,139520,139264,256,0,112640,102400,92160,128000,149504,143360,0,30720
.long 163840,21303808,21303808,21283328,21282816,21286912,123136,1966080,1280,17143808,17144832,17488896,17489920,0,0,1073741824,21303296,21303296,20873216,21200896,1051011932,163840,2048,1024,512,8421376,8425472,19562496,21303296,21292032,21292032,0,2621440,2621440,2621440,81920,0,0,21553152,163840,8519680,16807936,16777216,8433664,8421376,17022976,8519680,163840,0,4294967295,512,21303296,0,256,139264,139520,97280,117760,138240,81920,32768,47104,51200,147456
.long 166400,21303840,21307904,1073741824,21283840,21286916,1147904,1966080,1280,19011584,19012608,19013632,19357696,0,0,1073741824,21303300,21303296,20873344,21241856,1051011932,204800,2048,1024,512,8560640,8564736,19564544,21303296,21292032,21308416,0,2703360,2785280,2867200,97280,21553152,21553152,21553152,204800,8658944,16869376,16838656,8458240,8445952,17022976,8540160,184320,0,4294967295,512,21303296,256,0,139520,139264,81920,133120,122880,97280,149504,143360,0,30720
.long 168960,21303872,21312000,1073741824,21284864,21286920,246272,819200,1280,18099200,18100224,18101248,18102272,0,0,1073741824,21303304,21303296,20873472,21203456,1051011932,245760,2048,1024,512,8699904,8704000,19566592,21303296,21297152,21297152,0,5242880,5242880,5242880,112640,0,0,21553152,245760,8798208,16930816,16900096,8482816,8470528,17022976,8519680,204800,0,4294967295,512,21303296,139264,139520,0,256,128000,87040,107520,112640,32768,47104,51200,147456
.long 171520,21303904,21316096,1073741824,21285888,21286924,2432,1966080,3072,20545536,20627456,20547584,20629504,21231616,0,0,21303308,21303296,20873600,21244416,1051011932,286720,2048,1024,512,8839168,8843264,19568640,21303296,21297152,21313536,0,5324800,5406720,5488640,128000,21553152,21553152,21553152,286720,8937472,16992256,16961536,8507392,8495104,17022976,8540160,225280,0,4294967295,512,21303296,139520,139264,256,0,112640,102400,92160,128000,149504,143360,0,30720
.long 204800,21307904,21303808,21283344,21282816,21291008,123264,1966080,1280,17490944,17491968,17492992,17837056,0,0,1073741824,21307392,21303296,20914176,21211136,1051011932,196608,2048,1024,512,8445952,8450048,19890176,21304320,21293056,21293056,0,2631680,2631680,2631680,81920,0,0,21553152,174080,8529920,18200576,18169856,8433664,8421376,18415616,8519680,164480,0,4294967295,512,21307392,0,256,139264,139520,97280,117760,138240,81920,32768,47104,51200,147456
.long 207360,21307936,21307904,1073741824,21283840,21291012,1148032,1966080,1280,19358720,19359744,19360768,19361792,0,0,1073741824,21307396,21303296,20914304,21252096,1051011932,237568,2048,1024,512,8585216,8589312,19892224,21304320,21293056,21309440,0,2713600,2795520,2877440,97280,21553152,21553152,21553152,215040,8669184,18262016,18231296,8458240,8445952,18415616,8540160,184960,0,4294967295,512,21307392,256,0,139520,139264,81920,133120,122880,97280,149504,143360,0,30720
.long 209920,21307968,21312000,1073741824,21284864,21291016,246400,819200,1280,18446336,18447360,18448384,18449408,0,0,1073741824,21307400,21303296,20914432,21213696,1051011932,278528,2048,1024,512,8724480,8728576,19894272,21304320,21298176,21298176,0,5245440,5245440,5245440,112640,0,0,21553152,256000,8808448,18323456,18292736,8482816,8470528,18415616,8519680,205440,0,4294967295,512,21307392,139264,139520,0,256,128000,87040,107520,112640,32768,47104,51200,147456
.long 212480,21308000,21316096,1073741824,21285888,21291020,100736,1966080,3072,20549632,20631552,20551680,20633600,21231872,0,0,21307404,21303296,20914560,21254656,1051011932,319488,2048,1024,512,8863744,8867840,19896320,21304320,21298176,21314560,0,5327360,5409280,5491200,128000,21553152,21553152,21553152,296960,8947712,18384896,18354176,8507392,8495104,18415616,8540160,225920,0,4294967295,512,21307392,139520,139264,256,0,112640,102400,92160,128000,149504,143360,0,30720
.long 245760,21312000,21303808,21283360,21282816,21295104,123392,1966080,1280,17838080,17839104,17840128,17841152,0,0,1073741824,21311488,21303296,20955136,21221376,1065353216,2809856,2048,1024,512,8470528,8474624,20217856,21305344,21294080,21294080,0,2641920,2641920,2641920,81920,0,0,21553152,184320,8540160,16807936,16777216,8712192,8699904,17022976,8798208,245760,0,4294967295,512,21311488,0,256,139264,139520,97280,117760,138240,81920,32768,47104,51200,147456
.long 248320,21312032,21307904,1073741824,21283840,21295108,1187840,1966080,1280,16925696,16926720,16927744,16928768,0,0,1073741824,21311492,21303296,20955264,21262336,1065353216,2850816,2048,1024,512,8609792,8613888,20219904,21305344,21294080,21310464,0,2723840,2805760,2887680,97280,21553152,21553152,21553152,225280,8679424,16869376,16838656,8736768,8724480,17022976,8818688,266240,0,4294967295,512,21311488,256,0,139520,139264,81920,133120,122880,97280,149504,143360,0,30720
.long 250880,21312064,21312000,1073741824,21284864,21295112,246528,819200,1280,18450432,18794496,18795520,18796544,0,0,1073741824,21311496,21303296,20955392,21223936,1065353216,2891776,2048,1024,512,8749056,8753152,20221952,21305344,21299200,21299200,0,5248000,5248000,5248000,112640,0,0,21553152,266240,8818688,16930816,16900096,8761344,8749056,17022976,8798208,286720,0,4294967295,512,21311488,139264,139520,0,256,128000,87040,107520,112640,32768,47104,51200,147456
.long 253440,21312096,21316096,1073741824,21285888,21295116,199040,1966080,3072,20553728,20635648,20555776,20637696,21232128,0,0,21311500,21303296,20955520,21264896,1065353216,2932736,2048,1024,512,8888320,8892416,20224000,21305344,21299200,21315584,0,5329920,5411840,5493760,128000,21553152,21553152,21553152,307200,8957952,16992256,16961536,8785920,8773632,17022976,8818688,307200,0,4294967295,512,21311488,139520,139264,256,0,112640,102400,92160,128000,149504,143360,0,30720
.long 286720,21316096,21303808,21283376,21282816,21299200,123520,1966080,1280,18185216,18186240,18187264,18188288,0,0,1073741824,21315584,21303296,20996096,21231616,1065353216,5410816,512,20480,10240,8495104,8499200,20545536,21306368,21295104,21295104,1024,2652160,2652160,2652160,81920,0,0,21553152,194560,8550400,18200576,18169856,8712192,8699904,18415616,8798208,246400,0,4294967295,512,21315584,0,256,139264,139520,97280,117760,138240,81920,32768,47104,51200,147456
.long 289280,21316128,21307904,1073741824,21283840,21299204,1187968,1966080,1280,16929792,17273856,17274880,17275904,0,0,1073741824,21315588,21303296,20996224,21272576,1065353216,5451776,512,20480,10240,8634368,8638464,20547584,21306368,21295104,21311488,1024,2734080,2816000,2897920,97280,21553152,21553152,21553152,235520,8689664,18262016,18231296,8736768,8724480,18415616,8818688,266880,0,4294967295,512,21315584,256,0,139520,139264,81920,133120,122880,97280,149504,143360,0,30720
.long 291840,21316160,21312000,1073741824,21284864,21299208,246656,819200,1280,18797568,18798592,19142656,19143680,0,0,1073741824,21315592,21303296,20996352,21234176,1065353216,5492736,512,20480,10240,8773632,8777728,20549632,21306368,21300224,21300224,1024,5250560,5250560,5250560,112640,0,0,21553152,276480,8828928,18323456,18292736,8761344,8749056,18415616,8798208,287360,0,4294967295,512,21315584,139264,139520,0,256,128000,87040,107520,112640,32768,47104,51200,147456
.long 294400,21316192,21316096,1073741824,21285888,21299212,297344,1966080,3072,20557824,20639744,20559872,20641792,21232384,0,0,21315596,21303296,20996480,21275136,1065353216,5533696,512,20480,10240,8912896,8916992,20551680,21306368,21300224,21316608,1024,5332480,5414400,5496320,128000,21553152,21553152,21553152,317440,8968192,18384896,18354176,8785920,8773632,18415616,8818688,307840,0,4294967295,512,21315584,139520,139264,256,0,112640,102400,92160,128000,149504,143360,0,30720
.long 1474560,21434880,21434880,21283392,21282816,21417984,123648,1966080,1280,18189312,18533376,18534400,18535424,0,0,1073741824,21434368,21434368,21037056,21200896,1051011932,1474560,2048,1024,512,12877824,12881920,19562496,21434368,21406720,21423104,0,3768320,3850240,3932160,81920,21553152,21553152,21553152,1474560,12976128,16807936,16777216,12890112,12877824,17022976,12976128,1474560,0,4294967295,512,21434368,0,256,139264,139520,97280,117760,138240,81920,32768,47104,51200,147456
.long 1477120,21434912,21438976,1073741824,21283840,21417988,1188096,1966080,1280,17276928,17277952,17622016,17623040,0,0,1073741824,21434372,21434368,21037184,21241856,1051011932,1515520,2048,1024,512,13017088,13021184,19564544,21434368,21423104,21439488,0,4014080,4096000,4177920,97280,21553152,21553152,21553152,1515520,13115392,16869376,16838656,12914688,12902400,17022976,12996608,1495040,0,4294967295,512,21434368,256,0,139520,139264,81920,133120,122880,97280,149504,143360,0,30720
.long 1479680,21434944,21443072,1073741824,21284864,21417992,246784,819200,1280,19144704,19145728,19146752,19490816,0,0,1073741824,21434376,21434368,21037312,21203456,1051011932,1556480,2048,1024,512,13156352,13160448,19566592,21434368,21411840,21428224,0,6389760,6471680,6553600,112640,21553152,21553152,21553152,1556480,13254656,16930816,16900096,12939264,12926976,17022976,12976128,1515520,0,4294967295,512,21434368,139264,139520,0,256,128000,87040,107520,112640,32768,47104,51200,147456
.long 1482240,21434976,21447168,1073741824,21285888,21417996,395648,1966080,3072,20561920,20643840,20563968,20645888,21232640,0,0,21434380,21434368,21037440,21244416,1051011932,1597440,2048,1024,512,13295616,13299712,19568640,21434368,21428224,21444608,0,6635520,6717440,6799360,128000,21553152,21553152,21553152,1597440,13393920,16992256,16961536,12963840,12951552,17022976,12996608,1536000,0,4294967295,512,21434368,139520,139264,256,0,112640,102400,92160,128000,149504,143360,0,30720
.long 1515520,21438976,21434880,21283408,21282816,21422080,123776,1966080,1280,18536448,18537472,18881536,18882560,0,0,1073741824,21438464,21434368,21078016,21211136,1051011932,1507328,2048,1024,512,12902400,12906496,19890176,21435392,21407744,21424128,0,3778560,3860480,3942400,81920,21553152,21553152,21553152,1484800,12986368,18200576,18169856,12890112,12877824,18415616,12976128,1475200,0,4294967295,512,21438464,0,256,139264,139520,97280,117760,138240,81920,32768,47104,51200,147456
.long 1518080,21439008,21438976,1073741824,21283840,21422084,1188224,1966080,1280,17624064,17625088,17626112,17970176,0,0,1073741824,21438468,21434368,21078144,21252096,1051011932,1548288,2048,1024,512,13041664,13045760,19892224,21435392,21424128,21440512,0,4024320,4106240,4188160,97280,21553152,21553152,21553152,1525760,13125632,18262016,18231296,12914688,12902400,18415616,12996608,1495680,0,4294967295,512,21438464,256,0,139520,139264,81920,133120,122880,97280,149504,143360,0,30720
.long 1520640,21439040,21443072,1073741824,21284864,21422088,246912,819200,1280,19491840,19492864,19493888,19494912,0,0,1073741824,21438472,21434368,21078272,21213696,1051011932,1589248,2048,1024,512,13180928,13185024,19894272,21435392,21412864,21429248,0,6392320,6474240,6556160,112640,21553152,21553152,21553152,1566720,13264896,18323456,18292736,12939264,12926976,18415616,12976128,1516160,0,4294967295,512,21438464,139264,139520,0,256,128000,87040,107520,112640,32768,47104,51200,147456
.long 1523200,21439072,21447168,1073741824,21285888,21422092,493952,1966080,3072,20566016,20647936,20568064,20649984,21232896,0,0,21438476,21434368,21078400,21254656,1051011932,1630208,2048,1024,512,13320192,13324288,19896320,21435392,21429248,21445632,0,6638080,6720000,6801920,128000,21553152,21553152,21553152,1607680,13404160,18384896,18354176,12963840,12951552,18415616,12996608,1536640,0,4294967295,512,21438464,139520,139264,256,0,112640,102400,92160,128000,149504,143360,0,30720
.long 1556480,21443072,21434880,21283424,21282816,21426176,123904,1966080,1280,18883584,18884608,18885632,19229696,0,0,1073741824,21442560,21434368,21118976,21221376,1065353216,4120576,2048,1024,512,12926976,12931072,20217856,21436416,21408768,21425152,0,3788800,3870720,3952640,81920,21553152,21553152,21553152,1495040,12996608,16807936,16777216,13168640,13156352,17022976,13254656,1556480,0,4294967295,512,21442560,0,256,139264,139520,97280,117760,138240,81920,32768,47104,51200,147456
.long 1559040,21443104,21438976,1073741824,21283840,21426180,1188352,1966080,1280,17971200,17972224,17973248,17974272,0,0,1073741824,21442564,21434368,21119104,21262336,1065353216,4161536,2048,1024,512,13066240,13070336,20219904,21436416,21425152,21441536,0,4034560,4116480,4198400,97280,21553152,21553152,21553152,1536000,13135872,16869376,16838656,13193216,13180928,17022976,13275136,1576960,0,4294967295,512,21442560,256,0,139520,139264,81920,133120,122880,97280,149504,143360,0,30720
.long 1561600,21443136,21443072,1073741824,21284864,21426184,286720,819200,1280,17058816,17059840,17060864,17061888,0,0,1073741824,21442568,21434368,21119232,21223936,1065353216,4202496,2048,1024,512,13205504,13209600,20221952,21436416,21413888,21430272,0,6394880,6476800,6558720,112640,21553152,21553152,21553152,1576960,13275136,16930816,16900096,13217792,13205504,17022976,13254656,1597440,0,4294967295,512,21442560,139264,139520,0,256,128000,87040,107520,112640,32768,47104,51200,147456
.long 1564160,21443168,21447168,1073741824,21285888,21426188,592256,1966080,3072,20570112,20652032,20572160,20654080,21233152,0,0,21442572,21434368,21119360,21264896,1065353216,4243456,2048,1024,512,13344768,13348864,20224000,21436416,21430272,21446656,0,6640640,6722560,6804480,128000,21553152,21553152,21553152,1617920,13414400,16992256,16961536,13242368,13230080,17022976,13275136,1617920,0,4294967295,512,21442560,139520,139264,256,0,112640,102400,92160,128000,149504,143360,0,30720
.long 1597440,21447168,21434880,21283440,21282816,21430272,124032,1966080,1280,19230720,19231744,19232768,19233792,0,0,1073741824,21446656,21434368,21159936,21231616,1065353216,6721536,512,20480,10240,12951552,12955648,20545536,21437440,21409792,21426176,1024,3799040,3880960,3962880,81920,21553152,21553152,21553152,1505280,13006848,18200576,18169856,13168640,13156352,18415616,13254656,1557120,0,4294967295,512,21446656,0,256,139264,139520,97280,117760,138240,81920,32768,47104,51200,147456
.long 1600000,21447200,21438976,1073741824,21283840,21430276,1188480,1966080,1280,18318336,18319360,18320384,18321408,0,0,1073741824,21446660,21434368,21160064,21272576,1065353216,6762496,512,20480,10240,13090816,13094912,20547584,21437440,21426176,21442560,1024,4044800,4126720,4208640,97280,21553152,21553152,21553152,1546240,13146112,18262016,18231296,13193216,13180928,18415616,13275136,1577600,0,4294967295,512,21446656,256,0,139520,139264,81920,133120,122880,97280,149504,143360,0,30720
.long 1602560,21447232,21443072,1073741824,21284864,21430280,286848,819200,1280,17062912,17406976,17408000,17409024,0,0,1073741824,21446664,21434368,21160192,21234176,1065353216,6803456,512,20480,10240,13230080,13234176,20549632,21437440,21414912,21431296,1024,6397440,6479360,6561280,112640,21553152,21553152,21553152,1587200,13285376,18323456,18292736,13217792,13205504,18415616,13254656,1598080,0,4294967295,512,21446656,139264,139520,0,256,128000,87040,107520,112640,32768,47104,51200,147456
.long 1605120,21447264,21447168,1073741824,21285888,21430284,690560,1966080,3072,20574208,20656128,20576256,20658176,21233408,0,0,21446668,21434368,21160320,21275136,1065353216,6844416,512,20480,10240,13369344,13373440,20551680,21437440,21431296,21447680,1024,6643200,6725120,6807040,128000,21553152,21553152,21553152,1628160,13424640,18384896,18354176,13242368,13230080,18415616,13275136,1618560,0,4294967295,512,21446656,139520,139264,256,0,112640,102400,92160,128000,149504,143360,0,30720
.long 174080,21304832,21303808,21283456,21282816,21287936,163840,1966080,1280,16797696,16798720,16799744,16800768,0,0,1073741824,21304320,21303296,20883456,21201024,1051011932,172032,2048,1024,512,8429568,8427520,19644416,21303296,21292032,21292032,0,2624000,2624000,2624000,81920,0,0,21553152,166400,8522240,17156096,17125376,8433664,8421376,17371136,8519680,164000,0,4294967295,512,21304320,0,256,139264,139520,97280,117760,138240,81920,32768,47104,51200,147456
.long 176640,21304864,21307904,1073741824,21283840,21287940,1188608,1966080,1280,18322432,18666496,18667520,18668544,0,0,1073741824,21304324,21303296,20883584,21241984,1051011932,212992,2048,1024,512,8568832,8566784,19646464,21303296,21292032,21308416,0,2705920,2787840,2869760,97280,21553152,21553152,21553152,207360,8661504,17217536,17186816,8458240,8445952,17371136,8540160,184480,0,4294967295,512,21304320,256,0,139520,139264,81920,133120,122880,97280,149504,143360,0,30720
.long 179200,21304896,21312000,1073741824,21284864,21287944,286976,819200,1280,17410048,17411072,17755136,17756160,0,0,1073741824,21304328,21303296,20883712,21203584,1051011932,253952,2048,1024,512,8708096,8706048,19648512,21303296,21297152,21297152,0,5243520,5243520,5243520,112640,0,0,21553152,248320,8800768,17278976,17248256,8482816,8470528,17371136,8519680,204960,0,4294967295,512,21304320,139264,139520,0,256,128000,87040,107520,112640,32768,47104,51200,147456
.long 181760,21304928,21316096,1073741824,21285888,21287948,788864,1966080,3072,20578304,20660224,20580352,20662272,21233664,0,0,21304332,21303296,20883840,21244544,1051011932,294912,2048,1024,512,8847360,8845312,19650560,21303296,21297152,21313536,0,5325440,5407360,5489280,128000,21553152,21553152,21553152,289280,8940032,17340416,17309696,8507392,8495104,17371136,8540160,225440,0,4294967295,512,21304320,139520,139264,256,0,112640,102400,92160,128000,149504,143360,0,30720
.long 215040,21308928,21303808,21283472,21282816,21292032,163968,1966080,1280,16801792,17145856,17146880,17147904,0,0,1073741824,21308416,21303296,20924416,21211264,1065353216,2785280,2048,1024,512,8454144,8452096,19972096,21304320,21293056,21293056,0,2634240,2634240,2634240,81920,0,0,21553152,176640,8532480,18548736,18518016,8433664,8421376,18763776,8519680,164640,0,4294967295,512,21308416,0,256,139264,139520,97280,117760,138240,81920,32768,47104,51200,147456
.long 217600,21308960,21307904,1073741824,21283840,21292036,1188736,1966080,1280,18669568,18670592,19014656,19015680,0,0,1073741824,21308420,21303296,20924544,21252224,1065353216,2826240,2048,1024,512,8593408,8591360,19974144,21304320,21293056,21309440,0,2716160,2798080,2880000,97280,21553152,21553152,21553152,217600,8671744,18610176,18579456,8458240,8445952,18763776,8540160,185120,0,4294967295,512,21308416,256,0,139520,139264,81920,133120,122880,97280,149504,143360,0,30720
.long 220160,21308992,21312000,1073741824,21284864,21292040,287104,819200,1280,17757184,17758208,17759232,18103296,0,0,1073741824,21308424,21303296,20924672,21213824,1065353216,2867200,2048,1024,512,8732672,8730624,19976192,21304320,21298176,21298176,0,5246080,5246080,5246080,112640,0,0,21553152,258560,8811008,18671616,18640896,8482816,8470528,18763776,8519680,205600,0,4294967295,512,21308416,139264,139520,0,256,128000,87040,107520,112640,32768,47104,51200,147456
.long 222720,21309024,21316096,1073741824,21285888,21292044,887168,1966080,3072,20582400,20664320,20584448,20666368,21233920,0,0,21308428,21303296,20924800,21254784,1065353216,2908160,2048,1024,512,8871936,8869888,19978240,21304320,21298176,21314560,0,5328000,5409920,5491840,128000,21553152,21553152,21553152,299520,8950272,18733056,18702336,8507392,8495104,18763776,8540160,226080,0,4294967295,512,21308416,139520,139264,256,0,112640,102400,92160,128000,149504,143360,0,30720
.long 256000,21313024,21303808,21283488,21282816,21296128,164096,1966080,1280,17148928,17149952,17494016,17495040,0,0,1073741824,21312512,21303296,20965376,21221504,1065353216,2818048,2048,1024,512,8478720,8476672,20299776,21305344,21294080,21294080,1024,2644480,2644480,2644480,81920,0,0,21553152,186880,8542720,17156096,17125376,8712192,8699904,17371136,8798208,245920,0,4294967295,512,21312512,0,256,139264,139520,97280,117760,138240,81920,32768,47104,51200,147456
.long 258560,21313056,21307904,1073741824,21283840,21296132,1188864,1966080,1280,19016704,19017728,19018752,19362816,0,0,1073741824,21312516,21303296,20965504,21262464,1065353216,2859008,2048,1024,512,8617984,8615936,20301824,21305344,21294080,21310464,1024,2726400,2808320,2890240,97280,21553152,21553152,21553152,227840,8681984,17217536,17186816,8736768,8724480,17371136,8818688,266400,0,4294967295,512,21312512,256,0,139520,139264,81920,133120,122880,97280,149504,143360,0,30720
.long 261120,21313088,21312000,1073741824,21284864,21296136,287232,819200,1280,18104320,18105344,18106368,18107392,0,0,1073741824,21312520,21303296,20965632,21224064,1065353216,2899968,2048,1024,512,8757248,8755200,20303872,21305344,21299200,21299200,1024,5248640,5248640,5248640,112640,0,0,21553152,268800,8821248,17278976,17248256,8761344,8749056,17371136,8798208,286880,0,4294967295,512,21312512,139264,139520,0,256,128000,87040,107520,112640,32768,47104,51200,147456
.long 263680,21313120,21316096,1073741824,21285888,21296140,985472,1966080,3072,20586496,20668416,20588544,20670464,21234176,0,0,21312524,21303296,20965760,21265024,1065353216,2940928,2048,1024,512,8896512,8894464,20305920,21305344,21299200,21315584,1024,5330560,5412480,5494400,128000,21553152,21553152,21553152,309760,8960512,17340416,17309696,8785920,8773632,17371136,8818688,307360,0,4294967295,512,21312512,139520,139264,256,0,112640,102400,92160,128000,149504,143360,0,30720
.long 296960,21317120,21303808,21283504,21282816,21300224,164224,1966080,1280,17496064,17497088,17498112,17842176,0,0,1073741824,21316608,21303296,21006336,21231744,1065353216,5412864,512,20480,10240,8503296,8501248,20627456,21307392,21296128,21296128,0,2654720,2654720,2654720,81920,0,0,21553152,197120,8552960,18548736,18518016,8712192,8699904,18763776,8798208,246560,0,4294967295,512,21316608,0,256,139264,139520,97280,117760,138240,81920,32768,47104,51200,147456
.long 299520,21317152,21307904,1073741824,21283840,21300228,1188992,1966080,1280,19363840,19364864,19365888,19366912,0,0,1073741824,21316612,21303296,21006464,21272704,1065353216,5453824,512,20480,10240,8642560,8640512,20629504,21307392,21296128,21312512,0,2736640,2818560,2900480,97280,21553152,21553152,21553152,238080,8692224,18610176,18579456,8736768,8724480,18763776,8818688,267040,0,4294967295,512,21316608,256,0,139520,139264,81920,133120,122880,97280,149504,143360,0,30720
.long 302080,21317184,21312000,1073741824,21284864,21300232,287360,819200,1280,18451456,18452480,18453504,18454528,0,0,1073741824,21316616,21303296,21006592,21234304,1065353216,5494784,512,20480,10240,8781824,8779776,20631552,21307392,21301248,21301248,0,5251200,5251200,5251200,112640,0,0,21553152,279040,8831488,18671616,18640896,8761344,8749056,18763776,8798208,287520,0,4294967295,512,21316608,139264,139520,0,256,128000,87040,107520,112640,32768,47104,51200,147456
.long 304640,21317216,21316096,1073741824,21285888,21300236,1083776,1966080,3072,20590592,20672512,20592640,20674560,21234432,0,0,21316620,21303296,21006720,21275264,1065353216,5535744,512,20480,10240,8921088,8919040,20633600,21307392,21301248,21317632,0,5333120,5415040,5496960,128000,21553152,21553152,21553152,320000,8970752,18733056,18702336,8785920,8773632,18763776,8818688,308000,0,4294967295,512,21316608,139520,139264,256,0,112640,102400,92160,128000,149504,143360,0,30720
.long 1484800,21435904,21434880,21283520,21282816,21419008,164352,1966080,1280,17843200,17844224,17845248,17846272,0,0,1073741824,21435392,21434368,21047296,21201024,1051011932,1482752,2048,1024,512,12886016,12883968,19644416,21434368,21406720,21423104,0,3770880,3852800,3934720,81920,21553152,21553152,21553152,1477120,12978688,17156096,17125376,12890112,12877824,17371136,12976128,1474720,0,4294967295,512,21435392,0,256,139264,139520,97280,117760,138240,81920,32768,47104,51200,147456
.long 1487360,21435936,21438976,1073741824,21283840,21419012,1228800,1966080,1280,16930816,16931840,16932864,16933888,0,0,1073741824,21435396,21434368,21047424,21241984,1051011932,1523712,2048,1024,512,13025280,13023232,19646464,21434368,21423104,21439488,0,4016640,4098560,4180480,97280,21553152,21553152,21553152,1518080,13117952,17217536,17186816,12914688,12902400,17371136,12996608,1495200,0,4294967295,512,21435392,256,0,139520,139264,81920,133120,122880,97280,149504,143360,0,30720
.long 1489920,21435968,21443072,1073741824,21284864,21419016,287488,819200,1280,18455552,18799616,18800640,18801664,0,0,1073741824,21435400,21434368,21047552,21203584,1051011932,1564672,2048,1024,512,13164544,13162496,19648512,21434368,21411840,21428224,0,6390400,6472320,6554240,112640,21553152,21553152,21553152,1559040,13257216,17278976,17248256,12939264,12926976,17371136,12976128,1515680,0,4294967295,512,21435392,139264,139520,0,256,128000,87040,107520,112640,32768,47104,51200,147456
.long 1492480,21436000,21447168,1073741824,21285888,21419020,1182080,1966080,3072,20594688,20676608,20596736,20678656,21234688,0,0,21435404,21434368,21047680,21244544,1051011932,1605632,2048,1024,512,13303808,13301760,19650560,21434368,21428224,21444608,0,6636160,6718080,6800000,128000,21553152,21553152,21553152,1600000,13396480,17340416,17309696,12963840,12951552,17371136,12996608,1536160,0,4294967295,512,21435392,139520,139264,256,0,112640,102400,92160,128000,149504,143360,0,30720
.long 1525760,21440000,21434880,21283536,21282816,21423104,164480,1966080,1280,18190336,18191360,18192384,18193408,0,0,1073741824,21439488,21434368,21088256,21211264,1065353216,4096000,2048,1024,512,12910592,12908544,19972096,21435392,21407744,21424128,0,3781120,3863040,3944960,81920,21553152,21553152,21553152,1487360,12988928,18548736,18518016,12890112,12877824,18763776,12976128,1475360,0,4294967295,512,21439488,0,256,139264,139520,97280,117760,138240,81920,32768,47104,51200,147456
.long 1528320,21440032,21438976,1073741824,21283840,21423108,1228928,1966080,1280,16934912,17278976,17280000,17281024,0,0,1073741824,21439492,21434368,21088384,21252224,1065353216,4136960,2048,1024,512,13049856,13047808,19974144,21435392,21424128,21440512,0,4026880,4108800,4190720,97280,21553152,21553152,21553152,1528320,13128192,18610176,18579456,12914688,12902400,18763776,12996608,1495840,0,4294967295,512,21439488,256,0,139520,139264,81920,133120,122880,97280,149504,143360,0,30720
.long 1530880,21440064,21443072,1073741824,21284864,21423112,287616,819200,1280,18802688,18803712,19147776,19148800,0,0,1073741824,21439496,21434368,21088512,21213824,1065353216,4177920,2048,1024,512,13189120,13187072,19976192,21435392,21412864,21429248,0,6392960,6474880,6556800,112640,21553152,21553152,21553152,1569280,13267456,18671616,18640896,12939264,12926976,18763776,12976128,1516320,0,4294967295,512,21439488,139264,139520,0,256,128000,87040,107520,112640,32768,47104,51200,147456
.long 1533440,21440096,21447168,1073741824,21285888,21423116,1280384,1966080,3072,20598784,20680704,20600832,20682752,21234944,0,0,21439500,21434368,21088640,21254784,1065353216,4218880,2048,1024,512,13328384,13326336,19978240,21435392,21429248,21445632,0,6638720,6720640,6802560,128000,21553152,21553152,21553152,1610240,13406720,18733056,18702336,12963840,12951552,18763776,12996608,1536800,0,4294967295,512,21439488,139520,139264,256,0,112640,102400,92160,128000,149504,143360,0,30720
.long 1566720,21444096,21434880,21283552,21282816,21427200,164608,1966080,1280,18194432,18538496,18539520,18540544,0,0,1073741824,21443584,21434368,21129216,21221504,1065353216,4128768,2048,1024,512,12935168,12933120,20299776,21436416,21408768,21425152,1024,3791360,3873280,3955200,81920,21553152,21553152,21553152,1497600,12999168,17156096,17125376,13168640,13156352,17371136,13254656,1556640,0,4294967295,512,21443584,0,256,139264,139520,97280,117760,138240,81920,32768,47104,51200,147456
.long 1569280,21444128,21438976,1073741824,21283840,21427204,1229056,1966080,1280,17282048,17283072,17627136,17628160,0,0,1073741824,21443588,21434368,21129344,21262464,1065353216,4169728,2048,1024,512,13074432,13072384,20301824,21436416,21425152,21441536,1024,4037120,4119040,4200960,97280,21553152,21553152,21553152,1538560,13138432,17217536,17186816,13193216,13180928,17371136,13275136,1577120,0,4294967295,512,21443584,256,0,139520,139264,81920,133120,122880,97280,149504,143360,0,30720
.long 1571840,21444160,21443072,1073741824,21284864,21427208,287744,819200,1280,19149824,19150848,19151872,19495936,0,0,1073741824,21443592,21434368,21129472,21224064,1065353216,4210688,2048,1024,512,13213696,13211648,20303872,21436416,21413888,21430272,1024,6395520,6477440,6559360,112640,21553152,21553152,21553152,1579520,13277696,17278976,17248256,13217792,13205504,17371136,13254656,1597600,0,4294967295,512,21443584,139264,139520,0,256,128000,87040,107520,112640,32768,47104,51200,147456
.long 1574400,21444192,21447168,1073741824,21285888,21427212,1378688,1966080,3072,20602880,20684800,20604928,20686848,21235200,0,0,21443596,21434368,21129600,21265024,1065353216,4251648,2048,1024,512,13352960,13350912,20305920,21436416,21430272,21446656,1024,6641280,6723200,6805120,128000,21553152,21553152,21553152,1620480,13416960,17340416,17309696,13242368,13230080,17371136,13275136,1618080,0,4294967295,512,21443584,139520,139264,256,0,112640,102400,92160,128000,149504,143360,0,30720
.long 1607680,21448192,21434880,21283568,21282816,21431296,164736,1966080,1280,18541568,18542592,18886656,18887680,0,0,1073741824,21447680,21434368,21170176,21231744,1065353216,6723584,512,20480,10240,12959744,12957696,20627456,21438464,21410816,21427200,0,3801600,3883520,3965440,81920,21553152,21553152,21553152,1507840,13009408,18548736,18518016,13168640,13156352,18763776,13254656,1557280,0,4294967295,512,21447680,0,256,139264,139520,97280,117760,138240,81920,32768,47104,51200,147456
.long 1610240,21448224,21438976,1073741824,21283840,21431300,1229184,1966080,1280,17629184,17630208,17631232,17975296,0,0,1073741824,21447684,21434368,21170304,21272704,1065353216,6764544,512,20480,10240,13099008,13096960,20629504,21438464,21427200,21443584,0,4047360,4129280,4211200,97280,21553152,21553152,21553152,1548800,13148672,18610176,18579456,13193216,13180928,18763776,13275136,1577760,0,4294967295,512,21447680,256,0,139520,139264,81920,133120,122880,97280,149504,143360,0,30720
.long 1612800,21448256,21443072,1073741824,21284864,21431304,287872,819200,1280,19496960,19497984,19499008,19500032,0,0,1073741824,21447688,21434368,21170432,21234304,1065353216,6805504,512,20480,10240,13238272,13236224,20631552,21438464,21415936,21432320,0,6398080,6480000,6561920,112640,21553152,21553152,21553152,1589760,13287936,18671616,18640896,13217792,13205504,18763776,13254656,1598240,0,4294967295,512,21447680,139264,139520,0,256,128000,87040,107520,112640,32768,47104,51200,147456
.long 1615360,21448288,21447168,1073741824,21285888,21431308,1476992,1966080,3072,20606976,20688896,20609024,20690944,21235456,0,0,21447692,21434368,21170560,21275264,1065353216,6846464,512,20480,10240,13377536,13375488,20633600,21438464,21432320,21448704,0,6643840,6725760,6807680,128000,21553152,21553152,21553152,1630720,13427200,18733056,18702336,13242368,13230080,18763776,13275136,1618720,0,4294967295,512,21447680,139520,139264,256,0,112640,102400,92160,128000,149504,143360,0,30720
.long 184320,21305856,21303808,21283584,21282816,21288960,164864,1966080,1280,18888704,18889728,18890752,19234816,0,0,1073741824,21305344,21303296,20893696,21206016,1051011932,180224,2048,1024,512,8433664,8437760,19726336,21303296,21292032,21292032,0,2626560,2626560,2626560,81920,0,0,21553152,168960,8524800,17504256,17473536,8433664,8421376,17719296,8519680,164160,0,4294967295,512,21305344,0,256,139264,139520,97280,117760,138240,81920,32768,47104,51200,147456
.long 186880,21305888,21307904,1073741824,21283840,21288964,1229312,1966080,1280,17976320,17977344,17978368,17979392,0,0,1073741824,21305348,21303296,20893824,21246976,1051011932,221184,2048,1024,512,8572928,8577024,19728384,21303296,21292032,21308416,0,2708480,2790400,2872320,97280,21553152,21553152,21553152,209920,8664064,17565696,17534976,8458240,8445952,17719296,8540160,184640,0,4294967295,512,21305344,256,0,139520,139264,81920,133120,122880,97280,149504,143360,0,30720
.long 189440,21305920,21312000,1073741824,21284864,21288968,327680,819200,1280,17063936,17064960,17065984,17067008,0,0,1073741824,21305352,21303296,20893952,21208576,1051011932,262144,2048,1024,512,8712192,8716288,19730432,21303296,21297152,21297152,0,5244160,5244160,5244160,112640,0,0,21553152,250880,8803328,17627136,17596416,8482816,8470528,17719296,8519680,205120,0,4294967295,512,21305344,139264,139520,0,256,128000,87040,107520,112640,32768,47104,51200,147456
.long 192000,21305952,21316096,1073741824,21285888,21288972,1575296,1966080,3072,20611072,20692992,20613120,20695040,21235712,0,0,21305356,21303296,20894080,21249536,1051011932,303104,2048,1024,512,8851456,8855552,19732480,21303296,21297152,21313536,0,5326080,5408000,5489920,128000,21553152,21553152,21553152,291840,8942592,17688576,17657856,8507392,8495104,17719296,8540160,225600,0,4294967295,512,21305344,139520,139264,256,0,112640,102400,92160,128000,149504,143360,0,30720
.long 225280,21309952,21303808,21283600,21282816,21293056,164992,1966080,1280,19235840,19236864,19237888,19238912,0,0,1073741824,21309440,21303296,20934656,21216256,1065353216,2793472,2048,1024,512,8458240,8462336,20054016,21304320,21293056,21293056,1024,2636800,2636800,2636800,81920,0,0,21553152,179200,8535040,18896896,18866176,8433664,8421376,19111936,8519680,164800,0,4294967295,512,21309440,0,256,139264,139520,97280,117760,138240,81920,32768,47104,51200,147456
.long 227840,21309984,21307904,1073741824,21283840,21293060,1229440,1966080,1280,18323456,18324480,18325504,18326528,0,0,1073741824,21309444,21303296,20934784,21257216,1065353216,2834432,2048,1024,512,8597504,8601600,20056064,21304320,21293056,21309440,1024,2718720,2800640,2882560,97280,21553152,21553152,21553152,220160,8674304,18958336,18927616,8458240,8445952,19111936,8540160,185280,0,4294967295,512,21309440,256,0,139520,139264,81920,133120,122880,97280,149504,143360,0,30720
.long 230400,21310016,21312000,1073741824,21284864,21293064,327808,819200,1280,17068032,17412096,17413120,17414144,0,0,1073741824,21309448,21303296,20934912,21218816,1065353216,2875392,2048,1024,512,8736768,8740864,20058112,21304320,21298176,21298176,1024,5246720,5246720,5246720,112640,0,0,21553152,261120,8813568,19019776,18989056,8482816,8470528,19111936,8519680,205760,0,4294967295,512,21309440,139264,139520,0,256,128000,87040,107520,112640,32768,47104,51200,147456
.long 232960,21310048,21316096,1073741824,21285888,21293068,1673600,1966080,3072,20615168,20697088,20617216,20699136,21235968,0,0,21309452,21303296,20935040,21259776,1065353216,2916352,2048,1024,512,8876032,8880128,20060160,21304320,21298176,21314560,1024,5328640,5410560,5492480,128000,21553152,21553152,21553152,302080,8952832,19081216,19050496,8507392,8495104,19111936,8540160,226240,0,4294967295,512,21309440,139520,139264,256,0,112640,102400,92160,128000,149504,143360,0,30720
.long 266240,21314048,21303808,21283616,21282816,21297152,204800,1966080,1280,16802816,16803840,16804864,16805888,0,0,1073741824,21313536,21303296,20975616,21226496,1065353216,5406720,512,20480,10240,8482816,8486912,20381696,21306368,21295104,21295104,0,2647040,2647040,2647040,81920,0,0,21553152,189440,8545280,17504256,17473536,8712192,8699904,17719296,8798208,246080,0,4294967295,512,21313536,0,256,139264,139520,97280,117760,138240,81920,32768,47104,51200,147456
.long 268800,21314080,21307904,1073741824,21283840,21297156,1229568,1966080,1280,18327552,18671616,18672640,18673664,0,0,1073741824,21313540,21303296,20975744,21267456,1065353216,5447680,512,20480,10240,8622080,8626176,20383744,21306368,21295104,21311488,0,2728960,2810880,2892800,97280,21553152,21553152,21553152,230400,8684544,17565696,17534976,8736768,8724480,17719296,8818688,266560,0,4294967295,512,21313536,256,0,139520,139264,81920,133120,122880,97280,149504,143360,0,30720
.long 271360,21314112,21312000,1073741824,21284864,21297160,327936,819200,1280,17415168,17416192,17760256,17761280,0,0,1073741824,21313544,21303296,20975872,21229056,1065353216,5488640,512,20480,10240,8761344,8765440,20385792,21306368,21300224,21300224,0,5249280,5249280,5249280,112640,0,0,21553152,271360,8823808,17627136,17596416,8761344,8749056,17719296,8798208,287040,0,4294967295,512,21313536,139264,139520,0,256,128000,87040,107520,112640,32768,47104,51200,147456
.long 273920,21314144,21316096,1073741824,21285888,21297164,1771904,1966080,3072,20619264,20701184,20621312,20703232,21236224,0,0,21313548,21303296,20976000,21270016,1065353216,5529600,512,20480,10240,8900608,8904704,20387840,21306368,21300224,21316608,0,5331200,5413120,5495040,128000,21553152,21553152,21553152,312320,8963072,17688576,17657856,8785920,8773632,17719296,8818688,307520,0,4294967295,512,21313536,139520,139264,256,0,112640,102400,92160,128000,149504,143360,0,30720
.long 307200,21318144,21303808,21283632,21282816,21301248,204928,1966080,1280,16806912,17150976,17152000,17153024,0,0,1073741824,21317632,21303296,21016576,21236736,1065353216,5414912,512,20480,10240,8507392,8511488,20709376,21307392,21296128,21296128,0,2657280,2657280,2657280,81920,0,0,21553152,199680,8555520,18896896,18866176,8712192,8699904,19111936,8798208,246720,0,4294967295,512,21317632,0,256,139264,139520,97280,117760,138240,81920,32768,47104,51200,147456
.long 309760,21318176,21307904,1073741824,21283840,21301252,1229696,1966080,1280,18674688,18675712,19019776,19020800,0,0,1073741824,21317636,21303296,21016704,21277696,1065353216,5455872,512,20480,10240,8646656,8650752,20711424,21307392,21296128,21312512,0,2739200,2821120,2903040,97280,21553152,21553152,21553152,240640,8694784,18958336,18927616,8736768,8724480,19111936,8818688,267200,0,4294967295,512,21317632,256,0,139520,139264,81920,133120,122880,97280,149504,143360,0,30720
.long 312320,21318208,21312000,1073741824,21284864,21301256,328064,819200,1280,17762304,17763328,17764352,18108416,0,0,1073741824,21317640,21303296,21016832,21239296,1065353216,5496832,512,20480,10240,8785920,8790016,20713472,21307392,21301248,21301248,0,5251840,5251840,5251840,112640,0,0,21553152,281600,8834048,19019776,18989056,8761344,8749056,19111936,8798208,287680,0,4294967295,512,21317632,139264,139520,0,256,128000,87040,107520,112640,32768,47104,51200,147456
.long 314880,21318240,21316096,1073741824,21285888,21301260,1870208,1966080,3072,20623360,20705280,20625408,20707328,21236480,0,0,21317644,21303296,21016960,21280256,1065353216,5537792,512,20480,10240,8925184,8929280,20715520,21307392,21301248,21317632,0,5333760,5415680,5497600,128000,21553152,21553152,21553152,322560,8973312,19081216,19050496,8785920,8773632,19111936,8818688,308160,0,4294967295,512,21317632,139520,139264,256,0,112640,102400,92160,128000,149504,143360,0,30720
.long 1495040,21436928,21434880,21283648,21282816,21420032,205056,1966080,1280,17154048,17155072,17499136,17500160,0,0,1073741824,21436416,21434368,21057536,21206016,1051011932,1490944,2048,1024,512,12890112,12894208,19726336,21434368,21406720,21423104,0,3773440,3855360,3937280,81920,21553152,21553152,21553152,1479680,12981248,17504256,17473536,12890112,12877824,17719296,12976128,1474880,0,4294967295,512,21436416,0,256,139264,139520,97280,117760,138240,81920,32768,47104,51200,147456
.long 1497600,21436960,21438976,1073741824,21283840,21420036,1229824,1966080,1280,19021824,19022848,19023872,19367936,0,0,1073741824,21436420,21434368,21057664,21246976,1051011932,1531904,2048,1024,512,13029376,13033472,19728384,21434368,21423104,21439488,0,4019200,4101120,4183040,97280,21553152,21553152,21553152,1520640,13120512,17565696,17534976,12914688,12902400,17719296,12996608,1495360,0,4294967295,512,21436416,256,0,139520,139264,81920,133120,122880,97280,149504,143360,0,30720
.long 1500160,21436992,21443072,1073741824,21284864,21420040,328192,819200,1280,18109440,18110464,18111488,18112512,0,0,1073741824,21436424,21434368,21057792,21208576,1051011932,1572864,2048,1024,512,13168640,13172736,19730432,21434368,21411840,21428224,0,6391040,6472960,6554880,112640,21553152,21553152,21553152,1561600,13259776,17627136,17596416,12939264,12926976,17719296,12976128,1515840,0,4294967295,512,21436416,139264,139520,0,256,128000,87040,107520,112640,32768,47104,51200,147456
.long 1502720,21437024,21447168,1073741824,21285888,21420044,2816,1966080,3072,20709376,20791296,20711424,20793344,21236736,0,0,21436428,21434368,21057920,21249536,1051011932,1613824,2048,1024,512,13307904,13312000,19732480,21434368,21428224,21444608,0,6636800,6718720,6800640,128000,21553152,21553152,21553152,1602560,13399040,17688576,17657856,12963840,12951552,17719296,12996608,1536320,0,4294967295,512,21436416,139520,139264,256,0,112640,102400,92160,128000,149504,143360,0,30720
.long 1536000,21441024,21434880,21283664,21282816,21424128,205184,1966080,1280,17501184,17502208,17503232,17847296,0,0,1073741824,21440512,21434368,21098496,21216256,1065353216,4104192,2048,1024,512,12914688,12918784,20054016,21435392,21407744,21424128,1024,3783680,3865600,3947520,81920,21553152,21553152,21553152,1489920,12991488,18896896,18866176,12890112,12877824,19111936,12976128,1475520,0,4294967295,512,21440512,0,256,139264,139520,97280,117760,138240,81920,32768,47104,51200,147456
.long 1538560,21441056,21438976,1073741824,21283840,21424132,1229952,1966080,1280,19368960,19369984,19371008,19372032,0,0,1073741824,21440516,21434368,21098624,21257216,1065353216,4145152,2048,1024,512,13053952,13058048,20056064,21435392,21424128,21440512,1024,4029440,4111360,4193280,97280,21553152,21553152,21553152,1530880,13130752,18958336,18927616,12914688,12902400,19111936,12996608,1496000,0,4294967295,512,21440512,256,0,139520,139264,81920,133120,122880,97280,149504,143360,0,30720
.long 1541120,21441088,21443072,1073741824,21284864,21424136,328320,819200,1280,18456576,18457600,18458624,18459648,0,0,1073741824,21440520,21434368,21098752,21218816,1065353216,4186112,2048,1024,512,13193216,13197312,20058112,21435392,21412864,21429248,1024,6393600,6475520,6557440,112640,21553152,21553152,21553152,1571840,13270016,19019776,18989056,12939264,12926976,19111936,12976128,1516480,0,4294967295,512,21440512,139264,139520,0,256,128000,87040,107520,112640,32768,47104,51200,147456
.long 1543680,21441120,21447168,1073741824,21285888,21424140,101120,1966080,3072,20713472,20795392,20715520,20797440,21236992,0,0,21440524,21434368,21098880,21259776,1065353216,4227072,2048,1024,512,13332480,13336576,20060160,21435392,21429248,21445632,1024,6639360,6721280,6803200,128000,21553152,21553152,21553152,1612800,13409280,19081216,19050496,12963840,12951552,19111936,12996608,1536960,0,4294967295,512,21440512,139520,139264,256,0,112640,102400,92160,128000,149504,143360,0,30720
.long 1576960,21445120,21434880,21283680,21282816,21428224,205312,1966080,1280,17848320,17849344,17850368,17851392,0,0,1073741824,21444608,21434368,21139456,21226496,1065353216,6717440,512,20480,10240,12939264,12943360,20381696,21437440,21409792,21426176,0,3793920,3875840,3957760,81920,21553152,21553152,21553152,1500160,13001728,17504256,17473536,13168640,13156352,17719296,13254656,1556800,0,4294967295,512,21444608,0,256,139264,139520,97280,117760,138240,81920,32768,47104,51200,147456
.long 1579520,21445152,21438976,1073741824,21283840,21428228,1269760,1966080,1280,16935936,16936960,16937984,16939008,0,0,1073741824,21444612,21434368,21139584,21267456,1065353216,6758400,512,20480,10240,13078528,13082624,20383744,21437440,21426176,21442560,0,4039680,4121600,4203520,97280,21553152,21553152,21553152,1541120,13140992,17565696,17534976,13193216,13180928,17719296,13275136,1577280,0,4294967295,512,21444608,256,0,139520,139264,81920,133120,122880,97280,149504,143360,0,30720
.long 1582080,21445184,21443072,1073741824,21284864,21428232,328448,819200,1280,18460672,18804736,18805760,18806784,0,0,1073741824,21444616,21434368,21139712,21229056,1065353216,6799360,512,20480,10240,13217792,13221888,20385792,21437440,21414912,21431296,0,6396160,6478080,6560000,112640,21553152,21553152,21553152,1582080,13280256,17627136,17596416,13217792,13205504,17719296,13254656,1597760,0,4294967295,512,21444608,139264,139520,0,256,128000,87040,107520,112640,32768,47104,51200,147456
.long 1584640,21445216,21447168,1073741824,21285888,21428236,199424,1966080,3072,20717568,20799488,20719616,20801536,21237248,0,0,21444620,21434368,21139840,21270016,1065353216,6840320,512,20480,10240,13357056,13361152,20387840,21437440,21431296,21447680,0,6641920,6723840,6805760,128000,21553152,21553152,21553152,1623040,13419520,17688576,17657856,13242368,13230080,17719296,13275136,1618240,0,4294967295,512,21444608,139520,139264,256,0,112640,102400,92160,128000,149504,143360,0,30720
.long 1617920,21449216,21434880,21283696,21282816,21432320,205440,1966080,1280,18195456,18196480,18197504,18198528,0,0,1073741824,21448704,21434368,21180416,21236736,1065353216,6725632,512,20480,10240,12963840,12967936,20709376,21438464,21410816,21427200,0,3804160,3886080,3968000,81920,21553152,21553152,21553152,1510400,13011968,18896896,18866176,13168640,13156352,19111936,13254656,1557440,0,4294967295,512,21448704,0,256,139264,139520,97280,117760,138240,81920,32768,47104,51200,147456
.long 1620480,21449248,21438976,1073741824,21283840,21432324,1269888,1966080,1280,16940032,17284096,17285120,17286144,0,0,1073741824,21448708,21434368,21180544,21277696,1065353216,6766592,512,20480,10240,13103104,13107200,20711424,21438464,21427200,21443584,0,4049920,4131840,4213760,97280,21553152,21553152,21553152,1551360,13151232,18958336,18927616,13193216,13180928,19111936,13275136,1577920,0,4294967295,512,21448704,256,0,139520,139264,81920,133120,122880,97280,149504,143360,0,30720
.long 1623040,21449280,21443072,1073741824,21284864,21432328,328576,819200,1280,18807808,18808832,19152896,19153920,0,0,1073741824,21448712,21434368,21180672,21239296,1065353216,6807552,512,20480,10240,13242368,13246464,20713472,21438464,21415936,21432320,0,6398720,6480640,6562560,112640,21553152,21553152,21553152,1592320,13290496,19019776,18989056,13217792,13205504,19111936,13254656,1598400,0,4294967295,512,21448704,139264,139520,0,256,128000,87040,107520,112640,32768,47104,51200,147456
.long 1625600,21449312,21447168,1073741824,21285888,21432332,297728,1966080,3072,20721664,20803584,20723712,20805632,21237504,0,0,21448716,21434368,21180800,21280256,1065353216,6848512,512,20480,10240,13381632,13385728,20715520,21438464,21432320,21448704,0,6644480,6726400,6808320,128000,21553152,21553152,21553152,1633280,13429760,19081216,19050496,13242368,13230080,19111936,13275136,1618880,0,4294967295,512,21448704,139520,139264,256,0,112640,102400,92160,128000,149504,143360,0,30720
.long 194560,21306880,21303808,21283712,21282816,21289984,205568,1966080,1280,18199552,18543616,18544640,18545664,0,0,1073741824,21306368,21303296,20903936,21206144,1051011932,188416,2048,1024,512,8441856,8439808,19808256,21303296,21292032,21292032,1024,2629120,2629120,2629120,81920,0,0,21553152,171520,8527360,17852416,17821696,8433664,8421376,18067456,8519680,164320,0,4294967295,512,21306368,0,256,139264,139520,97280,117760,138240,81920,32768,47104,51200,147456
.long 197120,21306912,21307904,1073741824,21283840,21289988,1270016,1966080,1280,17287168,17288192,17632256,17633280,0,0,1073741824,21306372,21303296,20904064,21247104,1051011932,229376,2048,1024,512,8581120,8579072,19810304,21303296,21292032,21308416,1024,2711040,2792960,2874880,97280,21553152,21553152,21553152,212480,8666624,17913856,17883136,8458240,8445952,18067456,8540160,184800,0,4294967295,512,21306368,256,0,139520,139264,81920,133120,122880,97280,149504,143360,0,30720
.long 199680,21306944,21312000,1073741824,21284864,21289992,328704,819200,1280,19154944,19155968,19156992,19501056,0,0,1073741824,21306376,21303296,20904192,21208704,1051011932,270336,2048,1024,512,8720384,8718336,19812352,21303296,21297152,21297152,1024,5244800,5244800,5244800,112640,0,0,21553152,253440,8805888,17975296,17944576,8482816,8470528,18067456,8519680,205280,0,4294967295,512,21306368,139264,139520,0,256,128000,87040,107520,112640,32768,47104,51200,147456
.long 202240,21306976,21316096,1073741824,21285888,21289996,396032,1966080,3072,20725760,20807680,20727808,20809728,21237760,0,0,21306380,21303296,20904320,21249664,1051011932,311296,2048,1024,512,8859648,8857600,19814400,21303296,21297152,21313536,1024,5326720,5408640,5490560,128000,21553152,21553152,21553152,294400,8945152,18036736,18006016,8507392,8495104,18067456,8540160,225760,0,4294967295,512,21306368,139520,139264,256,0,112640,102400,92160,128000,149504,143360,0,30720
.long 235520,21310976,21303808,21283728,21282816,21294080,205696,1966080,1280,18546688,18547712,18891776,18892800,0,0,1073741824,21310464,21303296,20944896,21216384,1065353216,2801664,2048,1024,512,8466432,8464384,20135936,21305344,21294080,21294080,0,2639360,2639360,2639360,81920,0,0,21553152,181760,8537600,19245056,19214336,8433664,8421376,19460096,8519680,164960,0,4294967295,512,21310464,0,256,139264,139520,97280,117760,138240,81920,32768,47104,51200,147456
.long 238080,21311008,21307904,1073741824,21283840,21294084,1270144,1966080,1280,17634304,17635328,17636352,17980416,0,0,1073741824,21310468,21303296,20945024,21257344,1065353216,2842624,2048,1024,512,8605696,8603648,20137984,21305344,21294080,21310464,0,2721280,2803200,2885120,97280,21553152,21553152,21553152,222720,8676864,19306496,19275776,8458240,8445952,19460096,8540160,185440,0,4294967295,512,21310464,256,0,139520,139264,81920,133120,122880,97280,149504,143360,0,30720
.long 240640,21311040,21312000,1073741824,21284864,21294088,328832,819200,1280,19502080,19503104,19504128,19505152,0,0,1073741824,21310472,21303296,20945152,21218944,1065353216,2883584,2048,1024,512,8744960,8742912,20140032,21305344,21299200,21299200,0,5247360,5247360,5247360,112640,0,0,21553152,263680,8816128,19367936,19337216,8482816,8470528,19460096,8519680,205920,0,4294967295,512,21310464,139264,139520,0,256,128000,87040,107520,112640,32768,47104,51200,147456
.long 243200,21311072,21316096,1073741824,21285888,21294092,494336,1966080,3072,20729856,20811776,20731904,20813824,21238016,0,0,21310476,21303296,20945280,21259904,1065353216,2924544,2048,1024,512,8884224,8882176,20142080,21305344,21299200,21315584,0,5329280,5411200,5493120,128000,21553152,21553152,21553152,304640,8955392,19429376,19398656,8507392,8495104,19460096,8540160,226400,0,4294967295,512,21310464,139520,139264,256,0,112640,102400,92160,128000,149504,143360,0,30720
.long 276480,21315072,21303808,21283744,21282816,21298176,205824,1966080,1280,18893824,18894848,18895872,19239936,0,0,1073741824,21314560,21303296,20985856,21226624,1065353216,5408768,512,20480,10240,8491008,8488960,20463616,21306368,21295104,21295104,0,2649600,2649600,2649600,81920,0,0,21553152,192000,8547840,17852416,17821696,8712192,8699904,18067456,8798208,246240,0,4294967295,512,21314560,0,256,139264,139520,97280,117760,138240,81920,32768,47104,51200,147456
.long 279040,21315104,21307904,1073741824,21283840,21298180,1270272,1966080,1280,17981440,17982464,17983488,17984512,0,0,1073741824,21314564,21303296,20985984,21267584,1065353216,5449728,512,20480,10240,8630272,8628224,20465664,21306368,21295104,21311488,0,2731520,2813440,2895360,97280,21553152,21553152,21553152,232960,8687104,17913856,17883136,8736768,8724480,18067456,8818688,266720,0,4294967295,512,21314560,256,0,139520,139264,81920,133120,122880,97280,149504,143360,0,30720
.long 281600,21315136,21312000,1073741824,21284864,21298184,368640,819200,1280,17069056,17070080,17071104,17072128,0,0,1073741824,21314568,21303296,20986112,21229184,1065353216,5490688,512,20480,10240,8769536,8767488,20467712,21306368,21300224,21300224,0,5249920,5249920,5249920,112640,0,0,21553152,273920,8826368,17975296,17944576,8761344,8749056,18067456,8798208,287200,0,4294967295,512,21314560,139264,139520,0,256,128000,87040,107520,112640,32768,47104,51200,147456
.long 284160,21315168,21316096,1073741824,21285888,21298188,592640,1966080,3072,20733952,20815872,20736000,20817920,21238272,0,0,21314572,21303296,20986240,21270144,1065353216,5531648,512,20480,10240,8908800,8906752,20469760,21306368,21300224,21316608,0,5331840,5413760,5495680,128000,21553152,21553152,21553152,314880,8965632,18036736,18006016,8785920,8773632,18067456,8818688,307680,0,4294967295,512,21314560,139520,139264,256,0,112640,102400,92160,128000,149504,143360,0,30720
.long 317440,21319168,21303808,21283760,21282816,21302272,205952,1966080,1280,19240960,19241984,19243008,19244032,0,0,1073741824,21318656,21303296,21026816,21236864,1065353216,8028160,512,20480,10240,8515584,8513536,20791296,21307392,21296128,21296128,0,2659840,2659840,2659840,81920,0,0,21553152,202240,8558080,19245056,19214336,8712192,8699904,19460096,8798208,246880,0,4294967295,512,21318656,0,256,139264,139520,97280,117760,138240,81920,32768,47104,51200,147456
.long 320000,21319200,21307904,1073741824,21283840,21302276,1270400,1966080,1280,18328576,18329600,18330624,18331648,0,0,1073741824,21318660,21303296,21026944,21277824,1065353216,8069120,512,20480,10240,8654848,8652800,20793344,21307392,21296128,21312512,0,2741760,2823680,2905600,97280,21553152,21553152,21553152,243200,8697344,19306496,19275776,8736768,8724480,19460096,8818688,267360,0,4294967295,512,21318656,256,0,139520,139264,81920,133120,122880,97280,149504,143360,0,30720
.long 322560,21319232,21312000,1073741824,21284864,21302280,368768,819200,1280,17073152,17417216,17418240,17419264,0,0,1073741824,21318664,21303296,21027072,21239424,1065353216,8110080,512,20480,10240,8794112,8792064,20795392,21307392,21301248,21301248,0,5252480,5252480,5252480,112640,0,0,21553152,284160,8836608,19367936,19337216,8761344,8749056,19460096,8798208,287840,0,4294967295,512,21318656,139264,139520,0,256,128000,87040,107520,112640,32768,47104,51200,147456
.long 325120,21319264,21316096,1073741824,21285888,21302284,690944,1966080,3072,20738048,20819968,20740096,20822016,21238528,0,0,21318668,21303296,21027200,21280384,1065353216,8151040,512,20480,10240,8933376,8931328,20797440,21307392,21301248,21317632,0,5334400,5416320,5498240,128000,21553152,21553152,21553152,325120,8975872,19429376,19398656,8785920,8773632,19460096,8818688,308320,0,4294967295,512,21318656,139520,139264,256,0,112640,102400,92160,128000,149504,143360,0,30720
.long 1505280,21437952,21434880,21283776,21282816,21421056,245760,1966080,1280,16807936,16808960,16809984,16811008,0,0,1073741824,21437440,21434368,21067776,21206144,1051011932,1499136,2048,1024,512,12898304,12896256,19808256,21434368,21406720,21423104,1024,3776000,3857920,3939840,81920,21553152,21553152,21553152,1482240,12983808,17852416,17821696,12890112,12877824,18067456,12976128,1475040,0,4294967295,512,21437440,0,256,139264,139520,97280,117760,138240,81920,32768,47104,51200,147456
.long 1507840,21437984,21438976,1073741824,21283840,21421060,1270528,1966080,1280,18332672,18676736,18677760,18678784,0,0,1073741824,21437444,21434368,21067904,21247104,1051011932,1540096,2048,1024,512,13037568,13035520,19810304,21434368,21423104,21439488,1024,4021760,4103680,4185600,97280,21553152,21553152,21553152,1523200,13123072,17913856,17883136,12914688,12902400,18067456,12996608,1495520,0,4294967295,512,21437440,256,0,139520,139264,81920,133120,122880,97280,149504,143360,0,30720
.long 1510400,21438016,21443072,1073741824,21284864,21421064,368896,819200,1280,17420288,17421312,17765376,17766400,0,0,1073741824,21437448,21434368,21068032,21208704,1051011932,1581056,2048,1024,512,13176832,13174784,19812352,21434368,21411840,21428224,1024,6391680,6473600,6555520,112640,21553152,21553152,21553152,1564160,13262336,17975296,17944576,12939264,12926976,18067456,12976128,1516000,0,4294967295,512,21437440,139264,139520,0,256,128000,87040,107520,112640,32768,47104,51200,147456
.long 1512960,21438048,21447168,1073741824,21285888,21421068,789248,1966080,3072,20742144,20824064,20744192,20826112,21238784,0,0,21437452,21434368,21068160,21249664,1051011932,1622016,2048,1024,512,13316096,13314048,19814400,21434368,21428224,21444608,1024,6637440,6719360,6801280,128000,21553152,21553152,21553152,1605120,13401600,18036736,18006016,12963840,12951552,18067456,12996608,1536480,0,4294967295,512,21437440,139520,139264,256,0,112640,102400,92160,128000,149504,143360,0,30720
.long 1546240,21442048,21434880,21283792,21282816,21425152,245888,1966080,1280,16812032,17156096,17157120,17158144,0,0,1073741824,21441536,21434368,21108736,21216384,1065353216,4112384,2048,1024,512,12922880,12920832,20135936,21436416,21408768,21425152,0,3786240,3868160,3950080,81920,21553152,21553152,21553152,1492480,12994048,19245056,19214336,12890112,12877824,19460096,12976128,1475680,0,4294967295,512,21441536,0,256,139264,139520,97280,117760,138240,81920,32768,47104,51200,147456
.long 1548800,21442080,21438976,1073741824,21283840,21425156,1270656,1966080,1280,18679808,18680832,19024896,19025920,0,0,1073741824,21441540,21434368,21108864,21257344,1065353216,4153344,2048,1024,512,13062144,13060096,20137984,21436416,21425152,21441536,0,4032000,4113920,4195840,97280,21553152,21553152,21553152,1533440,13133312,19306496,19275776,12914688,12902400,19460096,12996608,1496160,0,4294967295,512,21441536,256,0,139520,139264,81920,133120,122880,97280,149504,143360,0,30720
.long 1551360,21442112,21443072,1073741824,21284864,21425160,369024,819200,1280,17767424,17768448,17769472,18113536,0,0,1073741824,21441544,21434368,21108992,21218944,1065353216,4194304,2048,1024,512,13201408,13199360,20140032,21436416,21413888,21430272,0,6394240,6476160,6558080,112640,21553152,21553152,21553152,1574400,13272576,19367936,19337216,12939264,12926976,19460096,12976128,1516640,0,4294967295,512,21441536,139264,139520,0,256,128000,87040,107520,112640,32768,47104,51200,147456
.long 1553920,21442144,21447168,1073741824,21285888,21425164,887552,1966080,3072,20746240,20828160,20748288,20830208,21239040,0,0,21441548,21434368,21109120,21259904,1065353216,4235264,2048,1024,512,13340672,13338624,20142080,21436416,21430272,21446656,0,6640000,6721920,6803840,128000,21553152,21553152,21553152,1615360,13411840,19429376,19398656,12963840,12951552,19460096,12996608,1537120,0,4294967295,512,21441536,139520,139264,256,0,112640,102400,92160,128000,149504,143360,0,30720
.long 1587200,21446144,21434880,21283808,21282816,21429248,246016,1966080,1280,17159168,17160192,17504256,17505280,0,0,1073741824,21445632,21434368,21149696,21226624,1065353216,6719488,512,20480,10240,12947456,12945408,20463616,21437440,21409792,21426176,0,3796480,3878400,3960320,81920,21553152,21553152,21553152,1502720,13004288,17852416,17821696,13168640,13156352,18067456,13254656,1556960,0,4294967295,512,21445632,0,256,139264,139520,97280,117760,138240,81920,32768,47104,51200,147456
.long 1589760,21446176,21438976,1073741824,21283840,21429252,1270784,1966080,1280,19026944,19027968,19028992,19373056,0,0,1073741824,21445636,21434368,21149824,21267584,1065353216,6760448,512,20480,10240,13086720,13084672,20465664,21437440,21426176,21442560,0,4042240,4124160,4206080,97280,21553152,21553152,21553152,1543680,13143552,17913856,17883136,13193216,13180928,18067456,13275136,1577440,0,4294967295,512,21445632,256,0,139520,139264,81920,133120,122880,97280,149504,143360,0,30720
.long 1592320,21446208,21443072,1073741824,21284864,21429256,369152,819200,1280,18114560,18115584,18116608,18117632,0,0,1073741824,21445640,21434368,21149952,21229184,1065353216,6801408,512,20480,10240,13225984,13223936,20467712,21437440,21414912,21431296,0,6396800,6478720,6560640,112640,21553152,21553152,21553152,1584640,13282816,17975296,17944576,13217792,13205504,18067456,13254656,1597920,0,4294967295,512,21445632,139264,139520,0,256,128000,87040,107520,112640,32768,47104,51200,147456
.long 1594880,21446240,21447168,1073741824,21285888,21429260,985856,1966080,3072,20750336,20832256,20752384,20834304,21239296,0,0,21445644,21434368,21150080,21270144,1065353216,6842368,512,20480,10240,13365248,13363200,20469760,21437440,21431296,21447680,0,6642560,6724480,6806400,128000,21553152,21553152,21553152,1625600,13422080,18036736,18006016,13242368,13230080,18067456,13275136,1618400,0,4294967295,512,21445632,139520,139264,256,0,112640,102400,92160,128000,149504,143360,0,30720
.long 1628160,21450240,21434880,21283824,21282816,21433344,246144,1966080,1280,17506304,17507328,17508352,17852416,0,0,1073741824,21449728,21434368,21190656,21236864,1065353216,9338880,512,20480,10240,12972032,12969984,20791296,21438464,21410816,21427200,0,3806720,3888640,3970560,81920,21553152,21553152,21553152,1512960,13014528,19245056,19214336,13168640,13156352,19460096,13254656,1557600,0,4294967295,512,21449728,0,256,139264,139520,97280,117760,138240,81920,32768,47104,51200,147456
.long 1630720,21450272,21438976,1073741824,21283840,21433348,1270912,1966080,1280,19374080,19375104,19376128,19377152,0,0,1073741824,21449732,21434368,21190784,21277824,1065353216,9379840,512,20480,10240,13111296,13109248,20793344,21438464,21427200,21443584,0,4052480,4134400,4216320,97280,21553152,21553152,21553152,1553920,13153792,19306496,19275776,13193216,13180928,19460096,13275136,1578080,0,4294967295,512,21449728,256,0,139520,139264,81920,133120,122880,97280,149504,143360,0,30720
.long 1633280,21450304,21443072,1073741824,21284864,21433352,369280,819200,1280,18461696,18462720,18463744,18464768,0,0,1073741824,21449736,21434368,21190912,21239424,1065353216,9420800,512,20480,10240,13250560,13248512,20795392,21438464,21415936,21432320,0,6399360,6481280,6563200,112640,21553152,21553152,21553152,1594880,13293056,19367936,19337216,13217792,13205504,19460096,13254656,1598560,0,4294967295,512,21449728,139264,139520,0,256,128000,87040,107520,112640,32768,47104,51200,147456
.long 1635840,21450336,21447168,1073741824,21285888,21433356,1084160,1966080,3072,20754432,20836352,20756480,20838400,21239552,0,0,21449740,21434368,21191040,21280384,1065353216,9461760,512,20480,10240,13389824,13387776,20797440,21438464,21432320,21448704,0,6645120,6727040,6808960,128000,21553152,21553152,21553152,1635840,13432320,19429376,19398656,13242368,13230080,19460096,13275136,1619040,0,4294967295,512,21449728,139520,139264,256,0,112640,102400,92160,128000,149504,143360,0,30720
.long 327680,21320192,21320192,21283840,21282816,21286912,246272,1966080,1280,17853440,17854464,17855488,17856512,0,0,1073741824,21319680,21319680,20873216,21200896,1051011932,327680,2048,1024,512,8978432,8982528,19562496,21319680,21292032,21308416,0,2621440,2703360,2785280,81920,21553152,21553152,21553152,327680,9076736,16777216,16807936,8978432,8990720,17022976,9076736,327680,0,0,1024,21319680,0,256,139264,139520,97280,117760,138240,81920,32768,47104,51200,147456
.long 330240,21320224,21324288,1073741824,21283840,21286916,1310720,1966080,1280,16941056,16942080,16943104,16944128,0,0,1073741824,21319684,21319680,20873344,21241856,1051011932,368640,2048,1024,512,9117696,9121792,19564544,21319680,21308416,21324800,0,2867200,2949120,3031040,97280,21553152,21553152,21553152,368640,9216000,16838656,16869376,9003008,9015296,17022976,9097216,348160,0,0,1024,21319680,256,0,139520,139264,81920,133120,122880,97280,149504,143360,0,30720
.long 332800,21320256,21328384,1073741824,21284864,21286920,369408,819200,1280,18465792,18809856,18810880,18811904,0,0,1073741824,21319688,21319680,20873472,21203456,1051011932,409600,2048,1024,512,9256960,9261056,19566592,21319680,21297152,21313536,0,5242880,5324800,5406720,112640,21553152,21553152,21553152,409600,9355264,16900096,16930816,9027584,9039872,17022976,9076736,368640,0,0,1024,21319680,139264,139520,0,256,128000,87040,107520,112640,32768,47104,51200,147456
.long 335360,21320288,21332480,1073741824,21285888,21286924,1182464,1966080,3072,20758528,20840448,20760576,20842496,21239808,0,0,21319692,21319680,20873600,21244416,1051011932,450560,2048,1024,512,9396224,9400320,19568640,21319680,21313536,21329920,0,5488640,5570560,5652480,128000,21553152,21553152,21553152,450560,9494528,16961536,16992256,9052160,9064448,17022976,9097216,389120,0,0,1024,21319680,139520,139264,256,0,112640,102400,92160,128000,149504,143360,0,30720
.long 368640,21324288,21320192,21283856,21282816,21291008,246400,1966080,1280,18200576,18201600,18202624,18203648,0,0,1073741824,21323776,21319680,20914176,21211136,1051011932,360448,2048,1024,512,9003008,9007104,19890176,21320704,21293056,21309440,0,2631680,2713600,2795520,81920,21553152,21553152,21553152,337920,9086976,18169856,18200576,8978432,8990720,18415616,9076736,328320,0,0,1024,21323776,0,256,139264,139520,97280,117760,138240,81920,32768,47104,51200,147456
.long 371200,21324320,21324288,1073741824,21283840,21291012,1310848,1966080,1280,16945152,17289216,17290240,17291264,0,0,1073741824,21323780,21319680,20914304,21252096,1051011932,401408,2048,1024,512,9142272,9146368,19892224,21320704,21309440,21325824,0,2877440,2959360,3041280,97280,21553152,21553152,21553152,378880,9226240,18231296,18262016,9003008,9015296,18415616,9097216,348800,0,0,1024,21323776,256,0,139520,139264,81920,133120,122880,97280,149504,143360,0,30720
.long 373760,21324352,21328384,1073741824,21284864,21291016,369536,819200,1280,18812928,18813952,19158016,19159040,0,0,1073741824,21323784,21319680,20914432,21213696,1051011932,442368,2048,1024,512,9281536,9285632,19894272,21320704,21298176,21314560,0,5245440,5327360,5409280,112640,21553152,21553152,21553152,419840,9365504,18292736,18323456,9027584,9039872,18415616,9076736,369280,0,0,1024,21323776,139264,139520,0,256,128000,87040,107520,112640,32768,47104,51200,147456
.long 376320,21324384,21332480,1073741824,21285888,21291020,1280768,1966080,3072,20762624,20844544,20764672,20846592,21240064,0,0,21323788,21319680,20914560,21254656,1051011932,483328,2048,1024,512,9420800,9424896,19896320,21320704,21314560,21330944,0,5491200,5573120,5655040,128000,21553152,21553152,21553152,460800,9504768,18354176,18384896,9052160,9064448,18415616,9097216,389760,0,0,1024,21323776,139520,139264,256,0,112640,102400,92160,128000,149504,143360,0,30720
.long 409600,21328384,21320192,21283872,21282816,21295104,246528,1966080,1280,18204672,18548736,18549760,18550784,0,0,1073741824,21327872,21319680,20955136,21221376,1065353216,2973696,2048,1024,512,9027584,9031680,20217856,21321728,21294080,21310464,0,2641920,2723840,2805760,81920,21553152,21553152,21553152,348160,9097216,16777216,16807936,9256960,9269248,17022976,9355264,409600,0,0,1024,21327872,0,256,139264,139520,97280,117760,138240,81920,32768,47104,51200,147456
.long 412160,21328416,21324288,1073741824,21283840,21295108,1310976,1966080,1280,17292288,17293312,17637376,17638400,0,0,1073741824,21327876,21319680,20955264,21262336,1065353216,3014656,2048,1024,512,9166848,9170944,20219904,21321728,21310464,21326848,0,2887680,2969600,3051520,97280,21553152,21553152,21553152,389120,9236480,16838656,16869376,9281536,9293824,17022976,9375744,430080,0,0,1024,21327872,256,0,139520,139264,81920,133120,122880,97280,149504,143360,0,30720
.long 414720,21328448,21328384,1073741824,21284864,21295112,369664,819200,1280,19160064,19161088,19162112,19506176,0,0,1073741824,21327880,21319680,20955392,21223936,1065353216,3055616,2048,1024,512,9306112,9310208,20221952,21321728,21299200,21315584,0,5248000,5329920,5411840,112640,21553152,21553152,21553152,430080,9375744,16900096,16930816,9306112,9318400,17022976,9355264,450560,0,0,1024,21327872,139264,139520,0,256,128000,87040,107520,112640,32768,47104,51200,147456
.long 417280,21328480,21332480,1073741824,21285888,21295116,1379072,1966080,3072,20766720,20848640,20768768,20850688,21240320,0,0,21327884,21319680,20955520,21264896,1065353216,3096576,2048,1024,512,9445376,9449472,20224000,21321728,21315584,21331968,0,5493760,5575680,5657600,128000,21553152,21553152,21553152,471040,9515008,16961536,16992256,9330688,9342976,17022976,9375744,471040,0,0,1024,21327872,139520,139264,256,0,112640,102400,92160,128000,149504,143360,0,30720
.long 450560,21332480,21320192,21283888,21282816,21299200,246656,1966080,1280,18551808,18552832,18896896,18897920,0,0,1073741824,21331968,21319680,20996096,21231616,1065353216,5574656,512,20480,10240,9052160,9056256,20545536,21322752,21295104,21311488,1024,2652160,2734080,2816000,81920,21553152,21553152,21553152,358400,9107456,18169856,18200576,9256960,9269248,18415616,9355264,410240,0,0,1024,21331968,0,256,139264,139520,97280,117760,138240,81920,32768,47104,51200,147456
.long 453120,21332512,21324288,1073741824,21283840,21299204,1311104,1966080,1280,17639424,17640448,17641472,17985536,0,0,1073741824,21331972,21319680,20996224,21272576,1065353216,5615616,512,20480,10240,9191424,9195520,20547584,21322752,21311488,21327872,1024,2897920,2979840,3061760,97280,21553152,21553152,21553152,399360,9246720,18231296,18262016,9281536,9293824,18415616,9375744,430720,0,0,1024,21331968,256,0,139520,139264,81920,133120,122880,97280,149504,143360,0,30720
.long 455680,21332544,21328384,1073741824,21284864,21299208,369792,819200,1280,19507200,19508224,19509248,19510272,0,0,1073741824,21331976,21319680,20996352,21234176,1065353216,5656576,512,20480,10240,9330688,9334784,20549632,21322752,21300224,21316608,1024,5250560,5332480,5414400,112640,21553152,21553152,21553152,440320,9385984,18292736,18323456,9306112,9318400,18415616,9355264,451200,0,0,1024,21331968,139264,139520,0,256,128000,87040,107520,112640,32768,47104,51200,147456
.long 458240,21332576,21332480,1073741824,21285888,21299212,1477376,1966080,3072,20770816,20852736,20772864,20854784,21240576,0,0,21331980,21319680,20996480,21275136,1065353216,5697536,512,20480,10240,9469952,9474048,20551680,21322752,21316608,21332992,1024,5496320,5578240,5660160,128000,21553152,21553152,21553152,481280,9525248,18354176,18384896,9330688,9342976,18415616,9375744,471680,0,0,1024,21331968,139520,139264,256,0,112640,102400,92160,128000,149504,143360,0,30720
.long 1638400,21451264,21451264,21283904,21282816,21417984,246784,1966080,1280,18898944,18899968,18900992,19245056,0,0,1073741824,21450752,21450752,21037056,21200896,1051011932,1638400,2048,1024,512,13434880,13438976,19562496,21450752,21423104,21439488,0,3932160,4014080,4096000,81920,21553152,21553152,21553152,1638400,13533184,16777216,16807936,13434880,13447168,17022976,13533184,1638400,0,0,1024,21450752,0,256,139264,139520,97280,117760,138240,81920,32768,47104,51200,147456
.long 1640960,21451296,21455360,1073741824,21283840,21417988,1311232,1966080,1280,17986560,17987584,17988608,17989632,0,0,1073741824,21450756,21450752,21037184,21241856,1051011932,1679360,2048,1024,512,13574144,13578240,19564544,21450752,21439488,21455872,0,4177920,4259840,4341760,97280,21553152,21553152,21553152,1679360,13672448,16838656,16869376,13459456,13471744,17022976,13553664,1658880,0,0,1024,21450752,256,0,139520,139264,81920,133120,122880,97280,149504,143360,0,30720
.long 1643520,21451328,21459456,1073741824,21284864,21417992,409600,819200,1280,17074176,17075200,17076224,17077248,0,0,1073741824,21450760,21450752,21037312,21203456,1051011932,1720320,2048,1024,512,13713408,13717504,19566592,21450752,21428224,21444608,0,6553600,6635520,6717440,112640,21553152,21553152,21553152,1720320,13811712,16900096,16930816,13484032,13496320,17022976,13533184,1679360,0,0,1024,21450752,139264,139520,0,256,128000,87040,107520,112640,32768,47104,51200,147456
.long 1646080,21451360,21463552,1073741824,21285888,21417996,1575680,1966080,3072,20774912,20856832,20776960,20858880,21240832,0,0,21450764,21450752,21037440,21244416,1051011932,1761280,2048,1024,512,13852672,13856768,19568640,21450752,21444608,21460992,0,6799360,6881280,6963200,128000,21553152,21553152,21553152,1761280,13950976,16961536,16992256,13508608,13520896,17022976,13553664,1699840,0,0,1024,21450752,139520,139264,256,0,112640,102400,92160,128000,149504,143360,0,30720
.long 1679360,21455360,21451264,21283920,21282816,21422080,246912,1966080,1280,19246080,19247104,19248128,19249152,0,0,1073741824,21454848,21450752,21078016,21211136,1051011932,1671168,2048,1024,512,13459456,13463552,19890176,21451776,21424128,21440512,0,3942400,4024320,4106240,81920,21553152,21553152,21553152,1648640,13543424,18169856,18200576,13434880,13447168,18415616,13533184,1639040,0,0,1024,21454848,0,256,139264,139520,97280,117760,138240,81920,32768,47104,51200,147456
.long 1681920,21455392,21455360,1073741824,21283840,21422084,1311360,1966080,1280,18333696,18334720,18335744,18336768,0,0,1073741824,21454852,21450752,21078144,21252096,1051011932,1712128,2048,1024,512,13598720,13602816,19892224,21451776,21440512,21456896,0,4188160,4270080,4352000,97280,21553152,21553152,21553152,1689600,13682688,18231296,18262016,13459456,13471744,18415616,13553664,1659520,0,0,1024,21454848,256,0,139520,139264,81920,133120,122880,97280,149504,143360,0,30720
.long 1684480,21455424,21459456,1073741824,21284864,21422088,409728,819200,1280,17078272,17422336,17423360,17424384,0,0,1073741824,21454856,21450752,21078272,21213696,1051011932,1753088,2048,1024,512,13737984,13742080,19894272,21451776,21429248,21445632,0,6556160,6638080,6720000,112640,21553152,21553152,21553152,1730560,13821952,18292736,18323456,13484032,13496320,18415616,13533184,1680000,0,0,1024,21454848,139264,139520,0,256,128000,87040,107520,112640,32768,47104,51200,147456
.long 1687040,21455456,21463552,1073741824,21285888,21422092,1673984,1966080,3072,20779008,20860928,20781056,20862976,21241088,0,0,21454860,21450752,21078400,21254656,1051011932,1794048,2048,1024,512,13877248,13881344,19896320,21451776,21445632,21462016,0,6801920,6883840,6965760,128000,21553152,21553152,21553152,1771520,13961216,18354176,18384896,13508608,13520896,18415616,13553664,1700480,0,0,1024,21454848,139520,139264,256,0,112640,102400,92160,128000,149504,143360,0,30720
.long 1720320,21459456,21451264,21283936,21282816,21426176,286720,1966080,1280,16813056,16814080,16815104,16816128,0,0,1073741824,21458944,21450752,21118976,21221376,1065353216,4284416,2048,1024,512,13484032,13488128,20217856,21452800,21425152,21441536,0,3952640,4034560,4116480,81920,21553152,21553152,21553152,1658880,13553664,16777216,16807936,13713408,13725696,17022976,13811712,1720320,0,0,1024,21458944,0,256,139264,139520,97280,117760,138240,81920,32768,47104,51200,147456
.long 1722880,21459488,21455360,1073741824,21283840,21426180,1311488,1966080,1280,18337792,18681856,18682880,18683904,0,0,1073741824,21458948,21450752,21119104,21262336,1065353216,4325376,2048,1024,512,13623296,13627392,20219904,21452800,21441536,21457920,0,4198400,4280320,4362240,97280,21553152,21553152,21553152,1699840,13692928,16838656,16869376,13737984,13750272,17022976,13832192,1740800,0,0,1024,21458944,256,0,139520,139264,81920,133120,122880,97280,149504,143360,0,30720
.long 1725440,21459520,21459456,1073741824,21284864,21426184,409856,819200,1280,17425408,17426432,17770496,17771520,0,0,1073741824,21458952,21450752,21119232,21223936,1065353216,4366336,2048,1024,512,13762560,13766656,20221952,21452800,21430272,21446656,0,6558720,6640640,6722560,112640,21553152,21553152,21553152,1740800,13832192,16900096,16930816,13762560,13774848,17022976,13811712,1761280,0,0,1024,21458944,139264,139520,0,256,128000,87040,107520,112640,32768,47104,51200,147456
.long 1728000,21459552,21463552,1073741824,21285888,21426188,1772288,1966080,3072,20783104,20865024,20785152,20867072,21241344,0,0,21458956,21450752,21119360,21264896,1065353216,4407296,2048,1024,512,13901824,13905920,20224000,21452800,21446656,21463040,0,6804480,6886400,6968320,128000,21553152,21553152,21553152,1781760,13971456,16961536,16992256,13787136,13799424,17022976,13832192,1781760,0,0,1024,21458944,139520,139264,256,0,112640,102400,92160,128000,149504,143360,0,30720
.long 1761280,21463552,21451264,21283952,21282816,21430272,286848,1966080,1280,16817152,17161216,17162240,17163264,0,0,1073741824,21463040,21450752,21159936,21231616,1065353216,6885376,512,20480,10240,13508608,13512704,20545536,21453824,21426176,21442560,1024,3962880,4044800,4126720,81920,21553152,21553152,21553152,1669120,13563904,18169856,18200576,13713408,13725696,18415616,13811712,1720960,0,0,1024,21463040,0,256,139264,139520,97280,117760,138240,81920,32768,47104,51200,147456
.long 1763840,21463584,21455360,1073741824,21283840,21430276,1311616,1966080,1280,18684928,18685952,19030016,19031040,0,0,1073741824,21463044,21450752,21160064,21272576,1065353216,6926336,512,20480,10240,13647872,13651968,20547584,21453824,21442560,21458944,1024,4208640,4290560,4372480,97280,21553152,21553152,21553152,1710080,13703168,18231296,18262016,13737984,13750272,18415616,13832192,1741440,0,0,1024,21463040,256,0,139520,139264,81920,133120,122880,97280,149504,143360,0,30720
.long 1766400,21463616,21459456,1073741824,21284864,21430280,409984,819200,1280,17772544,17773568,17774592,18118656,0,0,1073741824,21463048,21450752,21160192,21234176,1065353216,6967296,512,20480,10240,13787136,13791232,20549632,21453824,21431296,21447680,1024,6561280,6643200,6725120,112640,21553152,21553152,21553152,1751040,13842432,18292736,18323456,13762560,13774848,18415616,13811712,1761920,0,0,1024,21463040,139264,139520,0,256,128000,87040,107520,112640,32768,47104,51200,147456
.long 1768960,21463648,21463552,1073741824,21285888,21430284,1870592,1966080,3072,20787200,20869120,20789248,20871168,21241600,0,0,21463052,21450752,21160320,21275136,1065353216,7008256,512,20480,10240,13926400,13930496,20551680,21453824,21447680,21464064,1024,6807040,6888960,6970880,128000,21553152,21553152,21553152,1792000,13981696,18354176,18384896,13787136,13799424,18415616,13832192,1782400,0,0,1024,21463040,139520,139264,256,0,112640,102400,92160,128000,149504,143360,0,30720
.long 337920,21321216,21320192,21283968,21282816,21287936,286976,1966080,1280,17164288,17165312,17509376,17510400,0,0,1073741824,21320704,21319680,20883456,21201024,1051011932,335872,2048,1024,512,8986624,8984576,19644416,21319680,21292032,21308416,0,2624000,2705920,2787840,81920,21553152,21553152,21553152,330240,9079296,17125376,17156096,8978432,8990720,17371136,9076736,327840,0,0,1024,21320704,0,256,139264,139520,97280,117760,138240,81920,32768,47104,51200,147456
.long 340480,21321248,21324288,1073741824,21283840,21287940,1311744,1966080,1280,19032064,19033088,19034112,19378176,0,0,1073741824,21320708,21319680,20883584,21241984,1051011932,376832,2048,1024,512,9125888,9123840,19646464,21319680,21308416,21324800,0,2869760,2951680,3033600,97280,21553152,21553152,21553152,371200,9218560,17186816,17217536,9003008,9015296,17371136,9097216,348320,0,0,1024,21320704,256,0,139520,139264,81920,133120,122880,97280,149504,143360,0,30720
.long 343040,21321280,21328384,1073741824,21284864,21287944,410112,819200,1280,18119680,18120704,18121728,18122752,0,0,1073741824,21320712,21319680,20883712,21203584,1051011932,417792,2048,1024,512,9265152,9263104,19648512,21319680,21297152,21313536,0,5243520,5325440,5407360,112640,21553152,21553152,21553152,412160,9357824,17248256,17278976,9027584,9039872,17371136,9076736,368800,0,0,1024,21320704,139264,139520,0,256,128000,87040,107520,112640,32768,47104,51200,147456
.long 345600,21321312,21332480,1073741824,21285888,21287948,128,1966080,3072,19563520,19645440,19565568,19647488,21241856,0,0,21320716,21319680,20883840,21244544,1051011932,458752,2048,1024,512,9404416,9402368,19650560,21319680,21313536,21329920,0,5489280,5571200,5653120,128000,21553152,21553152,21553152,453120,9497088,17309696,17340416,9052160,9064448,17371136,9097216,389280,0,0,1024,21320704,139520,139264,256,0,112640,102400,92160,128000,149504,143360,0,30720
.long 378880,21325312,21320192,21283984,21282816,21292032,287104,1966080,1280,17511424,17512448,17513472,17857536,0,0,1073741824,21324800,21319680,20924416,21211264,1065353216,2949120,2048,1024,512,9011200,9009152,19972096,21320704,21293056,21309440,0,2634240,2716160,2798080,81920,21553152,21553152,21553152,340480,9089536,18518016,18548736,8978432,8990720,18763776,9076736,328480,0,0,1024,21324800,0,256,139264,139520,97280,117760,138240,81920,32768,47104,51200,147456
.long 381440,21325344,21324288,1073741824,21283840,21292036,1311872,1966080,1280,19379200,19380224,19381248,19382272,0,0,1073741824,21324804,21319680,20924544,21252224,1065353216,2990080,2048,1024,512,9150464,9148416,19974144,21320704,21309440,21325824,0,2880000,2961920,3043840,97280,21553152,21553152,21553152,381440,9228800,18579456,18610176,9003008,9015296,18763776,9097216,348960,0,0,1024,21324800,256,0,139520,139264,81920,133120,122880,97280,149504,143360,0,30720
.long 384000,21325376,21328384,1073741824,21284864,21292040,410240,819200,1280,18466816,18467840,18468864,18469888,0,0,1073741824,21324808,21319680,20924672,21213824,1065353216,3031040,2048,1024,512,9289728,9287680,19976192,21320704,21298176,21314560,0,5246080,5328000,5409920,112640,21553152,21553152,21553152,422400,9368064,18640896,18671616,9027584,9039872,18763776,9076736,369440,0,0,1024,21324800,139264,139520,0,256,128000,87040,107520,112640,32768,47104,51200,147456
.long 386560,21325408,21332480,1073741824,21285888,21292044,98432,1966080,3072,19567616,19649536,19569664,19651584,21242112,0,0,21324812,21319680,20924800,21254784,1065353216,3072000,2048,1024,512,9428992,9426944,19978240,21320704,21314560,21330944,0,5491840,5573760,5655680,128000,21553152,21553152,21553152,463360,9507328,18702336,18733056,9052160,9064448,18763776,9097216,389920,0,0,1024,21324800,139520,139264,256,0,112640,102400,92160,128000,149504,143360,0,30720
.long 419840,21329408,21320192,21284000,21282816,21296128,287232,1966080,1280,17858560,17859584,17860608,17861632,0,0,1073741824,21328896,21319680,20965376,21221504,1065353216,2981888,2048,1024,512,9035776,9033728,20299776,21321728,21294080,21310464,1024,2644480,2726400,2808320,81920,21553152,21553152,21553152,350720,9099776,17125376,17156096,9256960,9269248,17371136,9355264,409760,0,0,1024,21328896,0,256,139264,139520,97280,117760,138240,81920,32768,47104,51200,147456
.long 422400,21329440,21324288,1073741824,21283840,21296132,1351680,1966080,1280,16946176,16947200,16948224,16949248,0,0,1073741824,21328900,21319680,20965504,21262464,1065353216,3022848,2048,1024,512,9175040,9172992,20301824,21321728,21310464,21326848,1024,2890240,2972160,3054080,97280,21553152,21553152,21553152,391680,9239040,17186816,17217536,9281536,9293824,17371136,9375744,430240,0,0,1024,21328896,256,0,139520,139264,81920,133120,122880,97280,149504,143360,0,30720
.long 424960,21329472,21328384,1073741824,21284864,21296136,410368,819200,1280,18470912,18814976,18816000,18817024,0,0,1073741824,21328904,21319680,20965632,21224064,1065353216,3063808,2048,1024,512,9314304,9312256,20303872,21321728,21299200,21315584,1024,5248640,5330560,5412480,112640,21553152,21553152,21553152,432640,9378304,17248256,17278976,9306112,9318400,17371136,9355264,450720,0,0,1024,21328896,139264,139520,0,256,128000,87040,107520,112640,32768,47104,51200,147456
.long 427520,21329504,21332480,1073741824,21285888,21296140,196736,1966080,3072,19571712,19653632,19573760,19655680,21242368,0,0,21328908,21319680,20965760,21265024,1065353216,3104768,2048,1024,512,9453568,9451520,20305920,21321728,21315584,21331968,1024,5494400,5576320,5658240,128000,21553152,21553152,21553152,473600,9517568,17309696,17340416,9330688,9342976,17371136,9375744,471200,0,0,1024,21328896,139520,139264,256,0,112640,102400,92160,128000,149504,143360,0,30720
.long 460800,21333504,21320192,21284016,21282816,21300224,287360,1966080,1280,18205696,18206720,18207744,18208768,0,0,1073741824,21332992,21319680,21006336,21231744,1065353216,5576704,512,20480,10240,9060352,9058304,20627456,21323776,21296128,21312512,0,2654720,2736640,2818560,81920,21553152,21553152,21553152,360960,9110016,18518016,18548736,9256960,9269248,18763776,9355264,410400,0,0,1024,21332992,0,256,139264,139520,97280,117760,138240,81920,32768,47104,51200,147456
.long 463360,21333536,21324288,1073741824,21283840,21300228,1351808,1966080,1280,16950272,17294336,17295360,17296384,0,0,1073741824,21332996,21319680,21006464,21272704,1065353216,5617664,512,20480,10240,9199616,9197568,20629504,21323776,21312512,21328896,0,2900480,2982400,3064320,97280,21553152,21553152,21553152,401920,9249280,18579456,18610176,9281536,9293824,18763776,9375744,430880,0,0,1024,21332992,256,0,139520,139264,81920,133120,122880,97280,149504,143360,0,30720
.long 465920,21333568,21328384,1073741824,21284864,21300232,410496,819200,1280,18818048,18819072,19163136,19164160,0,0,1073741824,21333000,21319680,21006592,21234304,1065353216,5658624,512,20480,10240,9338880,9336832,20631552,21323776,21301248,21317632,0,5251200,5333120,5415040,112640,21553152,21553152,21553152,442880,9388544,18640896,18671616,9306112,9318400,18763776,9355264,451360,0,0,1024,21332992,139264,139520,0,256,128000,87040,107520,112640,32768,47104,51200,147456
.long 468480,21333600,21332480,1073741824,21285888,21300236,295040,1966080,3072,19575808,19657728,19577856,19659776,21242624,0,0,21333004,21319680,21006720,21275264,1065353216,5699584,512,20480,10240,9478144,9476096,20633600,21323776,21317632,21334016,0,5496960,5578880,5660800,128000,21553152,21553152,21553152,483840,9527808,18702336,18733056,9330688,9342976,18763776,9375744,471840,0,0,1024,21332992,139520,139264,256,0,112640,102400,92160,128000,149504,143360,0,30720
.long 1648640,21452288,21451264,21284032,21282816,21419008,287488,1966080,1280,18209792,18553856,18554880,18555904,0,0,1073741824,21451776,21450752,21047296,21201024,1051011932,1646592,2048,1024,512,13443072,13441024,19644416,21450752,21423104,21439488,0,3934720,4016640,4098560,81920,21553152,21553152,21553152,1640960,13535744,17125376,17156096,13434880,13447168,17371136,13533184,1638560,0,0,1024,21451776,0,256,139264,139520,97280,117760,138240,81920,32768,47104,51200,147456
.long 1651200,21452320,21455360,1073741824,21283840,21419012,1351936,1966080,1280,17297408,17298432,17642496,17643520,0,0,1073741824,21451780,21450752,21047424,21241984,1051011932,1687552,2048,1024,512,13582336,13580288,19646464,21450752,21439488,21455872,0,4180480,4262400,4344320,97280,21553152,21553152,21553152,1681920,13675008,17186816,17217536,13459456,13471744,17371136,13553664,1659040,0,0,1024,21451776,256,0,139520,139264,81920,133120,122880,97280,149504,143360,0,30720
.long 1653760,21452352,21459456,1073741824,21284864,21419016,410624,819200,1280,19165184,19166208,19167232,19511296,0,0,1073741824,21451784,21450752,21047552,21203584,1051011932,1728512,2048,1024,512,13721600,13719552,19648512,21450752,21428224,21444608,0,6554240,6636160,6718080,112640,21553152,21553152,21553152,1722880,13814272,17248256,17278976,13484032,13496320,17371136,13533184,1679520,0,0,1024,21451776,139264,139520,0,256,128000,87040,107520,112640,32768,47104,51200,147456
.long 1656320,21452384,21463552,1073741824,21285888,21419020,393344,1966080,3072,19579904,19661824,19581952,19663872,21242880,0,0,21451788,21450752,21047680,21244544,1051011932,1769472,2048,1024,512,13860864,13858816,19650560,21450752,21444608,21460992,0,6800000,6881920,6963840,128000,21553152,21553152,21553152,1763840,13953536,17309696,17340416,13508608,13520896,17371136,13553664,1700000,0,0,1024,21451776,139520,139264,256,0,112640,102400,92160,128000,149504,143360,0,30720
.long 1689600,21456384,21451264,21284048,21282816,21423104,287616,1966080,1280,18556928,18557952,18902016,18903040,0,0,1073741824,21455872,21450752,21088256,21211264,1065353216,4259840,2048,1024,512,13467648,13465600,19972096,21451776,21424128,21440512,0,3944960,4026880,4108800,81920,21553152,21553152,21553152,1651200,13545984,18518016,18548736,13434880,13447168,18763776,13533184,1639200,0,0,1024,21455872,0,256,139264,139520,97280,117760,138240,81920,32768,47104,51200,147456
.long 1692160,21456416,21455360,1073741824,21283840,21423108,1352064,1966080,1280,17644544,17645568,17646592,17990656,0,0,1073741824,21455876,21450752,21088384,21252224,1065353216,4300800,2048,1024,512,13606912,13604864,19974144,21451776,21440512,21456896,0,4190720,4272640,4354560,97280,21553152,21553152,21553152,1692160,13685248,18579456,18610176,13459456,13471744,18763776,13553664,1659680,0,0,1024,21455872,256,0,139520,139264,81920,133120,122880,97280,149504,143360,0,30720
.long 1694720,21456448,21459456,1073741824,21284864,21423112,410752,819200,1280,19512320,19513344,19514368,19515392,0,0,1073741824,21455880,21450752,21088512,21213824,1065353216,4341760,2048,1024,512,13746176,13744128,19976192,21451776,21429248,21445632,0,6556800,6638720,6720640,112640,21553152,21553152,21553152,1733120,13824512,18640896,18671616,13484032,13496320,18763776,13533184,1680160,0,0,1024,21455872,139264,139520,0,256,128000,87040,107520,112640,32768,47104,51200,147456
.long 1697280,21456480,21463552,1073741824,21285888,21423116,491648,1966080,3072,19584000,19665920,19586048,19667968,21243136,0,0,21455884,21450752,21088640,21254784,1065353216,4382720,2048,1024,512,13885440,13883392,19978240,21451776,21445632,21462016,0,6802560,6884480,6966400,128000,21553152,21553152,21553152,1774080,13963776,18702336,18733056,13508608,13520896,18763776,13553664,1700640,0,0,1024,21455872,139520,139264,256,0,112640,102400,92160,128000,149504,143360,0,30720
.long 1730560,21460480,21451264,21284064,21282816,21427200,287744,1966080,1280,18904064,18905088,18906112,19250176,0,0,1073741824,21459968,21450752,21129216,21221504,1065353216,4292608,2048,1024,512,13492224,13490176,20299776,21452800,21425152,21441536,1024,3955200,4037120,4119040,81920,21553152,21553152,21553152,1661440,13556224,17125376,17156096,13713408,13725696,17371136,13811712,1720480,0,0,1024,21459968,0,256,139264,139520,97280,117760,138240,81920,32768,47104,51200,147456
.long 1733120,21460512,21455360,1073741824,21283840,21427204,1352192,1966080,1280,17991680,17992704,17993728,17994752,0,0,1073741824,21459972,21450752,21129344,21262464,1065353216,4333568,2048,1024,512,13631488,13629440,20301824,21452800,21441536,21457920,1024,4200960,4282880,4364800,97280,21553152,21553152,21553152,1702400,13695488,17186816,17217536,13737984,13750272,17371136,13832192,1740960,0,0,1024,21459968,256,0,139520,139264,81920,133120,122880,97280,149504,143360,0,30720
.long 1735680,21460544,21459456,1073741824,21284864,21427208,450560,819200,1280,17079296,17080320,17081344,17082368,0,0,1073741824,21459976,21450752,21129472,21224064,1065353216,4374528,2048,1024,512,13770752,13768704,20303872,21452800,21430272,21446656,1024,6559360,6641280,6723200,112640,21553152,21553152,21553152,1743360,13834752,17248256,17278976,13762560,13774848,17371136,13811712,1761440,0,0,1024,21459968,139264,139520,0,256,128000,87040,107520,112640,32768,47104,51200,147456
.long 1738240,21460576,21463552,1073741824,21285888,21427212,589952,1966080,3072,19588096,19670016,19590144,19672064,21243392,0,0,21459980,21450752,21129600,21265024,1065353216,4415488,2048,1024,512,13910016,13907968,20305920,21452800,21446656,21463040,1024,6805120,6887040,6968960,128000,21553152,21553152,21553152,1784320,13974016,17309696,17340416,13787136,13799424,17371136,13832192,1781920,0,0,1024,21459968,139520,139264,256,0,112640,102400,92160,128000,149504,143360,0,30720
.long 1771520,21464576,21451264,21284080,21282816,21431296,287872,1966080,1280,19251200,19252224,19253248,19254272,0,0,1073741824,21464064,21450752,21170176,21231744,1065353216,6887424,512,20480,10240,13516800,13514752,20627456,21454848,21427200,21443584,0,3965440,4047360,4129280,81920,21553152,21553152,21553152,1671680,13566464,18518016,18548736,13713408,13725696,18763776,13811712,1721120,0,0,1024,21464064,0,256,139264,139520,97280,117760,138240,81920,32768,47104,51200,147456
.long 1774080,21464608,21455360,1073741824,21283840,21431300,1352320,1966080,1280,18338816,18339840,18340864,18341888,0,0,1073741824,21464068,21450752,21170304,21272704,1065353216,6928384,512,20480,10240,13656064,13654016,20629504,21454848,21443584,21459968,0,4211200,4293120,4375040,97280,21553152,21553152,21553152,1712640,13705728,18579456,18610176,13737984,13750272,18763776,13832192,1741600,0,0,1024,21464064,256,0,139520,139264,81920,133120,122880,97280,149504,143360,0,30720
.long 1776640,21464640,21459456,1073741824,21284864,21431304,450688,819200,1280,17083392,17427456,17428480,17429504,0,0,1073741824,21464072,21450752,21170432,21234304,1065353216,6969344,512,20480,10240,13795328,13793280,20631552,21454848,21432320,21448704,0,6561920,6643840,6725760,112640,21553152,21553152,21553152,1753600,13844992,18640896,18671616,13762560,13774848,18763776,13811712,1762080,0,0,1024,21464064,139264,139520,0,256,128000,87040,107520,112640,32768,47104,51200,147456
.long 1779200,21464672,21463552,1073741824,21285888,21431308,688256,1966080,3072,19592192,19674112,19594240,19676160,21243648,0,0,21464076,21450752,21170560,21275264,1065353216,7010304,512,20480,10240,13934592,13932544,20633600,21454848,21448704,21465088,0,6807680,6889600,6971520,128000,21553152,21553152,21553152,1794560,13984256,18702336,18733056,13787136,13799424,18763776,13832192,1782560,0,0,1024,21464064,139520,139264,256,0,112640,102400,92160,128000,149504,143360,0,30720
.long 348160,21322240,21320192,21284096,21282816,21288960,327680,1966080,1280,16818176,16819200,16820224,16821248,0,0,1073741824,21321728,21319680,20893696,21206016,1051011932,344064,2048,1024,512,8990720,8994816,19726336,21319680,21292032,21308416,0,2626560,2708480,2790400,81920,21553152,21553152,21553152,332800,9081856,17473536,17504256,8978432,8990720,17719296,9076736,328000,0,0,1024,21321728,0,256,139264,139520,97280,117760,138240,81920,32768,47104,51200,147456
.long 350720,21322272,21324288,1073741824,21283840,21288964,1352448,1966080,1280,18342912,18686976,18688000,18689024,0,0,1073741824,21321732,21319680,20893824,21246976,1051011932,385024,2048,1024,512,9129984,9134080,19728384,21319680,21308416,21324800,0,2872320,2954240,3036160,97280,21553152,21553152,21553152,373760,9221120,17534976,17565696,9003008,9015296,17719296,9097216,348480,0,0,1024,21321728,256,0,139520,139264,81920,133120,122880,97280,149504,143360,0,30720
.long 353280,21322304,21328384,1073741824,21284864,21288968,450816,819200,1280,17430528,17431552,17775616,17776640,0,0,1073741824,21321736,21319680,20893952,21208576,1051011932,425984,2048,1024,512,9269248,9273344,19730432,21319680,21297152,21313536,0,5244160,5326080,5408000,112640,21553152,21553152,21553152,414720,9360384,17596416,17627136,9027584,9039872,17719296,9076736,368960,0,0,1024,21321728,139264,139520,0,256,128000,87040,107520,112640,32768,47104,51200,147456
.long 355840,21322336,21332480,1073741824,21285888,21288972,786560,1966080,3072,19596288,19678208,19598336,19680256,21243904,0,0,21321740,21319680,20894080,21249536,1051011932,466944,2048,1024,512,9408512,9412608,19732480,21319680,21313536,21329920,0,5489920,5571840,5653760,128000,21553152,21553152,21553152,455680,9499648,17657856,17688576,9052160,9064448,17719296,9097216,389440,0,0,1024,21321728,139520,139264,256,0,112640,102400,92160,128000,149504,143360,0,30720
.long 389120,21326336,21320192,21284112,21282816,21293056,327808,1966080,1280,16822272,17166336,17167360,17168384,0,0,1073741824,21325824,21319680,20934656,21216256,1065353216,2957312,2048,1024,512,9015296,9019392,20054016,21320704,21293056,21309440,1024,2636800,2718720,2800640,81920,21553152,21553152,21553152,343040,9092096,18866176,18896896,8978432,8990720,19111936,9076736,328640,0,0,1024,21325824,0,256,139264,139520,97280,117760,138240,81920,32768,47104,51200,147456
.long 391680,21326368,21324288,1073741824,21283840,21293060,1352576,1966080,1280,18690048,18691072,19035136,19036160,0,0,1073741824,21325828,21319680,20934784,21257216,1065353216,2998272,2048,1024,512,9154560,9158656,20056064,21320704,21309440,21325824,1024,2882560,2964480,3046400,97280,21553152,21553152,21553152,384000,9231360,18927616,18958336,9003008,9015296,19111936,9097216,349120,0,0,1024,21325824,256,0,139520,139264,81920,133120,122880,97280,149504,143360,0,30720
.long 394240,21326400,21328384,1073741824,21284864,21293064,450944,819200,1280,17777664,17778688,17779712,18123776,0,0,1073741824,21325832,21319680,20934912,21218816,1065353216,3039232,2048,1024,512,9293824,9297920,20058112,21320704,21298176,21314560,1024,5246720,5328640,5410560,112640,21553152,21553152,21553152,424960,9370624,18989056,19019776,9027584,9039872,19111936,9076736,369600,0,0,1024,21325824,139264,139520,0,256,128000,87040,107520,112640,32768,47104,51200,147456
.long 396800,21326432,21332480,1073741824,21285888,21293068,884864,1966080,3072,19600384,19682304,19602432,19684352,21244160,0,0,21325836,21319680,20935040,21259776,1065353216,3080192,2048,1024,512,9433088,9437184,20060160,21320704,21314560,21330944,1024,5492480,5574400,5656320,128000,21553152,21553152,21553152,465920,9509888,19050496,19081216,9052160,9064448,19111936,9097216,390080,0,0,1024,21325824,139520,139264,256,0,112640,102400,92160,128000,149504,143360,0,30720
.long 430080,21330432,21320192,21284128,21282816,21297152,327936,1966080,1280,17169408,17170432,17514496,17515520,0,0,1073741824,21329920,21319680,20975616,21226496,1065353216,5570560,512,20480,10240,9039872,9043968,20381696,21322752,21295104,21311488,0,2647040,2728960,2810880,81920,21553152,21553152,21553152,353280,9102336,17473536,17504256,9256960,9269248,17719296,9355264,409920,0,0,1024,21329920,0,256,139264,139520,97280,117760,138240,81920,32768,47104,51200,147456
.long 432640,21330464,21324288,1073741824,21283840,21297156,1352704,1966080,1280,19037184,19038208,19039232,19383296,0,0,1073741824,21329924,21319680,20975744,21267456,1065353216,5611520,512,20480,10240,9179136,9183232,20383744,21322752,21311488,21327872,0,2892800,2974720,3056640,97280,21553152,21553152,21553152,394240,9241600,17534976,17565696,9281536,9293824,17719296,9375744,430400,0,0,1024,21329920,256,0,139520,139264,81920,133120,122880,97280,149504,143360,0,30720
.long 435200,21330496,21328384,1073741824,21284864,21297160,451072,819200,1280,18124800,18125824,18126848,18127872,0,0,1073741824,21329928,21319680,20975872,21229056,1065353216,5652480,512,20480,10240,9318400,9322496,20385792,21322752,21300224,21316608,0,5249280,5331200,5413120,112640,21553152,21553152,21553152,435200,9380864,17596416,17627136,9306112,9318400,17719296,9355264,450880,0,0,1024,21329920,139264,139520,0,256,128000,87040,107520,112640,32768,47104,51200,147456
.long 437760,21330528,21332480,1073741824,21285888,21297164,983168,1966080,3072,19604480,19686400,19606528,19688448,21244416,0,0,21329932,21319680,20976000,21270016,1065353216,5693440,512,20480,10240,9457664,9461760,20387840,21322752,21316608,21332992,0,5495040,5576960,5658880,128000,21553152,21553152,21553152,476160,9520128,17657856,17688576,9330688,9342976,17719296,9375744,471360,0,0,1024,21329920,139520,139264,256,0,112640,102400,92160,128000,149504,143360,0,30720
.long 471040,21334528,21320192,21284144,21282816,21301248,328064,1966080,1280,17516544,17517568,17518592,17862656,0,0,1073741824,21334016,21319680,21016576,21236736,1065353216,5578752,512,20480,10240,9064448,9068544,20709376,21323776,21296128,21312512,0,2657280,2739200,2821120,81920,21553152,21553152,21553152,363520,9112576,18866176,18896896,9256960,9269248,19111936,9355264,410560,0,0,1024,21334016,0,256,139264,139520,97280,117760,138240,81920,32768,47104,51200,147456
.long 473600,21334560,21324288,1073741824,21283840,21301252,1352832,1966080,1280,19384320,19385344,19386368,19387392,0,0,1073741824,21334020,21319680,21016704,21277696,1065353216,5619712,512,20480,10240,9203712,9207808,20711424,21323776,21312512,21328896,0,2903040,2984960,3066880,97280,21553152,21553152,21553152,404480,9251840,18927616,18958336,9281536,9293824,19111936,9375744,431040,0,0,1024,21334016,256,0,139520,139264,81920,133120,122880,97280,149504,143360,0,30720
.long 476160,21334592,21328384,1073741824,21284864,21301256,451200,819200,1280,18471936,18472960,18473984,18475008,0,0,1073741824,21334024,21319680,21016832,21239296,1065353216,5660672,512,20480,10240,9342976,9347072,20713472,21323776,21301248,21317632,0,5251840,5333760,5415680,112640,21553152,21553152,21553152,445440,9391104,18989056,19019776,9306112,9318400,19111936,9355264,451520,0,0,1024,21334016,139264,139520,0,256,128000,87040,107520,112640,32768,47104,51200,147456
.long 478720,21334624,21332480,1073741824,21285888,21301260,1081472,1966080,3072,19608576,19690496,19610624,19692544,21244672,0,0,21334028,21319680,21016960,21280256,1065353216,5701632,512,20480,10240,9482240,9486336,20715520,21323776,21317632,21334016,0,5497600,5579520,5661440,128000,21553152,21553152,21553152,486400,9530368,19050496,19081216,9330688,9342976,19111936,9375744,472000,0,0,1024,21334016,139520,139264,256,0,112640,102400,92160,128000,149504,143360,0,30720
.long 1658880,21453312,21451264,21284160,21282816,21420032,328192,1966080,1280,17863680,17864704,17865728,17866752,0,0,1073741824,21452800,21450752,21057536,21206016,1051011932,1654784,2048,1024,512,13447168,13451264,19726336,21450752,21423104,21439488,0,3937280,4019200,4101120,81920,21553152,21553152,21553152,1643520,13538304,17473536,17504256,13434880,13447168,17719296,13533184,1638720,0,0,1024,21452800,0,256,139264,139520,97280,117760,138240,81920,32768,47104,51200,147456
.long 1661440,21453344,21455360,1073741824,21283840,21420036,1392640,1966080,1280,16951296,16952320,16953344,16954368,0,0,1073741824,21452804,21450752,21057664,21246976,1051011932,1695744,2048,1024,512,13586432,13590528,19728384,21450752,21439488,21455872,0,4183040,4264960,4346880,97280,21553152,21553152,21553152,1684480,13677568,17534976,17565696,13459456,13471744,17719296,13553664,1659200,0,0,1024,21452800,256,0,139520,139264,81920,133120,122880,97280,149504,143360,0,30720
.long 1664000,21453376,21459456,1073741824,21284864,21420040,451328,819200,1280,18476032,18820096,18821120,18822144,0,0,1073741824,21452808,21450752,21057792,21208576,1051011932,1736704,2048,1024,512,13725696,13729792,19730432,21450752,21428224,21444608,0,6554880,6636800,6718720,112640,21553152,21553152,21553152,1725440,13816832,17596416,17627136,13484032,13496320,17719296,13533184,1679680,0,0,1024,21452800,139264,139520,0,256,128000,87040,107520,112640,32768,47104,51200,147456
.long 1666560,21453408,21463552,1073741824,21285888,21420044,1179776,1966080,3072,19612672,19694592,19614720,19696640,21244928,0,0,21452812,21450752,21057920,21249536,1051011932,1777664,2048,1024,512,13864960,13869056,19732480,21450752,21444608,21460992,0,6800640,6882560,6964480,128000,21553152,21553152,21553152,1766400,13956096,17657856,17688576,13508608,13520896,17719296,13553664,1700160,0,0,1024,21452800,139520,139264,256,0,112640,102400,92160,128000,149504,143360,0,30720
.long 1699840,21457408,21451264,21284176,21282816,21424128,328320,1966080,1280,18210816,18211840,18212864,18213888,0,0,1073741824,21456896,21450752,21098496,21216256,1065353216,4268032,2048,1024,512,13471744,13475840,20054016,21451776,21424128,21440512,1024,3947520,4029440,4111360,81920,21553152,21553152,21553152,1653760,13548544,18866176,18896896,13434880,13447168,19111936,13533184,1639360,0,0,1024,21456896,0,256,139264,139520,97280,117760,138240,81920,32768,47104,51200,147456
.long 1702400,21457440,21455360,1073741824,21283840,21424132,1392768,1966080,1280,16955392,17299456,17300480,17301504,0,0,1073741824,21456900,21450752,21098624,21257216,1065353216,4308992,2048,1024,512,13611008,13615104,20056064,21451776,21440512,21456896,1024,4193280,4275200,4357120,97280,21553152,21553152,21553152,1694720,13687808,18927616,18958336,13459456,13471744,19111936,13553664,1659840,0,0,1024,21456896,256,0,139520,139264,81920,133120,122880,97280,149504,143360,0,30720
.long 1704960,21457472,21459456,1073741824,21284864,21424136,451456,819200,1280,18823168,18824192,19168256,19169280,0,0,1073741824,21456904,21450752,21098752,21218816,1065353216,4349952,2048,1024,512,13750272,13754368,20058112,21451776,21429248,21445632,1024,6557440,6639360,6721280,112640,21553152,21553152,21553152,1735680,13827072,18989056,19019776,13484032,13496320,19111936,13533184,1680320,0,0,1024,21456896,139264,139520,0,256,128000,87040,107520,112640,32768,47104,51200,147456
.long 1707520,21457504,21463552,1073741824,21285888,21424140,1278080,1966080,3072,19616768,19698688,19618816,19700736,21245184,0,0,21456908,21450752,21098880,21259776,1065353216,4390912,2048,1024,512,13889536,13893632,20060160,21451776,21445632,21462016,1024,6803200,6885120,6967040,128000,21553152,21553152,21553152,1776640,13966336,19050496,19081216,13508608,13520896,19111936,13553664,1700800,0,0,1024,21456896,139520,139264,256,0,112640,102400,92160,128000,149504,143360,0,30720
.long 1740800,21461504,21451264,21284192,21282816,21428224,328448,1966080,1280,18214912,18558976,18560000,18561024,0,0,1073741824,21460992,21450752,21139456,21226496,1065353216,6881280,512,20480,10240,13496320,13500416,20381696,21453824,21426176,21442560,0,3957760,4039680,4121600,81920,21553152,21553152,21553152,1664000,13558784,17473536,17504256,13713408,13725696,17719296,13811712,1720640,0,0,1024,21460992,0,256,139264,139520,97280,117760,138240,81920,32768,47104,51200,147456
.long 1743360,21461536,21455360,1073741824,21283840,21428228,1392896,1966080,1280,17302528,17303552,17647616,17648640,0,0,1073741824,21460996,21450752,21139584,21267456,1065353216,6922240,512,20480,10240,13635584,13639680,20383744,21453824,21442560,21458944,0,4203520,4285440,4367360,97280,21553152,21553152,21553152,1704960,13698048,17534976,17565696,13737984,13750272,17719296,13832192,1741120,0,0,1024,21460992,256,0,139520,139264,81920,133120,122880,97280,149504,143360,0,30720
.long 1745920,21461568,21459456,1073741824,21284864,21428232,451584,819200,1280,19170304,19171328,19172352,19516416,0,0,1073741824,21461000,21450752,21139712,21229056,1065353216,6963200,512,20480,10240,13774848,13778944,20385792,21453824,21431296,21447680,0,6560000,6641920,6723840,112640,21553152,21553152,21553152,1745920,13837312,17596416,17627136,13762560,13774848,17719296,13811712,1761600,0,0,1024,21460992,139264,139520,0,256,128000,87040,107520,112640,32768,47104,51200,147456
.long 1748480,21461600,21463552,1073741824,21285888,21428236,1376384,1966080,3072,19620864,19702784,19622912,19704832,21245440,0,0,21461004,21450752,21139840,21270016,1065353216,7004160,512,20480,10240,13914112,13918208,20387840,21453824,21447680,21464064,0,6805760,6887680,6969600,128000,21553152,21553152,21553152,1786880,13976576,17657856,17688576,13787136,13799424,17719296,13832192,1782080,0,0,1024,21460992,139520,139264,256,0,112640,102400,92160,128000,149504,143360,0,30720
.long 1781760,21465600,21451264,21284208,21282816,21432320,328576,1966080,1280,18562048,18563072,18907136,18908160,0,0,1073741824,21465088,21450752,21180416,21236736,1065353216,6889472,512,20480,10240,13520896,13524992,20709376,21454848,21427200,21443584,0,3968000,4049920,4131840,81920,21553152,21553152,21553152,1674240,13569024,18866176,18896896,13713408,13725696,19111936,13811712,1721280,0,0,1024,21465088,0,256,139264,139520,97280,117760,138240,81920,32768,47104,51200,147456
.long 1784320,21465632,21455360,1073741824,21283840,21432324,1393024,1966080,1280,17649664,17650688,17651712,17995776,0,0,1073741824,21465092,21450752,21180544,21277696,1065353216,6930432,512,20480,10240,13660160,13664256,20711424,21454848,21443584,21459968,0,4213760,4295680,4377600,97280,21553152,21553152,21553152,1715200,13708288,18927616,18958336,13737984,13750272,19111936,13832192,1741760,0,0,1024,21465088,256,0,139520,139264,81920,133120,122880,97280,149504,143360,0,30720
.long 1786880,21465664,21459456,1073741824,21284864,21432328,451712,819200,1280,19517440,19518464,19519488,19520512,0,0,1073741824,21465096,21450752,21180672,21239296,1065353216,6971392,512,20480,10240,13799424,13803520,20713472,21454848,21432320,21448704,0,6562560,6644480,6726400,112640,21553152,21553152,21553152,1756160,13847552,18989056,19019776,13762560,13774848,19111936,13811712,1762240,0,0,1024,21465088,139264,139520,0,256,128000,87040,107520,112640,32768,47104,51200,147456
.long 1789440,21465696,21463552,1073741824,21285888,21432332,1474688,1966080,3072,19624960,19706880,19627008,19708928,21245696,0,0,21465100,21450752,21180800,21280256,1065353216,7012352,512,20480,10240,13938688,13942784,20715520,21454848,21448704,21465088,0,6808320,6890240,6972160,128000,21553152,21553152,21553152,1797120,13986816,19050496,19081216,13787136,13799424,19111936,13832192,1782720,0,0,1024,21465088,139520,139264,256,0,112640,102400,92160,128000,149504,143360,0,30720
.long 358400,21323264,21320192,21284224,21282816,21289984,328704,1966080,1280,18909184,18910208,18911232,19255296,0,0,1073741824,21322752,21319680,20903936,21206144,1051011932,352256,2048,1024,512,8998912,8996864,19808256,21319680,21292032,21308416,1024,2629120,2711040,2792960,81920,21553152,21553152,21553152,335360,9084416,17821696,17852416,8978432,8990720,18067456,9076736,328160,0,0,1024,21322752,0,256,139264,139520,97280,117760,138240,81920,32768,47104,51200,147456
.long 360960,21323296,21324288,1073741824,21283840,21289988,1393152,1966080,1280,17996800,17997824,17998848,17999872,0,0,1073741824,21322756,21319680,20904064,21247104,1051011932,393216,2048,1024,512,9138176,9136128,19810304,21319680,21308416,21324800,1024,2874880,2956800,3038720,97280,21553152,21553152,21553152,376320,9223680,17883136,17913856,9003008,9015296,18067456,9097216,348640,0,0,1024,21322752,256,0,139520,139264,81920,133120,122880,97280,149504,143360,0,30720
.long 363520,21323328,21328384,1073741824,21284864,21289992,491520,819200,1280,17084416,17085440,17086464,17087488,0,0,1073741824,21322760,21319680,20904192,21208704,1051011932,434176,2048,1024,512,9277440,9275392,19812352,21319680,21297152,21313536,1024,5244800,5326720,5408640,112640,21553152,21553152,21553152,417280,9362944,17944576,17975296,9027584,9039872,18067456,9076736,369120,0,0,1024,21322752,139264,139520,0,256,128000,87040,107520,112640,32768,47104,51200,147456
.long 366080,21323360,21332480,1073741824,21285888,21289996,1572992,1966080,3072,19629056,19710976,19631104,19713024,21245952,0,0,21322764,21319680,20904320,21249664,1051011932,475136,2048,1024,512,9416704,9414656,19814400,21319680,21313536,21329920,1024,5490560,5572480,5654400,128000,21553152,21553152,21553152,458240,9502208,18006016,18036736,9052160,9064448,18067456,9097216,389600,0,0,1024,21322752,139520,139264,256,0,112640,102400,92160,128000,149504,143360,0,30720
.long 399360,21327360,21320192,21284240,21282816,21294080,328832,1966080,1280,19256320,19257344,19258368,19259392,0,0,1073741824,21326848,21319680,20944896,21216384,1065353216,2965504,2048,1024,512,9023488,9021440,20135936,21321728,21294080,21310464,0,2639360,2721280,2803200,81920,21553152,21553152,21553152,345600,9094656,19214336,19245056,8978432,8990720,19460096,9076736,328800,0,0,1024,21326848,0,256,139264,139520,97280,117760,138240,81920,32768,47104,51200,147456
.long 401920,21327392,21324288,1073741824,21283840,21294084,1393280,1966080,1280,18343936,18344960,18345984,18347008,0,0,1073741824,21326852,21319680,20945024,21257344,1065353216,3006464,2048,1024,512,9162752,9160704,20137984,21321728,21310464,21326848,0,2885120,2967040,3048960,97280,21553152,21553152,21553152,386560,9233920,19275776,19306496,9003008,9015296,19460096,9097216,349280,0,0,1024,21326848,256,0,139520,139264,81920,133120,122880,97280,149504,143360,0,30720
.long 404480,21327424,21328384,1073741824,21284864,21294088,491648,819200,1280,17088512,17432576,17433600,17434624,0,0,1073741824,21326856,21319680,20945152,21218944,1065353216,3047424,2048,1024,512,9302016,9299968,20140032,21321728,21299200,21315584,0,5247360,5329280,5411200,112640,21553152,21553152,21553152,427520,9373184,19337216,19367936,9027584,9039872,19460096,9076736,369760,0,0,1024,21326848,139264,139520,0,256,128000,87040,107520,112640,32768,47104,51200,147456
.long 407040,21327456,21332480,1073741824,21285888,21294092,1671296,1966080,3072,19633152,19715072,19635200,19717120,21246208,0,0,21326860,21319680,20945280,21259904,1065353216,3088384,2048,1024,512,9441280,9439232,20142080,21321728,21315584,21331968,0,5493120,5575040,5656960,128000,21553152,21553152,21553152,468480,9512448,19398656,19429376,9052160,9064448,19460096,9097216,390240,0,0,1024,21326848,139520,139264,256,0,112640,102400,92160,128000,149504,143360,0,30720
.long 440320,21331456,21320192,21284256,21282816,21298176,368640,1966080,1280,16823296,16824320,16825344,16826368,0,0,1073741824,21330944,21319680,20985856,21226624,1065353216,5572608,512,20480,10240,9048064,9046016,20463616,21322752,21295104,21311488,0,2649600,2731520,2813440,81920,21553152,21553152,21553152,355840,9104896,17821696,17852416,9256960,9269248,18067456,9355264,410080,0,0,1024,21330944,0,256,139264,139520,97280,117760,138240,81920,32768,47104,51200,147456
.long 442880,21331488,21324288,1073741824,21283840,21298180,1393408,1966080,1280,18348032,18692096,18693120,18694144,0,0,1073741824,21330948,21319680,20985984,21267584,1065353216,5613568,512,20480,10240,9187328,9185280,20465664,21322752,21311488,21327872,0,2895360,2977280,3059200,97280,21553152,21553152,21553152,396800,9244160,17883136,17913856,9281536,9293824,18067456,9375744,430560,0,0,1024,21330944,256,0,139520,139264,81920,133120,122880,97280,149504,143360,0,30720
.long 445440,21331520,21328384,1073741824,21284864,21298184,491776,819200,1280,17435648,17436672,17780736,17781760,0,0,1073741824,21330952,21319680,20986112,21229184,1065353216,5654528,512,20480,10240,9326592,9324544,20467712,21322752,21300224,21316608,0,5249920,5331840,5413760,112640,21553152,21553152,21553152,437760,9383424,17944576,17975296,9306112,9318400,18067456,9355264,451040,0,0,1024,21330944,139264,139520,0,256,128000,87040,107520,112640,32768,47104,51200,147456
.long 448000,21331552,21332480,1073741824,21285888,21298188,1769600,1966080,3072,19637248,19719168,19639296,19721216,21246464,0,0,21330956,21319680,20986240,21270144,1065353216,5695488,512,20480,10240,9465856,9463808,20469760,21322752,21316608,21332992,0,5495680,5577600,5659520,128000,21553152,21553152,21553152,478720,9522688,18006016,18036736,9330688,9342976,18067456,9375744,471520,0,0,1024,21330944,139520,139264,256,0,112640,102400,92160,128000,149504,143360,0,30720
.long 481280,21335552,21320192,21284272,21282816,21302272,368768,1966080,1280,16827392,17171456,17172480,17173504,0,0,1073741824,21335040,21319680,21026816,21236864,1065353216,8192000,512,20480,10240,9072640,9070592,20791296,21323776,21296128,21312512,0,2659840,2741760,2823680,81920,21553152,21553152,21553152,366080,9115136,19214336,19245056,9256960,9269248,19460096,9355264,410720,0,0,1024,21335040,0,256,139264,139520,97280,117760,138240,81920,32768,47104,51200,147456
.long 483840,21335584,21324288,1073741824,21283840,21302276,1393536,1966080,1280,18695168,18696192,19040256,19041280,0,0,1073741824,21335044,21319680,21026944,21277824,1065353216,8232960,512,20480,10240,9211904,9209856,20793344,21323776,21312512,21328896,0,2905600,2987520,3069440,97280,21553152,21553152,21553152,407040,9254400,19275776,19306496,9281536,9293824,19460096,9375744,431200,0,0,1024,21335040,256,0,139520,139264,81920,133120,122880,97280,149504,143360,0,30720
.long 486400,21335616,21328384,1073741824,21284864,21302280,491904,819200,1280,17782784,17783808,17784832,18128896,0,0,1073741824,21335048,21319680,21027072,21239424,1065353216,8273920,512,20480,10240,9351168,9349120,20795392,21323776,21301248,21317632,0,5252480,5334400,5416320,112640,21553152,21553152,21553152,448000,9393664,19337216,19367936,9306112,9318400,19460096,9355264,451680,0,0,1024,21335040,139264,139520,0,256,128000,87040,107520,112640,32768,47104,51200,147456
.long 488960,21335648,21332480,1073741824,21285888,21302284,1867904,1966080,3072,19641344,19723264,19643392,19725312,21246720,0,0,21335052,21319680,21027200,21280384,1065353216,8314880,512,20480,10240,9490432,9488384,20797440,21323776,21317632,21334016,0,5498240,5580160,5662080,128000,21553152,21553152,21553152,488960,9532928,19398656,19429376,9330688,9342976,19460096,9375744,472160,0,0,1024,21335040,139520,139264,256,0,112640,102400,92160,128000,149504,143360,0,30720
.long 1669120,21454336,21451264,21284288,21282816,21421056,368896,1966080,1280,17174528,17175552,17519616,17520640,0,0,1073741824,21453824,21450752,21067776,21206144,1051011932,1662976,2048,1024,512,13455360,13453312,19808256,21450752,21423104,21439488,1024,3939840,4021760,4103680,81920,21553152,21553152,21553152,1646080,13540864,17821696,17852416,13434880,13447168,18067456,13533184,1638880,0,0,1024,21453824,0,256,139264,139520,97280,117760,138240,81920,32768,47104,51200,147456
.long 1671680,21454368,21455360,1073741824,21283840,21421060,1393664,1966080,1280,19042304,19043328,19044352,19388416,0,0,1073741824,21453828,21450752,21067904,21247104,1051011932,1703936,2048,1024,512,13594624,13592576,19810304,21450752,21439488,21455872,1024,4185600,4267520,4349440,97280,21553152,21553152,21553152,1687040,13680128,17883136,17913856,13459456,13471744,18067456,13553664,1659360,0,0,1024,21453824,256,0,139520,139264,81920,133120,122880,97280,149504,143360,0,30720
.long 1674240,21454400,21459456,1073741824,21284864,21421064,492032,819200,1280,18129920,18130944,18131968,18132992,0,0,1073741824,21453832,21450752,21068032,21208704,1051011932,1744896,2048,1024,512,13733888,13731840,19812352,21450752,21428224,21444608,1024,6555520,6637440,6719360,112640,21553152,21553152,21553152,1728000,13819392,17944576,17975296,13484032,13496320,18067456,13533184,1679840,0,0,1024,21453824,139264,139520,0,256,128000,87040,107520,112640,32768,47104,51200,147456
.long 1676800,21454432,21463552,1073741824,21285888,21421068,512,1966080,3072,19727360,19809280,19729408,19811328,21246976,0,0,21453836,21450752,21068160,21249664,1051011932,1785856,2048,1024,512,13873152,13871104,19814400,21450752,21444608,21460992,1024,6801280,6883200,6965120,128000,21553152,21553152,21553152,1768960,13958656,18006016,18036736,13508608,13520896,18067456,13553664,1700320,0,0,1024,21453824,139520,139264,256,0,112640,102400,92160,128000,149504,143360,0,30720
.long 1710080,21458432,21451264,21284304,21282816,21425152,369024,1966080,1280,17521664,17522688,17523712,17867776,0,0,1073741824,21457920,21450752,21108736,21216384,1065353216,4276224,2048,1024,512,13479936,13477888,20135936,21452800,21425152,21441536,0,3950080,4032000,4113920,81920,21553152,21553152,21553152,1656320,13551104,19214336,19245056,13434880,13447168,19460096,13533184,1639520,0,0,1024,21457920,0,256,139264,139520,97280,117760,138240,81920,32768,47104,51200,147456
.long 1712640,21458464,21455360,1073741824,21283840,21425156,1393792,1966080,1280,19389440,19390464,19391488,19392512,0,0,1073741824,21457924,21450752,21108864,21257344,1065353216,4317184,2048,1024,512,13619200,13617152,20137984,21452800,21441536,21457920,0,4195840,4277760,4359680,97280,21553152,21553152,21553152,1697280,13690368,19275776,19306496,13459456,13471744,19460096,13553664,1660000,0,0,1024,21457920,256,0,139520,139264,81920,133120,122880,97280,149504,143360,0,30720
.long 1715200,21458496,21459456,1073741824,21284864,21425160,492160,819200,1280,18477056,18478080,18479104,18480128,0,0,1073741824,21457928,21450752,21108992,21218944,1065353216,4358144,2048,1024,512,13758464,13756416,20140032,21452800,21430272,21446656,0,6558080,6640000,6721920,112640,21553152,21553152,21553152,1738240,13829632,19337216,19367936,13484032,13496320,19460096,13533184,1680480,0,0,1024,21457920,139264,139520,0,256,128000,87040,107520,112640,32768,47104,51200,147456
.long 1717760,21458528,21463552,1073741824,21285888,21425164,98816,1966080,3072,19731456,19813376,19733504,19815424,21247232,0,0,21457932,21450752,21109120,21259904,1065353216,4399104,2048,1024,512,13897728,13895680,20142080,21452800,21446656,21463040,0,6803840,6885760,6967680,128000,21553152,21553152,21553152,1779200,13968896,19398656,19429376,13508608,13520896,19460096,13553664,1700960,0,0,1024,21457920,139520,139264,256,0,112640,102400,92160,128000,149504,143360,0,30720
.long 1751040,21462528,21451264,21284320,21282816,21429248,369152,1966080,1280,17868800,17869824,17870848,17871872,0,0,1073741824,21462016,21450752,21149696,21226624,1065353216,6883328,512,20480,10240,13504512,13502464,20463616,21453824,21426176,21442560,0,3960320,4042240,4124160,81920,21553152,21553152,21553152,1666560,13561344,17821696,17852416,13713408,13725696,18067456,13811712,1720800,0,0,1024,21462016,0,256,139264,139520,97280,117760,138240,81920,32768,47104,51200,147456
.long 1753600,21462560,21455360,1073741824,21283840,21429252,1433600,1966080,1280,16956416,16957440,16958464,16959488,0,0,1073741824,21462020,21450752,21149824,21267584,1065353216,6924288,512,20480,10240,13643776,13641728,20465664,21453824,21442560,21458944,0,4206080,4288000,4369920,97280,21553152,21553152,21553152,1707520,13700608,17883136,17913856,13737984,13750272,18067456,13832192,1741280,0,0,1024,21462016,256,0,139520,139264,81920,133120,122880,97280,149504,143360,0,30720
.long 1756160,21462592,21459456,1073741824,21284864,21429256,492288,819200,1280,18481152,18825216,18826240,18827264,0,0,1073741824,21462024,21450752,21149952,21229184,1065353216,6965248,512,20480,10240,13783040,13780992,20467712,21453824,21431296,21447680,0,6560640,6642560,6724480,112640,21553152,21553152,21553152,1748480,13839872,17944576,17975296,13762560,13774848,18067456,13811712,1761760,0,0,1024,21462016,139264,139520,0,256,128000,87040,107520,112640,32768,47104,51200,147456
.long 1758720,21462624,21463552,1073741824,21285888,21429260,197120,1966080,3072,19735552,19817472,19737600,19819520,21247488,0,0,21462028,21450752,21150080,21270144,1065353216,7006208,512,20480,10240,13922304,13920256,20469760,21453824,21447680,21464064,0,6806400,6888320,6970240,128000,21553152,21553152,21553152,1789440,13979136,18006016,18036736,13787136,13799424,18067456,13832192,1782240,0,0,1024,21462016,139520,139264,256,0,112640,102400,92160,128000,149504,143360,0,30720
.long 1792000,21466624,21451264,21284336,21282816,21433344,369280,1966080,1280,18215936,18216960,18217984,18219008,0,0,1073741824,21466112,21450752,21190656,21236864,1065353216,9502720,512,20480,10240,13529088,13527040,20791296,21454848,21427200,21443584,0,3970560,4052480,4134400,81920,21553152,21553152,21553152,1676800,13571584,19214336,19245056,13713408,13725696,19460096,13811712,1721440,0,0,1024,21466112,0,256,139264,139520,97280,117760,138240,81920,32768,47104,51200,147456
.long 1794560,21466656,21455360,1073741824,21283840,21433348,1433728,1966080,1280,16960512,17304576,17305600,17306624,0,0,1073741824,21466116,21450752,21190784,21277824,1065353216,9543680,512,20480,10240,13668352,13666304,20793344,21454848,21443584,21459968,0,4216320,4298240,4380160,97280,21553152,21553152,21553152,1717760,13710848,19275776,19306496,13737984,13750272,19460096,13832192,1741920,0,0,1024,21466112,256,0,139520,139264,81920,133120,122880,97280,149504,143360,0,30720
.long 1797120,21466688,21459456,1073741824,21284864,21433352,492416,819200,1280,18828288,18829312,19173376,19174400,0,0,1073741824,21466120,21450752,21190912,21239424,1065353216,9584640,512,20480,10240,13807616,13805568,20795392,21454848,21432320,21448704,0,6563200,6645120,6727040,112640,21553152,21553152,21553152,1758720,13850112,19337216,19367936,13762560,13774848,19460096,13811712,1762400,0,0,1024,21466112,139264,139520,0,256,128000,87040,107520,112640,32768,47104,51200,147456
.long 1799680,21466720,21463552,1073741824,21285888,21433356,295424,1966080,3072,19739648,19821568,19741696,19823616,21247744,0,0,21466124,21450752,21191040,21280384,1065353216,9625600,512,20480,10240,13946880,13944832,20797440,21454848,21448704,21465088,0,6808960,6890880,6972800,128000,21553152,21553152,21553152,1799680,13989376,19398656,19429376,13787136,13799424,19460096,13832192,1782880,0,0,1024,21466112,139520,139264,256,0,112640,102400,92160,128000,149504,143360,0,30720
.long 491520,21336576,21336576,21284352,21282816,21286912,369408,1966080,1280,18220032,18564096,18565120,18566144,0,0,1073741824,21336064,21336064,20873216,21200896,1051011932,491520,2048,1024,512,9535488,9539584,19562496,21336064,21308416,21324800,0,2785280,2867200,2949120,81920,21553152,21553152,21553152,491520,9633792,16807936,16777216,9547776,9535488,17022976,9633792,491520,0,0,1536,21336064,0,256,139264,139520,97280,117760,138240,81920,32768,47104,51200,147456
.long 494080,21336608,21340672,1073741824,21283840,21286916,1433856,1966080,1280,17307648,17308672,17652736,17653760,0,0,1073741824,21336068,21336064,20873344,21241856,1051011932,532480,2048,1024,512,9674752,9678848,19564544,21336064,21324800,21341184,0,3031040,3112960,3194880,97280,21553152,21553152,21553152,532480,9773056,16869376,16838656,9572352,9560064,17022976,9654272,512000,0,0,1536,21336064,256,0,139520,139264,81920,133120,122880,97280,149504,143360,0,30720
.long 496640,21336640,21344768,1073741824,21284864,21286920,492544,819200,1280,19175424,19176448,19177472,19521536,0,0,1073741824,21336072,21336064,20873472,21203456,1051011932,573440,2048,1024,512,9814016,9818112,19566592,21336064,21313536,21329920,0,5406720,5488640,5570560,112640,21553152,21553152,21553152,573440,9912320,16930816,16900096,9596928,9584640,17022976,9633792,532480,0,0,1536,21336064,139264,139520,0,256,128000,87040,107520,112640,32768,47104,51200,147456
.long 499200,21336672,21348864,1073741824,21285888,21286924,393728,1966080,3072,19743744,19825664,19745792,19827712,21248000,0,0,21336076,21336064,20873600,21244416,1051011932,614400,2048,1024,512,9953280,9957376,19568640,21336064,21329920,21346304,0,5652480,5734400,5816320,128000,21553152,21553152,21553152,614400,10051584,16992256,16961536,9621504,9609216,17022976,9654272,552960,0,0,1536,21336064,139520,139264,256,0,112640,102400,92160,128000,149504,143360,0,30720
.long 532480,21340672,21336576,21284368,21282816,21291008,369536,1966080,1280,18567168,18568192,18912256,18913280,0,0,1073741824,21340160,21336064,20914176,21211136,1051011932,524288,2048,1024,512,9560064,9564160,19890176,21337088,21309440,21325824,0,2795520,2877440,2959360,81920,21553152,21553152,21553152,501760,9644032,18200576,18169856,9547776,9535488,18415616,9633792,492160,0,0,1536,21340160,0,256,139264,139520,97280,117760,138240,81920,32768,47104,51200,147456
.long 535040,21340704,21340672,1073741824,21283840,21291012,1433984,1966080,1280,17654784,17655808,17656832,18000896,0,0,1073741824,21340164,21336064,20914304,21252096,1051011932,565248,2048,1024,512,9699328,9703424,19892224,21337088,21325824,21342208,0,3041280,3123200,3205120,97280,21553152,21553152,21553152,542720,9783296,18262016,18231296,9572352,9560064,18415616,9654272,512640,0,0,1536,21340160,256,0,139520,139264,81920,133120,122880,97280,149504,143360,0,30720
.long 537600,21340736,21344768,1073741824,21284864,21291016,492672,819200,1280,19522560,19523584,19524608,19525632,0,0,1073741824,21340168,21336064,20914432,21213696,1051011932,606208,2048,1024,512,9838592,9842688,19894272,21337088,21314560,21330944,0,5409280,5491200,5573120,112640,21553152,21553152,21553152,583680,9922560,18323456,18292736,9596928,9584640,18415616,9633792,533120,0,0,1536,21340160,139264,139520,0,256,128000,87040,107520,112640,32768,47104,51200,147456
.long 540160,21340768,21348864,1073741824,21285888,21291020,492032,1966080,3072,19747840,19829760,19749888,19831808,21248256,0,0,21340172,21336064,20914560,21254656,1051011932,647168,2048,1024,512,9977856,9981952,19896320,21337088,21330944,21347328,0,5655040,5736960,5818880,128000,21553152,21553152,21553152,624640,10061824,18384896,18354176,9621504,9609216,18415616,9654272,553600,0,0,1536,21340160,139520,139264,256,0,112640,102400,92160,128000,149504,143360,0,30720
.long 573440,21344768,21336576,21284384,21282816,21295104,369664,1966080,1280,18914304,18915328,18916352,19260416,0,0,1073741824,21344256,21336064,20955136,21221376,1065353216,3137536,2048,1024,512,9584640,9588736,20217856,21338112,21310464,21326848,0,2805760,2887680,2969600,81920,21553152,21553152,21553152,512000,9654272,16807936,16777216,9826304,9814016,17022976,9912320,573440,0,0,1536,21344256,0,256,139264,139520,97280,117760,138240,81920,32768,47104,51200,147456
.long 576000,21344800,21340672,1073741824,21283840,21295108,1434112,1966080,1280,18001920,18002944,18003968,18004992,0,0,1073741824,21344260,21336064,20955264,21262336,1065353216,3178496,2048,1024,512,9723904,9728000,20219904,21338112,21326848,21343232,0,3051520,3133440,3215360,97280,21553152,21553152,21553152,552960,9793536,16869376,16838656,9850880,9838592,17022976,9932800,593920,0,0,1536,21344256,256,0,139520,139264,81920,133120,122880,97280,149504,143360,0,30720
.long 578560,21344832,21344768,1073741824,21284864,21295112,532480,819200,1280,17089536,17090560,17091584,17092608,0,0,1073741824,21344264,21336064,20955392,21223936,1065353216,3219456,2048,1024,512,9863168,9867264,20221952,21338112,21315584,21331968,0,5411840,5493760,5575680,112640,21553152,21553152,21553152,593920,9932800,16930816,16900096,9875456,9863168,17022976,9912320,614400,0,0,1536,21344256,139264,139520,0,256,128000,87040,107520,112640,32768,47104,51200,147456
.long 581120,21344864,21348864,1073741824,21285888,21295116,590336,1966080,3072,19751936,19833856,19753984,19835904,21248512,0,0,21344268,21336064,20955520,21264896,1065353216,3260416,2048,1024,512,10002432,10006528,20224000,21338112,21331968,21348352,0,5657600,5739520,5821440,128000,21553152,21553152,21553152,634880,10072064,16992256,16961536,9900032,9887744,17022976,9932800,634880,0,0,1536,21344256,139520,139264,256,0,112640,102400,92160,128000,149504,143360,0,30720
.long 614400,21348864,21336576,21284400,21282816,21299200,369792,1966080,1280,19261440,19262464,19263488,19264512,0,0,1073741824,21348352,21336064,20996096,21231616,1065353216,5738496,512,20480,10240,9609216,9613312,20545536,21339136,21311488,21327872,1024,2816000,2897920,2979840,81920,21553152,21553152,21553152,522240,9664512,18200576,18169856,9826304,9814016,18415616,9912320,574080,0,0,1536,21348352,0,256,139264,139520,97280,117760,138240,81920,32768,47104,51200,147456
.long 616960,21348896,21340672,1073741824,21283840,21299204,1434240,1966080,1280,18349056,18350080,18351104,18352128,0,0,1073741824,21348356,21336064,20996224,21272576,1065353216,5779456,512,20480,10240,9748480,9752576,20547584,21339136,21327872,21344256,1024,3061760,3143680,3225600,97280,21553152,21553152,21553152,563200,9803776,18262016,18231296,9850880,9838592,18415616,9932800,594560,0,0,1536,21348352,256,0,139520,139264,81920,133120,122880,97280,149504,143360,0,30720
.long 619520,21348928,21344768,1073741824,21284864,21299208,532608,819200,1280,17093632,17437696,17438720,17439744,0,0,1073741824,21348360,21336064,20996352,21234176,1065353216,5820416,512,20480,10240,9887744,9891840,20549632,21339136,21316608,21332992,1024,5414400,5496320,5578240,112640,21553152,21553152,21553152,604160,9943040,18323456,18292736,9875456,9863168,18415616,9912320,615040,0,0,1536,21348352,139264,139520,0,256,128000,87040,107520,112640,32768,47104,51200,147456
.long 622080,21348960,21348864,1073741824,21285888,21299212,688640,1966080,3072,19756032,19837952,19758080,19840000,21248768,0,0,21348364,21336064,20996480,21275136,1065353216,5861376,512,20480,10240,10027008,10031104,20551680,21339136,21332992,21349376,1024,5660160,5742080,5824000,128000,21553152,21553152,21553152,645120,10082304,18384896,18354176,9900032,9887744,18415616,9932800,635520,0,0,1536,21348352,139520,139264,256,0,112640,102400,92160,128000,149504,143360,0,30720
.long 1802240,21467648,21467648,21284416,21282816,21417984,409600,1966080,1280,16828416,16829440,16830464,16831488,0,0,1073741824,21467136,21467136,21037056,21200896,1051011932,1802240,2048,1024,512,13991936,13996032,19562496,21467136,21439488,21455872,0,4096000,4177920,4259840,81920,21553152,21553152,21553152,1802240,14090240,16807936,16777216,14004224,13991936,17022976,14090240,1802240,0,0,1536,21467136,0,256,139264,139520,97280,117760,138240,81920,32768,47104,51200,147456
.long 1804800,21467680,21471744,1073741824,21283840,21417988,1434368,1966080,1280,18353152,18697216,18698240,18699264,0,0,1073741824,21467140,21467136,21037184,21241856,1051011932,1843200,2048,1024,512,14131200,14135296,19564544,21467136,21455872,21472256,0,4341760,4423680,4505600,97280,21553152,21553152,21553152,1843200,14229504,16869376,16838656,14028800,14016512,17022976,14110720,1822720,0,0,1536,21467136,256,0,139520,139264,81920,133120,122880,97280,149504,143360,0,30720
.long 1807360,21467712,21475840,1073741824,21284864,21417992,532736,819200,1280,17440768,17441792,17785856,17786880,0,0,1073741824,21467144,21467136,21037312,21203456,1051011932,1884160,2048,1024,512,14270464,14274560,19566592,21467136,21444608,21460992,0,6717440,6799360,6881280,112640,21553152,21553152,21553152,1884160,14368768,16930816,16900096,14053376,14041088,17022976,14090240,1843200,0,0,1536,21467136,139264,139520,0,256,128000,87040,107520,112640,32768,47104,51200,147456
.long 1809920,21467744,21479936,1073741824,21285888,21417996,786944,1966080,3072,19760128,19842048,19762176,19844096,21249024,0,0,21467148,21467136,21037440,21244416,1051011932,1925120,2048,1024,512,14409728,14413824,19568640,21467136,21460992,21477376,0,6963200,7045120,7127040,128000,21553152,21553152,21553152,1925120,14508032,16992256,16961536,14077952,14065664,17022976,14110720,1863680,0,0,1536,21467136,139520,139264,256,0,112640,102400,92160,128000,149504,143360,0,30720
.long 1843200,21471744,21467648,21284432,21282816,21422080,409728,1966080,1280,16832512,17176576,17177600,17178624,0,0,1073741824,21471232,21467136,21078016,21211136,1051011932,1835008,2048,1024,512,14016512,14020608,19890176,21468160,21440512,21456896,0,4106240,4188160,4270080,81920,21553152,21553152,21553152,1812480,14100480,18200576,18169856,14004224,13991936,18415616,14090240,1802880,0,0,1536,21471232,0,256,139264,139520,97280,117760,138240,81920,32768,47104,51200,147456
.long 1845760,21471776,21471744,1073741824,21283840,21422084,1434496,1966080,1280,18700288,18701312,19045376,19046400,0,0,1073741824,21471236,21467136,21078144,21252096,1051011932,1875968,2048,1024,512,14155776,14159872,19892224,21468160,21456896,21473280,0,4352000,4433920,4515840,97280,21553152,21553152,21553152,1853440,14239744,18262016,18231296,14028800,14016512,18415616,14110720,1823360,0,0,1536,21471232,256,0,139520,139264,81920,133120,122880,97280,149504,143360,0,30720
.long 1848320,21471808,21475840,1073741824,21284864,21422088,532864,819200,1280,17787904,17788928,17789952,18134016,0,0,1073741824,21471240,21467136,21078272,21213696,1051011932,1916928,2048,1024,512,14295040,14299136,19894272,21468160,21445632,21462016,0,6720000,6801920,6883840,112640,21553152,21553152,21553152,1894400,14379008,18323456,18292736,14053376,14041088,18415616,14090240,1843840,0,0,1536,21471232,139264,139520,0,256,128000,87040,107520,112640,32768,47104,51200,147456
.long 1850880,21471840,21479936,1073741824,21285888,21422092,885248,1966080,3072,19764224,19846144,19766272,19848192,21249280,0,0,21471244,21467136,21078400,21254656,1051011932,1957888,2048,1024,512,14434304,14438400,19896320,21468160,21462016,21478400,0,6965760,7047680,7129600,128000,21553152,21553152,21553152,1935360,14518272,18384896,18354176,14077952,14065664,18415616,14110720,1864320,0,0,1536,21471232,139520,139264,256,0,112640,102400,92160,128000,149504,143360,0,30720
.long 1884160,21475840,21467648,21284448,21282816,21426176,409856,1966080,1280,17179648,17180672,17524736,17525760,0,0,1073741824,21475328,21467136,21118976,21221376,1065353216,4448256,2048,1024,512,14041088,14045184,20217856,21469184,21441536,21457920,0,4116480,4198400,4280320,81920,21553152,21553152,21553152,1822720,14110720,16807936,16777216,14282752,14270464,17022976,14368768,1884160,0,0,1536,21475328,0,256,139264,139520,97280,117760,138240,81920,32768,47104,51200,147456
.long 1886720,21475872,21471744,1073741824,21283840,21426180,1434624,1966080,1280,19047424,19048448,19049472,19393536,0,0,1073741824,21475332,21467136,21119104,21262336,1065353216,4489216,2048,1024,512,14180352,14184448,20219904,21469184,21457920,21474304,0,4362240,4444160,4526080,97280,21553152,21553152,21553152,1863680,14249984,16869376,16838656,14307328,14295040,17022976,14389248,1904640,0,0,1536,21475328,256,0,139520,139264,81920,133120,122880,97280,149504,143360,0,30720
.long 1889280,21475904,21475840,1073741824,21284864,21426184,532992,819200,1280,18135040,18136064,18137088,18138112,0,0,1073741824,21475336,21467136,21119232,21223936,1065353216,4530176,2048,1024,512,14319616,14323712,20221952,21469184,21446656,21463040,0,6722560,6804480,6886400,112640,21553152,21553152,21553152,1904640,14389248,16930816,16900096,14331904,14319616,17022976,14368768,1925120,0,0,1536,21475328,139264,139520,0,256,128000,87040,107520,112640,32768,47104,51200,147456
.long 1891840,21475936,21479936,1073741824,21285888,21426188,983552,1966080,3072,19768320,19850240,19770368,19852288,21249536,0,0,21475340,21467136,21119360,21264896,1065353216,4571136,2048,1024,512,14458880,14462976,20224000,21469184,21463040,21479424,0,6968320,7050240,7132160,128000,21553152,21553152,21553152,1945600,14528512,16992256,16961536,14356480,14344192,17022976,14389248,1945600,0,0,1536,21475328,139520,139264,256,0,112640,102400,92160,128000,149504,143360,0,30720
.long 1925120,21479936,21467648,21284464,21282816,21430272,409984,1966080,1280,17526784,17527808,17528832,17872896,0,0,1073741824,21479424,21467136,21159936,21231616,1065353216,7049216,512,20480,10240,14065664,14069760,20545536,21470208,21442560,21458944,1024,4126720,4208640,4290560,81920,21553152,21553152,21553152,1832960,14120960,18200576,18169856,14282752,14270464,18415616,14368768,1884800,0,0,1536,21479424,0,256,139264,139520,97280,117760,138240,81920,32768,47104,51200,147456
.long 1927680,21479968,21471744,1073741824,21283840,21430276,1434752,1966080,1280,19394560,19395584,19396608,19397632,0,0,1073741824,21479428,21467136,21160064,21272576,1065353216,7090176,512,20480,10240,14204928,14209024,20547584,21470208,21458944,21475328,1024,4372480,4454400,4536320,97280,21553152,21553152,21553152,1873920,14260224,18262016,18231296,14307328,14295040,18415616,14389248,1905280,0,0,1536,21479424,256,0,139520,139264,81920,133120,122880,97280,149504,143360,0,30720
.long 1930240,21480000,21475840,1073741824,21284864,21430280,533120,819200,1280,18482176,18483200,18484224,18485248,0,0,1073741824,21479432,21467136,21160192,21234176,1065353216,7131136,512,20480,10240,14344192,14348288,20549632,21470208,21447680,21464064,1024,6725120,6807040,6888960,112640,21553152,21553152,21553152,1914880,14399488,18323456,18292736,14331904,14319616,18415616,14368768,1925760,0,0,1536,21479424,139264,139520,0,256,128000,87040,107520,112640,32768,47104,51200,147456
.long 1932800,21480032,21479936,1073741824,21285888,21430284,1081856,1966080,3072,19772416,19854336,19774464,19856384,21249792,0,0,21479436,21467136,21160320,21275136,1065353216,7172096,512,20480,10240,14483456,14487552,20551680,21470208,21464064,21480448,1024,6970880,7052800,7134720,128000,21553152,21553152,21553152,1955840,14538752,18384896,18354176,14356480,14344192,18415616,14389248,1946240,0,0,1536,21479424,139520,139264,256,0,112640,102400,92160,128000,149504,143360,0,30720
.long 501760,21337600,21336576,21284480,21282816,21287936,410112,1966080,1280,17873920,17874944,17875968,17876992,0,0,1073741824,21337088,21336064,20883456,21201024,1051011932,499712,2048,1024,512,9543680,9541632,19644416,21336064,21308416,21324800,0,2787840,2869760,2951680,81920,21553152,21553152,21553152,494080,9636352,17156096,17125376,9547776,9535488,17371136,9633792,491680,0,0,1536,21337088,0,256,139264,139520,97280,117760,138240,81920,32768,47104,51200,147456
.long 504320,21337632,21340672,1073741824,21283840,21287940,1474560,1966080,1280,16961536,16962560,16963584,16964608,0,0,1073741824,21337092,21336064,20883584,21241984,1051011932,540672,2048,1024,512,9682944,9680896,19646464,21336064,21324800,21341184,0,3033600,3115520,3197440,97280,21553152,21553152,21553152,535040,9775616,17217536,17186816,9572352,9560064,17371136,9654272,512160,0,0,1536,21337088,256,0,139520,139264,81920,133120,122880,97280,149504,143360,0,30720
.long 506880,21337664,21344768,1073741824,21284864,21287944,533248,819200,1280,18486272,18830336,18831360,18832384,0,0,1073741824,21337096,21336064,20883712,21203584,1051011932,581632,2048,1024,512,9822208,9820160,19648512,21336064,21313536,21329920,0,5407360,5489280,5571200,112640,21553152,21553152,21553152,576000,9914880,17278976,17248256,9596928,9584640,17371136,9633792,532640,0,0,1536,21337088,139264,139520,0,256,128000,87040,107520,112640,32768,47104,51200,147456
.long 509440,21337696,21348864,1073741824,21285888,21287948,1180160,1966080,3072,19776512,19858432,19778560,19860480,21250048,0,0,21337100,21336064,20883840,21244544,1051011932,622592,2048,1024,512,9961472,9959424,19650560,21336064,21329920,21346304,0,5653120,5735040,5816960,128000,21553152,21553152,21553152,616960,10054144,17340416,17309696,9621504,9609216,17371136,9654272,553120,0,0,1536,21337088,139520,139264,256,0,112640,102400,92160,128000,149504,143360,0,30720
.long 542720,21341696,21336576,21284496,21282816,21292032,410240,1966080,1280,18221056,18222080,18223104,18224128,0,0,1073741824,21341184,21336064,20924416,21211264,1065353216,3112960,2048,1024,512,9568256,9566208,19972096,21337088,21309440,21325824,0,2798080,2880000,2961920,81920,21553152,21553152,21553152,504320,9646592,18548736,18518016,9547776,9535488,18763776,9633792,492320,0,0,1536,21341184,0,256,139264,139520,97280,117760,138240,81920,32768,47104,51200,147456
.long 545280,21341728,21340672,1073741824,21283840,21292036,1474688,1966080,1280,16965632,17309696,17310720,17311744,0,0,1073741824,21341188,21336064,20924544,21252224,1065353216,3153920,2048,1024,512,9707520,9705472,19974144,21337088,21325824,21342208,0,3043840,3125760,3207680,97280,21553152,21553152,21553152,545280,9785856,18610176,18579456,9572352,9560064,18763776,9654272,512800,0,0,1536,21341184,256,0,139520,139264,81920,133120,122880,97280,149504,143360,0,30720
.long 547840,21341760,21344768,1073741824,21284864,21292040,533376,819200,1280,18833408,18834432,19178496,19179520,0,0,1073741824,21341192,21336064,20924672,21213824,1065353216,3194880,2048,1024,512,9846784,9844736,19976192,21337088,21314560,21330944,0,5409920,5491840,5573760,112640,21553152,21553152,21553152,586240,9925120,18671616,18640896,9596928,9584640,18763776,9633792,533280,0,0,1536,21341184,139264,139520,0,256,128000,87040,107520,112640,32768,47104,51200,147456
.long 550400,21341792,21348864,1073741824,21285888,21292044,1278464,1966080,3072,19780608,19862528,19782656,19864576,21250304,0,0,21341196,21336064,20924800,21254784,1065353216,3235840,2048,1024,512,9986048,9984000,19978240,21337088,21330944,21347328,0,5655680,5737600,5819520,128000,21553152,21553152,21553152,627200,10064384,18733056,18702336,9621504,9609216,18763776,9654272,553760,0,0,1536,21341184,139520,139264,256,0,112640,102400,92160,128000,149504,143360,0,30720
.long 583680,21345792,21336576,21284512,21282816,21296128,410368,1966080,1280,18225152,18569216,18570240,18571264,0,0,1073741824,21345280,21336064,20965376,21221504,1065353216,3145728,2048,1024,512,9592832,9590784,20299776,21338112,21310464,21326848,1024,2808320,2890240,2972160,81920,21553152,21553152,21553152,514560,9656832,17156096,17125376,9826304,9814016,17371136,9912320,573600,0,0,1536,21345280,0,256,139264,139520,97280,117760,138240,81920,32768,47104,51200,147456
.long 586240,21345824,21340672,1073741824,21283840,21296132,1474816,1966080,1280,17312768,17313792,17657856,17658880,0,0,1073741824,21345284,21336064,20965504,21262464,1065353216,3186688,2048,1024,512,9732096,9730048,20301824,21338112,21326848,21343232,1024,3054080,3136000,3217920,97280,21553152,21553152,21553152,555520,9796096,17217536,17186816,9850880,9838592,17371136,9932800,594080,0,0,1536,21345280,256,0,139520,139264,81920,133120,122880,97280,149504,143360,0,30720
.long 588800,21345856,21344768,1073741824,21284864,21296136,533504,819200,1280,19180544,19181568,19182592,19526656,0,0,1073741824,21345288,21336064,20965632,21224064,1065353216,3227648,2048,1024,512,9871360,9869312,20303872,21338112,21315584,21331968,1024,5412480,5494400,5576320,112640,21553152,21553152,21553152,596480,9935360,17278976,17248256,9875456,9863168,17371136,9912320,614560,0,0,1536,21345280,139264,139520,0,256,128000,87040,107520,112640,32768,47104,51200,147456
.long 591360,21345888,21348864,1073741824,21285888,21296140,1376768,1966080,3072,19784704,19866624,19786752,19868672,21250560,0,0,21345292,21336064,20965760,21265024,1065353216,3268608,2048,1024,512,10010624,10008576,20305920,21338112,21331968,21348352,1024,5658240,5740160,5822080,128000,21553152,21553152,21553152,637440,10074624,17340416,17309696,9900032,9887744,17371136,9932800,635040,0,0,1536,21345280,139520,139264,256,0,112640,102400,92160,128000,149504,143360,0,30720
.long 624640,21349888,21336576,21284528,21282816,21300224,410496,1966080,1280,18572288,18573312,18917376,18918400,0,0,1073741824,21349376,21336064,21006336,21231744,1065353216,5740544,512,20480,10240,9617408,9615360,20627456,21340160,21312512,21328896,0,2818560,2900480,2982400,81920,21553152,21553152,21553152,524800,9667072,18548736,18518016,9826304,9814016,18763776,9912320,574240,0,0,1536,21349376,0,256,139264,139520,97280,117760,138240,81920,32768,47104,51200,147456
.long 627200,21349920,21340672,1073741824,21283840,21300228,1474944,1966080,1280,17659904,17660928,17661952,18006016,0,0,1073741824,21349380,21336064,21006464,21272704,1065353216,5781504,512,20480,10240,9756672,9754624,20629504,21340160,21328896,21345280,0,3064320,3146240,3228160,97280,21553152,21553152,21553152,565760,9806336,18610176,18579456,9850880,9838592,18763776,9932800,594720,0,0,1536,21349376,256,0,139520,139264,81920,133120,122880,97280,149504,143360,0,30720
.long 629760,21349952,21344768,1073741824,21284864,21300232,533632,819200,1280,19527680,19528704,19529728,19530752,0,0,1073741824,21349384,21336064,21006592,21234304,1065353216,5822464,512,20480,10240,9895936,9893888,20631552,21340160,21317632,21334016,0,5415040,5496960,5578880,112640,21553152,21553152,21553152,606720,9945600,18671616,18640896,9875456,9863168,18763776,9912320,615200,0,0,1536,21349376,139264,139520,0,256,128000,87040,107520,112640,32768,47104,51200,147456
.long 632320,21349984,21348864,1073741824,21285888,21300236,1475072,1966080,3072,19788800,19870720,19790848,19872768,21250816,0,0,21349388,21336064,21006720,21275264,1065353216,5863424,512,20480,10240,10035200,10033152,20633600,21340160,21334016,21350400,0,5660800,5742720,5824640,128000,21553152,21553152,21553152,647680,10084864,18733056,18702336,9900032,9887744,18763776,9932800,635680,0,0,1536,21349376,139520,139264,256,0,112640,102400,92160,128000,149504,143360,0,30720
.long 1812480,21468672,21467648,21284544,21282816,21419008,410624,1966080,1280,18919424,18920448,18921472,19265536,0,0,1073741824,21468160,21467136,21047296,21201024,1051011932,1810432,2048,1024,512,14000128,13998080,19644416,21467136,21439488,21455872,0,4098560,4180480,4262400,81920,21553152,21553152,21553152,1804800,14092800,17156096,17125376,14004224,13991936,17371136,14090240,1802400,0,0,1536,21468160,0,256,139264,139520,97280,117760,138240,81920,32768,47104,51200,147456
.long 1815040,21468704,21471744,1073741824,21283840,21419012,1475072,1966080,1280,18007040,18008064,18009088,18010112,0,0,1073741824,21468164,21467136,21047424,21241984,1051011932,1851392,2048,1024,512,14139392,14137344,19646464,21467136,21455872,21472256,0,4344320,4426240,4508160,97280,21553152,21553152,21553152,1845760,14232064,17217536,17186816,14028800,14016512,17371136,14110720,1822880,0,0,1536,21468160,256,0,139520,139264,81920,133120,122880,97280,149504,143360,0,30720
.long 1817600,21468736,21475840,1073741824,21284864,21419016,573440,819200,1280,17094656,17095680,17096704,17097728,0,0,1073741824,21468168,21467136,21047552,21203584,1051011932,1892352,2048,1024,512,14278656,14276608,19648512,21467136,21444608,21460992,0,6718080,6800000,6881920,112640,21553152,21553152,21553152,1886720,14371328,17278976,17248256,14053376,14041088,17371136,14090240,1843360,0,0,1536,21468160,139264,139520,0,256,128000,87040,107520,112640,32768,47104,51200,147456
.long 1820160,21468768,21479936,1073741824,21285888,21419020,1573376,1966080,3072,19792896,19874816,19794944,19876864,21251072,0,0,21468172,21467136,21047680,21244544,1051011932,1933312,2048,1024,512,14417920,14415872,19650560,21467136,21460992,21477376,0,6963840,7045760,7127680,128000,21553152,21553152,21553152,1927680,14510592,17340416,17309696,14077952,14065664,17371136,14110720,1863840,0,0,1536,21468160,139520,139264,256,0,112640,102400,92160,128000,149504,143360,0,30720
.long 1853440,21472768,21467648,21284560,21282816,21423104,410752,1966080,1280,19266560,19267584,19268608,19269632,0,0,1073741824,21472256,21467136,21088256,21211264,1065353216,4423680,2048,1024,512,14024704,14022656,19972096,21468160,21440512,21456896,0,4108800,4190720,4272640,81920,21553152,21553152,21553152,1815040,14103040,18548736,18518016,14004224,13991936,18763776,14090240,1803040,0,0,1536,21472256,0,256,139264,139520,97280,117760,138240,81920,32768,47104,51200,147456
.long 1856000,21472800,21471744,1073741824,21283840,21423108,1475200,1966080,1280,18354176,18355200,18356224,18357248,0,0,1073741824,21472260,21467136,21088384,21252224,1065353216,4464640,2048,1024,512,14163968,14161920,19974144,21468160,21456896,21473280,0,4354560,4436480,4518400,97280,21553152,21553152,21553152,1856000,14242304,18610176,18579456,14028800,14016512,18763776,14110720,1823520,0,0,1536,21472256,256,0,139520,139264,81920,133120,122880,97280,149504,143360,0,30720
.long 1858560,21472832,21475840,1073741824,21284864,21423112,573568,819200,1280,17098752,17442816,17443840,17444864,0,0,1073741824,21472264,21467136,21088512,21213824,1065353216,4505600,2048,1024,512,14303232,14301184,19976192,21468160,21445632,21462016,0,6720640,6802560,6884480,112640,21553152,21553152,21553152,1896960,14381568,18671616,18640896,14053376,14041088,18763776,14090240,1844000,0,0,1536,21472256,139264,139520,0,256,128000,87040,107520,112640,32768,47104,51200,147456
.long 1861120,21472864,21479936,1073741824,21285888,21423116,1671680,1966080,3072,19796992,19878912,19799040,19880960,21251328,0,0,21472268,21467136,21088640,21254784,1065353216,4546560,2048,1024,512,14442496,14440448,19978240,21468160,21462016,21478400,0,6966400,7048320,7130240,128000,21553152,21553152,21553152,1937920,14520832,18733056,18702336,14077952,14065664,18763776,14110720,1864480,0,0,1536,21472256,139520,139264,256,0,112640,102400,92160,128000,149504,143360,0,30720
.long 1894400,21476864,21467648,21284576,21282816,21427200,450560,1966080,1280,16833536,16834560,16835584,16836608,0,0,1073741824,21476352,21467136,21129216,21221504,1065353216,4456448,2048,1024,512,14049280,14047232,20299776,21469184,21441536,21457920,1024,4119040,4200960,4282880,81920,21553152,21553152,21553152,1825280,14113280,17156096,17125376,14282752,14270464,17371136,14368768,1884320,0,0,1536,21476352,0,256,139264,139520,97280,117760,138240,81920,32768,47104,51200,147456
.long 1896960,21476896,21471744,1073741824,21283840,21427204,1475328,1966080,1280,18358272,18702336,18703360,18704384,0,0,1073741824,21476356,21467136,21129344,21262464,1065353216,4497408,2048,1024,512,14188544,14186496,20301824,21469184,21457920,21474304,1024,4364800,4446720,4528640,97280,21553152,21553152,21553152,1866240,14252544,17217536,17186816,14307328,14295040,17371136,14389248,1904800,0,0,1536,21476352,256,0,139520,139264,81920,133120,122880,97280,149504,143360,0,30720
.long 1899520,21476928,21475840,1073741824,21284864,21427208,573696,819200,1280,17445888,17446912,17790976,17792000,0,0,1073741824,21476360,21467136,21129472,21224064,1065353216,4538368,2048,1024,512,14327808,14325760,20303872,21469184,21446656,21463040,1024,6723200,6805120,6887040,112640,21553152,21553152,21553152,1907200,14391808,17278976,17248256,14331904,14319616,17371136,14368768,1925280,0,0,1536,21476352,139264,139520,0,256,128000,87040,107520,112640,32768,47104,51200,147456
.long 1902080,21476960,21479936,1073741824,21285888,21427212,1769984,1966080,3072,19801088,19883008,19803136,19885056,21251584,0,0,21476364,21467136,21129600,21265024,1065353216,4579328,2048,1024,512,14467072,14465024,20305920,21469184,21463040,21479424,1024,6968960,7050880,7132800,128000,21553152,21553152,21553152,1948160,14531072,17340416,17309696,14356480,14344192,17371136,14389248,1945760,0,0,1536,21476352,139520,139264,256,0,112640,102400,92160,128000,149504,143360,0,30720
.long 1935360,21480960,21467648,21284592,21282816,21431296,450688,1966080,1280,16837632,17181696,17182720,17183744,0,0,1073741824,21480448,21467136,21170176,21231744,1065353216,7051264,512,20480,10240,14073856,14071808,20627456,21471232,21443584,21459968,0,4129280,4211200,4293120,81920,21553152,21553152,21553152,1835520,14123520,18548736,18518016,14282752,14270464,18763776,14368768,1884960,0,0,1536,21480448,0,256,139264,139520,97280,117760,138240,81920,32768,47104,51200,147456
.long 1937920,21480992,21471744,1073741824,21283840,21431300,1475456,1966080,1280,18705408,18706432,19050496,19051520,0,0,1073741824,21480452,21467136,21170304,21272704,1065353216,7092224,512,20480,10240,14213120,14211072,20629504,21471232,21459968,21476352,0,4375040,4456960,4538880,97280,21553152,21553152,21553152,1876480,14262784,18610176,18579456,14307328,14295040,18763776,14389248,1905440,0,0,1536,21480448,256,0,139520,139264,81920,133120,122880,97280,149504,143360,0,30720
.long 1940480,21481024,21475840,1073741824,21284864,21431304,573824,819200,1280,17793024,17794048,17795072,18139136,0,0,1073741824,21480456,21467136,21170432,21234304,1065353216,7133184,512,20480,10240,14352384,14350336,20631552,21471232,21448704,21465088,0,6725760,6807680,6889600,112640,21553152,21553152,21553152,1917440,14402048,18671616,18640896,14331904,14319616,18763776,14368768,1925920,0,0,1536,21480448,139264,139520,0,256,128000,87040,107520,112640,32768,47104,51200,147456
.long 1943040,21481056,21479936,1073741824,21285888,21431308,1868288,1966080,3072,19805184,19887104,19807232,19889152,21251840,0,0,21480460,21467136,21170560,21275264,1065353216,7174144,512,20480,10240,14491648,14489600,20633600,21471232,21465088,21481472,0,6971520,7053440,7135360,128000,21553152,21553152,21553152,1958400,14541312,18733056,18702336,14356480,14344192,18763776,14389248,1946400,0,0,1536,21480448,139520,139264,256,0,112640,102400,92160,128000,149504,143360,0,30720
.long 512000,21338624,21336576,21284608,21282816,21288960,450816,1966080,1280,17184768,17185792,17529856,17530880,0,0,1073741824,21338112,21336064,20893696,21206016,1051011932,507904,2048,1024,512,9547776,9551872,19726336,21336064,21308416,21324800,0,2790400,2872320,2954240,81920,21553152,21553152,21553152,496640,9638912,17504256,17473536,9547776,9535488,17719296,9633792,491840,0,0,1536,21338112,0,256,139264,139520,97280,117760,138240,81920,32768,47104,51200,147456
.long 514560,21338656,21340672,1073741824,21283840,21288964,1475584,1966080,1280,19052544,19053568,19054592,19398656,0,0,1073741824,21338116,21336064,20893824,21246976,1051011932,548864,2048,1024,512,9687040,9691136,19728384,21336064,21324800,21341184,0,3036160,3118080,3200000,97280,21553152,21553152,21553152,537600,9778176,17565696,17534976,9572352,9560064,17719296,9654272,512320,0,0,1536,21338112,256,0,139520,139264,81920,133120,122880,97280,149504,143360,0,30720
.long 517120,21338688,21344768,1073741824,21284864,21288968,573952,819200,1280,18140160,18141184,18142208,18143232,0,0,1073741824,21338120,21336064,20893952,21208576,1051011932,589824,2048,1024,512,9826304,9830400,19730432,21336064,21313536,21329920,0,5408000,5489920,5571840,112640,21553152,21553152,21553152,578560,9917440,17627136,17596416,9596928,9584640,17719296,9633792,532800,0,0,1536,21338112,139264,139520,0,256,128000,87040,107520,112640,32768,47104,51200,147456
.long 519680,21338720,21348864,1073741824,21285888,21288972,896,1966080,3072,19891200,19973120,19893248,19975168,21252096,0,0,21338124,21336064,20894080,21249536,1051011932,630784,2048,1024,512,9965568,9969664,19732480,21336064,21329920,21346304,0,5653760,5735680,5817600,128000,21553152,21553152,21553152,619520,10056704,17688576,17657856,9621504,9609216,17719296,9654272,553280,0,0,1536,21338112,139520,139264,256,0,112640,102400,92160,128000,149504,143360,0,30720
.long 552960,21342720,21336576,21284624,21282816,21293056,450944,1966080,1280,17531904,17532928,17533952,17878016,0,0,1073741824,21342208,21336064,20934656,21216256,1065353216,3121152,2048,1024,512,9572352,9576448,20054016,21337088,21309440,21325824,1024,2800640,2882560,2964480,81920,21553152,21553152,21553152,506880,9649152,18896896,18866176,9547776,9535488,19111936,9633792,492480,0,0,1536,21342208,0,256,139264,139520,97280,117760,138240,81920,32768,47104,51200,147456
.long 555520,21342752,21340672,1073741824,21283840,21293060,1475712,1966080,1280,19399680,19400704,19401728,19402752,0,0,1073741824,21342212,21336064,20934784,21257216,1065353216,3162112,2048,1024,512,9711616,9715712,20056064,21337088,21325824,21342208,1024,3046400,3128320,3210240,97280,21553152,21553152,21553152,547840,9788416,18958336,18927616,9572352,9560064,19111936,9654272,512960,0,0,1536,21342208,256,0,139520,139264,81920,133120,122880,97280,149504,143360,0,30720
.long 558080,21342784,21344768,1073741824,21284864,21293064,574080,819200,1280,18487296,18488320,18489344,18490368,0,0,1073741824,21342216,21336064,20934912,21218816,1065353216,3203072,2048,1024,512,9850880,9854976,20058112,21337088,21314560,21330944,1024,5410560,5492480,5574400,112640,21553152,21553152,21553152,588800,9927680,19019776,18989056,9596928,9584640,19111936,9633792,533440,0,0,1536,21342208,139264,139520,0,256,128000,87040,107520,112640,32768,47104,51200,147456
.long 560640,21342816,21348864,1073741824,21285888,21293068,99200,1966080,3072,19895296,19977216,19897344,19979264,21252352,0,0,21342220,21336064,20935040,21259776,1065353216,3244032,2048,1024,512,9990144,9994240,20060160,21337088,21330944,21347328,1024,5656320,5738240,5820160,128000,21553152,21553152,21553152,629760,10066944,19081216,19050496,9621504,9609216,19111936,9654272,553920,0,0,1536,21342208,139520,139264,256,0,112640,102400,92160,128000,149504,143360,0,30720
.long 593920,21346816,21336576,21284640,21282816,21297152,451072,1966080,1280,17879040,17880064,17881088,17882112,0,0,1073741824,21346304,21336064,20975616,21226496,1065353216,5734400,512,20480,10240,9596928,9601024,20381696,21339136,21311488,21327872,0,2810880,2892800,2974720,81920,21553152,21553152,21553152,517120,9659392,17504256,17473536,9826304,9814016,17719296,9912320,573760,0,0,1536,21346304,0,256,139264,139520,97280,117760,138240,81920,32768,47104,51200,147456
.long 596480,21346848,21340672,1073741824,21283840,21297156,1515520,1966080,1280,16966656,16967680,16968704,16969728,0,0,1073741824,21346308,21336064,20975744,21267456,1065353216,5775360,512,20480,10240,9736192,9740288,20383744,21339136,21327872,21344256,0,3056640,3138560,3220480,97280,21553152,21553152,21553152,558080,9798656,17565696,17534976,9850880,9838592,17719296,9932800,594240,0,0,1536,21346304,256,0,139520,139264,81920,133120,122880,97280,149504,143360,0,30720
.long 599040,21346880,21344768,1073741824,21284864,21297160,574208,819200,1280,18491392,18835456,18836480,18837504,0,0,1073741824,21346312,21336064,20975872,21229056,1065353216,5816320,512,20480,10240,9875456,9879552,20385792,21339136,21316608,21332992,0,5413120,5495040,5576960,112640,21553152,21553152,21553152,599040,9937920,17627136,17596416,9875456,9863168,17719296,9912320,614720,0,0,1536,21346304,139264,139520,0,256,128000,87040,107520,112640,32768,47104,51200,147456
.long 601600,21346912,21348864,1073741824,21285888,21297164,197504,1966080,3072,19899392,19981312,19901440,19983360,21252608,0,0,21346316,21336064,20976000,21270016,1065353216,5857280,512,20480,10240,10014720,10018816,20387840,21339136,21332992,21349376,0,5658880,5740800,5822720,128000,21553152,21553152,21553152,640000,10077184,17688576,17657856,9900032,9887744,17719296,9932800,635200,0,0,1536,21346304,139520,139264,256,0,112640,102400,92160,128000,149504,143360,0,30720
.long 634880,21350912,21336576,21284656,21282816,21301248,451200,1966080,1280,18226176,18227200,18228224,18229248,0,0,1073741824,21350400,21336064,21016576,21236736,1065353216,5742592,512,20480,10240,9621504,9625600,20709376,21340160,21312512,21328896,0,2821120,2903040,2984960,81920,21553152,21553152,21553152,527360,9669632,18896896,18866176,9826304,9814016,19111936,9912320,574400,0,0,1536,21350400,0,256,139264,139520,97280,117760,138240,81920,32768,47104,51200,147456
.long 637440,21350944,21340672,1073741824,21283840,21301252,1515648,1966080,1280,16970752,17314816,17315840,17316864,0,0,1073741824,21350404,21336064,21016704,21277696,1065353216,5783552,512,20480,10240,9760768,9764864,20711424,21340160,21328896,21345280,0,3066880,3148800,3230720,97280,21553152,21553152,21553152,568320,9808896,18958336,18927616,9850880,9838592,19111936,9932800,594880,0,0,1536,21350400,256,0,139520,139264,81920,133120,122880,97280,149504,143360,0,30720
.long 640000,21350976,21344768,1073741824,21284864,21301256,574336,819200,1280,18838528,18839552,19183616,19184640,0,0,1073741824,21350408,21336064,21016832,21239296,1065353216,5824512,512,20480,10240,9900032,9904128,20713472,21340160,21317632,21334016,0,5415680,5497600,5579520,112640,21553152,21553152,21553152,609280,9948160,19019776,18989056,9875456,9863168,19111936,9912320,615360,0,0,1536,21350400,139264,139520,0,256,128000,87040,107520,112640,32768,47104,51200,147456
.long 642560,21351008,21348864,1073741824,21285888,21301260,295808,1966080,3072,19903488,19985408,19905536,19987456,21252864,0,0,21350412,21336064,21016960,21280256,1065353216,5865472,512,20480,10240,10039296,10043392,20715520,21340160,21334016,21350400,0,5661440,5743360,5825280,128000,21553152,21553152,21553152,650240,10087424,19081216,19050496,9900032,9887744,19111936,9932800,635840,0,0,1536,21350400,139520,139264,256,0,112640,102400,92160,128000,149504,143360,0,30720
.long 1822720,21469696,21467648,21284672,21282816,21420032,451328,1966080,1280,18230272,18574336,18575360,18576384,0,0,1073741824,21469184,21467136,21057536,21206016,1051011932,1818624,2048,1024,512,14004224,14008320,19726336,21467136,21439488,21455872,0,4101120,4183040,4264960,81920,21553152,21553152,21553152,1807360,14095360,17504256,17473536,14004224,13991936,17719296,14090240,1802560,0,0,1536,21469184,0,256,139264,139520,97280,117760,138240,81920,32768,47104,51200,147456
.long 1825280,21469728,21471744,1073741824,21283840,21420036,1515776,1966080,1280,17317888,17318912,17662976,17664000,0,0,1073741824,21469188,21467136,21057664,21246976,1051011932,1859584,2048,1024,512,14143488,14147584,19728384,21467136,21455872,21472256,0,4346880,4428800,4510720,97280,21553152,21553152,21553152,1848320,14234624,17565696,17534976,14028800,14016512,17719296,14110720,1823040,0,0,1536,21469184,256,0,139520,139264,81920,133120,122880,97280,149504,143360,0,30720
.long 1827840,21469760,21475840,1073741824,21284864,21420040,574464,819200,1280,19185664,19186688,19187712,19531776,0,0,1073741824,21469192,21467136,21057792,21208576,1051011932,1900544,2048,1024,512,14282752,14286848,19730432,21467136,21444608,21460992,0,6718720,6800640,6882560,112640,21553152,21553152,21553152,1889280,14373888,17627136,17596416,14053376,14041088,17719296,14090240,1843520,0,0,1536,21469184,139264,139520,0,256,128000,87040,107520,112640,32768,47104,51200,147456
.long 1830400,21469792,21479936,1073741824,21285888,21420044,394112,1966080,3072,19907584,19989504,19909632,19991552,21253120,0,0,21469196,21467136,21057920,21249536,1051011932,1941504,2048,1024,512,14422016,14426112,19732480,21467136,21460992,21477376,0,6964480,7046400,7128320,128000,21553152,21553152,21553152,1930240,14513152,17688576,17657856,14077952,14065664,17719296,14110720,1864000,0,0,1536,21469184,139520,139264,256,0,112640,102400,92160,128000,149504,143360,0,30720
.long 1863680,21473792,21467648,21284688,21282816,21424128,451456,1966080,1280,18577408,18578432,18922496,18923520,0,0,1073741824,21473280,21467136,21098496,21216256,1065353216,4431872,2048,1024,512,14028800,14032896,20054016,21468160,21440512,21456896,1024,4111360,4193280,4275200,81920,21553152,21553152,21553152,1817600,14105600,18896896,18866176,14004224,13991936,19111936,14090240,1803200,0,0,1536,21473280,0,256,139264,139520,97280,117760,138240,81920,32768,47104,51200,147456
.long 1866240,21473824,21471744,1073741824,21283840,21424132,1515904,1966080,1280,17665024,17666048,17667072,18011136,0,0,1073741824,21473284,21467136,21098624,21257216,1065353216,4472832,2048,1024,512,14168064,14172160,20056064,21468160,21456896,21473280,1024,4357120,4439040,4520960,97280,21553152,21553152,21553152,1858560,14244864,18958336,18927616,14028800,14016512,19111936,14110720,1823680,0,0,1536,21473280,256,0,139520,139264,81920,133120,122880,97280,149504,143360,0,30720
.long 1868800,21473856,21475840,1073741824,21284864,21424136,574592,819200,1280,19532800,19533824,19534848,19535872,0,0,1073741824,21473288,21467136,21098752,21218816,1065353216,4513792,2048,1024,512,14307328,14311424,20058112,21468160,21445632,21462016,1024,6721280,6803200,6885120,112640,21553152,21553152,21553152,1899520,14384128,19019776,18989056,14053376,14041088,19111936,14090240,1844160,0,0,1536,21473280,139264,139520,0,256,128000,87040,107520,112640,32768,47104,51200,147456
.long 1871360,21473888,21479936,1073741824,21285888,21424140,492416,1966080,3072,19911680,19993600,19913728,19995648,21253376,0,0,21473292,21467136,21098880,21259776,1065353216,4554752,2048,1024,512,14446592,14450688,20060160,21468160,21462016,21478400,1024,6967040,7048960,7130880,128000,21553152,21553152,21553152,1940480,14523392,19081216,19050496,14077952,14065664,19111936,14110720,1864640,0,0,1536,21473280,139520,139264,256,0,112640,102400,92160,128000,149504,143360,0,30720
.long 1904640,21477888,21467648,21284704,21282816,21428224,451584,1966080,1280,18924544,18925568,18926592,19270656,0,0,1073741824,21477376,21467136,21139456,21226496,1065353216,7045120,512,20480,10240,14053376,14057472,20381696,21470208,21442560,21458944,0,4121600,4203520,4285440,81920,21553152,21553152,21553152,1827840,14115840,17504256,17473536,14282752,14270464,17719296,14368768,1884480,0,0,1536,21477376,0,256,139264,139520,97280,117760,138240,81920,32768,47104,51200,147456
.long 1907200,21477920,21471744,1073741824,21283840,21428228,1516032,1966080,1280,18012160,18013184,18014208,18015232,0,0,1073741824,21477380,21467136,21139584,21267456,1065353216,7086080,512,20480,10240,14192640,14196736,20383744,21470208,21458944,21475328,0,4367360,4449280,4531200,97280,21553152,21553152,21553152,1868800,14255104,17565696,17534976,14307328,14295040,17719296,14389248,1904960,0,0,1536,21477376,256,0,139520,139264,81920,133120,122880,97280,149504,143360,0,30720
.long 1909760,21477952,21475840,1073741824,21284864,21428232,614400,819200,1280,17099776,17100800,17101824,17102848,0,0,1073741824,21477384,21467136,21139712,21229056,1065353216,7127040,512,20480,10240,14331904,14336000,20385792,21470208,21447680,21464064,0,6723840,6805760,6887680,112640,21553152,21553152,21553152,1909760,14394368,17627136,17596416,14331904,14319616,17719296,14368768,1925440,0,0,1536,21477376,139264,139520,0,256,128000,87040,107520,112640,32768,47104,51200,147456
.long 1912320,21477984,21479936,1073741824,21285888,21428236,590720,1966080,3072,19915776,19997696,19917824,19999744,21253632,0,0,21477388,21467136,21139840,21270016,1065353216,7168000,512,20480,10240,14471168,14475264,20387840,21470208,21464064,21480448,0,6969600,7051520,7133440,128000,21553152,21553152,21553152,1950720,14533632,17688576,17657856,14356480,14344192,17719296,14389248,1945920,0,0,1536,21477376,139520,139264,256,0,112640,102400,92160,128000,149504,143360,0,30720
.long 1945600,21481984,21467648,21284720,21282816,21432320,451712,1966080,1280,19271680,19272704,19273728,19274752,0,0,1073741824,21481472,21467136,21180416,21236736,1065353216,7053312,512,20480,10240,14077952,14082048,20709376,21471232,21443584,21459968,0,4131840,4213760,4295680,81920,21553152,21553152,21553152,1838080,14126080,18896896,18866176,14282752,14270464,19111936,14368768,1885120,0,0,1536,21481472,0,256,139264,139520,97280,117760,138240,81920,32768,47104,51200,147456
.long 1948160,21482016,21471744,1073741824,21283840,21432324,1516160,1966080,1280,18359296,18360320,18361344,18362368,0,0,1073741824,21481476,21467136,21180544,21277696,1065353216,7094272,512,20480,10240,14217216,14221312,20711424,21471232,21459968,21476352,0,4377600,4459520,4541440,97280,21553152,21553152,21553152,1879040,14265344,18958336,18927616,14307328,14295040,19111936,14389248,1905600,0,0,1536,21481472,256,0,139520,139264,81920,133120,122880,97280,149504,143360,0,30720
.long 1950720,21482048,21475840,1073741824,21284864,21432328,614528,819200,1280,17103872,17447936,17448960,17449984,0,0,1073741824,21481480,21467136,21180672,21239296,1065353216,7135232,512,20480,10240,14356480,14360576,20713472,21471232,21448704,21465088,0,6726400,6808320,6890240,112640,21553152,21553152,21553152,1920000,14404608,19019776,18989056,14331904,14319616,19111936,14368768,1926080,0,0,1536,21481472,139264,139520,0,256,128000,87040,107520,112640,32768,47104,51200,147456
.long 1953280,21482080,21479936,1073741824,21285888,21432332,689024,1966080,3072,19919872,20001792,19921920,20003840,21253888,0,0,21481484,21467136,21180800,21280256,1065353216,7176192,512,20480,10240,14495744,14499840,20715520,21471232,21465088,21481472,0,6972160,7054080,7136000,128000,21553152,21553152,21553152,1960960,14543872,19081216,19050496,14356480,14344192,19111936,14389248,1946560,0,0,1536,21481472,139520,139264,256,0,112640,102400,92160,128000,149504,143360,0,30720
.long 522240,21339648,21336576,21284736,21282816,21289984,491520,1966080,1280,16838656,16839680,16840704,16841728,0,0,1073741824,21339136,21336064,20903936,21206144,1051011932,516096,2048,1024,512,9555968,9553920,19808256,21336064,21308416,21324800,1024,2792960,2874880,2956800,81920,21553152,21553152,21553152,499200,9641472,17852416,17821696,9547776,9535488,18067456,9633792,492000,0,0,1536,21339136,0,256,139264,139520,97280,117760,138240,81920,32768,47104,51200,147456
.long 524800,21339680,21340672,1073741824,21283840,21289988,1516288,1966080,1280,18363392,18707456,18708480,18709504,0,0,1073741824,21339140,21336064,20904064,21247104,1051011932,557056,2048,1024,512,9695232,9693184,19810304,21336064,21324800,21341184,1024,3038720,3120640,3202560,97280,21553152,21553152,21553152,540160,9780736,17913856,17883136,9572352,9560064,18067456,9654272,512480,0,0,1536,21339136,256,0,139520,139264,81920,133120,122880,97280,149504,143360,0,30720
.long 527360,21339712,21344768,1073741824,21284864,21289992,614656,819200,1280,17451008,17452032,17796096,17797120,0,0,1073741824,21339144,21336064,20904192,21208704,1051011932,598016,2048,1024,512,9834496,9832448,19812352,21336064,21313536,21329920,1024,5408640,5490560,5572480,112640,21553152,21553152,21553152,581120,9920000,17975296,17944576,9596928,9584640,18067456,9633792,532960,0,0,1536,21339136,139264,139520,0,256,128000,87040,107520,112640,32768,47104,51200,147456
.long 529920,21339744,21348864,1073741824,21285888,21289996,787328,1966080,3072,19923968,20005888,19926016,20007936,21254144,0,0,21339148,21336064,20904320,21249664,1051011932,638976,2048,1024,512,9973760,9971712,19814400,21336064,21329920,21346304,1024,5654400,5736320,5818240,128000,21553152,21553152,21553152,622080,10059264,18036736,18006016,9621504,9609216,18067456,9654272,553440,0,0,1536,21339136,139520,139264,256,0,112640,102400,92160,128000,149504,143360,0,30720
.long 563200,21343744,21336576,21284752,21282816,21294080,491648,1966080,1280,16842752,17186816,17187840,17188864,0,0,1073741824,21343232,21336064,20944896,21216384,1065353216,3129344,2048,1024,512,9580544,9578496,20135936,21338112,21310464,21326848,0,2803200,2885120,2967040,81920,21553152,21553152,21553152,509440,9651712,19245056,19214336,9547776,9535488,19460096,9633792,492640,0,0,1536,21343232,0,256,139264,139520,97280,117760,138240,81920,32768,47104,51200,147456
.long 565760,21343776,21340672,1073741824,21283840,21294084,1516416,1966080,1280,18710528,18711552,19055616,19056640,0,0,1073741824,21343236,21336064,20945024,21257344,1065353216,3170304,2048,1024,512,9719808,9717760,20137984,21338112,21326848,21343232,0,3048960,3130880,3212800,97280,21553152,21553152,21553152,550400,9790976,19306496,19275776,9572352,9560064,19460096,9654272,513120,0,0,1536,21343232,256,0,139520,139264,81920,133120,122880,97280,149504,143360,0,30720
.long 568320,21343808,21344768,1073741824,21284864,21294088,614784,819200,1280,17798144,17799168,17800192,18144256,0,0,1073741824,21343240,21336064,20945152,21218944,1065353216,3211264,2048,1024,512,9859072,9857024,20140032,21338112,21315584,21331968,0,5411200,5493120,5575040,112640,21553152,21553152,21553152,591360,9930240,19367936,19337216,9596928,9584640,19460096,9633792,533600,0,0,1536,21343232,139264,139520,0,256,128000,87040,107520,112640,32768,47104,51200,147456
.long 570880,21343840,21348864,1073741824,21285888,21294092,885632,1966080,3072,19928064,20009984,19930112,20012032,21254400,0,0,21343244,21336064,20945280,21259904,1065353216,3252224,2048,1024,512,9998336,9996288,20142080,21338112,21331968,21348352,0,5656960,5738880,5820800,128000,21553152,21553152,21553152,632320,10069504,19429376,19398656,9621504,9609216,19460096,9654272,554080,0,0,1536,21343232,139520,139264,256,0,112640,102400,92160,128000,149504,143360,0,30720
.long 604160,21347840,21336576,21284768,21282816,21298176,491776,1966080,1280,17189888,17190912,17534976,17536000,0,0,1073741824,21347328,21336064,20985856,21226624,1065353216,5736448,512,20480,10240,9605120,9603072,20463616,21339136,21311488,21327872,0,2813440,2895360,2977280,81920,21553152,21553152,21553152,519680,9661952,17852416,17821696,9826304,9814016,18067456,9912320,573920,0,0,1536,21347328,0,256,139264,139520,97280,117760,138240,81920,32768,47104,51200,147456
.long 606720,21347872,21340672,1073741824,21283840,21298180,1516544,1966080,1280,19057664,19058688,19059712,19403776,0,0,1073741824,21347332,21336064,20985984,21267584,1065353216,5777408,512,20480,10240,9744384,9742336,20465664,21339136,21327872,21344256,0,3059200,3141120,3223040,97280,21553152,21553152,21553152,560640,9801216,17913856,17883136,9850880,9838592,18067456,9932800,594400,0,0,1536,21347328,256,0,139520,139264,81920,133120,122880,97280,149504,143360,0,30720
.long 609280,21347904,21344768,1073741824,21284864,21298184,614912,819200,1280,18145280,18146304,18147328,18148352,0,0,1073741824,21347336,21336064,20986112,21229184,1065353216,5818368,512,20480,10240,9883648,9881600,20467712,21339136,21316608,21332992,0,5413760,5495680,5577600,112640,21553152,21553152,21553152,601600,9940480,17975296,17944576,9875456,9863168,18067456,9912320,614880,0,0,1536,21347328,139264,139520,0,256,128000,87040,107520,112640,32768,47104,51200,147456
.long 611840,21347936,21348864,1073741824,21285888,21298188,983936,1966080,3072,19932160,20014080,19934208,20016128,21254656,0,0,21347340,21336064,20986240,21270144,1065353216,5859328,512,20480,10240,10022912,10020864,20469760,21339136,21332992,21349376,0,5659520,5741440,5823360,128000,21553152,21553152,21553152,642560,10079744,18036736,18006016,9900032,9887744,18067456,9932800,635360,0,0,1536,21347328,139520,139264,256,0,112640,102400,92160,128000,149504,143360,0,30720
.long 645120,21351936,21336576,21284784,21282816,21302272,491904,1966080,1280,17537024,17538048,17539072,17883136,0,0,1073741824,21351424,21336064,21026816,21236864,1065353216,8355840,512,20480,10240,9629696,9627648,20791296,21340160,21312512,21328896,0,2823680,2905600,2987520,81920,21553152,21553152,21553152,529920,9672192,19245056,19214336,9826304,9814016,19460096,9912320,574560,0,0,1536,21351424,0,256,139264,139520,97280,117760,138240,81920,32768,47104,51200,147456
.long 647680,21351968,21340672,1073741824,21283840,21302276,1516672,1966080,1280,19404800,19405824,19406848,19407872,0,0,1073741824,21351428,21336064,21026944,21277824,1065353216,8396800,512,20480,10240,9768960,9766912,20793344,21340160,21328896,21345280,0,3069440,3151360,3233280,97280,21553152,21553152,21553152,570880,9811456,19306496,19275776,9850880,9838592,19460096,9932800,595040,0,0,1536,21351424,256,0,139520,139264,81920,133120,122880,97280,149504,143360,0,30720
.long 650240,21352000,21344768,1073741824,21284864,21302280,615040,819200,1280,18492416,18493440,18494464,18495488,0,0,1073741824,21351432,21336064,21027072,21239424,1065353216,8437760,512,20480,10240,9908224,9906176,20795392,21340160,21317632,21334016,0,5416320,5498240,5580160,112640,21553152,21553152,21553152,611840,9950720,19367936,19337216,9875456,9863168,19460096,9912320,615520,0,0,1536,21351424,139264,139520,0,256,128000,87040,107520,112640,32768,47104,51200,147456
.long 652800,21352032,21348864,1073741824,21285888,21302284,1082240,1966080,3072,19936256,20018176,19938304,20020224,21254912,0,0,21351436,21336064,21027200,21280384,1065353216,8478720,512,20480,10240,10047488,10045440,20797440,21340160,21334016,21350400,0,5662080,5744000,5825920,128000,21553152,21553152,21553152,652800,10089984,19429376,19398656,9900032,9887744,19460096,9932800,636000,0,0,1536,21351424,139520,139264,256,0,112640,102400,92160,128000,149504,143360,0,30720
.long 1832960,21470720,21467648,21284800,21282816,21421056,492032,1966080,1280,17884160,17885184,17886208,17887232,0,0,1073741824,21470208,21467136,21067776,21206144,1051011932,1826816,2048,1024,512,14012416,14010368,19808256,21467136,21439488,21455872,1024,4103680,4185600,4267520,81920,21553152,21553152,21553152,1809920,14097920,17852416,17821696,14004224,13991936,18067456,14090240,1802720,0,0,1536,21470208,0,256,139264,139520,97280,117760,138240,81920,32768,47104,51200,147456
.long 1835520,21470752,21471744,1073741824,21283840,21421060,1556480,1966080,1280,16971776,16972800,16973824,16974848,0,0,1073741824,21470212,21467136,21067904,21247104,1051011932,1867776,2048,1024,512,14151680,14149632,19810304,21467136,21455872,21472256,1024,4349440,4431360,4513280,97280,21553152,21553152,21553152,1850880,14237184,17913856,17883136,14028800,14016512,18067456,14110720,1823200,0,0,1536,21470208,256,0,139520,139264,81920,133120,122880,97280,149504,143360,0,30720
.long 1838080,21470784,21475840,1073741824,21284864,21421064,615168,819200,1280,18496512,18840576,18841600,18842624,0,0,1073741824,21470216,21467136,21068032,21208704,1051011932,1908736,2048,1024,512,14290944,14288896,19812352,21467136,21444608,21460992,1024,6719360,6801280,6883200,112640,21553152,21553152,21553152,1891840,14376448,17975296,17944576,14053376,14041088,18067456,14090240,1843680,0,0,1536,21470208,139264,139520,0,256,128000,87040,107520,112640,32768,47104,51200,147456
.long 1840640,21470816,21479936,1073741824,21285888,21421068,1180544,1966080,3072,19940352,20022272,19942400,20024320,21255168,0,0,21470220,21467136,21068160,21249664,1051011932,1949696,2048,1024,512,14430208,14428160,19814400,21467136,21460992,21477376,1024,6965120,7047040,7128960,128000,21553152,21553152,21553152,1932800,14515712,18036736,18006016,14077952,14065664,18067456,14110720,1864160,0,0,1536,21470208,139520,139264,256,0,112640,102400,92160,128000,149504,143360,0,30720
.long 1873920,21474816,21467648,21284816,21282816,21425152,492160,1966080,1280,18231296,18232320,18233344,18234368,0,0,1073741824,21474304,21467136,21108736,21216384,1065353216,4440064,2048,1024,512,14036992,14034944,20135936,21469184,21441536,21457920,0,4113920,4195840,4277760,81920,21553152,21553152,21553152,1820160,14108160,19245056,19214336,14004224,13991936,19460096,14090240,1803360,0,0,1536,21474304,0,256,139264,139520,97280,117760,138240,81920,32768,47104,51200,147456
.long 1876480,21474848,21471744,1073741824,21283840,21425156,1556608,1966080,1280,16975872,17319936,17320960,17321984,0,0,1073741824,21474308,21467136,21108864,21257344,1065353216,4481024,2048,1024,512,14176256,14174208,20137984,21469184,21457920,21474304,0,4359680,4441600,4523520,97280,21553152,21553152,21553152,1861120,14247424,19306496,19275776,14028800,14016512,19460096,14110720,1823840,0,0,1536,21474304,256,0,139520,139264,81920,133120,122880,97280,149504,143360,0,30720
.long 1879040,21474880,21475840,1073741824,21284864,21425160,615296,819200,1280,18843648,18844672,19188736,19189760,0,0,1073741824,21474312,21467136,21108992,21218944,1065353216,4521984,2048,1024,512,14315520,14313472,20140032,21469184,21446656,21463040,0,6721920,6803840,6885760,112640,21553152,21553152,21553152,1902080,14386688,19367936,19337216,14053376,14041088,19460096,14090240,1844320,0,0,1536,21474304,139264,139520,0,256,128000,87040,107520,112640,32768,47104,51200,147456
.long 1881600,21474912,21479936,1073741824,21285888,21425164,1278848,1966080,3072,19944448,20026368,19946496,20028416,21255424,0,0,21474316,21467136,21109120,21259904,1065353216,4562944,2048,1024,512,14454784,14452736,20142080,21469184,21463040,21479424,0,6967680,7049600,7131520,128000,21553152,21553152,21553152,1943040,14525952,19429376,19398656,14077952,14065664,19460096,14110720,1864800,0,0,1536,21474304,139520,139264,256,0,112640,102400,92160,128000,149504,143360,0,30720
.long 1914880,21478912,21467648,21284832,21282816,21429248,492288,1966080,1280,18235392,18579456,18580480,18581504,0,0,1073741824,21478400,21467136,21149696,21226624,1065353216,7047168,512,20480,10240,14061568,14059520,20463616,21470208,21442560,21458944,0,4124160,4206080,4288000,81920,21553152,21553152,21553152,1830400,14118400,17852416,17821696,14282752,14270464,18067456,14368768,1884640,0,0,1536,21478400,0,256,139264,139520,97280,117760,138240,81920,32768,47104,51200,147456
.long 1917440,21478944,21471744,1073741824,21283840,21429252,1556736,1966080,1280,17323008,17324032,17668096,17669120,0,0,1073741824,21478404,21467136,21149824,21267584,1065353216,7088128,512,20480,10240,14200832,14198784,20465664,21470208,21458944,21475328,0,4369920,4451840,4533760,97280,21553152,21553152,21553152,1871360,14257664,17913856,17883136,14307328,14295040,18067456,14389248,1905120,0,0,1536,21478400,256,0,139520,139264,81920,133120,122880,97280,149504,143360,0,30720
.long 1920000,21478976,21475840,1073741824,21284864,21429256,615424,819200,1280,19190784,19191808,19192832,19536896,0,0,1073741824,21478408,21467136,21149952,21229184,1065353216,7129088,512,20480,10240,14340096,14338048,20467712,21470208,21447680,21464064,0,6724480,6806400,6888320,112640,21553152,21553152,21553152,1912320,14396928,17975296,17944576,14331904,14319616,18067456,14368768,1925600,0,0,1536,21478400,139264,139520,0,256,128000,87040,107520,112640,32768,47104,51200,147456
.long 1922560,21479008,21479936,1073741824,21285888,21429260,1377152,1966080,3072,19948544,20030464,19950592,20032512,21255680,0,0,21478412,21467136,21150080,21270144,1065353216,7170048,512,20480,10240,14479360,14477312,20469760,21470208,21464064,21480448,0,6970240,7052160,7134080,128000,21553152,21553152,21553152,1953280,14536192,18036736,18006016,14356480,14344192,18067456,14389248,1946080,0,0,1536,21478400,139520,139264,256,0,112640,102400,92160,128000,149504,143360,0,30720
.long 1955840,21483008,21467648,21284848,21282816,21433344,492416,1966080,1280,18582528,18583552,18927616,18928640,0,0,1073741824,21482496,21467136,21190656,21236864,1065353216,9666560,512,20480,10240,14086144,14084096,20791296,21471232,21443584,21459968,0,4134400,4216320,4298240,81920,21553152,21553152,21553152,1840640,14128640,19245056,19214336,14282752,14270464,19460096,14368768,1885280,0,0,1536,21482496,0,256,139264,139520,97280,117760,138240,81920,32768,47104,51200,147456
.long 1958400,21483040,21471744,1073741824,21283840,21433348,1556864,1966080,1280,17670144,17671168,17672192,18016256,0,0,1073741824,21482500,21467136,21190784,21277824,1065353216,9707520,512,20480,10240,14225408,14223360,20793344,21471232,21459968,21476352,0,4380160,4462080,4544000,97280,21553152,21553152,21553152,1881600,14267904,19306496,19275776,14307328,14295040,19460096,14389248,1905760,0,0,1536,21482496,256,0,139520,139264,81920,133120,122880,97280,149504,143360,0,30720
.long 1960960,21483072,21475840,1073741824,21284864,21433352,615552,819200,1280,19537920,19538944,19539968,19540992,0,0,1073741824,21482504,21467136,21190912,21239424,1065353216,9748480,512,20480,10240,14364672,14362624,20795392,21471232,21448704,21465088,0,6727040,6808960,6890880,112640,21553152,21553152,21553152,1922560,14407168,19367936,19337216,14331904,14319616,19460096,14368768,1926240,0,0,1536,21482496,139264,139520,0,256,128000,87040,107520,112640,32768,47104,51200,147456
.long 1963520,21483104,21479936,1073741824,21285888,21433356,1475456,1966080,3072,19952640,20034560,19954688,20036608,21255936,0,0,21482508,21467136,21191040,21280384,1065353216,9789440,512,20480,10240,14503936,14501888,20797440,21471232,21465088,21481472,0,6972800,7054720,7136640,128000,21553152,21553152,21553152,1963520,14546432,19429376,19398656,14356480,14344192,19460096,14389248,1946720,0,0,1536,21482496,139520,139264,256,0,112640,102400,92160,128000,149504,143360,0,30720
.long 655360,21352960,21352960,21284864,21282816,21286912,492544,1966080,1280,18929664,18930688,18931712,19275776,0,0,1073741824,21352448,21352448,20873216,21200896,1051011932,655360,2048,1024,512,10092544,10096640,19562496,21352448,21324800,21341184,0,2949120,3031040,3112960,81920,21553152,21553152,21553152,655360,10190848,16777216,16807936,10092544,10104832,17022976,10190848,655360,0,0,2048,21352448,0,256,139264,139520,97280,117760,138240,81920,32768,47104,51200,147456
.long 657920,21352992,21357056,1073741824,21283840,21286916,1556992,1966080,1280,18017280,18018304,18019328,18020352,0,0,1073741824,21352452,21352448,20873344,21241856,1051011932,696320,2048,1024,512,10231808,10235904,19564544,21352448,21341184,21357568,0,3194880,3276800,3358720,97280,21553152,21553152,21553152,696320,10330112,16838656,16869376,10117120,10129408,17022976,10211328,675840,0,0,2048,21352448,256,0,139520,139264,81920,133120,122880,97280,149504,143360,0,30720
.long 660480,21353024,21361152,1073741824,21284864,21286920,655360,819200,1280,17104896,17105920,17106944,17107968,0,0,1073741824,21352456,21352448,20873472,21203456,1051011932,737280,2048,1024,512,10371072,10375168,19566592,21352448,21329920,21346304,0,5570560,5652480,5734400,112640,21553152,21553152,21553152,737280,10469376,16900096,16930816,10141696,10153984,17022976,10190848,696320,0,0,2048,21352448,139264,139520,0,256,128000,87040,107520,112640,32768,47104,51200,147456
.long 663040,21353056,21365248,1073741824,21285888,21286924,1573760,1966080,3072,19956736,20038656,19958784,20040704,21256192,0,0,21352460,21352448,20873600,21244416,1051011932,778240,2048,1024,512,10510336,10514432,19568640,21352448,21346304,21362688,0,5816320,5898240,5980160,128000,21553152,21553152,21553152,778240,10608640,16961536,16992256,10166272,10178560,17022976,10211328,716800,0,0,2048,21352448,139520,139264,256,0,112640,102400,92160,128000,149504,143360,0,30720
.long 696320,21357056,21352960,21284880,21282816,21291008,492672,1966080,1280,19276800,19277824,19278848,19279872,0,0,1073741824,21356544,21352448,20914176,21211136,1051011932,688128,2048,1024,512,10117120,10121216,19890176,21353472,21325824,21342208,0,2959360,3041280,3123200,81920,21553152,21553152,21553152,665600,10201088,18169856,18200576,10092544,10104832,18415616,10190848,656000,0,0,2048,21356544,0,256,139264,139520,97280,117760,138240,81920,32768,47104,51200,147456
.long 698880,21357088,21357056,1073741824,21283840,21291012,1557120,1966080,1280,18364416,18365440,18366464,18367488,0,0,1073741824,21356548,21352448,20914304,21252096,1051011932,729088,2048,1024,512,10256384,10260480,19892224,21353472,21342208,21358592,0,3205120,3287040,3368960,97280,21553152,21553152,21553152,706560,10340352,18231296,18262016,10117120,10129408,18415616,10211328,676480,0,0,2048,21356544,256,0,139520,139264,81920,133120,122880,97280,149504,143360,0,30720
.long 701440,21357120,21361152,1073741824,21284864,21291016,655488,819200,1280,17108992,17453056,17454080,17455104,0,0,1073741824,21356552,21352448,20914432,21213696,1051011932,770048,2048,1024,512,10395648,10399744,19894272,21353472,21330944,21347328,0,5573120,5655040,5736960,112640,21553152,21553152,21553152,747520,10479616,18292736,18323456,10141696,10153984,18415616,10190848,696960,0,0,2048,21356544,139264,139520,0,256,128000,87040,107520,112640,32768,47104,51200,147456
.long 704000,21357152,21365248,1073741824,21285888,21291020,1672064,1966080,3072,19960832,20042752,19962880,20044800,21256448,0,0,21356556,21352448,20914560,21254656,1051011932,811008,2048,1024,512,10534912,10539008,19896320,21353472,21347328,21363712,0,5818880,5900800,5982720,128000,21553152,21553152,21553152,788480,10618880,18354176,18384896,10166272,10178560,18415616,10211328,717440,0,0,2048,21356544,139520,139264,256,0,112640,102400,92160,128000,149504,143360,0,30720
.long 737280,21361152,21352960,21284896,21282816,21295104,532480,1966080,1280,16843776,16844800,16845824,16846848,0,0,1073741824,21360640,21352448,20955136,21221376,1065353216,3301376,2048,1024,512,10141696,10145792,20217856,21354496,21326848,21343232,0,2969600,3051520,3133440,81920,21553152,21553152,21553152,675840,10211328,16777216,16807936,10371072,10383360,17022976,10469376,737280,0,0,2048,21360640,0,256,139264,139520,97280,117760,138240,81920,32768,47104,51200,147456
.long 739840,21361184,21357056,1073741824,21283840,21295108,1557248,1966080,1280,18368512,18712576,18713600,18714624,0,0,1073741824,21360644,21352448,20955264,21262336,1065353216,3342336,2048,1024,512,10280960,10285056,20219904,21354496,21343232,21359616,0,3215360,3297280,3379200,97280,21553152,21553152,21553152,716800,10350592,16838656,16869376,10395648,10407936,17022976,10489856,757760,0,0,2048,21360640,256,0,139520,139264,81920,133120,122880,97280,149504,143360,0,30720
.long 742400,21361216,21361152,1073741824,21284864,21295112,655616,819200,1280,17456128,17457152,17801216,17802240,0,0,1073741824,21360648,21352448,20955392,21223936,1065353216,3383296,2048,1024,512,10420224,10424320,20221952,21354496,21331968,21348352,0,5575680,5657600,5739520,112640,21553152,21553152,21553152,757760,10489856,16900096,16930816,10420224,10432512,17022976,10469376,778240,0,0,2048,21360640,139264,139520,0,256,128000,87040,107520,112640,32768,47104,51200,147456
.long 744960,21361248,21365248,1073741824,21285888,21295116,1770368,1966080,3072,19964928,20046848,19966976,20048896,21256704,0,0,21360652,21352448,20955520,21264896,1065353216,3424256,2048,1024,512,10559488,10563584,20224000,21354496,21348352,21364736,0,5821440,5903360,5985280,128000,21553152,21553152,21553152,798720,10629120,16961536,16992256,10444800,10457088,17022976,10489856,798720,0,0,2048,21360640,139520,139264,256,0,112640,102400,92160,128000,149504,143360,0,30720
.long 778240,21365248,21352960,21284912,21282816,21299200,532608,1966080,1280,16847872,17191936,17192960,17193984,0,0,1073741824,21364736,21352448,20996096,21231616,1065353216,5902336,512,20480,10240,10166272,10170368,20545536,21355520,21327872,21344256,1024,2979840,3061760,3143680,81920,21553152,21553152,21553152,686080,10221568,18169856,18200576,10371072,10383360,18415616,10469376,737920,0,0,2048,21364736,0,256,139264,139520,97280,117760,138240,81920,32768,47104,51200,147456
.long 780800,21365280,21357056,1073741824,21283840,21299204,1557376,1966080,1280,18715648,18716672,19060736,19061760,0,0,1073741824,21364740,21352448,20996224,21272576,1065353216,5943296,512,20480,10240,10305536,10309632,20547584,21355520,21344256,21360640,1024,3225600,3307520,3389440,97280,21553152,21553152,21553152,727040,10360832,18231296,18262016,10395648,10407936,18415616,10489856,758400,0,0,2048,21364736,256,0,139520,139264,81920,133120,122880,97280,149504,143360,0,30720
.long 783360,21365312,21361152,1073741824,21284864,21299208,655744,819200,1280,17803264,17804288,17805312,18149376,0,0,1073741824,21364744,21352448,20996352,21234176,1065353216,5984256,512,20480,10240,10444800,10448896,20549632,21355520,21332992,21349376,1024,5578240,5660160,5742080,112640,21553152,21553152,21553152,768000,10500096,18292736,18323456,10420224,10432512,18415616,10469376,778880,0,0,2048,21364736,139264,139520,0,256,128000,87040,107520,112640,32768,47104,51200,147456
.long 785920,21365344,21365248,1073741824,21285888,21299212,1868672,1966080,3072,19969024,20050944,19971072,20052992,21256960,0,0,21364748,21352448,20996480,21275136,1065353216,6025216,512,20480,10240,10584064,10588160,20551680,21355520,21349376,21365760,1024,5824000,5905920,5987840,128000,21553152,21553152,21553152,808960,10639360,18354176,18384896,10444800,10457088,18415616,10489856,799360,0,0,2048,21364736,139520,139264,256,0,112640,102400,92160,128000,149504,143360,0,30720
.long 1966080,21484032,21484032,21284928,21282816,21417984,532736,1966080,1280,17195008,17196032,17540096,17541120,0,0,1073741824,21483520,21483520,21037056,21200896,1051011932,1966080,2048,1024,512,14548992,14553088,19562496,21483520,21455872,21472256,0,4259840,4341760,4423680,81920,21553152,21553152,21553152,1966080,14647296,16777216,16807936,14548992,14561280,17022976,14647296,1966080,0,0,2048,21483520,0,256,139264,139520,97280,117760,138240,81920,32768,47104,51200,147456
.long 1968640,21484064,21488128,1073741824,21283840,21417988,1557504,1966080,1280,19062784,19063808,19064832,19408896,0,0,1073741824,21483524,21483520,21037184,21241856,1051011932,2007040,2048,1024,512,14688256,14692352,19564544,21483520,21472256,21488640,0,4505600,4587520,4669440,97280,21553152,21553152,21553152,2007040,14786560,16838656,16869376,14573568,14585856,17022976,14667776,1986560,0,0,2048,21483520,256,0,139520,139264,81920,133120,122880,97280,149504,143360,0,30720
.long 1971200,21484096,21492224,1073741824,21284864,21417992,655872,819200,1280,18150400,18151424,18152448,18153472,0,0,1073741824,21483528,21483520,21037312,21203456,1051011932,2048000,2048,1024,512,14827520,14831616,19566592,21483520,21460992,21477376,0,6881280,6963200,7045120,112640,21553152,21553152,21553152,2048000,14925824,16900096,16930816,14598144,14610432,17022976,14647296,2007040,0,0,2048,21483520,139264,139520,0,256,128000,87040,107520,112640,32768,47104,51200,147456
.long 1973760,21484128,21496320,1073741824,21285888,21417996,1280,1966080,3072,20055040,20136960,20057088,20139008,21257216,0,0,21483532,21483520,21037440,21244416,1051011932,2088960,2048,1024,512,14966784,14970880,19568640,21483520,21477376,21493760,0,7127040,7208960,7290880,128000,21553152,21553152,21553152,2088960,15065088,16961536,16992256,14622720,14635008,17022976,14667776,2027520,0,0,2048,21483520,139520,139264,256,0,112640,102400,92160,128000,149504,143360,0,30720
.long 2007040,21488128,21484032,21284944,21282816,21422080,532864,1966080,1280,17542144,17543168,17544192,17888256,0,0,1073741824,21487616,21483520,21078016,21211136,1051011932,1998848,2048,1024,512,14573568,14577664,19890176,21484544,21456896,21473280,0,4270080,4352000,4433920,81920,21553152,21553152,21553152,1976320,14657536,18169856,18200576,14548992,14561280,18415616,14647296,1966720,0,0,2048,21487616,0,256,139264,139520,97280,117760,138240,81920,32768,47104,51200,147456
.long 2009600,21488160,21488128,1073741824,21283840,21422084,1557632,1966080,1280,19409920,19410944,19411968,19412992,0,0,1073741824,21487620,21483520,21078144,21252096,1051011932,2039808,2048,1024,512,14712832,14716928,19892224,21484544,21473280,21489664,0,4515840,4597760,4679680,97280,21553152,21553152,21553152,2017280,14796800,18231296,18262016,14573568,14585856,18415616,14667776,1987200,0,0,2048,21487616,256,0,139520,139264,81920,133120,122880,97280,149504,143360,0,30720
.long 2012160,21488192,21492224,1073741824,21284864,21422088,656000,819200,1280,18497536,18498560,18499584,18500608,0,0,1073741824,21487624,21483520,21078272,21213696,1051011932,2080768,2048,1024,512,14852096,14856192,19894272,21484544,21462016,21478400,0,6883840,6965760,7047680,112640,21553152,21553152,21553152,2058240,14936064,18292736,18323456,14598144,14610432,18415616,14647296,2007680,0,0,2048,21487616,139264,139520,0,256,128000,87040,107520,112640,32768,47104,51200,147456
.long 2014720,21488224,21496320,1073741824,21285888,21422092,99584,1966080,3072,20059136,20141056,20061184,20143104,21257472,0,0,21487628,21483520,21078400,21254656,1051011932,2121728,2048,1024,512,14991360,14995456,19896320,21484544,21478400,21494784,0,7129600,7211520,7293440,128000,21553152,21553152,21553152,2099200,15075328,18354176,18384896,14622720,14635008,18415616,14667776,2028160,0,0,2048,21487616,139520,139264,256,0,112640,102400,92160,128000,149504,143360,0,30720
.long 2048000,21492224,21484032,21284960,21282816,21426176,532992,1966080,1280,17889280,17890304,17891328,17892352,0,0,1073741824,21491712,21483520,21118976,21221376,1065353216,4612096,2048,1024,512,14598144,14602240,20217856,21485568,21457920,21474304,0,4280320,4362240,4444160,81920,21553152,21553152,21553152,1986560,14667776,16777216,16807936,14827520,14839808,17022976,14925824,2048000,0,0,2048,21491712,0,256,139264,139520,97280,117760,138240,81920,32768,47104,51200,147456
.long 2050560,21492256,21488128,1073741824,21283840,21426180,1597440,1966080,1280,16976896,16977920,16978944,16979968,0,0,1073741824,21491716,21483520,21119104,21262336,1065353216,4653056,2048,1024,512,14737408,14741504,20219904,21485568,21474304,21490688,0,4526080,4608000,4689920,97280,21553152,21553152,21553152,2027520,14807040,16838656,16869376,14852096,14864384,17022976,14946304,2068480,0,0,2048,21491712,256,0,139520,139264,81920,133120,122880,97280,149504,143360,0,30720
.long 2053120,21492288,21492224,1073741824,21284864,21426184,656128,819200,1280,18501632,18845696,18846720,18847744,0,0,1073741824,21491720,21483520,21119232,21223936,1065353216,4694016,2048,1024,512,14876672,14880768,20221952,21485568,21463040,21479424,0,6886400,6968320,7050240,112640,21553152,21553152,21553152,2068480,14946304,16900096,16930816,14876672,14888960,17022976,14925824,2088960,0,0,2048,21491712,139264,139520,0,256,128000,87040,107520,112640,32768,47104,51200,147456
.long 2055680,21492320,21496320,1073741824,21285888,21426188,197888,1966080,3072,20063232,20145152,20065280,20147200,21257728,0,0,21491724,21483520,21119360,21264896,1065353216,4734976,2048,1024,512,15015936,15020032,20224000,21485568,21479424,21495808,0,7132160,7214080,7296000,128000,21553152,21553152,21553152,2109440,15085568,16961536,16992256,14901248,14913536,17022976,14946304,2109440,0,0,2048,21491712,139520,139264,256,0,112640,102400,92160,128000,149504,143360,0,30720
.long 2088960,21496320,21484032,21284976,21282816,21430272,533120,1966080,1280,18236416,18237440,18238464,18239488,0,0,1073741824,21495808,21483520,21159936,21231616,1065353216,7213056,512,20480,10240,14622720,14626816,20545536,21486592,21458944,21475328,1024,4290560,4372480,4454400,81920,21553152,21553152,21553152,1996800,14678016,18169856,18200576,14827520,14839808,18415616,14925824,2048640,0,0,2048,21495808,0,256,139264,139520,97280,117760,138240,81920,32768,47104,51200,147456
.long 2091520,21496352,21488128,1073741824,21283840,21430276,1597568,1966080,1280,16980992,17325056,17326080,17327104,0,0,1073741824,21495812,21483520,21160064,21272576,1065353216,7254016,512,20480,10240,14761984,14766080,20547584,21486592,21475328,21491712,1024,4536320,4618240,4700160,97280,21553152,21553152,21553152,2037760,14817280,18231296,18262016,14852096,14864384,18415616,14946304,2069120,0,0,2048,21495808,256,0,139520,139264,81920,133120,122880,97280,149504,143360,0,30720
.long 2094080,21496384,21492224,1073741824,21284864,21430280,656256,819200,1280,18848768,18849792,19193856,19194880,0,0,1073741824,21495816,21483520,21160192,21234176,1065353216,7294976,512,20480,10240,14901248,14905344,20549632,21486592,21464064,21480448,1024,6888960,6970880,7052800,112640,21553152,21553152,21553152,2078720,14956544,18292736,18323456,14876672,14888960,18415616,14925824,2089600,0,0,2048,21495808,139264,139520,0,256,128000,87040,107520,112640,32768,47104,51200,147456
.long 2096640,21496416,21496320,1073741824,21285888,21430284,296192,1966080,3072,20067328,20149248,20069376,20151296,21257984,0,0,21495820,21483520,21160320,21275136,1065353216,7335936,512,20480,10240,15040512,15044608,20551680,21486592,21480448,21496832,1024,7134720,7216640,7298560,128000,21553152,21553152,21553152,2119680,15095808,18354176,18384896,14901248,14913536,18415616,14946304,2110080,0,0,2048,21495808,139520,139264,256,0,112640,102400,92160,128000,149504,143360,0,30720
.long 665600,21353984,21352960,21284992,21282816,21287936,533248,1966080,1280,18240512,18584576,18585600,18586624,0,0,1073741824,21353472,21352448,20883456,21201024,1051011932,663552,2048,1024,512,10100736,10098688,19644416,21352448,21324800,21341184,0,2951680,3033600,3115520,81920,21553152,21553152,21553152,657920,10193408,17125376,17156096,10092544,10104832,17371136,10190848,655520,0,0,2048,21353472,0,256,139264,139520,97280,117760,138240,81920,32768,47104,51200,147456
.long 668160,21354016,21357056,1073741824,21283840,21287940,1597696,1966080,1280,17328128,17329152,17673216,17674240,0,0,1073741824,21353476,21352448,20883584,21241984,1051011932,704512,2048,1024,512,10240000,10237952,19646464,21352448,21341184,21357568,0,3197440,3279360,3361280,97280,21553152,21553152,21553152,698880,10332672,17186816,17217536,10117120,10129408,17371136,10211328,676000,0,0,2048,21353472,256,0,139520,139264,81920,133120,122880,97280,149504,143360,0,30720
.long 670720,21354048,21361152,1073741824,21284864,21287944,656384,819200,1280,19195904,19196928,19197952,19542016,0,0,1073741824,21353480,21352448,20883712,21203584,1051011932,745472,2048,1024,512,10379264,10377216,19648512,21352448,21329920,21346304,0,5571200,5653120,5735040,112640,21553152,21553152,21553152,739840,10471936,17248256,17278976,10141696,10153984,17371136,10190848,696480,0,0,2048,21353472,139264,139520,0,256,128000,87040,107520,112640,32768,47104,51200,147456
.long 673280,21354080,21365248,1073741824,21285888,21287948,394496,1966080,3072,20071424,20153344,20073472,20155392,21258240,0,0,21353484,21352448,20883840,21244544,1051011932,786432,2048,1024,512,10518528,10516480,19650560,21352448,21346304,21362688,0,5816960,5898880,5980800,128000,21553152,21553152,21553152,780800,10611200,17309696,17340416,10166272,10178560,17371136,10211328,716960,0,0,2048,21353472,139520,139264,256,0,112640,102400,92160,128000,149504,143360,0,30720
.long 706560,21358080,21352960,21285008,21282816,21292032,533376,1966080,1280,18587648,18588672,18932736,18933760,0,0,1073741824,21357568,21352448,20924416,21211264,1065353216,3276800,2048,1024,512,10125312,10123264,19972096,21353472,21325824,21342208,0,2961920,3043840,3125760,81920,21553152,21553152,21553152,668160,10203648,18518016,18548736,10092544,10104832,18763776,10190848,656160,0,0,2048,21357568,0,256,139264,139520,97280,117760,138240,81920,32768,47104,51200,147456
.long 709120,21358112,21357056,1073741824,21283840,21292036,1597824,1966080,1280,17675264,17676288,17677312,18021376,0,0,1073741824,21357572,21352448,20924544,21252224,1065353216,3317760,2048,1024,512,10264576,10262528,19974144,21353472,21342208,21358592,0,3207680,3289600,3371520,97280,21553152,21553152,21553152,709120,10342912,18579456,18610176,10117120,10129408,18763776,10211328,676640,0,0,2048,21357568,256,0,139520,139264,81920,133120,122880,97280,149504,143360,0,30720
.long 711680,21358144,21361152,1073741824,21284864,21292040,656512,819200,1280,19543040,19544064,19545088,19546112,0,0,1073741824,21357576,21352448,20924672,21213824,1065353216,3358720,2048,1024,512,10403840,10401792,19976192,21353472,21330944,21347328,0,5573760,5655680,5737600,112640,21553152,21553152,21553152,750080,10482176,18640896,18671616,10141696,10153984,18763776,10190848,697120,0,0,2048,21357568,139264,139520,0,256,128000,87040,107520,112640,32768,47104,51200,147456
.long 714240,21358176,21365248,1073741824,21285888,21292044,492800,1966080,3072,20075520,20157440,20077568,20159488,21258496,0,0,21357580,21352448,20924800,21254784,1065353216,3399680,2048,1024,512,10543104,10541056,19978240,21353472,21347328,21363712,0,5819520,5901440,5983360,128000,21553152,21553152,21553152,791040,10621440,18702336,18733056,10166272,10178560,18763776,10211328,717600,0,0,2048,21357568,139520,139264,256,0,112640,102400,92160,128000,149504,143360,0,30720
.long 747520,21362176,21352960,21285024,21282816,21296128,533504,1966080,1280,18934784,18935808,18936832,19280896,0,0,1073741824,21361664,21352448,20965376,21221504,1065353216,3309568,2048,1024,512,10149888,10147840,20299776,21354496,21326848,21343232,1024,2972160,3054080,3136000,81920,21553152,21553152,21553152,678400,10213888,17125376,17156096,10371072,10383360,17371136,10469376,737440,0,0,2048,21361664,0,256,139264,139520,97280,117760,138240,81920,32768,47104,51200,147456
.long 750080,21362208,21357056,1073741824,21283840,21296132,1597952,1966080,1280,18022400,18023424,18024448,18025472,0,0,1073741824,21361668,21352448,20965504,21262464,1065353216,3350528,2048,1024,512,10289152,10287104,20301824,21354496,21343232,21359616,1024,3217920,3299840,3381760,97280,21553152,21553152,21553152,719360,10353152,17186816,17217536,10395648,10407936,17371136,10489856,757920,0,0,2048,21361664,256,0,139520,139264,81920,133120,122880,97280,149504,143360,0,30720
.long 752640,21362240,21361152,1073741824,21284864,21296136,696320,819200,1280,17110016,17111040,17112064,17113088,0,0,1073741824,21361672,21352448,20965632,21224064,1065353216,3391488,2048,1024,512,10428416,10426368,20303872,21354496,21331968,21348352,1024,5576320,5658240,5740160,112640,21553152,21553152,21553152,760320,10492416,17248256,17278976,10420224,10432512,17371136,10469376,778400,0,0,2048,21361664,139264,139520,0,256,128000,87040,107520,112640,32768,47104,51200,147456
.long 755200,21362272,21365248,1073741824,21285888,21296140,591104,1966080,3072,20079616,20161536,20081664,20163584,21258752,0,0,21361676,21352448,20965760,21265024,1065353216,3432448,2048,1024,512,10567680,10565632,20305920,21354496,21348352,21364736,1024,5822080,5904000,5985920,128000,21553152,21553152,21553152,801280,10631680,17309696,17340416,10444800,10457088,17371136,10489856,798880,0,0,2048,21361664,139520,139264,256,0,112640,102400,92160,128000,149504,143360,0,30720
.long 788480,21366272,21352960,21285040,21282816,21300224,533632,1966080,1280,19281920,19282944,19283968,19284992,0,0,1073741824,21365760,21352448,21006336,21231744,1065353216,5904384,512,20480,10240,10174464,10172416,20627456,21356544,21328896,21345280,0,2982400,3064320,3146240,81920,21553152,21553152,21553152,688640,10224128,18518016,18548736,10371072,10383360,18763776,10469376,738080,0,0,2048,21365760,0,256,139264,139520,97280,117760,138240,81920,32768,47104,51200,147456
.long 791040,21366304,21357056,1073741824,21283840,21300228,1598080,1966080,1280,18369536,18370560,18371584,18372608,0,0,1073741824,21365764,21352448,21006464,21272704,1065353216,5945344,512,20480,10240,10313728,10311680,20629504,21356544,21345280,21361664,0,3228160,3310080,3392000,97280,21553152,21553152,21553152,729600,10363392,18579456,18610176,10395648,10407936,18763776,10489856,758560,0,0,2048,21365760,256,0,139520,139264,81920,133120,122880,97280,149504,143360,0,30720
.long 793600,21366336,21361152,1073741824,21284864,21300232,696448,819200,1280,17114112,17458176,17459200,17460224,0,0,1073741824,21365768,21352448,21006592,21234304,1065353216,5986304,512,20480,10240,10452992,10450944,20631552,21356544,21334016,21350400,0,5578880,5660800,5742720,112640,21553152,21553152,21553152,770560,10502656,18640896,18671616,10420224,10432512,18763776,10469376,779040,0,0,2048,21365760,139264,139520,0,256,128000,87040,107520,112640,32768,47104,51200,147456
.long 796160,21366368,21365248,1073741824,21285888,21300236,689408,1966080,3072,20083712,20165632,20085760,20167680,21259008,0,0,21365772,21352448,21006720,21275264,1065353216,6027264,512,20480,10240,10592256,10590208,20633600,21356544,21350400,21366784,0,5824640,5906560,5988480,128000,21553152,21553152,21553152,811520,10641920,18702336,18733056,10444800,10457088,18763776,10489856,799520,0,0,2048,21365760,139520,139264,256,0,112640,102400,92160,128000,149504,143360,0,30720
.long 1976320,21485056,21484032,21285056,21282816,21419008,573440,1966080,1280,16848896,16849920,16850944,16851968,0,0,1073741824,21484544,21483520,21047296,21201024,1051011932,1974272,2048,1024,512,14557184,14555136,19644416,21483520,21455872,21472256,0,4262400,4344320,4426240,81920,21553152,21553152,21553152,1968640,14649856,17125376,17156096,14548992,14561280,17371136,14647296,1966240,0,0,2048,21484544,0,256,139264,139520,97280,117760,138240,81920,32768,47104,51200,147456
.long 1978880,21485088,21488128,1073741824,21283840,21419012,1598208,1966080,1280,18373632,18717696,18718720,18719744,0,0,1073741824,21484548,21483520,21047424,21241984,1051011932,2015232,2048,1024,512,14696448,14694400,19646464,21483520,21472256,21488640,0,4508160,4590080,4672000,97280,21553152,21553152,21553152,2009600,14789120,17186816,17217536,14573568,14585856,17371136,14667776,1986720,0,0,2048,21484544,256,0,139520,139264,81920,133120,122880,97280,149504,143360,0,30720
.long 1981440,21485120,21492224,1073741824,21284864,21419016,696576,819200,1280,17461248,17462272,17806336,17807360,0,0,1073741824,21484552,21483520,21047552,21203584,1051011932,2056192,2048,1024,512,14835712,14833664,19648512,21483520,21460992,21477376,0,6881920,6963840,7045760,112640,21553152,21553152,21553152,2050560,14928384,17248256,17278976,14598144,14610432,17371136,14647296,2007200,0,0,2048,21484544,139264,139520,0,256,128000,87040,107520,112640,32768,47104,51200,147456
.long 1984000,21485152,21496320,1073741824,21285888,21419020,787712,1966080,3072,20087808,20169728,20089856,20171776,21259264,0,0,21484556,21483520,21047680,21244544,1051011932,2097152,2048,1024,512,14974976,14972928,19650560,21483520,21477376,21493760,0,7127680,7209600,7291520,128000,21553152,21553152,21553152,2091520,15067648,17309696,17340416,14622720,14635008,17371136,14667776,2027680,0,0,2048,21484544,139520,139264,256,0,112640,102400,92160,128000,149504,143360,0,30720
.long 2017280,21489152,21484032,21285072,21282816,21423104,573568,1966080,1280,16852992,17197056,17198080,17199104,0,0,1073741824,21488640,21483520,21088256,21211264,1065353216,4587520,2048,1024,512,14581760,14579712,19972096,21484544,21456896,21473280,0,4272640,4354560,4436480,81920,21553152,21553152,21553152,1978880,14660096,18518016,18548736,14548992,14561280,18763776,14647296,1966880,0,0,2048,21488640,0,256,139264,139520,97280,117760,138240,81920,32768,47104,51200,147456
.long 2019840,21489184,21488128,1073741824,21283840,21423108,1598336,1966080,1280,18720768,18721792,19065856,19066880,0,0,1073741824,21488644,21483520,21088384,21252224,1065353216,4628480,2048,1024,512,14721024,14718976,19974144,21484544,21473280,21489664,0,4518400,4600320,4682240,97280,21553152,21553152,21553152,2019840,14799360,18579456,18610176,14573568,14585856,18763776,14667776,1987360,0,0,2048,21488640,256,0,139520,139264,81920,133120,122880,97280,149504,143360,0,30720
.long 2022400,21489216,21492224,1073741824,21284864,21423112,696704,819200,1280,17808384,17809408,17810432,18154496,0,0,1073741824,21488648,21483520,21088512,21213824,1065353216,4669440,2048,1024,512,14860288,14858240,19976192,21484544,21462016,21478400,0,6884480,6966400,7048320,112640,21553152,21553152,21553152,2060800,14938624,18640896,18671616,14598144,14610432,18763776,14647296,2007840,0,0,2048,21488640,139264,139520,0,256,128000,87040,107520,112640,32768,47104,51200,147456
.long 2024960,21489248,21496320,1073741824,21285888,21423116,886016,1966080,3072,20091904,20173824,20093952,20175872,21259520,0,0,21488652,21483520,21088640,21254784,1065353216,4710400,2048,1024,512,14999552,14997504,19978240,21484544,21478400,21494784,0,7130240,7212160,7294080,128000,21553152,21553152,21553152,2101760,15077888,18702336,18733056,14622720,14635008,18763776,14667776,2028320,0,0,2048,21488640,139520,139264,256,0,112640,102400,92160,128000,149504,143360,0,30720
.long 2058240,21493248,21484032,21285088,21282816,21427200,573696,1966080,1280,17200128,17201152,17545216,17546240,0,0,1073741824,21492736,21483520,21129216,21221504,1065353216,4620288,2048,1024,512,14606336,14604288,20299776,21485568,21457920,21474304,1024,4282880,4364800,4446720,81920,21553152,21553152,21553152,1989120,14670336,17125376,17156096,14827520,14839808,17371136,14925824,2048160,0,0,2048,21492736,0,256,139264,139520,97280,117760,138240,81920,32768,47104,51200,147456
.long 2060800,21493280,21488128,1073741824,21283840,21427204,1598464,1966080,1280,19067904,19068928,19069952,19414016,0,0,1073741824,21492740,21483520,21129344,21262464,1065353216,4661248,2048,1024,512,14745600,14743552,20301824,21485568,21474304,21490688,1024,4528640,4610560,4692480,97280,21553152,21553152,21553152,2030080,14809600,17186816,17217536,14852096,14864384,17371136,14946304,2068640,0,0,2048,21492736,256,0,139520,139264,81920,133120,122880,97280,149504,143360,0,30720
.long 2063360,21493312,21492224,1073741824,21284864,21427208,696832,819200,1280,18155520,18156544,18157568,18158592,0,0,1073741824,21492744,21483520,21129472,21224064,1065353216,4702208,2048,1024,512,14884864,14882816,20303872,21485568,21463040,21479424,1024,6887040,6968960,7050880,112640,21553152,21553152,21553152,2071040,14948864,17248256,17278976,14876672,14888960,17371136,14925824,2089120,0,0,2048,21492736,139264,139520,0,256,128000,87040,107520,112640,32768,47104,51200,147456
.long 2065920,21493344,21496320,1073741824,21285888,21427212,984320,1966080,3072,20096000,20177920,20098048,20179968,21259776,0,0,21492748,21483520,21129600,21265024,1065353216,4743168,2048,1024,512,15024128,15022080,20305920,21485568,21479424,21495808,1024,7132800,7214720,7296640,128000,21553152,21553152,21553152,2112000,15088128,17309696,17340416,14901248,14913536,17371136,14946304,2109600,0,0,2048,21492736,139520,139264,256,0,112640,102400,92160,128000,149504,143360,0,30720
.long 2099200,21497344,21484032,21285104,21282816,21431296,573824,1966080,1280,17547264,17548288,17549312,17893376,0,0,1073741824,21496832,21483520,21170176,21231744,1065353216,7215104,512,20480,10240,14630912,14628864,20627456,21487616,21459968,21476352,0,4293120,4375040,4456960,81920,21553152,21553152,21553152,1999360,14680576,18518016,18548736,14827520,14839808,18763776,14925824,2048800,0,0,2048,21496832,0,256,139264,139520,97280,117760,138240,81920,32768,47104,51200,147456
.long 2101760,21497376,21488128,1073741824,21283840,21431300,1598592,1966080,1280,19415040,19416064,19417088,19418112,0,0,1073741824,21496836,21483520,21170304,21272704,1065353216,7256064,512,20480,10240,14770176,14768128,20629504,21487616,21476352,21492736,0,4538880,4620800,4702720,97280,21553152,21553152,21553152,2040320,14819840,18579456,18610176,14852096,14864384,18763776,14946304,2069280,0,0,2048,21496832,256,0,139520,139264,81920,133120,122880,97280,149504,143360,0,30720
.long 2104320,21497408,21492224,1073741824,21284864,21431304,696960,819200,1280,18502656,18503680,18504704,18505728,0,0,1073741824,21496840,21483520,21170432,21234304,1065353216,7297024,512,20480,10240,14909440,14907392,20631552,21487616,21465088,21481472,0,6889600,6971520,7053440,112640,21553152,21553152,21553152,2081280,14959104,18640896,18671616,14876672,14888960,18763776,14925824,2089760,0,0,2048,21496832,139264,139520,0,256,128000,87040,107520,112640,32768,47104,51200,147456
.long 2106880,21497440,21496320,1073741824,21285888,21431308,1082624,1966080,3072,20100096,20182016,20102144,20184064,21260032,0,0,21496844,21483520,21170560,21275264,1065353216,7337984,512,20480,10240,15048704,15046656,20633600,21487616,21481472,21497856,0,7135360,7217280,7299200,128000,21553152,21553152,21553152,2122240,15098368,18702336,18733056,14901248,14913536,18763776,14946304,2110240,0,0,2048,21496832,139520,139264,256,0,112640,102400,92160,128000,149504,143360,0,30720
.long 675840,21355008,21352960,21285120,21282816,21288960,573952,1966080,1280,17894400,17895424,17896448,17897472,0,0,1073741824,21354496,21352448,20893696,21206016,1051011932,671744,2048,1024,512,10104832,10108928,19726336,21352448,21324800,21341184,0,2954240,3036160,3118080,81920,21553152,21553152,21553152,660480,10195968,17473536,17504256,10092544,10104832,17719296,10190848,655680,0,0,2048,21354496,0,256,139264,139520,97280,117760,138240,81920,32768,47104,51200,147456
.long 678400,21355040,21357056,1073741824,21283840,21288964,1638400,1966080,1280,16982016,16983040,16984064,16985088,0,0,1073741824,21354500,21352448,20893824,21246976,1051011932,712704,2048,1024,512,10244096,10248192,19728384,21352448,21341184,21357568,0,3200000,3281920,3363840,97280,21553152,21553152,21553152,701440,10335232,17534976,17565696,10117120,10129408,17719296,10211328,676160,0,0,2048,21354496,256,0,139520,139264,81920,133120,122880,97280,149504,143360,0,30720
.long 680960,21355072,21361152,1073741824,21284864,21288968,697088,819200,1280,18506752,18850816,18851840,18852864,0,0,1073741824,21354504,21352448,20893952,21208576,1051011932,753664,2048,1024,512,10383360,10387456,19730432,21352448,21329920,21346304,0,5571840,5653760,5735680,112640,21553152,21553152,21553152,742400,10474496,17596416,17627136,10141696,10153984,17719296,10190848,696640,0,0,2048,21354496,139264,139520,0,256,128000,87040,107520,112640,32768,47104,51200,147456
.long 683520,21355104,21365248,1073741824,21285888,21288972,1180928,1966080,3072,20104192,20186112,20106240,20188160,21260288,0,0,21354508,21352448,20894080,21249536,1051011932,794624,2048,1024,512,10522624,10526720,19732480,21352448,21346304,21362688,0,5817600,5899520,5981440,128000,21553152,21553152,21553152,783360,10613760,17657856,17688576,10166272,10178560,17719296,10211328,717120,0,0,2048,21354496,139520,139264,256,0,112640,102400,92160,128000,149504,143360,0,30720
.long 716800,21359104,21352960,21285136,21282816,21293056,574080,1966080,1280,18241536,18242560,18243584,18244608,0,0,1073741824,21358592,21352448,20934656,21216256,1065353216,3284992,2048,1024,512,10129408,10133504,20054016,21353472,21325824,21342208,1024,2964480,3046400,3128320,81920,21553152,21553152,21553152,670720,10206208,18866176,18896896,10092544,10104832,19111936,10190848,656320,0,0,2048,21358592,0,256,139264,139520,97280,117760,138240,81920,32768,47104,51200,147456
.long 719360,21359136,21357056,1073741824,21283840,21293060,1638528,1966080,1280,16986112,17330176,17331200,17332224,0,0,1073741824,21358596,21352448,20934784,21257216,1065353216,3325952,2048,1024,512,10268672,10272768,20056064,21353472,21342208,21358592,1024,3210240,3292160,3374080,97280,21553152,21553152,21553152,711680,10345472,18927616,18958336,10117120,10129408,19111936,10211328,676800,0,0,2048,21358592,256,0,139520,139264,81920,133120,122880,97280,149504,143360,0,30720
.long 721920,21359168,21361152,1073741824,21284864,21293064,697216,819200,1280,18853888,18854912,19198976,19200000,0,0,1073741824,21358600,21352448,20934912,21218816,1065353216,3366912,2048,1024,512,10407936,10412032,20058112,21353472,21330944,21347328,1024,5574400,5656320,5738240,112640,21553152,21553152,21553152,752640,10484736,18989056,19019776,10141696,10153984,19111936,10190848,697280,0,0,2048,21358592,139264,139520,0,256,128000,87040,107520,112640,32768,47104,51200,147456
.long 724480,21359200,21365248,1073741824,21285888,21293068,1279232,1966080,3072,20108288,20190208,20110336,20192256,21260544,0,0,21358604,21352448,20935040,21259776,1065353216,3407872,2048,1024,512,10547200,10551296,20060160,21353472,21347328,21363712,1024,5820160,5902080,5984000,128000,21553152,21553152,21553152,793600,10624000,19050496,19081216,10166272,10178560,19111936,10211328,717760,0,0,2048,21358592,139520,139264,256,0,112640,102400,92160,128000,149504,143360,0,30720
.long 757760,21363200,21352960,21285152,21282816,21297152,574208,1966080,1280,18245632,18589696,18590720,18591744,0,0,1073741824,21362688,21352448,20975616,21226496,1065353216,5898240,512,20480,10240,10153984,10158080,20381696,21355520,21327872,21344256,0,2974720,3056640,3138560,81920,21553152,21553152,21553152,680960,10216448,17473536,17504256,10371072,10383360,17719296,10469376,737600,0,0,2048,21362688,0,256,139264,139520,97280,117760,138240,81920,32768,47104,51200,147456
.long 760320,21363232,21357056,1073741824,21283840,21297156,1638656,1966080,1280,17333248,17334272,17678336,17679360,0,0,1073741824,21362692,21352448,20975744,21267456,1065353216,5939200,512,20480,10240,10293248,10297344,20383744,21355520,21344256,21360640,0,3220480,3302400,3384320,97280,21553152,21553152,21553152,721920,10355712,17534976,17565696,10395648,10407936,17719296,10489856,758080,0,0,2048,21362688,256,0,139520,139264,81920,133120,122880,97280,149504,143360,0,30720
.long 762880,21363264,21361152,1073741824,21284864,21297160,697344,819200,1280,19201024,19202048,19203072,19547136,0,0,1073741824,21362696,21352448,20975872,21229056,1065353216,5980160,512,20480,10240,10432512,10436608,20385792,21355520,21332992,21349376,0,5576960,5658880,5740800,112640,21553152,21553152,21553152,762880,10494976,17596416,17627136,10420224,10432512,17719296,10469376,778560,0,0,2048,21362688,139264,139520,0,256,128000,87040,107520,112640,32768,47104,51200,147456
.long 765440,21363296,21365248,1073741824,21285888,21297164,1377536,1966080,3072,20112384,20194304,20114432,20196352,21260800,0,0,21362700,21352448,20976000,21270016,1065353216,6021120,512,20480,10240,10571776,10575872,20387840,21355520,21349376,21365760,0,5822720,5904640,5986560,128000,21553152,21553152,21553152,803840,10634240,17657856,17688576,10444800,10457088,17719296,10489856,799040,0,0,2048,21362688,139520,139264,256,0,112640,102400,92160,128000,149504,143360,0,30720
.long 798720,21367296,21352960,21285168,21282816,21301248,574336,1966080,1280,18592768,18593792,18937856,18938880,0,0,1073741824,21366784,21352448,21016576,21236736,1065353216,5906432,512,20480,10240,10178560,10182656,20709376,21356544,21328896,21345280,0,2984960,3066880,3148800,81920,21553152,21553152,21553152,691200,10226688,18866176,18896896,10371072,10383360,19111936,10469376,738240,0,0,2048,21366784,0,256,139264,139520,97280,117760,138240,81920,32768,47104,51200,147456
.long 801280,21367328,21357056,1073741824,21283840,21301252,1638784,1966080,1280,17680384,17681408,17682432,18026496,0,0,1073741824,21366788,21352448,21016704,21277696,1065353216,5947392,512,20480,10240,10317824,10321920,20711424,21356544,21345280,21361664,0,3230720,3312640,3394560,97280,21553152,21553152,21553152,732160,10365952,18927616,18958336,10395648,10407936,19111936,10489856,758720,0,0,2048,21366784,256,0,139520,139264,81920,133120,122880,97280,149504,143360,0,30720
.long 803840,21367360,21361152,1073741824,21284864,21301256,697472,819200,1280,19548160,19549184,19550208,19551232,0,0,1073741824,21366792,21352448,21016832,21239296,1065353216,5988352,512,20480,10240,10457088,10461184,20713472,21356544,21334016,21350400,0,5579520,5661440,5743360,112640,21553152,21553152,21553152,773120,10505216,18989056,19019776,10420224,10432512,19111936,10469376,779200,0,0,2048,21366784,139264,139520,0,256,128000,87040,107520,112640,32768,47104,51200,147456
.long 806400,21367392,21365248,1073741824,21285888,21301260,1475840,1966080,3072,20116480,20198400,20118528,20200448,21261056,0,0,21366796,21352448,21016960,21280256,1065353216,6029312,512,20480,10240,10596352,10600448,20715520,21356544,21350400,21366784,0,5825280,5907200,5989120,128000,21553152,21553152,21553152,814080,10644480,19050496,19081216,10444800,10457088,19111936,10489856,799680,0,0,2048,21366784,139520,139264,256,0,112640,102400,92160,128000,149504,143360,0,30720
.long 1986560,21486080,21484032,21285184,21282816,21420032,574464,1966080,1280,18939904,18940928,18941952,19286016,0,0,1073741824,21485568,21483520,21057536,21206016,1051011932,1982464,2048,1024,512,14561280,14565376,19726336,21483520,21455872,21472256,0,4264960,4346880,4428800,81920,21553152,21553152,21553152,1971200,14652416,17473536,17504256,14548992,14561280,17719296,14647296,1966400,0,0,2048,21485568,0,256,139264,139520,97280,117760,138240,81920,32768,47104,51200,147456
.long 1989120,21486112,21488128,1073741824,21283840,21420036,1638912,1966080,1280,18027520,18028544,18029568,18030592,0,0,1073741824,21485572,21483520,21057664,21246976,1051011932,2023424,2048,1024,512,14700544,14704640,19728384,21483520,21472256,21488640,0,4510720,4592640,4674560,97280,21553152,21553152,21553152,2012160,14791680,17534976,17565696,14573568,14585856,17719296,14667776,1986880,0,0,2048,21485568,256,0,139520,139264,81920,133120,122880,97280,149504,143360,0,30720
.long 1991680,21486144,21492224,1073741824,21284864,21420040,737280,819200,1280,17115136,17116160,17117184,17118208,0,0,1073741824,21485576,21483520,21057792,21208576,1051011932,2064384,2048,1024,512,14839808,14843904,19730432,21483520,21460992,21477376,0,6882560,6964480,7046400,112640,21553152,21553152,21553152,2053120,14930944,17596416,17627136,14598144,14610432,17719296,14647296,2007360,0,0,2048,21485568,139264,139520,0,256,128000,87040,107520,112640,32768,47104,51200,147456
.long 1994240,21486176,21496320,1073741824,21285888,21420044,1574144,1966080,3072,20120576,20202496,20122624,20204544,21261312,0,0,21485580,21483520,21057920,21249536,1051011932,2105344,2048,1024,512,14979072,14983168,19732480,21483520,21477376,21493760,0,7128320,7210240,7292160,128000,21553152,21553152,21553152,2094080,15070208,17657856,17688576,14622720,14635008,17719296,14667776,2027840,0,0,2048,21485568,139520,139264,256,0,112640,102400,92160,128000,149504,143360,0,30720
.long 2027520,21490176,21484032,21285200,21282816,21424128,574592,1966080,1280,19287040,19288064,19289088,19290112,0,0,1073741824,21489664,21483520,21098496,21216256,1065353216,4595712,2048,1024,512,14585856,14589952,20054016,21484544,21456896,21473280,1024,4275200,4357120,4439040,81920,21553152,21553152,21553152,1981440,14662656,18866176,18896896,14548992,14561280,19111936,14647296,1967040,0,0,2048,21489664,0,256,139264,139520,97280,117760,138240,81920,32768,47104,51200,147456
.long 2030080,21490208,21488128,1073741824,21283840,21424132,1639040,1966080,1280,18374656,18375680,18376704,18377728,0,0,1073741824,21489668,21483520,21098624,21257216,1065353216,4636672,2048,1024,512,14725120,14729216,20056064,21484544,21473280,21489664,1024,4520960,4602880,4684800,97280,21553152,21553152,21553152,2022400,14801920,18927616,18958336,14573568,14585856,19111936,14667776,1987520,0,0,2048,21489664,256,0,139520,139264,81920,133120,122880,97280,149504,143360,0,30720
.long 2032640,21490240,21492224,1073741824,21284864,21424136,737408,819200,1280,17119232,17463296,17464320,17465344,0,0,1073741824,21489672,21483520,21098752,21218816,1065353216,4677632,2048,1024,512,14864384,14868480,20058112,21484544,21462016,21478400,1024,6885120,6967040,7048960,112640,21553152,21553152,21553152,2063360,14941184,18989056,19019776,14598144,14610432,19111936,14647296,2008000,0,0,2048,21489664,139264,139520,0,256,128000,87040,107520,112640,32768,47104,51200,147456
.long 2035200,21490272,21496320,1073741824,21285888,21424140,1672448,1966080,3072,20124672,20206592,20126720,20208640,21261568,0,0,21489676,21483520,21098880,21259776,1065353216,4718592,2048,1024,512,15003648,15007744,20060160,21484544,21478400,21494784,1024,7130880,7212800,7294720,128000,21553152,21553152,21553152,2104320,15080448,19050496,19081216,14622720,14635008,19111936,14667776,2028480,0,0,2048,21489664,139520,139264,256,0,112640,102400,92160,128000,149504,143360,0,30720
.long 2068480,21494272,21484032,21285216,21282816,21428224,614400,1966080,1280,16854016,16855040,16856064,16857088,0,0,1073741824,21493760,21483520,21139456,21226496,1065353216,7208960,512,20480,10240,14610432,14614528,20381696,21486592,21458944,21475328,0,4285440,4367360,4449280,81920,21553152,21553152,21553152,1991680,14672896,17473536,17504256,14827520,14839808,17719296,14925824,2048320,0,0,2048,21493760,0,256,139264,139520,97280,117760,138240,81920,32768,47104,51200,147456
.long 2071040,21494304,21488128,1073741824,21283840,21428228,1639168,1966080,1280,18378752,18722816,18723840,18724864,0,0,1073741824,21493764,21483520,21139584,21267456,1065353216,7249920,512,20480,10240,14749696,14753792,20383744,21486592,21475328,21491712,0,4531200,4613120,4695040,97280,21553152,21553152,21553152,2032640,14812160,17534976,17565696,14852096,14864384,17719296,14946304,2068800,0,0,2048,21493760,256,0,139520,139264,81920,133120,122880,97280,149504,143360,0,30720
.long 2073600,21494336,21492224,1073741824,21284864,21428232,737536,819200,1280,17466368,17467392,17811456,17812480,0,0,1073741824,21493768,21483520,21139712,21229056,1065353216,7290880,512,20480,10240,14888960,14893056,20385792,21486592,21464064,21480448,0,6887680,6969600,7051520,112640,21553152,21553152,21553152,2073600,14951424,17596416,17627136,14876672,14888960,17719296,14925824,2089280,0,0,2048,21493760,139264,139520,0,256,128000,87040,107520,112640,32768,47104,51200,147456
.long 2076160,21494368,21496320,1073741824,21285888,21428236,1770752,1966080,3072,20128768,20210688,20130816,20212736,21261824,0,0,21493772,21483520,21139840,21270016,1065353216,7331840,512,20480,10240,15028224,15032320,20387840,21486592,21480448,21496832,0,7133440,7215360,7297280,128000,21553152,21553152,21553152,2114560,15090688,17657856,17688576,14901248,14913536,17719296,14946304,2109760,0,0,2048,21493760,139520,139264,256,0,112640,102400,92160,128000,149504,143360,0,30720
.long 2109440,21498368,21484032,21285232,21282816,21432320,614528,1966080,1280,16858112,17202176,17203200,17204224,0,0,1073741824,21497856,21483520,21180416,21236736,1065353216,7217152,512,20480,10240,14635008,14639104,20709376,21487616,21459968,21476352,0,4295680,4377600,4459520,81920,21553152,21553152,21553152,2001920,14683136,18866176,18896896,14827520,14839808,19111936,14925824,2048960,0,0,2048,21497856,0,256,139264,139520,97280,117760,138240,81920,32768,47104,51200,147456
.long 2112000,21498400,21488128,1073741824,21283840,21432324,1639296,1966080,1280,18725888,18726912,19070976,19072000,0,0,1073741824,21497860,21483520,21180544,21277696,1065353216,7258112,512,20480,10240,14774272,14778368,20711424,21487616,21476352,21492736,0,4541440,4623360,4705280,97280,21553152,21553152,21553152,2042880,14822400,18927616,18958336,14852096,14864384,19111936,14946304,2069440,0,0,2048,21497856,256,0,139520,139264,81920,133120,122880,97280,149504,143360,0,30720
.long 2114560,21498432,21492224,1073741824,21284864,21432328,737664,819200,1280,17813504,17814528,17815552,18159616,0,0,1073741824,21497864,21483520,21180672,21239296,1065353216,7299072,512,20480,10240,14913536,14917632,20713472,21487616,21465088,21481472,0,6890240,6972160,7054080,112640,21553152,21553152,21553152,2083840,14961664,18989056,19019776,14876672,14888960,19111936,14925824,2089920,0,0,2048,21497856,139264,139520,0,256,128000,87040,107520,112640,32768,47104,51200,147456
.long 2117120,21498464,21496320,1073741824,21285888,21432332,1869056,1966080,3072,20132864,20214784,20134912,20216832,21262080,0,0,21497868,21483520,21180800,21280256,1065353216,7340032,512,20480,10240,15052800,15056896,20715520,21487616,21481472,21497856,0,7136000,7217920,7299840,128000,21553152,21553152,21553152,2124800,15100928,19050496,19081216,14901248,14913536,19111936,14946304,2110400,0,0,2048,21497856,139520,139264,256,0,112640,102400,92160,128000,149504,143360,0,30720
.long 686080,21356032,21352960,21285248,21282816,21289984,614656,1966080,1280,17205248,17206272,17550336,17551360,0,0,1073741824,21355520,21352448,20903936,21206144,1051011932,679936,2048,1024,512,10113024,10110976,19808256,21352448,21324800,21341184,1024,2956800,3038720,3120640,81920,21553152,21553152,21553152,663040,10198528,17821696,17852416,10092544,10104832,18067456,10190848,655840,0,0,2048,21355520,0,256,139264,139520,97280,117760,138240,81920,32768,47104,51200,147456
.long 688640,21356064,21357056,1073741824,21283840,21289988,1639424,1966080,1280,19073024,19074048,19075072,19419136,0,0,1073741824,21355524,21352448,20904064,21247104,1051011932,720896,2048,1024,512,10252288,10250240,19810304,21352448,21341184,21357568,1024,3202560,3284480,3366400,97280,21553152,21553152,21553152,704000,10337792,17883136,17913856,10117120,10129408,18067456,10211328,676320,0,0,2048,21355520,256,0,139520,139264,81920,133120,122880,97280,149504,143360,0,30720
.long 691200,21356096,21361152,1073741824,21284864,21289992,737792,819200,1280,18160640,18161664,18162688,18163712,0,0,1073741824,21355528,21352448,20904192,21208704,1051011932,761856,2048,1024,512,10391552,10389504,19812352,21352448,21329920,21346304,1024,5572480,5654400,5736320,112640,21553152,21553152,21553152,744960,10477056,17944576,17975296,10141696,10153984,18067456,10190848,696800,0,0,2048,21355520,139264,139520,0,256,128000,87040,107520,112640,32768,47104,51200,147456
.long 693760,21356128,21365248,1073741824,21285888,21289996,1664,1966080,3072,20218880,20300800,20220928,20302848,21262336,0,0,21355532,21352448,20904320,21249664,1051011932,802816,2048,1024,512,10530816,10528768,19814400,21352448,21346304,21362688,1024,5818240,5900160,5982080,128000,21553152,21553152,21553152,785920,10616320,18006016,18036736,10166272,10178560,18067456,10211328,717280,0,0,2048,21355520,139520,139264,256,0,112640,102400,92160,128000,149504,143360,0,30720
.long 727040,21360128,21352960,21285264,21282816,21294080,614784,1966080,1280,17552384,17553408,17554432,17898496,0,0,1073741824,21359616,21352448,20944896,21216384,1065353216,3293184,2048,1024,512,10137600,10135552,20135936,21354496,21326848,21343232,0,2967040,3048960,3130880,81920,21553152,21553152,21553152,673280,10208768,19214336,19245056,10092544,10104832,19460096,10190848,656480,0,0,2048,21359616,0,256,139264,139520,97280,117760,138240,81920,32768,47104,51200,147456
.long 729600,21360160,21357056,1073741824,21283840,21294084,1639552,1966080,1280,19420160,19421184,19422208,19423232,0,0,1073741824,21359620,21352448,20945024,21257344,1065353216,3334144,2048,1024,512,10276864,10274816,20137984,21354496,21343232,21359616,0,3212800,3294720,3376640,97280,21553152,21553152,21553152,714240,10348032,19275776,19306496,10117120,10129408,19460096,10211328,676960,0,0,2048,21359616,256,0,139520,139264,81920,133120,122880,97280,149504,143360,0,30720
.long 732160,21360192,21361152,1073741824,21284864,21294088,737920,819200,1280,18507776,18508800,18509824,18510848,0,0,1073741824,21359624,21352448,20945152,21218944,1065353216,3375104,2048,1024,512,10416128,10414080,20140032,21354496,21331968,21348352,0,5575040,5656960,5738880,112640,21553152,21553152,21553152,755200,10487296,19337216,19367936,10141696,10153984,19460096,10190848,697440,0,0,2048,21359616,139264,139520,0,256,128000,87040,107520,112640,32768,47104,51200,147456
.long 734720,21360224,21365248,1073741824,21285888,21294092,99968,1966080,3072,20222976,20304896,20225024,20306944,21262592,0,0,21359628,21352448,20945280,21259904,1065353216,3416064,2048,1024,512,10555392,10553344,20142080,21354496,21348352,21364736,0,5820800,5902720,5984640,128000,21553152,21553152,21553152,796160,10626560,19398656,19429376,10166272,10178560,19460096,10211328,717920,0,0,2048,21359616,139520,139264,256,0,112640,102400,92160,128000,149504,143360,0,30720
.long 768000,21364224,21352960,21285280,21282816,21298176,614912,1966080,1280,17899520,17900544,17901568,17902592,0,0,1073741824,21363712,21352448,20985856,21226624,1065353216,5900288,512,20480,10240,10162176,10160128,20463616,21355520,21327872,21344256,0,2977280,3059200,3141120,81920,21553152,21553152,21553152,683520,10219008,17821696,17852416,10371072,10383360,18067456,10469376,737760,0,0,2048,21363712,0,256,139264,139520,97280,117760,138240,81920,32768,47104,51200,147456
.long 770560,21364256,21357056,1073741824,21283840,21298180,1679360,1966080,1280,16987136,16988160,16989184,16990208,0,0,1073741824,21363716,21352448,20985984,21267584,1065353216,5941248,512,20480,10240,10301440,10299392,20465664,21355520,21344256,21360640,0,3223040,3304960,3386880,97280,21553152,21553152,21553152,724480,10358272,17883136,17913856,10395648,10407936,18067456,10489856,758240,0,0,2048,21363712,256,0,139520,139264,81920,133120,122880,97280,149504,143360,0,30720
.long 773120,21364288,21361152,1073741824,21284864,21298184,738048,819200,1280,18511872,18855936,18856960,18857984,0,0,1073741824,21363720,21352448,20986112,21229184,1065353216,5982208,512,20480,10240,10440704,10438656,20467712,21355520,21332992,21349376,0,5577600,5659520,5741440,112640,21553152,21553152,21553152,765440,10497536,17944576,17975296,10420224,10432512,18067456,10469376,778720,0,0,2048,21363712,139264,139520,0,256,128000,87040,107520,112640,32768,47104,51200,147456
.long 775680,21364320,21365248,1073741824,21285888,21298188,198272,1966080,3072,20227072,20308992,20229120,20311040,21262848,0,0,21363724,21352448,20986240,21270144,1065353216,6023168,512,20480,10240,10579968,10577920,20469760,21355520,21349376,21365760,0,5823360,5905280,5987200,128000,21553152,21553152,21553152,806400,10636800,18006016,18036736,10444800,10457088,18067456,10489856,799200,0,0,2048,21363712,139520,139264,256,0,112640,102400,92160,128000,149504,143360,0,30720
.long 808960,21368320,21352960,21285296,21282816,21302272,615040,1966080,1280,18246656,18247680,18248704,18249728,0,0,1073741824,21367808,21352448,21026816,21236864,1065353216,8519680,512,20480,10240,10186752,10184704,20791296,21356544,21328896,21345280,0,2987520,3069440,3151360,81920,21553152,21553152,21553152,693760,10229248,19214336,19245056,10371072,10383360,19460096,10469376,738400,0,0,2048,21367808,0,256,139264,139520,97280,117760,138240,81920,32768,47104,51200,147456
.long 811520,21368352,21357056,1073741824,21283840,21302276,1679488,1966080,1280,16991232,17335296,17336320,17337344,0,0,1073741824,21367812,21352448,21026944,21277824,1065353216,8560640,512,20480,10240,10326016,10323968,20793344,21356544,21345280,21361664,0,3233280,3315200,3397120,97280,21553152,21553152,21553152,734720,10368512,19275776,19306496,10395648,10407936,19460096,10489856,758880,0,0,2048,21367808,256,0,139520,139264,81920,133120,122880,97280,149504,143360,0,30720
.long 814080,21368384,21361152,1073741824,21284864,21302280,738176,819200,1280,18859008,18860032,19204096,19205120,0,0,1073741824,21367816,21352448,21027072,21239424,1065353216,8601600,512,20480,10240,10465280,10463232,20795392,21356544,21334016,21350400,0,5580160,5662080,5744000,112640,21553152,21553152,21553152,775680,10507776,19337216,19367936,10420224,10432512,19460096,10469376,779360,0,0,2048,21367808,139264,139520,0,256,128000,87040,107520,112640,32768,47104,51200,147456
.long 816640,21368416,21365248,1073741824,21285888,21302284,296576,1966080,3072,20231168,20313088,20233216,20315136,21263104,0,0,21367820,21352448,21027200,21280384,1065353216,8642560,512,20480,10240,10604544,10602496,20797440,21356544,21350400,21366784,0,5825920,5907840,5989760,128000,21553152,21553152,21553152,816640,10647040,19398656,19429376,10444800,10457088,19460096,10489856,799840,0,0,2048,21367808,139520,139264,256,0,112640,102400,92160,128000,149504,143360,0,30720
.long 1996800,21487104,21484032,21285312,21282816,21421056,615168,1966080,1280,18250752,18594816,18595840,18596864,0,0,1073741824,21486592,21483520,21067776,21206144,1051011932,1990656,2048,1024,512,14569472,14567424,19808256,21483520,21455872,21472256,1024,4267520,4349440,4431360,81920,21553152,21553152,21553152,1973760,14654976,17821696,17852416,14548992,14561280,18067456,14647296,1966560,0,0,2048,21486592,0,256,139264,139520,97280,117760,138240,81920,32768,47104,51200,147456
.long 1999360,21487136,21488128,1073741824,21283840,21421060,1679616,1966080,1280,17338368,17339392,17683456,17684480,0,0,1073741824,21486596,21483520,21067904,21247104,1051011932,2031616,2048,1024,512,14708736,14706688,19810304,21483520,21472256,21488640,1024,4513280,4595200,4677120,97280,21553152,21553152,21553152,2014720,14794240,17883136,17913856,14573568,14585856,18067456,14667776,1987040,0,0,2048,21486592,256,0,139520,139264,81920,133120,122880,97280,149504,143360,0,30720
.long 2001920,21487168,21492224,1073741824,21284864,21421064,738304,819200,1280,19206144,19207168,19208192,19552256,0,0,1073741824,21486600,21483520,21068032,21208704,1051011932,2072576,2048,1024,512,14848000,14845952,19812352,21483520,21460992,21477376,1024,6883200,6965120,7047040,112640,21553152,21553152,21553152,2055680,14933504,17944576,17975296,14598144,14610432,18067456,14647296,2007520,0,0,2048,21486592,139264,139520,0,256,128000,87040,107520,112640,32768,47104,51200,147456
.long 2004480,21487200,21496320,1073741824,21285888,21421068,394880,1966080,3072,20235264,20317184,20237312,20319232,21263360,0,0,21486604,21483520,21068160,21249664,1051011932,2113536,2048,1024,512,14987264,14985216,19814400,21483520,21477376,21493760,1024,7128960,7210880,7292800,128000,21553152,21553152,21553152,2096640,15072768,18006016,18036736,14622720,14635008,18067456,14667776,2028000,0,0,2048,21486592,139520,139264,256,0,112640,102400,92160,128000,149504,143360,0,30720
.long 2037760,21491200,21484032,21285328,21282816,21425152,615296,1966080,1280,18597888,18598912,18942976,18944000,0,0,1073741824,21490688,21483520,21108736,21216384,1065353216,4603904,2048,1024,512,14594048,14592000,20135936,21485568,21457920,21474304,0,4277760,4359680,4441600,81920,21553152,21553152,21553152,1984000,14665216,19214336,19245056,14548992,14561280,19460096,14647296,1967200,0,0,2048,21490688,0,256,139264,139520,97280,117760,138240,81920,32768,47104,51200,147456
.long 2040320,21491232,21488128,1073741824,21283840,21425156,1679744,1966080,1280,17685504,17686528,17687552,18031616,0,0,1073741824,21490692,21483520,21108864,21257344,1065353216,4644864,2048,1024,512,14733312,14731264,20137984,21485568,21474304,21490688,0,4523520,4605440,4687360,97280,21553152,21553152,21553152,2024960,14804480,19275776,19306496,14573568,14585856,19460096,14667776,1987680,0,0,2048,21490688,256,0,139520,139264,81920,133120,122880,97280,149504,143360,0,30720
.long 2042880,21491264,21492224,1073741824,21284864,21425160,738432,819200,1280,19553280,19554304,19555328,19556352,0,0,1073741824,21490696,21483520,21108992,21218944,1065353216,4685824,2048,1024,512,14872576,14870528,20140032,21485568,21463040,21479424,0,6885760,6967680,7049600,112640,21553152,21553152,21553152,2065920,14943744,19337216,19367936,14598144,14610432,19460096,14647296,2008160,0,0,2048,21490688,139264,139520,0,256,128000,87040,107520,112640,32768,47104,51200,147456
.long 2045440,21491296,21496320,1073741824,21285888,21425164,493184,1966080,3072,20239360,20321280,20241408,20323328,21263616,0,0,21490700,21483520,21109120,21259904,1065353216,4726784,2048,1024,512,15011840,15009792,20142080,21485568,21479424,21495808,0,7131520,7213440,7295360,128000,21553152,21553152,21553152,2106880,15083008,19398656,19429376,14622720,14635008,19460096,14667776,2028640,0,0,2048,21490688,139520,139264,256,0,112640,102400,92160,128000,149504,143360,0,30720
.long 2078720,21495296,21484032,21285344,21282816,21429248,615424,1966080,1280,18945024,18946048,18947072,19291136,0,0,1073741824,21494784,21483520,21149696,21226624,1065353216,7211008,512,20480,10240,14618624,14616576,20463616,21486592,21458944,21475328,0,4288000,4369920,4451840,81920,21553152,21553152,21553152,1994240,14675456,17821696,17852416,14827520,14839808,18067456,14925824,2048480,0,0,2048,21494784,0,256,139264,139520,97280,117760,138240,81920,32768,47104,51200,147456
.long 2081280,21495328,21488128,1073741824,21283840,21429252,1679872,1966080,1280,18032640,18033664,18034688,18035712,0,0,1073741824,21494788,21483520,21149824,21267584,1065353216,7251968,512,20480,10240,14757888,14755840,20465664,21486592,21475328,21491712,0,4533760,4615680,4697600,97280,21553152,21553152,21553152,2035200,14814720,17883136,17913856,14852096,14864384,18067456,14946304,2068960,0,0,2048,21494784,256,0,139520,139264,81920,133120,122880,97280,149504,143360,0,30720
.long 2083840,21495360,21492224,1073741824,21284864,21429256,778240,819200,1280,17120256,17121280,17122304,17123328,0,0,1073741824,21494792,21483520,21149952,21229184,1065353216,7292928,512,20480,10240,14897152,14895104,20467712,21486592,21464064,21480448,0,6888320,6970240,7052160,112640,21553152,21553152,21553152,2076160,14953984,17944576,17975296,14876672,14888960,18067456,14925824,2089440,0,0,2048,21494784,139264,139520,0,256,128000,87040,107520,112640,32768,47104,51200,147456
.long 2086400,21495392,21496320,1073741824,21285888,21429260,591488,1966080,3072,20243456,20325376,20245504,20327424,21263872,0,0,21494796,21483520,21150080,21270144,1065353216,7333888,512,20480,10240,15036416,15034368,20469760,21486592,21480448,21496832,0,7134080,7216000,7297920,128000,21553152,21553152,21553152,2117120,15093248,18006016,18036736,14901248,14913536,18067456,14946304,2109920,0,0,2048,21494784,139520,139264,256,0,112640,102400,92160,128000,149504,143360,0,30720
.long 2119680,21499392,21484032,21285360,21282816,21433344,615552,1966080,1280,19292160,19293184,19294208,19295232,0,0,1073741824,21498880,21483520,21190656,21236864,1065353216,9830400,512,20480,10240,14643200,14641152,20791296,21487616,21459968,21476352,0,4298240,4380160,4462080,81920,21553152,21553152,21553152,2004480,14685696,19214336,19245056,14827520,14839808,19460096,14925824,2049120,0,0,2048,21498880,0,256,139264,139520,97280,117760,138240,81920,32768,47104,51200,147456
.long 2122240,21499424,21488128,1073741824,21283840,21433348,1680000,1966080,1280,18379776,18380800,18381824,18382848,0,0,1073741824,21498884,21483520,21190784,21277824,1065353216,9871360,512,20480,10240,14782464,14780416,20793344,21487616,21476352,21492736,0,4544000,4625920,4707840,97280,21553152,21553152,21553152,2045440,14824960,19275776,19306496,14852096,14864384,19460096,14946304,2069600,0,0,2048,21498880,256,0,139520,139264,81920,133120,122880,97280,149504,143360,0,30720
.long 2124800,21499456,21492224,1073741824,21284864,21433352,778368,819200,1280,17124352,17468416,17469440,17470464,0,0,1073741824,21498888,21483520,21190912,21239424,1065353216,9912320,512,20480,10240,14921728,14919680,20795392,21487616,21465088,21481472,0,6890880,6972800,7054720,112640,21553152,21553152,21553152,2086400,14964224,19337216,19367936,14876672,14888960,19460096,14925824,2090080,0,0,2048,21498880,139264,139520,0,256,128000,87040,107520,112640,32768,47104,51200,147456
.long 2127360,21499488,21496320,1073741824,21285888,21433356,689792,1966080,3072,20247552,20329472,20249600,20331520,21264128,0,0,21498892,21483520,21191040,21280384,1065353216,9953280,512,20480,10240,15060992,15058944,20797440,21487616,21481472,21497856,0,7136640,7218560,7300480,128000,21553152,21553152,21553152,2127360,15103488,19398656,19429376,14901248,14913536,19460096,14946304,2110560,0,0,2048,21498880,139520,139264,256,0,112640,102400,92160,128000,149504,143360,0,30720
.long 819200,21369344,21369344,21285376,21282816,21286912,655360,1966080,1280,16859136,16860160,16861184,16862208,0,0,1073741824,21368832,21368832,20873216,21200896,1051011932,819200,2048,1024,512,10649600,10653696,19562496,21368832,21341184,21357568,0,3112960,3194880,3276800,81920,21553152,21553152,21553152,819200,10747904,16807936,16777216,10661888,10649600,17022976,10747904,819200,0,0,2560,21368832,0,256,139264,139520,97280,117760,138240,81920,32768,47104,51200,147456
.long 821760,21369376,21373440,1073741824,21283840,21286916,1680128,1966080,1280,18383872,18727936,18728960,18729984,0,0,1073741824,21368836,21368832,20873344,21241856,1051011932,860160,2048,1024,512,10788864,10792960,19564544,21368832,21357568,21373952,0,3358720,3440640,3522560,97280,21553152,21553152,21553152,860160,10887168,16869376,16838656,10686464,10674176,17022976,10768384,839680,0,0,2560,21368832,256,0,139520,139264,81920,133120,122880,97280,149504,143360,0,30720
.long 824320,21369408,21377536,1073741824,21284864,21286920,778496,819200,1280,17471488,17472512,17816576,17817600,0,0,1073741824,21368840,21368832,20873472,21203456,1051011932,901120,2048,1024,512,10928128,10932224,19566592,21368832,21346304,21362688,0,5734400,5816320,5898240,112640,21553152,21553152,21553152,901120,11026432,16930816,16900096,10711040,10698752,17022976,10747904,860160,0,0,2560,21368832,139264,139520,0,256,128000,87040,107520,112640,32768,47104,51200,147456
.long 826880,21369440,21381632,1073741824,21285888,21286924,788096,1966080,3072,20251648,20333568,20253696,20335616,21264384,0,0,21368844,21368832,20873600,21244416,1051011932,942080,2048,1024,512,11067392,11071488,19568640,21368832,21362688,21379072,0,5980160,6062080,6144000,128000,21553152,21553152,21553152,942080,11165696,16992256,16961536,10735616,10723328,17022976,10768384,880640,0,0,2560,21368832,139520,139264,256,0,112640,102400,92160,128000,149504,143360,0,30720
.long 860160,21373440,21369344,21285392,21282816,21291008,655488,1966080,1280,16863232,17207296,17208320,17209344,0,0,1073741824,21372928,21368832,20914176,21211136,1051011932,851968,2048,1024,512,10674176,10678272,19890176,21369856,21342208,21358592,0,3123200,3205120,3287040,81920,21553152,21553152,21553152,829440,10758144,18200576,18169856,10661888,10649600,18415616,10747904,819840,0,0,2560,21372928,0,256,139264,139520,97280,117760,138240,81920,32768,47104,51200,147456
.long 862720,21373472,21373440,1073741824,21283840,21291012,1680256,1966080,1280,18731008,18732032,19076096,19077120,0,0,1073741824,21372932,21368832,20914304,21252096,1051011932,892928,2048,1024,512,10813440,10817536,19892224,21369856,21358592,21374976,0,3368960,3450880,3532800,97280,21553152,21553152,21553152,870400,10897408,18262016,18231296,10686464,10674176,18415616,10768384,840320,0,0,2560,21372928,256,0,139520,139264,81920,133120,122880,97280,149504,143360,0,30720
.long 865280,21373504,21377536,1073741824,21284864,21291016,778624,819200,1280,17818624,17819648,17820672,18164736,0,0,1073741824,21372936,21368832,20914432,21213696,1051011932,933888,2048,1024,512,10952704,10956800,19894272,21369856,21347328,21363712,0,5736960,5818880,5900800,112640,21553152,21553152,21553152,911360,11036672,18323456,18292736,10711040,10698752,18415616,10747904,860800,0,0,2560,21372928,139264,139520,0,256,128000,87040,107520,112640,32768,47104,51200,147456
.long 867840,21373536,21381632,1073741824,21285888,21291020,886400,1966080,3072,20255744,20337664,20257792,20339712,21264640,0,0,21372940,21368832,20914560,21254656,1051011932,974848,2048,1024,512,11091968,11096064,19896320,21369856,21363712,21380096,0,5982720,6064640,6146560,128000,21553152,21553152,21553152,952320,11175936,18384896,18354176,10735616,10723328,18415616,10768384,881280,0,0,2560,21372928,139520,139264,256,0,112640,102400,92160,128000,149504,143360,0,30720
.long 901120,21377536,21369344,21285408,21282816,21295104,655616,1966080,1280,17210368,17211392,17555456,17556480,0,0,1073741824,21377024,21368832,20955136,21221376,1065353216,3465216,2048,1024,512,10698752,10702848,20217856,21370880,21343232,21359616,0,3133440,3215360,3297280,81920,21553152,21553152,21553152,839680,10768384,16807936,16777216,10940416,10928128,17022976,11026432,901120,0,0,2560,21377024,0,256,139264,139520,97280,117760,138240,81920,32768,47104,51200,147456
.long 903680,21377568,21373440,1073741824,21283840,21295108,1680384,1966080,1280,19078144,19079168,19080192,19424256,0,0,1073741824,21377028,21368832,20955264,21262336,1065353216,3506176,2048,1024,512,10838016,10842112,20219904,21370880,21359616,21376000,0,3379200,3461120,3543040,97280,21553152,21553152,21553152,880640,10907648,16869376,16838656,10964992,10952704,17022976,11046912,921600,0,0,2560,21377024,256,0,139520,139264,81920,133120,122880,97280,149504,143360,0,30720
.long 906240,21377600,21377536,1073741824,21284864,21295112,778752,819200,1280,18165760,18166784,18167808,18168832,0,0,1073741824,21377032,21368832,20955392,21223936,1065353216,3547136,2048,1024,512,10977280,10981376,20221952,21370880,21348352,21364736,0,5739520,5821440,5903360,112640,21553152,21553152,21553152,921600,11046912,16930816,16900096,10989568,10977280,17022976,11026432,942080,0,0,2560,21377024,139264,139520,0,256,128000,87040,107520,112640,32768,47104,51200,147456
.long 908800,21377632,21381632,1073741824,21285888,21295116,984704,1966080,3072,20259840,20341760,20261888,20343808,21264896,0,0,21377036,21368832,20955520,21264896,1065353216,3588096,2048,1024,512,11116544,11120640,20224000,21370880,21364736,21381120,0,5985280,6067200,6149120,128000,21553152,21553152,21553152,962560,11186176,16992256,16961536,11014144,11001856,17022976,11046912,962560,0,0,2560,21377024,139520,139264,256,0,112640,102400,92160,128000,149504,143360,0,30720
.long 942080,21381632,21369344,21285424,21282816,21299200,655744,1966080,1280,17557504,17558528,17559552,17903616,0,0,1073741824,21381120,21368832,20996096,21231616,1065353216,6066176,512,20480,10240,10723328,10727424,20545536,21371904,21344256,21360640,1024,3143680,3225600,3307520,81920,21553152,21553152,21553152,849920,10778624,18200576,18169856,10940416,10928128,18415616,11026432,901760,0,0,2560,21381120,0,256,139264,139520,97280,117760,138240,81920,32768,47104,51200,147456
.long 944640,21381664,21373440,1073741824,21283840,21299204,1680512,1966080,1280,19425280,19426304,19427328,19428352,0,0,1073741824,21381124,21368832,20996224,21272576,1065353216,6107136,512,20480,10240,10862592,10866688,20547584,21371904,21360640,21377024,1024,3389440,3471360,3553280,97280,21553152,21553152,21553152,890880,10917888,18262016,18231296,10964992,10952704,18415616,11046912,922240,0,0,2560,21381120,256,0,139520,139264,81920,133120,122880,97280,149504,143360,0,30720
.long 947200,21381696,21377536,1073741824,21284864,21299208,778880,819200,1280,18512896,18513920,18514944,18515968,0,0,1073741824,21381128,21368832,20996352,21234176,1065353216,6148096,512,20480,10240,11001856,11005952,20549632,21371904,21349376,21365760,1024,5742080,5824000,5905920,112640,21553152,21553152,21553152,931840,11057152,18323456,18292736,10989568,10977280,18415616,11026432,942720,0,0,2560,21381120,139264,139520,0,256,128000,87040,107520,112640,32768,47104,51200,147456
.long 949760,21381728,21381632,1073741824,21285888,21299212,1083008,1966080,3072,20263936,20345856,20265984,20347904,21265152,0,0,21381132,21368832,20996480,21275136,1065353216,6189056,512,20480,10240,11141120,11145216,20551680,21371904,21365760,21382144,1024,5987840,6069760,6151680,128000,21553152,21553152,21553152,972800,11196416,18384896,18354176,11014144,11001856,18415616,11046912,963200,0,0,2560,21381120,139520,139264,256,0,112640,102400,92160,128000,149504,143360,0,30720
.long 2129920,21500416,21500416,21285440,21282816,21417984,655872,1966080,1280,17904640,17905664,17906688,17907712,0,0,1073741824,21499904,21499904,21037056,21200896,1051011932,2129920,2048,1024,512,15106048,15110144,19562496,21499904,21472256,21488640,0,4423680,4505600,4587520,81920,21553152,21553152,21553152,2129920,15204352,16807936,16777216,15118336,15106048,17022976,15204352,2129920,0,0,2560,21499904,0,256,139264,139520,97280,117760,138240,81920,32768,47104,51200,147456
.long 2132480,21500448,21504512,1073741824,21283840,21417988,1720320,1966080,1280,16992256,16993280,16994304,16995328,0,0,1073741824,21499908,21499904,21037184,21241856,1051011932,2170880,2048,1024,512,15245312,15249408,19564544,21499904,21488640,21505024,0,4669440,4751360,4833280,97280,21553152,21553152,21553152,2170880,15343616,16869376,16838656,15142912,15130624,17022976,15224832,2150400,0,0,2560,21499904,256,0,139520,139264,81920,133120,122880,97280,149504,143360,0,30720
.long 2135040,21500480,21508608,1073741824,21284864,21417992,779008,819200,1280,18516992,18861056,18862080,18863104,0,0,1073741824,21499912,21499904,21037312,21203456,1051011932,2211840,2048,1024,512,15384576,15388672,19566592,21499904,21477376,21493760,0,7045120,7127040,7208960,112640,21553152,21553152,21553152,2211840,15482880,16930816,16900096,15167488,15155200,17022976,15204352,2170880,0,0,2560,21499904,139264,139520,0,256,128000,87040,107520,112640,32768,47104,51200,147456
.long 2137600,21500512,21512704,1073741824,21285888,21417996,1181312,1966080,3072,20268032,20349952,20270080,20352000,21265408,0,0,21499916,21499904,21037440,21244416,1051011932,2252800,2048,1024,512,15523840,15527936,19568640,21499904,21493760,21510144,0,7290880,7372800,7454720,128000,21553152,21553152,21553152,2252800,15622144,16992256,16961536,15192064,15179776,17022976,15224832,2191360,0,0,2560,21499904,139520,139264,256,0,112640,102400,92160,128000,149504,143360,0,30720
.long 2170880,21504512,21500416,21285456,21282816,21422080,656000,1966080,1280,18251776,18252800,18253824,18254848,0,0,1073741824,21504000,21499904,21078016,21211136,1051011932,2162688,2048,1024,512,15130624,15134720,19890176,21500928,21473280,21489664,0,4433920,4515840,4597760,81920,21553152,21553152,21553152,2140160,15214592,18200576,18169856,15118336,15106048,18415616,15204352,2130560,0,0,2560,21504000,0,256,139264,139520,97280,117760,138240,81920,32768,47104,51200,147456
.long 2173440,21504544,21504512,1073741824,21283840,21422084,1720448,1966080,1280,16996352,17340416,17341440,17342464,0,0,1073741824,21504004,21499904,21078144,21252096,1051011932,2203648,2048,1024,512,15269888,15273984,19892224,21500928,21489664,21506048,0,4679680,4761600,4843520,97280,21553152,21553152,21553152,2181120,15353856,18262016,18231296,15142912,15130624,18415616,15224832,2151040,0,0,2560,21504000,256,0,139520,139264,81920,133120,122880,97280,149504,143360,0,30720
.long 2176000,21504576,21508608,1073741824,21284864,21422088,779136,819200,1280,18864128,18865152,19209216,19210240,0,0,1073741824,21504008,21499904,21078272,21213696,1051011932,2244608,2048,1024,512,15409152,15413248,19894272,21500928,21478400,21494784,0,7047680,7129600,7211520,112640,21553152,21553152,21553152,2222080,15493120,18323456,18292736,15167488,15155200,18415616,15204352,2171520,0,0,2560,21504000,139264,139520,0,256,128000,87040,107520,112640,32768,47104,51200,147456
.long 2178560,21504608,21512704,1073741824,21285888,21422092,1279616,1966080,3072,20272128,20354048,20274176,20356096,21265664,0,0,21504012,21499904,21078400,21254656,1051011932,2285568,2048,1024,512,15548416,15552512,19896320,21500928,21494784,21511168,0,7293440,7375360,7457280,128000,21553152,21553152,21553152,2263040,15632384,18384896,18354176,15192064,15179776,18415616,15224832,2192000,0,0,2560,21504000,139520,139264,256,0,112640,102400,92160,128000,149504,143360,0,30720
.long 2211840,21508608,21500416,21285472,21282816,21426176,656128,1966080,1280,18255872,18599936,18600960,18601984,0,0,1073741824,21508096,21499904,21118976,21221376,1065353216,4775936,2048,1024,512,15155200,15159296,20217856,21501952,21474304,21490688,0,4444160,4526080,4608000,81920,21553152,21553152,21553152,2150400,15224832,16807936,16777216,15396864,15384576,17022976,15482880,2211840,0,0,2560,21508096,0,256,139264,139520,97280,117760,138240,81920,32768,47104,51200,147456
.long 2214400,21508640,21504512,1073741824,21283840,21426180,1720576,1966080,1280,17343488,17344512,17688576,17689600,0,0,1073741824,21508100,21499904,21119104,21262336,1065353216,4816896,2048,1024,512,15294464,15298560,20219904,21501952,21490688,21507072,0,4689920,4771840,4853760,97280,21553152,21553152,21553152,2191360,15364096,16869376,16838656,15421440,15409152,17022976,15503360,2232320,0,0,2560,21508096,256,0,139520,139264,81920,133120,122880,97280,149504,143360,0,30720
.long 2216960,21508672,21508608,1073741824,21284864,21426184,779264,819200,1280,19211264,19212288,19213312,19557376,0,0,1073741824,21508104,21499904,21119232,21223936,1065353216,4857856,2048,1024,512,15433728,15437824,20221952,21501952,21479424,21495808,0,7050240,7132160,7214080,112640,21553152,21553152,21553152,2232320,15503360,16930816,16900096,15446016,15433728,17022976,15482880,2252800,0,0,2560,21508096,139264,139520,0,256,128000,87040,107520,112640,32768,47104,51200,147456
.long 2219520,21508704,21512704,1073741824,21285888,21426188,1377920,1966080,3072,20276224,20358144,20278272,20360192,21265920,0,0,21508108,21499904,21119360,21264896,1065353216,4898816,2048,1024,512,15572992,15577088,20224000,21501952,21495808,21512192,0,7296000,7377920,7459840,128000,21553152,21553152,21553152,2273280,15642624,16992256,16961536,15470592,15458304,17022976,15503360,2273280,0,0,2560,21508096,139520,139264,256,0,112640,102400,92160,128000,149504,143360,0,30720
.long 2252800,21512704,21500416,21285488,21282816,21430272,656256,1966080,1280,18603008,18604032,18948096,18949120,0,0,1073741824,21512192,21499904,21159936,21231616,1065353216,7376896,512,20480,10240,15179776,15183872,20545536,21502976,21475328,21491712,1024,4454400,4536320,4618240,81920,21553152,21553152,21553152,2160640,15235072,18200576,18169856,15396864,15384576,18415616,15482880,2212480,0,0,2560,21512192,0,256,139264,139520,97280,117760,138240,81920,32768,47104,51200,147456
.long 2255360,21512736,21504512,1073741824,21283840,21430276,1720704,1966080,1280,17690624,17691648,17692672,18036736,0,0,1073741824,21512196,21499904,21160064,21272576,1065353216,7417856,512,20480,10240,15319040,15323136,20547584,21502976,21491712,21508096,1024,4700160,4782080,4864000,97280,21553152,21553152,21553152,2201600,15374336,18262016,18231296,15421440,15409152,18415616,15503360,2232960,0,0,2560,21512192,256,0,139520,139264,81920,133120,122880,97280,149504,143360,0,30720
.long 2257920,21512768,21508608,1073741824,21284864,21430280,779392,819200,1280,19558400,19559424,19560448,19561472,0,0,1073741824,21512200,21499904,21160192,21234176,1065353216,7458816,512,20480,10240,15458304,15462400,20549632,21502976,21480448,21496832,1024,7052800,7134720,7216640,112640,21553152,21553152,21553152,2242560,15513600,18323456,18292736,15446016,15433728,18415616,15482880,2253440,0,0,2560,21512192,139264,139520,0,256,128000,87040,107520,112640,32768,47104,51200,147456
.long 2260480,21512800,21512704,1073741824,21285888,21430284,1476224,1966080,3072,20280320,20362240,20282368,20364288,21266176,0,0,21512204,21499904,21160320,21275136,1065353216,7499776,512,20480,10240,15597568,15601664,20551680,21502976,21496832,21513216,1024,7298560,7380480,7462400,128000,21553152,21553152,21553152,2283520,15652864,18384896,18354176,15470592,15458304,18415616,15503360,2273920,0,0,2560,21512192,139520,139264,256,0,112640,102400,92160,128000,149504,143360,0,30720
.long 829440,21370368,21369344,21285504,21282816,21287936,656384,1966080,1280,18950144,18951168,18952192,19296256,0,0,1073741824,21369856,21368832,20883456,21201024,1051011932,827392,2048,1024,512,10657792,10655744,19644416,21368832,21341184,21357568,0,3115520,3197440,3279360,81920,21553152,21553152,21553152,821760,10750464,17156096,17125376,10661888,10649600,17371136,10747904,819360,0,0,2560,21369856,0,256,139264,139520,97280,117760,138240,81920,32768,47104,51200,147456
.long 832000,21370400,21373440,1073741824,21283840,21287940,1720832,1966080,1280,18037760,18038784,18039808,18040832,0,0,1073741824,21369860,21368832,20883584,21241984,1051011932,868352,2048,1024,512,10797056,10795008,19646464,21368832,21357568,21373952,0,3361280,3443200,3525120,97280,21553152,21553152,21553152,862720,10889728,17217536,17186816,10686464,10674176,17371136,10768384,839840,0,0,2560,21369856,256,0,139520,139264,81920,133120,122880,97280,149504,143360,0,30720
.long 834560,21370432,21377536,1073741824,21284864,21287944,128,1966080,3072,19562496,19644416,19564544,19646464,21200896,0,0,21369864,21368832,20883712,21203584,1051011932,909312,2048,1024,512,10936320,10934272,19648512,21368832,21346304,21362688,0,5735040,5816960,5898880,112640,21553152,21553152,21553152,903680,11028992,17278976,17248256,10711040,10698752,17371136,10747904,860320,0,0,2560,21369856,139264,139520,0,256,128000,87040,107520,112640,32768,47104,51200,147456
.long 837120,21370464,21381632,1073741824,21285888,21287948,1574528,1966080,3072,20284416,20366336,20286464,20368384,21266432,0,0,21369868,21368832,20883840,21244544,1051011932,950272,2048,1024,512,11075584,11073536,19650560,21368832,21362688,21379072,0,5980800,6062720,6144640,128000,21553152,21553152,21553152,944640,11168256,17340416,17309696,10735616,10723328,17371136,10768384,880800,0,0,2560,21369856,139520,139264,256,0,112640,102400,92160,128000,149504,143360,0,30720
.long 870400,21374464,21369344,21285520,21282816,21292032,656512,1966080,1280,19297280,19298304,19299328,19300352,0,0,1073741824,21373952,21368832,20924416,21211264,1065353216,3440640,2048,1024,512,10682368,10680320,19972096,21369856,21342208,21358592,0,3125760,3207680,3289600,81920,21553152,21553152,21553152,832000,10760704,18548736,18518016,10661888,10649600,18763776,10747904,820000,0,0,2560,21373952,0,256,139264,139520,97280,117760,138240,81920,32768,47104,51200,147456
.long 872960,21374496,21373440,1073741824,21283840,21292036,1720960,1966080,1280,18384896,18385920,18386944,18387968,0,0,1073741824,21373956,21368832,20924544,21252224,1065353216,3481600,2048,1024,512,10821632,10819584,19974144,21369856,21358592,21374976,0,3371520,3453440,3535360,97280,21553152,21553152,21553152,872960,10899968,18610176,18579456,10686464,10674176,18763776,10768384,840480,0,0,2560,21373952,256,0,139520,139264,81920,133120,122880,97280,149504,143360,0,30720
.long 875520,21374528,21377536,1073741824,21284864,21292040,98432,1966080,3072,19566592,19648512,19568640,19650560,21201152,0,0,21373960,21368832,20924672,21213824,1065353216,3522560,2048,1024,512,10960896,10958848,19976192,21369856,21347328,21363712,0,5737600,5819520,5901440,112640,21553152,21553152,21553152,913920,11039232,18671616,18640896,10711040,10698752,18763776,10747904,860960,0,0,2560,21373952,139264,139520,0,256,128000,87040,107520,112640,32768,47104,51200,147456
.long 878080,21374560,21381632,1073741824,21285888,21292044,1672832,1966080,3072,20288512,20370432,20290560,20372480,21266688,0,0,21373964,21368832,20924800,21254784,1065353216,3563520,2048,1024,512,11100160,11098112,19978240,21369856,21363712,21380096,0,5983360,6065280,6147200,128000,21553152,21553152,21553152,954880,11178496,18733056,18702336,10735616,10723328,18763776,10768384,881440,0,0,2560,21373952,139520,139264,256,0,112640,102400,92160,128000,149504,143360,0,30720
.long 911360,21378560,21369344,21285536,21282816,21296128,696320,1966080,1280,16864256,16865280,16866304,16867328,0,0,1073741824,21378048,21368832,20965376,21221504,1065353216,3473408,2048,1024,512,10706944,10704896,20299776,21370880,21343232,21359616,1024,3136000,3217920,3299840,81920,21553152,21553152,21553152,842240,10770944,17156096,17125376,10940416,10928128,17371136,11026432,901280,0,0,2560,21378048,0,256,139264,139520,97280,117760,138240,81920,32768,47104,51200,147456
.long 913920,21378592,21373440,1073741824,21283840,21296132,1721088,1966080,1280,18388992,18733056,18734080,18735104,0,0,1073741824,21378052,21368832,20965504,21262464,1065353216,3514368,2048,1024,512,10846208,10844160,20301824,21370880,21359616,21376000,1024,3381760,3463680,3545600,97280,21553152,21553152,21553152,883200,10910208,17217536,17186816,10964992,10952704,17371136,11046912,921760,0,0,2560,21378048,256,0,139520,139264,81920,133120,122880,97280,149504,143360,0,30720
.long 916480,21378624,21377536,1073741824,21284864,21296136,196736,1966080,3072,19570688,19652608,19572736,19654656,21201408,0,0,21378056,21368832,20965632,21224064,1065353216,3555328,2048,1024,512,10985472,10983424,20303872,21370880,21348352,21364736,1024,5740160,5822080,5904000,112640,21553152,21553152,21553152,924160,11049472,17278976,17248256,10989568,10977280,17371136,11026432,942240,0,0,2560,21378048,139264,139520,0,256,128000,87040,107520,112640,32768,47104,51200,147456
.long 919040,21378656,21381632,1073741824,21285888,21296140,1771136,1966080,3072,20292608,20374528,20294656,20376576,21266944,0,0,21378060,21368832,20965760,21265024,1065353216,3596288,2048,1024,512,11124736,11122688,20305920,21370880,21364736,21381120,1024,5985920,6067840,6149760,128000,21553152,21553152,21553152,965120,11188736,17340416,17309696,11014144,11001856,17371136,11046912,962720,0,0,2560,21378048,139520,139264,256,0,112640,102400,92160,128000,149504,143360,0,30720
.long 952320,21382656,21369344,21285552,21282816,21300224,696448,1966080,1280,16868352,17212416,17213440,17214464,0,0,1073741824,21382144,21368832,21006336,21231744,1065353216,6068224,512,20480,10240,10731520,10729472,20627456,21372928,21345280,21361664,0,3146240,3228160,3310080,81920,21553152,21553152,21553152,852480,10781184,18548736,18518016,10940416,10928128,18763776,11026432,901920,0,0,2560,21382144,0,256,139264,139520,97280,117760,138240,81920,32768,47104,51200,147456
.long 954880,21382688,21373440,1073741824,21283840,21300228,1721216,1966080,1280,18736128,18737152,19081216,19082240,0,0,1073741824,21382148,21368832,21006464,21272704,1065353216,6109184,512,20480,10240,10870784,10868736,20629504,21372928,21361664,21378048,0,3392000,3473920,3555840,97280,21553152,21553152,21553152,893440,10920448,18610176,18579456,10964992,10952704,18763776,11046912,922400,0,0,2560,21382144,256,0,139520,139264,81920,133120,122880,97280,149504,143360,0,30720
.long 957440,21382720,21377536,1073741824,21284864,21300232,295040,1966080,3072,19574784,19656704,19576832,19658752,21201664,0,0,21382152,21368832,21006592,21234304,1065353216,6150144,512,20480,10240,11010048,11008000,20631552,21372928,21350400,21366784,0,5742720,5824640,5906560,112640,21553152,21553152,21553152,934400,11059712,18671616,18640896,10989568,10977280,18763776,11026432,942880,0,0,2560,21382144,139264,139520,0,256,128000,87040,107520,112640,32768,47104,51200,147456
.long 960000,21382752,21381632,1073741824,21285888,21300236,1869440,1966080,3072,20296704,20378624,20298752,20380672,21267200,0,0,21382156,21368832,21006720,21275264,1065353216,6191104,512,20480,10240,11149312,11147264,20633600,21372928,21366784,21383168,0,5988480,6070400,6152320,128000,21553152,21553152,21553152,975360,11198976,18733056,18702336,11014144,11001856,18763776,11046912,963360,0,0,2560,21382144,139520,139264,256,0,112640,102400,92160,128000,149504,143360,0,30720
.long 2140160,21501440,21500416,21285568,21282816,21419008,696576,1966080,1280,17215488,17216512,17560576,17561600,0,0,1073741824,21500928,21499904,21047296,21201024,1051011932,2138112,2048,1024,512,15114240,15112192,19644416,21499904,21472256,21488640,0,4426240,4508160,4590080,81920,21553152,21553152,21553152,2132480,15206912,17156096,17125376,15118336,15106048,17371136,15204352,2130080,0,0,2560,21500928,0,256,139264,139520,97280,117760,138240,81920,32768,47104,51200,147456
.long 2142720,21501472,21504512,1073741824,21283840,21419012,1721344,1966080,1280,19083264,19084288,19085312,19429376,0,0,1073741824,21500932,21499904,21047424,21241984,1051011932,2179072,2048,1024,512,15253504,15251456,19646464,21499904,21488640,21505024,0,4672000,4753920,4835840,97280,21553152,21553152,21553152,2173440,15346176,17217536,17186816,15142912,15130624,17371136,15224832,2150560,0,0,2560,21500928,256,0,139520,139264,81920,133120,122880,97280,149504,143360,0,30720
.long 2145280,21501504,21508608,1073741824,21284864,21419016,393344,1966080,3072,19578880,19660800,19580928,19662848,21201920,0,0,21500936,21499904,21047552,21203584,1051011932,2220032,2048,1024,512,15392768,15390720,19648512,21499904,21477376,21493760,0,7045760,7127680,7209600,112640,21553152,21553152,21553152,2214400,15485440,17278976,17248256,15167488,15155200,17371136,15204352,2171040,0,0,2560,21500928,139264,139520,0,256,128000,87040,107520,112640,32768,47104,51200,147456
.long 2147840,21501536,21512704,1073741824,21285888,21419020,2048,1966080,3072,20382720,20464640,20384768,20466688,21267456,0,0,21500940,21499904,21047680,21244544,1051011932,2260992,2048,1024,512,15532032,15529984,19650560,21499904,21493760,21510144,0,7291520,7373440,7455360,128000,21553152,21553152,21553152,2255360,15624704,17340416,17309696,15192064,15179776,17371136,15224832,2191520,0,0,2560,21500928,139520,139264,256,0,112640,102400,92160,128000,149504,143360,0,30720
.long 2181120,21505536,21500416,21285584,21282816,21423104,696704,1966080,1280,17562624,17563648,17564672,17908736,0,0,1073741824,21505024,21499904,21088256,21211264,1065353216,4751360,2048,1024,512,15138816,15136768,19972096,21500928,21473280,21489664,0,4436480,4518400,4600320,81920,21553152,21553152,21553152,2142720,15217152,18548736,18518016,15118336,15106048,18763776,15204352,2130720,0,0,2560,21505024,0,256,139264,139520,97280,117760,138240,81920,32768,47104,51200,147456
.long 2183680,21505568,21504512,1073741824,21283840,21423108,1721472,1966080,1280,19430400,19431424,19432448,19433472,0,0,1073741824,21505028,21499904,21088384,21252224,1065353216,4792320,2048,1024,512,15278080,15276032,19974144,21500928,21489664,21506048,0,4682240,4764160,4846080,97280,21553152,21553152,21553152,2183680,15356416,18610176,18579456,15142912,15130624,18763776,15224832,2151200,0,0,2560,21505024,256,0,139520,139264,81920,133120,122880,97280,149504,143360,0,30720
.long 2186240,21505600,21508608,1073741824,21284864,21423112,491648,1966080,3072,19582976,19664896,19585024,19666944,21202176,0,0,21505032,21499904,21088512,21213824,1065353216,4833280,2048,1024,512,15417344,15415296,19976192,21500928,21478400,21494784,0,7048320,7130240,7212160,112640,21553152,21553152,21553152,2224640,15495680,18671616,18640896,15167488,15155200,18763776,15204352,2171680,0,0,2560,21505024,139264,139520,0,256,128000,87040,107520,112640,32768,47104,51200,147456
.long 2188800,21505632,21512704,1073741824,21285888,21423116,100352,1966080,3072,20386816,20468736,20388864,20470784,21267712,0,0,21505036,21499904,21088640,21254784,1065353216,4874240,2048,1024,512,15556608,15554560,19978240,21500928,21494784,21511168,0,7294080,7376000,7457920,128000,21553152,21553152,21553152,2265600,15634944,18733056,18702336,15192064,15179776,18763776,15224832,2192160,0,0,2560,21505024,139520,139264,256,0,112640,102400,92160,128000,149504,143360,0,30720
.long 2222080,21509632,21500416,21285600,21282816,21427200,696832,1966080,1280,17909760,17910784,17911808,17912832,0,0,1073741824,21509120,21499904,21129216,21221504,1065353216,4784128,2048,1024,512,15163392,15161344,20299776,21501952,21474304,21490688,1024,4446720,4528640,4610560,81920,21553152,21553152,21553152,2152960,15227392,17156096,17125376,15396864,15384576,17371136,15482880,2212000,0,0,2560,21509120,0,256,139264,139520,97280,117760,138240,81920,32768,47104,51200,147456
.long 2224640,21509664,21504512,1073741824,21283840,21427204,1761280,1966080,1280,16997376,16998400,16999424,17000448,0,0,1073741824,21509124,21499904,21129344,21262464,1065353216,4825088,2048,1024,512,15302656,15300608,20301824,21501952,21490688,21507072,1024,4692480,4774400,4856320,97280,21553152,21553152,21553152,2193920,15366656,17217536,17186816,15421440,15409152,17371136,15503360,2232480,0,0,2560,21509120,256,0,139520,139264,81920,133120,122880,97280,149504,143360,0,30720
.long 2227200,21509696,21508608,1073741824,21284864,21427208,589952,1966080,3072,19587072,19668992,19589120,19671040,21202432,0,0,21509128,21499904,21129472,21224064,1065353216,4866048,2048,1024,512,15441920,15439872,20303872,21501952,21479424,21495808,1024,7050880,7132800,7214720,112640,21553152,21553152,21553152,2234880,15505920,17278976,17248256,15446016,15433728,17371136,15482880,2252960,0,0,2560,21509120,139264,139520,0,256,128000,87040,107520,112640,32768,47104,51200,147456
.long 2229760,21509728,21512704,1073741824,21285888,21427212,198656,1966080,3072,20390912,20472832,20392960,20474880,21267968,0,0,21509132,21499904,21129600,21265024,1065353216,4907008,2048,1024,512,15581184,15579136,20305920,21501952,21495808,21512192,1024,7296640,7378560,7460480,128000,21553152,21553152,21553152,2275840,15645184,17340416,17309696,15470592,15458304,17371136,15503360,2273440,0,0,2560,21509120,139520,139264,256,0,112640,102400,92160,128000,149504,143360,0,30720
.long 2263040,21513728,21500416,21285616,21282816,21431296,696960,1966080,1280,18256896,18257920,18258944,18259968,0,0,1073741824,21513216,21499904,21170176,21231744,1065353216,7378944,512,20480,10240,15187968,15185920,20627456,21504000,21476352,21492736,0,4456960,4538880,4620800,81920,21553152,21553152,21553152,2163200,15237632,18548736,18518016,15396864,15384576,18763776,15482880,2212640,0,0,2560,21513216,0,256,139264,139520,97280,117760,138240,81920,32768,47104,51200,147456
.long 2265600,21513760,21504512,1073741824,21283840,21431300,1761408,1966080,1280,17001472,17345536,17346560,17347584,0,0,1073741824,21513220,21499904,21170304,21272704,1065353216,7419904,512,20480,10240,15327232,15325184,20629504,21504000,21492736,21509120,0,4702720,4784640,4866560,97280,21553152,21553152,21553152,2204160,15376896,18610176,18579456,15421440,15409152,18763776,15503360,2233120,0,0,2560,21513216,256,0,139520,139264,81920,133120,122880,97280,149504,143360,0,30720
.long 2268160,21513792,21508608,1073741824,21284864,21431304,688256,1966080,3072,19591168,19673088,19593216,19675136,21202688,0,0,21513224,21499904,21170432,21234304,1065353216,7460864,512,20480,10240,15466496,15464448,20631552,21504000,21481472,21497856,0,7053440,7135360,7217280,112640,21553152,21553152,21553152,2245120,15516160,18671616,18640896,15446016,15433728,18763776,15482880,2253600,0,0,2560,21513216,139264,139520,0,256,128000,87040,107520,112640,32768,47104,51200,147456
.long 2270720,21513824,21512704,1073741824,21285888,21431308,296960,1966080,3072,20395008,20476928,20397056,20478976,21268224,0,0,21513228,21499904,21170560,21275264,1065353216,7501824,512,20480,10240,15605760,15603712,20633600,21504000,21497856,21514240,0,7299200,7381120,7463040,128000,21553152,21553152,21553152,2286080,15655424,18733056,18702336,15470592,15458304,18763776,15503360,2274080,0,0,2560,21513216,139520,139264,256,0,112640,102400,92160,128000,149504,143360,0,30720
.long 839680,21371392,21369344,21285632,21282816,21288960,697088,1966080,1280,18260992,18605056,18606080,18607104,0,0,1073741824,21370880,21368832,20893696,21206016,1051011932,835584,2048,1024,512,10661888,10665984,19726336,21368832,21341184,21357568,0,3118080,3200000,3281920,81920,21553152,21553152,21553152,824320,10753024,17504256,17473536,10661888,10649600,17719296,10747904,819520,0,0,2560,21370880,0,256,139264,139520,97280,117760,138240,81920,32768,47104,51200,147456
.long 842240,21371424,21373440,1073741824,21283840,21288964,1761536,1966080,1280,17348608,17349632,17693696,17694720,0,0,1073741824,21370884,21368832,20893824,21246976,1051011932,876544,2048,1024,512,10801152,10805248,19728384,21368832,21357568,21373952,0,3363840,3445760,3527680,97280,21553152,21553152,21553152,865280,10892288,17565696,17534976,10686464,10674176,17719296,10768384,840000,0,0,2560,21370880,256,0,139520,139264,81920,133120,122880,97280,149504,143360,0,30720
.long 844800,21371456,21377536,1073741824,21284864,21288968,786560,1966080,3072,19595264,19677184,19597312,19679232,21202944,0,0,21370888,21368832,20893952,21208576,1051011932,917504,2048,1024,512,10940416,10944512,19730432,21368832,21346304,21362688,0,5735680,5817600,5899520,112640,21553152,21553152,21553152,906240,11031552,17627136,17596416,10711040,10698752,17719296,10747904,860480,0,0,2560,21370880,139264,139520,0,256,128000,87040,107520,112640,32768,47104,51200,147456
.long 847360,21371488,21381632,1073741824,21285888,21288972,395264,1966080,3072,20399104,20481024,20401152,20483072,21268480,0,0,21370892,21368832,20894080,21249536,1051011932,958464,2048,1024,512,11079680,11083776,19732480,21368832,21362688,21379072,0,5981440,6063360,6145280,128000,21553152,21553152,21553152,947200,11170816,17688576,17657856,10735616,10723328,17719296,10768384,880960,0,0,2560,21370880,139520,139264,256,0,112640,102400,92160,128000,149504,143360,0,30720
.long 880640,21375488,21369344,21285648,21282816,21293056,697216,1966080,1280,18608128,18609152,18953216,18954240,0,0,1073741824,21374976,21368832,20934656,21216256,1065353216,3448832,2048,1024,512,10686464,10690560,20054016,21369856,21342208,21358592,1024,3128320,3210240,3292160,81920,21553152,21553152,21553152,834560,10763264,18896896,18866176,10661888,10649600,19111936,10747904,820160,0,0,2560,21374976,0,256,139264,139520,97280,117760,138240,81920,32768,47104,51200,147456
.long 883200,21375520,21373440,1073741824,21283840,21293060,1761664,1966080,1280,17695744,17696768,17697792,18041856,0,0,1073741824,21374980,21368832,20934784,21257216,1065353216,3489792,2048,1024,512,10825728,10829824,20056064,21369856,21358592,21374976,1024,3374080,3456000,3537920,97280,21553152,21553152,21553152,875520,10902528,18958336,18927616,10686464,10674176,19111936,10768384,840640,0,0,2560,21374976,256,0,139520,139264,81920,133120,122880,97280,149504,143360,0,30720
.long 885760,21375552,21377536,1073741824,21284864,21293064,884864,1966080,3072,19599360,19681280,19601408,19683328,21203200,0,0,21374984,21368832,20934912,21218816,1065353216,3530752,2048,1024,512,10964992,10969088,20058112,21369856,21347328,21363712,1024,5738240,5820160,5902080,112640,21553152,21553152,21553152,916480,11041792,19019776,18989056,10711040,10698752,19111936,10747904,861120,0,0,2560,21374976,139264,139520,0,256,128000,87040,107520,112640,32768,47104,51200,147456
.long 888320,21375584,21381632,1073741824,21285888,21293068,493568,1966080,3072,20403200,20485120,20405248,20487168,21268736,0,0,21374988,21368832,20935040,21259776,1065353216,3571712,2048,1024,512,11104256,11108352,20060160,21369856,21363712,21380096,1024,5984000,6065920,6147840,128000,21553152,21553152,21553152,957440,11181056,19081216,19050496,10735616,10723328,19111936,10768384,881600,0,0,2560,21374976,139520,139264,256,0,112640,102400,92160,128000,149504,143360,0,30720
.long 921600,21379584,21369344,21285664,21282816,21297152,697344,1966080,1280,18955264,18956288,18957312,19301376,0,0,1073741824,21379072,21368832,20975616,21226496,1065353216,6062080,512,20480,10240,10711040,10715136,20381696,21371904,21344256,21360640,0,3138560,3220480,3302400,81920,21553152,21553152,21553152,844800,10773504,17504256,17473536,10940416,10928128,17719296,11026432,901440,0,0,2560,21379072,0,256,139264,139520,97280,117760,138240,81920,32768,47104,51200,147456
.long 924160,21379616,21373440,1073741824,21283840,21297156,1761792,1966080,1280,18042880,18043904,18044928,18045952,0,0,1073741824,21379076,21368832,20975744,21267456,1065353216,6103040,512,20480,10240,10850304,10854400,20383744,21371904,21360640,21377024,0,3384320,3466240,3548160,97280,21553152,21553152,21553152,885760,10912768,17565696,17534976,10964992,10952704,17719296,11046912,921920,0,0,2560,21379072,256,0,139520,139264,81920,133120,122880,97280,149504,143360,0,30720
.long 926720,21379648,21377536,1073741824,21284864,21297160,983168,1966080,3072,19603456,19685376,19605504,19687424,21203456,0,0,21379080,21368832,20975872,21229056,1065353216,6144000,512,20480,10240,10989568,10993664,20385792,21371904,21349376,21365760,0,5740800,5822720,5904640,112640,21553152,21553152,21553152,926720,11052032,17627136,17596416,10989568,10977280,17719296,11026432,942400,0,0,2560,21379072,139264,139520,0,256,128000,87040,107520,112640,32768,47104,51200,147456
.long 929280,21379680,21381632,1073741824,21285888,21297164,591872,1966080,3072,20407296,20489216,20409344,20491264,21268992,0,0,21379084,21368832,20976000,21270016,1065353216,6184960,512,20480,10240,11128832,11132928,20387840,21371904,21365760,21382144,0,5986560,6068480,6150400,128000,21553152,21553152,21553152,967680,11191296,17688576,17657856,11014144,11001856,17719296,11046912,962880,0,0,2560,21379072,139520,139264,256,0,112640,102400,92160,128000,149504,143360,0,30720
.long 962560,21383680,21369344,21285680,21282816,21301248,697472,1966080,1280,19302400,19303424,19304448,19305472,0,0,1073741824,21383168,21368832,21016576,21236736,1065353216,6070272,512,20480,10240,10735616,10739712,20709376,21372928,21345280,21361664,0,3148800,3230720,3312640,81920,21553152,21553152,21553152,855040,10783744,18896896,18866176,10940416,10928128,19111936,11026432,902080,0,0,2560,21383168,0,256,139264,139520,97280,117760,138240,81920,32768,47104,51200,147456
.long 965120,21383712,21373440,1073741824,21283840,21301252,1761920,1966080,1280,18390016,18391040,18392064,18393088,0,0,1073741824,21383172,21368832,21016704,21277696,1065353216,6111232,512,20480,10240,10874880,10878976,20711424,21372928,21361664,21378048,0,3394560,3476480,3558400,97280,21553152,21553152,21553152,896000,10923008,18958336,18927616,10964992,10952704,19111936,11046912,922560,0,0,2560,21383168,256,0,139520,139264,81920,133120,122880,97280,149504,143360,0,30720
.long 967680,21383744,21377536,1073741824,21284864,21301256,1081472,1966080,3072,19607552,19689472,19609600,19691520,21203712,0,0,21383176,21368832,21016832,21239296,1065353216,6152192,512,20480,10240,11014144,11018240,20713472,21372928,21350400,21366784,0,5743360,5825280,5907200,112640,21553152,21553152,21553152,936960,11062272,19019776,18989056,10989568,10977280,19111936,11026432,943040,0,0,2560,21383168,139264,139520,0,256,128000,87040,107520,112640,32768,47104,51200,147456
.long 970240,21383776,21381632,1073741824,21285888,21301260,690176,1966080,3072,20411392,20493312,20413440,20495360,21269248,0,0,21383180,21368832,21016960,21280256,1065353216,6193152,512,20480,10240,11153408,11157504,20715520,21372928,21366784,21383168,0,5989120,6071040,6152960,128000,21553152,21553152,21553152,977920,11201536,19081216,19050496,11014144,11001856,19111936,11046912,963520,0,0,2560,21383168,139520,139264,256,0,112640,102400,92160,128000,149504,143360,0,30720
.long 2150400,21502464,21500416,21285696,21282816,21420032,737280,1966080,1280,16869376,16870400,16871424,16872448,0,0,1073741824,21501952,21499904,21057536,21206016,1051011932,2146304,2048,1024,512,15118336,15122432,19726336,21499904,21472256,21488640,0,4428800,4510720,4592640,81920,21553152,21553152,21553152,2135040,15209472,17504256,17473536,15118336,15106048,17719296,15204352,2130240,0,0,2560,21501952,0,256,139264,139520,97280,117760,138240,81920,32768,47104,51200,147456
.long 2152960,21502496,21504512,1073741824,21283840,21420036,1762048,1966080,1280,18394112,18738176,18739200,18740224,0,0,1073741824,21501956,21499904,21057664,21246976,1051011932,2187264,2048,1024,512,15257600,15261696,19728384,21499904,21488640,21505024,0,4674560,4756480,4838400,97280,21553152,21553152,21553152,2176000,15348736,17565696,17534976,15142912,15130624,17719296,15224832,2150720,0,0,2560,21501952,256,0,139520,139264,81920,133120,122880,97280,149504,143360,0,30720
.long 2155520,21502528,21508608,1073741824,21284864,21420040,1179776,1966080,3072,19611648,19693568,19613696,19695616,21203968,0,0,21501960,21499904,21057792,21208576,1051011932,2228224,2048,1024,512,15396864,15400960,19730432,21499904,21477376,21493760,0,7046400,7128320,7210240,112640,21553152,21553152,21553152,2216960,15488000,17627136,17596416,15167488,15155200,17719296,15204352,2171200,0,0,2560,21501952,139264,139520,0,256,128000,87040,107520,112640,32768,47104,51200,147456
.long 2158080,21502560,21512704,1073741824,21285888,21420044,788480,1966080,3072,20415488,20497408,20417536,20499456,21269504,0,0,21501964,21499904,21057920,21249536,1051011932,2269184,2048,1024,512,15536128,15540224,19732480,21499904,21493760,21510144,0,7292160,7374080,7456000,128000,21553152,21553152,21553152,2257920,15627264,17688576,17657856,15192064,15179776,17719296,15224832,2191680,0,0,2560,21501952,139520,139264,256,0,112640,102400,92160,128000,149504,143360,0,30720
.long 2191360,21506560,21500416,21285712,21282816,21424128,737408,1966080,1280,16873472,17217536,17218560,17219584,0,0,1073741824,21506048,21499904,21098496,21216256,1065353216,4759552,2048,1024,512,15142912,15147008,20054016,21500928,21473280,21489664,1024,4439040,4520960,4602880,81920,21553152,21553152,21553152,2145280,15219712,18896896,18866176,15118336,15106048,19111936,15204352,2130880,0,0,2560,21506048,0,256,139264,139520,97280,117760,138240,81920,32768,47104,51200,147456
.long 2193920,21506592,21504512,1073741824,21283840,21424132,1762176,1966080,1280,18741248,18742272,19086336,19087360,0,0,1073741824,21506052,21499904,21098624,21257216,1065353216,4800512,2048,1024,512,15282176,15286272,20056064,21500928,21489664,21506048,1024,4684800,4766720,4848640,97280,21553152,21553152,21553152,2186240,15358976,18958336,18927616,15142912,15130624,19111936,15224832,2151360,0,0,2560,21506048,256,0,139520,139264,81920,133120,122880,97280,149504,143360,0,30720
.long 2196480,21506624,21508608,1073741824,21284864,21424136,1278080,1966080,3072,19615744,19697664,19617792,19699712,21204224,0,0,21506056,21499904,21098752,21218816,1065353216,4841472,2048,1024,512,15421440,15425536,20058112,21500928,21478400,21494784,1024,7048960,7130880,7212800,112640,21553152,21553152,21553152,2227200,15498240,19019776,18989056,15167488,15155200,19111936,15204352,2171840,0,0,2560,21506048,139264,139520,0,256,128000,87040,107520,112640,32768,47104,51200,147456
.long 2199040,21506656,21512704,1073741824,21285888,21424140,886784,1966080,3072,20419584,20501504,20421632,20503552,21269760,0,0,21506060,21499904,21098880,21259776,1065353216,4882432,2048,1024,512,15560704,15564800,20060160,21500928,21494784,21511168,1024,7294720,7376640,7458560,128000,21553152,21553152,21553152,2268160,15637504,19081216,19050496,15192064,15179776,19111936,15224832,2192320,0,0,2560,21506048,139520,139264,256,0,112640,102400,92160,128000,149504,143360,0,30720
.long 2232320,21510656,21500416,21285728,21282816,21428224,737536,1966080,1280,17220608,17221632,17565696,17566720,0,0,1073741824,21510144,21499904,21139456,21226496,1065353216,7372800,512,20480,10240,15167488,15171584,20381696,21502976,21475328,21491712,0,4449280,4531200,4613120,81920,21553152,21553152,21553152,2155520,15229952,17504256,17473536,15396864,15384576,17719296,15482880,2212160,0,0,2560,21510144,0,256,139264,139520,97280,117760,138240,81920,32768,47104,51200,147456
.long 2234880,21510688,21504512,1073741824,21283840,21428228,1762304,1966080,1280,19088384,19089408,19090432,19434496,0,0,1073741824,21510148,21499904,21139584,21267456,1065353216,7413760,512,20480,10240,15306752,15310848,20383744,21502976,21491712,21508096,0,4695040,4776960,4858880,97280,21553152,21553152,21553152,2196480,15369216,17565696,17534976,15421440,15409152,17719296,15503360,2232640,0,0,2560,21510144,256,0,139520,139264,81920,133120,122880,97280,149504,143360,0,30720
.long 2237440,21510720,21508608,1073741824,21284864,21428232,1376384,1966080,3072,19619840,19701760,19621888,19703808,21204480,0,0,21510152,21499904,21139712,21229056,1065353216,7454720,512,20480,10240,15446016,15450112,20385792,21502976,21480448,21496832,0,7051520,7133440,7215360,112640,21553152,21553152,21553152,2237440,15508480,17627136,17596416,15446016,15433728,17719296,15482880,2253120,0,0,2560,21510144,139264,139520,0,256,128000,87040,107520,112640,32768,47104,51200,147456
.long 2240000,21510752,21512704,1073741824,21285888,21428236,985088,1966080,3072,20423680,20505600,20425728,20507648,21270016,0,0,21510156,21499904,21139840,21270016,1065353216,7495680,512,20480,10240,15585280,15589376,20387840,21502976,21496832,21513216,0,7297280,7379200,7461120,128000,21553152,21553152,21553152,2278400,15647744,17688576,17657856,15470592,15458304,17719296,15503360,2273600,0,0,2560,21510144,139520,139264,256,0,112640,102400,92160,128000,149504,143360,0,30720
.long 2273280,21514752,21500416,21285744,21282816,21432320,737664,1966080,1280,17567744,17568768,17569792,17913856,0,0,1073741824,21514240,21499904,21180416,21236736,1065353216,7380992,512,20480,10240,15192064,15196160,20709376,21504000,21476352,21492736,0,4459520,4541440,4623360,81920,21553152,21553152,21553152,2165760,15240192,18896896,18866176,15396864,15384576,19111936,15482880,2212800,0,0,2560,21514240,0,256,139264,139520,97280,117760,138240,81920,32768,47104,51200,147456
.long 2275840,21514784,21504512,1073741824,21283840,21432324,1762432,1966080,1280,19435520,19436544,19437568,19438592,0,0,1073741824,21514244,21499904,21180544,21277696,1065353216,7421952,512,20480,10240,15331328,15335424,20711424,21504000,21492736,21509120,0,4705280,4787200,4869120,97280,21553152,21553152,21553152,2206720,15379456,18958336,18927616,15421440,15409152,19111936,15503360,2233280,0,0,2560,21514240,256,0,139520,139264,81920,133120,122880,97280,149504,143360,0,30720
.long 2278400,21514816,21508608,1073741824,21284864,21432328,1474688,1966080,3072,19623936,19705856,19625984,19707904,21204736,0,0,21514248,21499904,21180672,21239296,1065353216,7462912,512,20480,10240,15470592,15474688,20713472,21504000,21481472,21497856,0,7054080,7136000,7217920,112640,21553152,21553152,21553152,2247680,15518720,19019776,18989056,15446016,15433728,19111936,15482880,2253760,0,0,2560,21514240,139264,139520,0,256,128000,87040,107520,112640,32768,47104,51200,147456
.long 2280960,21514848,21512704,1073741824,21285888,21432332,1083392,1966080,3072,20427776,20509696,20429824,20511744,21270272,0,0,21514252,21499904,21180800,21280256,1065353216,7503872,512,20480,10240,15609856,15613952,20715520,21504000,21497856,21514240,0,7299840,7381760,7463680,128000,21553152,21553152,21553152,2288640,15657984,19081216,19050496,15470592,15458304,19111936,15503360,2274240,0,0,2560,21514240,139520,139264,256,0,112640,102400,92160,128000,149504,143360,0,30720
.long 849920,21372416,21369344,21285760,21282816,21289984,737792,1966080,1280,17914880,17915904,17916928,17917952,0,0,1073741824,21371904,21368832,20903936,21206144,1051011932,843776,2048,1024,512,10670080,10668032,19808256,21368832,21341184,21357568,1024,3120640,3202560,3284480,81920,21553152,21553152,21553152,826880,10755584,17852416,17821696,10661888,10649600,18067456,10747904,819680,0,0,2560,21371904,0,256,139264,139520,97280,117760,138240,81920,32768,47104,51200,147456
.long 852480,21372448,21373440,1073741824,21283840,21289988,1802240,1966080,1280,17002496,17003520,17004544,17005568,0,0,1073741824,21371908,21368832,20904064,21247104,1051011932,884736,2048,1024,512,10809344,10807296,19810304,21368832,21357568,21373952,1024,3366400,3448320,3530240,97280,21553152,21553152,21553152,867840,10894848,17913856,17883136,10686464,10674176,18067456,10768384,840160,0,0,2560,21371904,256,0,139520,139264,81920,133120,122880,97280,149504,143360,0,30720
.long 855040,21372480,21377536,1073741824,21284864,21289992,1572992,1966080,3072,19628032,19709952,19630080,19712000,21204992,0,0,21371912,21368832,20904192,21208704,1051011932,925696,2048,1024,512,10948608,10946560,19812352,21368832,21346304,21362688,1024,5736320,5818240,5900160,112640,21553152,21553152,21553152,908800,11034112,17975296,17944576,10711040,10698752,18067456,10747904,860640,0,0,2560,21371904,139264,139520,0,256,128000,87040,107520,112640,32768,47104,51200,147456
.long 857600,21372512,21381632,1073741824,21285888,21289996,1181696,1966080,3072,20431872,20513792,20433920,20515840,21270528,0,0,21371916,21368832,20904320,21249664,1051011932,966656,2048,1024,512,11087872,11085824,19814400,21368832,21362688,21379072,1024,5982080,6064000,6145920,128000,21553152,21553152,21553152,949760,11173376,18036736,18006016,10735616,10723328,18067456,10768384,881120,0,0,2560,21371904,139520,139264,256,0,112640,102400,92160,128000,149504,143360,0,30720
.long 890880,21376512,21369344,21285776,21282816,21294080,737920,1966080,1280,18262016,18263040,18264064,18265088,0,0,1073741824,21376000,21368832,20944896,21216384,1065353216,3457024,2048,1024,512,10694656,10692608,20135936,21370880,21343232,21359616,0,3130880,3212800,3294720,81920,21553152,21553152,21553152,837120,10765824,19245056,19214336,10661888,10649600,19460096,10747904,820320,0,0,2560,21376000,0,256,139264,139520,97280,117760,138240,81920,32768,47104,51200,147456
.long 893440,21376544,21373440,1073741824,21283840,21294084,1802368,1966080,1280,17006592,17350656,17351680,17352704,0,0,1073741824,21376004,21368832,20945024,21257344,1065353216,3497984,2048,1024,512,10833920,10831872,20137984,21370880,21359616,21376000,0,3376640,3458560,3540480,97280,21553152,21553152,21553152,878080,10905088,19306496,19275776,10686464,10674176,19460096,10768384,840800,0,0,2560,21376000,256,0,139520,139264,81920,133120,122880,97280,149504,143360,0,30720
.long 896000,21376576,21377536,1073741824,21284864,21294088,1671296,1966080,3072,19632128,19714048,19634176,19716096,21205248,0,0,21376008,21368832,20945152,21218944,1065353216,3538944,2048,1024,512,10973184,10971136,20140032,21370880,21348352,21364736,0,5738880,5820800,5902720,112640,21553152,21553152,21553152,919040,11044352,19367936,19337216,10711040,10698752,19460096,10747904,861280,0,0,2560,21376000,139264,139520,0,256,128000,87040,107520,112640,32768,47104,51200,147456
.long 898560,21376608,21381632,1073741824,21285888,21294092,1280000,1966080,3072,20435968,20517888,20438016,20519936,21270784,0,0,21376012,21368832,20945280,21259904,1065353216,3579904,2048,1024,512,11112448,11110400,20142080,21370880,21364736,21381120,0,5984640,6066560,6148480,128000,21553152,21553152,21553152,960000,11183616,19429376,19398656,10735616,10723328,19460096,10768384,881760,0,0,2560,21376000,139520,139264,256,0,112640,102400,92160,128000,149504,143360,0,30720
.long 931840,21380608,21369344,21285792,21282816,21298176,738048,1966080,1280,18266112,18610176,18611200,18612224,0,0,1073741824,21380096,21368832,20985856,21226624,1065353216,6064128,512,20480,10240,10719232,10717184,20463616,21371904,21344256,21360640,0,3141120,3223040,3304960,81920,21553152,21553152,21553152,847360,10776064,17852416,17821696,10940416,10928128,18067456,11026432,901600,0,0,2560,21380096,0,256,139264,139520,97280,117760,138240,81920,32768,47104,51200,147456
.long 934400,21380640,21373440,1073741824,21283840,21298180,1802496,1966080,1280,17353728,17354752,17698816,17699840,0,0,1073741824,21380100,21368832,20985984,21267584,1065353216,6105088,512,20480,10240,10858496,10856448,20465664,21371904,21360640,21377024,0,3386880,3468800,3550720,97280,21553152,21553152,21553152,888320,10915328,17913856,17883136,10964992,10952704,18067456,11046912,922080,0,0,2560,21380096,256,0,139520,139264,81920,133120,122880,97280,149504,143360,0,30720
.long 936960,21380672,21377536,1073741824,21284864,21298184,1769600,1966080,3072,19636224,19718144,19638272,19720192,21205504,0,0,21380104,21368832,20986112,21229184,1065353216,6146048,512,20480,10240,10997760,10995712,20467712,21371904,21349376,21365760,0,5741440,5823360,5905280,112640,21553152,21553152,21553152,929280,11054592,17975296,17944576,10989568,10977280,18067456,11026432,942560,0,0,2560,21380096,139264,139520,0,256,128000,87040,107520,112640,32768,47104,51200,147456
.long 939520,21380704,21381632,1073741824,21285888,21298188,1378304,1966080,3072,20440064,20521984,20442112,20524032,21271040,0,0,21380108,21368832,20986240,21270144,1065353216,6187008,512,20480,10240,11137024,11134976,20469760,21371904,21365760,21382144,0,5987200,6069120,6151040,128000,21553152,21553152,21553152,970240,11193856,18036736,18006016,11014144,11001856,18067456,11046912,963040,0,0,2560,21380096,139520,139264,256,0,112640,102400,92160,128000,149504,143360,0,30720
.long 972800,21384704,21369344,21285808,21282816,21302272,738176,1966080,1280,18613248,18614272,18958336,18959360,0,0,1073741824,21384192,21368832,21026816,21236864,1065353216,8683520,512,20480,10240,10743808,10741760,20791296,21372928,21345280,21361664,0,3151360,3233280,3315200,81920,21553152,21553152,21553152,857600,10786304,19245056,19214336,10940416,10928128,19460096,11026432,902240,0,0,2560,21384192,0,256,139264,139520,97280,117760,138240,81920,32768,47104,51200,147456
.long 975360,21384736,21373440,1073741824,21283840,21302276,1802624,1966080,1280,17700864,17701888,17702912,18046976,0,0,1073741824,21384196,21368832,21026944,21277824,1065353216,8724480,512,20480,10240,10883072,10881024,20793344,21372928,21361664,21378048,0,3397120,3479040,3560960,97280,21553152,21553152,21553152,898560,10925568,19306496,19275776,10964992,10952704,19460096,11046912,922720,0,0,2560,21384192,256,0,139520,139264,81920,133120,122880,97280,149504,143360,0,30720
.long 977920,21384768,21377536,1073741824,21284864,21302280,1867904,1966080,3072,19640320,19722240,19642368,19724288,21205760,0,0,21384200,21368832,21027072,21239424,1065353216,8765440,512,20480,10240,11022336,11020288,20795392,21372928,21350400,21366784,0,5744000,5825920,5907840,112640,21553152,21553152,21553152,939520,11064832,19367936,19337216,10989568,10977280,19460096,11026432,943200,0,0,2560,21384192,139264,139520,0,256,128000,87040,107520,112640,32768,47104,51200,147456
.long 980480,21384800,21381632,1073741824,21285888,21302284,1476608,1966080,3072,20444160,20526080,20446208,20528128,21271296,0,0,21384204,21368832,21027200,21280384,1065353216,8806400,512,20480,10240,11161600,11159552,20797440,21372928,21366784,21383168,0,5989760,6071680,6153600,128000,21553152,21553152,21553152,980480,11204096,19429376,19398656,11014144,11001856,19460096,11046912,963680,0,0,2560,21384192,139520,139264,256,0,112640,102400,92160,128000,149504,143360,0,30720
.long 2160640,21503488,21500416,21285824,21282816,21421056,738304,1966080,1280,18960384,18961408,18962432,19306496,0,0,1073741824,21502976,21499904,21067776,21206144,1051011932,2154496,2048,1024,512,15126528,15124480,19808256,21499904,21472256,21488640,1024,4431360,4513280,4595200,81920,21553152,21553152,21553152,2137600,15212032,17852416,17821696,15118336,15106048,18067456,15204352,2130400,0,0,2560,21502976,0,256,139264,139520,97280,117760,138240,81920,32768,47104,51200,147456
.long 2163200,21503520,21504512,1073741824,21283840,21421060,1802752,1966080,1280,18048000,18049024,18050048,18051072,0,0,1073741824,21502980,21499904,21067904,21247104,1051011932,2195456,2048,1024,512,15265792,15263744,19810304,21499904,21488640,21505024,1024,4677120,4759040,4840960,97280,21553152,21553152,21553152,2178560,15351296,17913856,17883136,15142912,15130624,18067456,15224832,2150880,0,0,2560,21502976,256,0,139520,139264,81920,133120,122880,97280,149504,143360,0,30720
.long 2165760,21503552,21508608,1073741824,21284864,21421064,512,1966080,3072,19726336,19808256,19728384,19810304,21206016,0,0,21502984,21499904,21068032,21208704,1051011932,2236416,2048,1024,512,15405056,15403008,19812352,21499904,21477376,21493760,1024,7047040,7128960,7210880,112640,21553152,21553152,21553152,2219520,15490560,17975296,17944576,15167488,15155200,18067456,15204352,2171360,0,0,2560,21502976,139264,139520,0,256,128000,87040,107520,112640,32768,47104,51200,147456
.long 2168320,21503584,21512704,1073741824,21285888,21421068,1574912,1966080,3072,20448256,20530176,20450304,20532224,21271552,0,0,21502988,21499904,21068160,21249664,1051011932,2277376,2048,1024,512,15544320,15542272,19814400,21499904,21493760,21510144,1024,7292800,7374720,7456640,128000,21553152,21553152,21553152,2260480,15629824,18036736,18006016,15192064,15179776,18067456,15224832,2191840,0,0,2560,21502976,139520,139264,256,0,112640,102400,92160,128000,149504,143360,0,30720
.long 2201600,21507584,21500416,21285840,21282816,21425152,738432,1966080,1280,19307520,19308544,19309568,19310592,0,0,1073741824,21507072,21499904,21108736,21216384,1065353216,4767744,2048,1024,512,15151104,15149056,20135936,21501952,21474304,21490688,0,4441600,4523520,4605440,81920,21553152,21553152,21553152,2147840,15222272,19245056,19214336,15118336,15106048,19460096,15204352,2131040,0,0,2560,21507072,0,256,139264,139520,97280,117760,138240,81920,32768,47104,51200,147456
.long 2204160,21507616,21504512,1073741824,21283840,21425156,1802880,1966080,1280,18395136,18396160,18397184,18398208,0,0,1073741824,21507076,21499904,21108864,21257344,1065353216,4808704,2048,1024,512,15290368,15288320,20137984,21501952,21490688,21507072,0,4687360,4769280,4851200,97280,21553152,21553152,21553152,2188800,15361536,19306496,19275776,15142912,15130624,19460096,15224832,2151520,0,0,2560,21507072,256,0,139520,139264,81920,133120,122880,97280,149504,143360,0,30720
.long 2206720,21507648,21508608,1073741824,21284864,21425160,98816,1966080,3072,19730432,19812352,19732480,19814400,21206272,0,0,21507080,21499904,21108992,21218944,1065353216,4849664,2048,1024,512,15429632,15427584,20140032,21501952,21479424,21495808,0,7049600,7131520,7213440,112640,21553152,21553152,21553152,2229760,15500800,19367936,19337216,15167488,15155200,19460096,15204352,2172000,0,0,2560,21507072,139264,139520,0,256,128000,87040,107520,112640,32768,47104,51200,147456
.long 2209280,21507680,21512704,1073741824,21285888,21425164,1673216,1966080,3072,20452352,20534272,20454400,20536320,21271808,0,0,21507084,21499904,21109120,21259904,1065353216,4890624,2048,1024,512,15568896,15566848,20142080,21501952,21495808,21512192,0,7295360,7377280,7459200,128000,21553152,21553152,21553152,2270720,15640064,19429376,19398656,15192064,15179776,19460096,15224832,2192480,0,0,2560,21507072,139520,139264,256,0,112640,102400,92160,128000,149504,143360,0,30720
.long 2242560,21511680,21500416,21285856,21282816,21429248,778240,1966080,1280,16874496,16875520,16876544,16877568,0,0,1073741824,21511168,21499904,21149696,21226624,1065353216,7374848,512,20480,10240,15175680,15173632,20463616,21502976,21475328,21491712,0,4451840,4533760,4615680,81920,21553152,21553152,21553152,2158080,15232512,17852416,17821696,15396864,15384576,18067456,15482880,2212320,0,0,2560,21511168,0,256,139264,139520,97280,117760,138240,81920,32768,47104,51200,147456
.long 2245120,21511712,21504512,1073741824,21283840,21429252,1803008,1966080,1280,18399232,18743296,18744320,18745344,0,0,1073741824,21511172,21499904,21149824,21267584,1065353216,7415808,512,20480,10240,15314944,15312896,20465664,21502976,21491712,21508096,0,4697600,4779520,4861440,97280,21553152,21553152,21553152,2199040,15371776,17913856,17883136,15421440,15409152,18067456,15503360,2232800,0,0,2560,21511168,256,0,139520,139264,81920,133120,122880,97280,149504,143360,0,30720
.long 2247680,21511744,21508608,1073741824,21284864,21429256,197120,1966080,3072,19734528,19816448,19736576,19818496,21206528,0,0,21511176,21499904,21149952,21229184,1065353216,7456768,512,20480,10240,15454208,15452160,20467712,21502976,21480448,21496832,0,7052160,7134080,7216000,112640,21553152,21553152,21553152,2240000,15511040,17975296,17944576,15446016,15433728,18067456,15482880,2253280,0,0,2560,21511168,139264,139520,0,256,128000,87040,107520,112640,32768,47104,51200,147456
.long 2250240,21511776,21512704,1073741824,21285888,21429260,1771520,1966080,3072,20456448,20538368,20458496,20540416,21272064,0,0,21511180,21499904,21150080,21270144,1065353216,7497728,512,20480,10240,15593472,15591424,20469760,21502976,21496832,21513216,0,7297920,7379840,7461760,128000,21553152,21553152,21553152,2280960,15650304,18036736,18006016,15470592,15458304,18067456,15503360,2273760,0,0,2560,21511168,139520,139264,256,0,112640,102400,92160,128000,149504,143360,0,30720
.long 2283520,21515776,21500416,21285872,21282816,21433344,778368,1966080,1280,16878592,17222656,17223680,17224704,0,0,1073741824,21515264,21499904,21190656,21236864,1065353216,9994240,512,20480,10240,15200256,15198208,20791296,21504000,21476352,21492736,0,4462080,4544000,4625920,81920,21553152,21553152,21553152,2168320,15242752,19245056,19214336,15396864,15384576,19460096,15482880,2212960,0,0,2560,21515264,0,256,139264,139520,97280,117760,138240,81920,32768,47104,51200,147456
.long 2286080,21515808,21504512,1073741824,21283840,21433348,1803136,1966080,1280,18746368,18747392,19091456,19092480,0,0,1073741824,21515268,21499904,21190784,21277824,1065353216,10035200,512,20480,10240,15339520,15337472,20793344,21504000,21492736,21509120,0,4707840,4789760,4871680,97280,21553152,21553152,21553152,2209280,15382016,19306496,19275776,15421440,15409152,19460096,15503360,2233440,0,0,2560,21515264,256,0,139520,139264,81920,133120,122880,97280,149504,143360,0,30720
.long 2288640,21515840,21508608,1073741824,21284864,21433352,295424,1966080,3072,19738624,19820544,19740672,19822592,21206784,0,0,21515272,21499904,21190912,21239424,1065353216,10076160,512,20480,10240,15478784,15476736,20795392,21504000,21481472,21497856,0,7054720,7136640,7218560,112640,21553152,21553152,21553152,2250240,15521280,19367936,19337216,15446016,15433728,19460096,15482880,2253920,0,0,2560,21515264,139264,139520,0,256,128000,87040,107520,112640,32768,47104,51200,147456
.long 2291200,21515872,21512704,1073741824,21285888,21433356,1869824,1966080,3072,20460544,20542464,20462592,20544512,21272320,0,0,21515276,21499904,21191040,21280384,1065353216,10117120,512,20480,10240,15618048,15616000,20797440,21504000,21497856,21514240,0,7300480,7382400,7464320,128000,21553152,21553152,21553152,2291200,15660544,19429376,19398656,15470592,15458304,19460096,15503360,2274400,0,0,2560,21515264,139520,139264,256,0,112640,102400,92160,128000,149504,143360,0,30720
.long 983040,21385728,21385728,21285888,21282816,21286912,778496,1966080,1280,17225728,17226752,17570816,17571840,0,0,1073741824,21385216,21385216,20873216,21200896,1051011932,983040,2048,1024,512,11206656,11210752,19562496,21385216,21357568,21373952,0,3276800,3358720,3440640,81920,21553152,21553152,21553152,983040,11304960,16777216,16807936,11206656,11218944,17022976,11304960,983040,0,0,3072,21385216,0,256,139264,139520,97280,117760,138240,81920,32768,47104,51200,147456
.long 985600,21385760,21389824,1073741824,21283840,21286916,1803264,1966080,1280,19093504,19094528,19095552,19439616,0,0,1073741824,21385220,21385216,20873344,21241856,1051011932,1024000,2048,1024,512,11345920,11350016,19564544,21385216,21373952,21390336,0,3522560,3604480,3686400,97280,21553152,21553152,21553152,1024000,11444224,16838656,16869376,11231232,11243520,17022976,11325440,1003520,0,0,3072,21385216,256,0,139520,139264,81920,133120,122880,97280,149504,143360,0,30720
.long 988160,21385792,21393920,1073741824,21284864,21286920,393728,1966080,3072,19742720,19824640,19744768,19826688,21207040,0,0,21385224,21385216,20873472,21203456,1051011932,1064960,2048,1024,512,11485184,11489280,19566592,21385216,21362688,21379072,0,5898240,5980160,6062080,112640,21553152,21553152,21553152,1064960,11583488,16900096,16930816,11255808,11268096,17022976,11304960,1024000,0,0,3072,21385216,139264,139520,0,256,128000,87040,107520,112640,32768,47104,51200,147456
.long 990720,21385824,21398016,1073741824,21285888,21286924,2432,1966080,3072,20546560,20628480,20548608,20630528,21272576,0,0,21385228,21385216,20873600,21244416,1051011932,1105920,2048,1024,512,11624448,11628544,19568640,21385216,21379072,21395456,0,6144000,6225920,6307840,128000,21553152,21553152,21553152,1105920,11722752,16961536,16992256,11280384,11292672,17022976,11325440,1044480,0,0,3072,21385216,139520,139264,256,0,112640,102400,92160,128000,149504,143360,0,30720
.long 1024000,21389824,21385728,21285904,21282816,21291008,778624,1966080,1280,17572864,17573888,17574912,17918976,0,0,1073741824,21389312,21385216,20914176,21211136,1051011932,1015808,2048,1024,512,11231232,11235328,19890176,21386240,21358592,21374976,0,3287040,3368960,3450880,81920,21553152,21553152,21553152,993280,11315200,18169856,18200576,11206656,11218944,18415616,11304960,983680,0,0,3072,21389312,0,256,139264,139520,97280,117760,138240,81920,32768,47104,51200,147456
.long 1026560,21389856,21389824,1073741824,21283840,21291012,1803392,1966080,1280,19440640,19441664,19442688,19443712,0,0,1073741824,21389316,21385216,20914304,21252096,1051011932,1056768,2048,1024,512,11370496,11374592,19892224,21386240,21374976,21391360,0,3532800,3614720,3696640,97280,21553152,21553152,21553152,1034240,11454464,18231296,18262016,11231232,11243520,18415616,11325440,1004160,0,0,3072,21389312,256,0,139520,139264,81920,133120,122880,97280,149504,143360,0,30720
.long 1029120,21389888,21393920,1073741824,21284864,21291016,492032,1966080,3072,19746816,19828736,19748864,19830784,21207296,0,0,21389320,21385216,20914432,21213696,1051011932,1097728,2048,1024,512,11509760,11513856,19894272,21386240,21363712,21380096,0,5900800,5982720,6064640,112640,21553152,21553152,21553152,1075200,11593728,18292736,18323456,11255808,11268096,18415616,11304960,1024640,0,0,3072,21389312,139264,139520,0,256,128000,87040,107520,112640,32768,47104,51200,147456
.long 1031680,21389920,21398016,1073741824,21285888,21291020,100736,1966080,3072,20550656,20632576,20552704,20634624,21272832,0,0,21389324,21385216,20914560,21254656,1051011932,1138688,2048,1024,512,11649024,11653120,19896320,21386240,21380096,21396480,0,6146560,6228480,6310400,128000,21553152,21553152,21553152,1116160,11732992,18354176,18384896,11280384,11292672,18415616,11325440,1045120,0,0,3072,21389312,139520,139264,256,0,112640,102400,92160,128000,149504,143360,0,30720
.long 1064960,21393920,21385728,21285920,21282816,21295104,778752,1966080,1280,17920000,17921024,17922048,17923072,0,0,1073741824,21393408,21385216,20955136,21221376,1065353216,3629056,2048,1024,512,11255808,11259904,20217856,21387264,21359616,21376000,0,3297280,3379200,3461120,81920,21553152,21553152,21553152,1003520,11325440,16777216,16807936,11485184,11497472,17022976,11583488,1064960,0,0,3072,21393408,0,256,139264,139520,97280,117760,138240,81920,32768,47104,51200,147456
.long 1067520,21393952,21389824,1073741824,21283840,21295108,1843200,1966080,1280,17007616,17008640,17009664,17010688,0,0,1073741824,21393412,21385216,20955264,21262336,1065353216,3670016,2048,1024,512,11395072,11399168,20219904,21387264,21376000,21392384,0,3543040,3624960,3706880,97280,21553152,21553152,21553152,1044480,11464704,16838656,16869376,11509760,11522048,17022976,11603968,1085440,0,0,3072,21393408,256,0,139520,139264,81920,133120,122880,97280,149504,143360,0,30720
.long 1070080,21393984,21393920,1073741824,21284864,21295112,590336,1966080,3072,19750912,19832832,19752960,19834880,21207552,0,0,21393416,21385216,20955392,21223936,1065353216,3710976,2048,1024,512,11534336,11538432,20221952,21387264,21364736,21381120,0,5903360,5985280,6067200,112640,21553152,21553152,21553152,1085440,11603968,16900096,16930816,11534336,11546624,17022976,11583488,1105920,0,0,3072,21393408,139264,139520,0,256,128000,87040,107520,112640,32768,47104,51200,147456
.long 1072640,21394016,21398016,1073741824,21285888,21295116,199040,1966080,3072,20554752,20636672,20556800,20638720,21273088,0,0,21393420,21385216,20955520,21264896,1065353216,3751936,2048,1024,512,11673600,11677696,20224000,21387264,21381120,21397504,0,6149120,6231040,6312960,128000,21553152,21553152,21553152,1126400,11743232,16961536,16992256,11558912,11571200,17022976,11603968,1126400,0,0,3072,21393408,139520,139264,256,0,112640,102400,92160,128000,149504,143360,0,30720
.long 1105920,21398016,21385728,21285936,21282816,21299200,778880,1966080,1280,18267136,18268160,18269184,18270208,0,0,1073741824,21397504,21385216,20996096,21231616,1065353216,6230016,512,20480,10240,11280384,11284480,20545536,21388288,21360640,21377024,1024,3307520,3389440,3471360,81920,21553152,21553152,21553152,1013760,11335680,18169856,18200576,11485184,11497472,18415616,11583488,1065600,0,0,3072,21397504,0,256,139264,139520,97280,117760,138240,81920,32768,47104,51200,147456
.long 1108480,21398048,21389824,1073741824,21283840,21299204,1843328,1966080,1280,17011712,17355776,17356800,17357824,0,0,1073741824,21397508,21385216,20996224,21272576,1065353216,6270976,512,20480,10240,11419648,11423744,20547584,21388288,21377024,21393408,1024,3553280,3635200,3717120,97280,21553152,21553152,21553152,1054720,11474944,18231296,18262016,11509760,11522048,18415616,11603968,1086080,0,0,3072,21397504,256,0,139520,139264,81920,133120,122880,97280,149504,143360,0,30720
.long 1111040,21398080,21393920,1073741824,21284864,21299208,688640,1966080,3072,19755008,19836928,19757056,19838976,21207808,0,0,21397512,21385216,20996352,21234176,1065353216,6311936,512,20480,10240,11558912,11563008,20549632,21388288,21365760,21382144,1024,5905920,5987840,6069760,112640,21553152,21553152,21553152,1095680,11614208,18292736,18323456,11534336,11546624,18415616,11583488,1106560,0,0,3072,21397504,139264,139520,0,256,128000,87040,107520,112640,32768,47104,51200,147456
.long 1113600,21398112,21398016,1073741824,21285888,21299212,297344,1966080,3072,20558848,20640768,20560896,20642816,21273344,0,0,21397516,21385216,20996480,21275136,1065353216,6352896,512,20480,10240,11698176,11702272,20551680,21388288,21382144,21398528,1024,6151680,6233600,6315520,128000,21553152,21553152,21553152,1136640,11753472,18354176,18384896,11558912,11571200,18415616,11603968,1127040,0,0,3072,21397504,139520,139264,256,0,112640,102400,92160,128000,149504,143360,0,30720
.long 2293760,21516800,21516800,21285952,21282816,21417984,779008,1966080,1280,18271232,18615296,18616320,18617344,0,0,1073741824,21516288,21516288,21037056,21200896,1051011932,2293760,2048,1024,512,15663104,15667200,19562496,21516288,21488640,21505024,0,4587520,4669440,4751360,81920,21553152,21553152,21553152,2293760,15761408,16777216,16807936,15663104,15675392,17022976,15761408,2293760,0,0,3072,21516288,0,256,139264,139520,97280,117760,138240,81920,32768,47104,51200,147456
.long 2296320,21516832,21520896,1073741824,21283840,21417988,1843456,1966080,1280,17358848,17359872,17703936,17704960,0,0,1073741824,21516292,21516288,21037184,21241856,1051011932,2334720,2048,1024,512,15802368,15806464,19564544,21516288,21505024,21521408,0,4833280,4915200,4997120,97280,21553152,21553152,21553152,2334720,15900672,16838656,16869376,15687680,15699968,17022976,15781888,2314240,0,0,3072,21516288,256,0,139520,139264,81920,133120,122880,97280,149504,143360,0,30720
.long 2298880,21516864,21524992,1073741824,21284864,21417992,786944,1966080,3072,19759104,19841024,19761152,19843072,21208064,0,0,21516296,21516288,21037312,21203456,1051011932,2375680,2048,1024,512,15941632,15945728,19566592,21516288,21493760,21510144,0,7208960,7290880,7372800,112640,21553152,21553152,21553152,2375680,16039936,16900096,16930816,15712256,15724544,17022976,15761408,2334720,0,0,3072,21516288,139264,139520,0,256,128000,87040,107520,112640,32768,47104,51200,147456
.long 2301440,21516896,21529088,1073741824,21285888,21417996,395648,1966080,3072,20562944,20644864,20564992,20646912,21273600,0,0,21516300,21516288,21037440,21244416,1051011932,2416640,2048,1024,512,16080896,16084992,19568640,21516288,21510144,21526528,0,7454720,7536640,7618560,128000,21553152,21553152,21553152,2416640,16179200,16961536,16992256,15736832,15749120,17022976,15781888,2355200,0,0,3072,21516288,139520,139264,256,0,112640,102400,92160,128000,149504,143360,0,30720
.long 2334720,21520896,21516800,21285968,21282816,21422080,779136,1966080,1280,18618368,18619392,18963456,18964480,0,0,1073741824,21520384,21516288,21078016,21211136,1051011932,2326528,2048,1024,512,15687680,15691776,19890176,21517312,21489664,21506048,0,4597760,4679680,4761600,81920,21553152,21553152,21553152,2304000,15771648,18169856,18200576,15663104,15675392,18415616,15761408,2294400,0,0,3072,21520384,0,256,139264,139520,97280,117760,138240,81920,32768,47104,51200,147456
.long 2337280,21520928,21520896,1073741824,21283840,21422084,1843584,1966080,1280,17705984,17707008,17708032,18052096,0,0,1073741824,21520388,21516288,21078144,21252096,1051011932,2367488,2048,1024,512,15826944,15831040,19892224,21517312,21506048,21522432,0,4843520,4925440,5007360,97280,21553152,21553152,21553152,2344960,15910912,18231296,18262016,15687680,15699968,18415616,15781888,2314880,0,0,3072,21520384,256,0,139520,139264,81920,133120,122880,97280,149504,143360,0,30720
.long 2339840,21520960,21524992,1073741824,21284864,21422088,885248,1966080,3072,19763200,19845120,19765248,19847168,21208320,0,0,21520392,21516288,21078272,21213696,1051011932,2408448,2048,1024,512,15966208,15970304,19894272,21517312,21494784,21511168,0,7211520,7293440,7375360,112640,21553152,21553152,21553152,2385920,16050176,18292736,18323456,15712256,15724544,18415616,15761408,2335360,0,0,3072,21520384,139264,139520,0,256,128000,87040,107520,112640,32768,47104,51200,147456
.long 2342400,21520992,21529088,1073741824,21285888,21422092,493952,1966080,3072,20567040,20648960,20569088,20651008,21273856,0,0,21520396,21516288,21078400,21254656,1051011932,2449408,2048,1024,512,16105472,16109568,19896320,21517312,21511168,21527552,0,7457280,7539200,7621120,128000,21553152,21553152,21553152,2426880,16189440,18354176,18384896,15736832,15749120,18415616,15781888,2355840,0,0,3072,21520384,139520,139264,256,0,112640,102400,92160,128000,149504,143360,0,30720
.long 2375680,21524992,21516800,21285984,21282816,21426176,779264,1966080,1280,18965504,18966528,18967552,19311616,0,0,1073741824,21524480,21516288,21118976,21221376,1065353216,4939776,2048,1024,512,15712256,15716352,20217856,21518336,21490688,21507072,0,4608000,4689920,4771840,81920,21553152,21553152,21553152,2314240,15781888,16777216,16807936,15941632,15953920,17022976,16039936,2375680,0,0,3072,21524480,0,256,139264,139520,97280,117760,138240,81920,32768,47104,51200,147456
.long 2378240,21525024,21520896,1073741824,21283840,21426180,1843712,1966080,1280,18053120,18054144,18055168,18056192,0,0,1073741824,21524484,21516288,21119104,21262336,1065353216,4980736,2048,1024,512,15851520,15855616,20219904,21518336,21507072,21523456,0,4853760,4935680,5017600,97280,21553152,21553152,21553152,2355200,15921152,16838656,16869376,15966208,15978496,17022976,16060416,2396160,0,0,3072,21524480,256,0,139520,139264,81920,133120,122880,97280,149504,143360,0,30720
.long 2380800,21525056,21524992,1073741824,21284864,21426184,983552,1966080,3072,19767296,19849216,19769344,19851264,21208576,0,0,21524488,21516288,21119232,21223936,1065353216,5021696,2048,1024,512,15990784,15994880,20221952,21518336,21495808,21512192,0,7214080,7296000,7377920,112640,21553152,21553152,21553152,2396160,16060416,16900096,16930816,15990784,16003072,17022976,16039936,2416640,0,0,3072,21524480,139264,139520,0,256,128000,87040,107520,112640,32768,47104,51200,147456
.long 2383360,21525088,21529088,1073741824,21285888,21426188,592256,1966080,3072,20571136,20653056,20573184,20655104,21274112,0,0,21524492,21516288,21119360,21264896,1065353216,5062656,2048,1024,512,16130048,16134144,20224000,21518336,21512192,21528576,0,7459840,7541760,7623680,128000,21553152,21553152,21553152,2437120,16199680,16961536,16992256,16015360,16027648,17022976,16060416,2437120,0,0,3072,21524480,139520,139264,256,0,112640,102400,92160,128000,149504,143360,0,30720
.long 2416640,21529088,21516800,21286000,21282816,21430272,779392,1966080,1280,19312640,19313664,19314688,19315712,0,0,1073741824,21528576,21516288,21159936,21231616,1065353216,7540736,512,20480,10240,15736832,15740928,20545536,21519360,21491712,21508096,1024,4618240,4700160,4782080,81920,21553152,21553152,21553152,2324480,15792128,18169856,18200576,15941632,15953920,18415616,16039936,2376320,0,0,3072,21528576,0,256,139264,139520,97280,117760,138240,81920,32768,47104,51200,147456
.long 2419200,21529120,21520896,1073741824,21283840,21430276,1843840,1966080,1280,18400256,18401280,18402304,18403328,0,0,1073741824,21528580,21516288,21160064,21272576,1065353216,7581696,512,20480,10240,15876096,15880192,20547584,21519360,21508096,21524480,1024,4864000,4945920,5027840,97280,21553152,21553152,21553152,2365440,15931392,18231296,18262016,15966208,15978496,18415616,16060416,2396800,0,0,3072,21528576,256,0,139520,139264,81920,133120,122880,97280,149504,143360,0,30720
.long 2421760,21529152,21524992,1073741824,21284864,21430280,1081856,1966080,3072,19771392,19853312,19773440,19855360,21208832,0,0,21528584,21516288,21160192,21234176,1065353216,7622656,512,20480,10240,16015360,16019456,20549632,21519360,21496832,21513216,1024,7216640,7298560,7380480,112640,21553152,21553152,21553152,2406400,16070656,18292736,18323456,15990784,16003072,18415616,16039936,2417280,0,0,3072,21528576,139264,139520,0,256,128000,87040,107520,112640,32768,47104,51200,147456
.long 2424320,21529184,21529088,1073741824,21285888,21430284,690560,1966080,3072,20575232,20657152,20577280,20659200,21274368,0,0,21528588,21516288,21160320,21275136,1065353216,7663616,512,20480,10240,16154624,16158720,20551680,21519360,21513216,21529600,1024,7462400,7544320,7626240,128000,21553152,21553152,21553152,2447360,16209920,18354176,18384896,16015360,16027648,18415616,16060416,2437760,0,0,3072,21528576,139520,139264,256,0,112640,102400,92160,128000,149504,143360,0,30720
.long 993280,21386752,21385728,21286016,21282816,21287936,819200,1966080,1280,16879616,16880640,16881664,16882688,0,0,1073741824,21386240,21385216,20883456,21201024,1051011932,991232,2048,1024,512,11214848,11212800,19644416,21385216,21357568,21373952,0,3279360,3361280,3443200,81920,21553152,21553152,21553152,985600,11307520,17125376,17156096,11206656,11218944,17371136,11304960,983200,0,0,3072,21386240,0,256,139264,139520,97280,117760,138240,81920,32768,47104,51200,147456
.long 995840,21386784,21389824,1073741824,21283840,21287940,1843968,1966080,1280,18404352,18748416,18749440,18750464,0,0,1073741824,21386244,21385216,20883584,21241984,1051011932,1032192,2048,1024,512,11354112,11352064,19646464,21385216,21373952,21390336,0,3525120,3607040,3688960,97280,21553152,21553152,21553152,1026560,11446784,17186816,17217536,11231232,11243520,17371136,11325440,1003680,0,0,3072,21386240,256,0,139520,139264,81920,133120,122880,97280,149504,143360,0,30720
.long 998400,21386816,21393920,1073741824,21284864,21287944,1180160,1966080,3072,19775488,19857408,19777536,19859456,21209088,0,0,21386248,21385216,20883712,21203584,1051011932,1073152,2048,1024,512,11493376,11491328,19648512,21385216,21362688,21379072,0,5898880,5980800,6062720,112640,21553152,21553152,21553152,1067520,11586048,17248256,17278976,11255808,11268096,17371136,11304960,1024160,0,0,3072,21386240,139264,139520,0,256,128000,87040,107520,112640,32768,47104,51200,147456
.long 1000960,21386848,21398016,1073741824,21285888,21287948,788864,1966080,3072,20579328,20661248,20581376,20663296,21274624,0,0,21386252,21385216,20883840,21244544,1051011932,1114112,2048,1024,512,11632640,11630592,19650560,21385216,21379072,21395456,0,6144640,6226560,6308480,128000,21553152,21553152,21553152,1108480,11725312,17309696,17340416,11280384,11292672,17371136,11325440,1044640,0,0,3072,21386240,139520,139264,256,0,112640,102400,92160,128000,149504,143360,0,30720
.long 1034240,21390848,21385728,21286032,21282816,21292032,819328,1966080,1280,16883712,17227776,17228800,17229824,0,0,1073741824,21390336,21385216,20924416,21211264,1065353216,3604480,2048,1024,512,11239424,11237376,19972096,21386240,21358592,21374976,0,3289600,3371520,3453440,81920,21553152,21553152,21553152,995840,11317760,18518016,18548736,11206656,11218944,18763776,11304960,983840,0,0,3072,21390336,0,256,139264,139520,97280,117760,138240,81920,32768,47104,51200,147456
.long 1036800,21390880,21389824,1073741824,21283840,21292036,1844096,1966080,1280,18751488,18752512,19096576,19097600,0,0,1073741824,21390340,21385216,20924544,21252224,1065353216,3645440,2048,1024,512,11378688,11376640,19974144,21386240,21374976,21391360,0,3535360,3617280,3699200,97280,21553152,21553152,21553152,1036800,11457024,18579456,18610176,11231232,11243520,18763776,11325440,1004320,0,0,3072,21390336,256,0,139520,139264,81920,133120,122880,97280,149504,143360,0,30720
.long 1039360,21390912,21393920,1073741824,21284864,21292040,1278464,1966080,3072,19779584,19861504,19781632,19863552,21209344,0,0,21390344,21385216,20924672,21213824,1065353216,3686400,2048,1024,512,11517952,11515904,19976192,21386240,21363712,21380096,0,5901440,5983360,6065280,112640,21553152,21553152,21553152,1077760,11596288,18640896,18671616,11255808,11268096,18763776,11304960,1024800,0,0,3072,21390336,139264,139520,0,256,128000,87040,107520,112640,32768,47104,51200,147456
.long 1041920,21390944,21398016,1073741824,21285888,21292044,887168,1966080,3072,20583424,20665344,20585472,20667392,21274880,0,0,21390348,21385216,20924800,21254784,1065353216,3727360,2048,1024,512,11657216,11655168,19978240,21386240,21380096,21396480,0,6147200,6229120,6311040,128000,21553152,21553152,21553152,1118720,11735552,18702336,18733056,11280384,11292672,18763776,11325440,1045280,0,0,3072,21390336,139520,139264,256,0,112640,102400,92160,128000,149504,143360,0,30720
.long 1075200,21394944,21385728,21286048,21282816,21296128,819456,1966080,1280,17230848,17231872,17575936,17576960,0,0,1073741824,21394432,21385216,20965376,21221504,1065353216,3637248,2048,1024,512,11264000,11261952,20299776,21387264,21359616,21376000,1024,3299840,3381760,3463680,81920,21553152,21553152,21553152,1006080,11328000,17125376,17156096,11485184,11497472,17371136,11583488,1065120,0,0,3072,21394432,0,256,139264,139520,97280,117760,138240,81920,32768,47104,51200,147456
.long 1077760,21394976,21389824,1073741824,21283840,21296132,1844224,1966080,1280,19098624,19099648,19100672,19444736,0,0,1073741824,21394436,21385216,20965504,21262464,1065353216,3678208,2048,1024,512,11403264,11401216,20301824,21387264,21376000,21392384,1024,3545600,3627520,3709440,97280,21553152,21553152,21553152,1047040,11467264,17186816,17217536,11509760,11522048,17371136,11603968,1085600,0,0,3072,21394432,256,0,139520,139264,81920,133120,122880,97280,149504,143360,0,30720
.long 1080320,21395008,21393920,1073741824,21284864,21296136,1376768,1966080,3072,19783680,19865600,19785728,19867648,21209600,0,0,21394440,21385216,20965632,21224064,1065353216,3719168,2048,1024,512,11542528,11540480,20303872,21387264,21364736,21381120,1024,5904000,5985920,6067840,112640,21553152,21553152,21553152,1088000,11606528,17248256,17278976,11534336,11546624,17371136,11583488,1106080,0,0,3072,21394432,139264,139520,0,256,128000,87040,107520,112640,32768,47104,51200,147456
.long 1082880,21395040,21398016,1073741824,21285888,21296140,985472,1966080,3072,20587520,20669440,20589568,20671488,21275136,0,0,21394444,21385216,20965760,21265024,1065353216,3760128,2048,1024,512,11681792,11679744,20305920,21387264,21381120,21397504,1024,6149760,6231680,6313600,128000,21553152,21553152,21553152,1128960,11745792,17309696,17340416,11558912,11571200,17371136,11603968,1126560,0,0,3072,21394432,139520,139264,256,0,112640,102400,92160,128000,149504,143360,0,30720
.long 1116160,21399040,21385728,21286064,21282816,21300224,819584,1966080,1280,17577984,17579008,17580032,17924096,0,0,1073741824,21398528,21385216,21006336,21231744,1065353216,6232064,512,20480,10240,11288576,11286528,20627456,21389312,21361664,21378048,0,3310080,3392000,3473920,81920,21553152,21553152,21553152,1016320,11338240,18518016,18548736,11485184,11497472,18763776,11583488,1065760,0,0,3072,21398528,0,256,139264,139520,97280,117760,138240,81920,32768,47104,51200,147456
.long 1118720,21399072,21389824,1073741824,21283840,21300228,1844352,1966080,1280,19445760,19446784,19447808,19448832,0,0,1073741824,21398532,21385216,21006464,21272704,1065353216,6273024,512,20480,10240,11427840,11425792,20629504,21389312,21378048,21394432,0,3555840,3637760,3719680,97280,21553152,21553152,21553152,1057280,11477504,18579456,18610176,11509760,11522048,18763776,11603968,1086240,0,0,3072,21398528,256,0,139520,139264,81920,133120,122880,97280,149504,143360,0,30720
.long 1121280,21399104,21393920,1073741824,21284864,21300232,1475072,1966080,3072,19787776,19869696,19789824,19871744,21209856,0,0,21398536,21385216,21006592,21234304,1065353216,6313984,512,20480,10240,11567104,11565056,20631552,21389312,21366784,21383168,0,5906560,5988480,6070400,112640,21553152,21553152,21553152,1098240,11616768,18640896,18671616,11534336,11546624,18763776,11583488,1106720,0,0,3072,21398528,139264,139520,0,256,128000,87040,107520,112640,32768,47104,51200,147456
.long 1123840,21399136,21398016,1073741824,21285888,21300236,1083776,1966080,3072,20591616,20673536,20593664,20675584,21275392,0,0,21398540,21385216,21006720,21275264,1065353216,6354944,512,20480,10240,11706368,11704320,20633600,21389312,21383168,21399552,0,6152320,6234240,6316160,128000,21553152,21553152,21553152,1139200,11756032,18702336,18733056,11558912,11571200,18763776,11603968,1127200,0,0,3072,21398528,139520,139264,256,0,112640,102400,92160,128000,149504,143360,0,30720
.long 2304000,21517824,21516800,21286080,21282816,21419008,819712,1966080,1280,17925120,17926144,17927168,17928192,0,0,1073741824,21517312,21516288,21047296,21201024,1051011932,2301952,2048,1024,512,15671296,15669248,19644416,21516288,21488640,21505024,0,4590080,4672000,4753920,81920,21553152,21553152,21553152,2296320,15763968,17125376,17156096,15663104,15675392,17371136,15761408,2293920,0,0,3072,21517312,0,256,139264,139520,97280,117760,138240,81920,32768,47104,51200,147456
.long 2306560,21517856,21520896,1073741824,21283840,21419012,1884160,1966080,1280,17012736,17013760,17014784,17015808,0,0,1073741824,21517316,21516288,21047424,21241984,1051011932,2342912,2048,1024,512,15810560,15808512,19646464,21516288,21505024,21521408,0,4835840,4917760,4999680,97280,21553152,21553152,21553152,2337280,15903232,17186816,17217536,15687680,15699968,17371136,15781888,2314400,0,0,3072,21517312,256,0,139520,139264,81920,133120,122880,97280,149504,143360,0,30720
.long 2309120,21517888,21524992,1073741824,21284864,21419016,1573376,1966080,3072,19791872,19873792,19793920,19875840,21210112,0,0,21517320,21516288,21047552,21203584,1051011932,2383872,2048,1024,512,15949824,15947776,19648512,21516288,21493760,21510144,0,7209600,7291520,7373440,112640,21553152,21553152,21553152,2378240,16042496,17248256,17278976,15712256,15724544,17371136,15761408,2334880,0,0,3072,21517312,139264,139520,0,256,128000,87040,107520,112640,32768,47104,51200,147456
.long 2311680,21517920,21529088,1073741824,21285888,21419020,1182080,1966080,3072,20595712,20677632,20597760,20679680,21275648,0,0,21517324,21516288,21047680,21244544,1051011932,2424832,2048,1024,512,16089088,16087040,19650560,21516288,21510144,21526528,0,7455360,7537280,7619200,128000,21553152,21553152,21553152,2419200,16181760,17309696,17340416,15736832,15749120,17371136,15781888,2355360,0,0,3072,21517312,139520,139264,256,0,112640,102400,92160,128000,149504,143360,0,30720
.long 2344960,21521920,21516800,21286096,21282816,21423104,819840,1966080,1280,18272256,18273280,18274304,18275328,0,0,1073741824,21521408,21516288,21088256,21211264,1065353216,4915200,2048,1024,512,15695872,15693824,19972096,21517312,21489664,21506048,0,4600320,4682240,4764160,81920,21553152,21553152,21553152,2306560,15774208,18518016,18548736,15663104,15675392,18763776,15761408,2294560,0,0,3072,21521408,0,256,139264,139520,97280,117760,138240,81920,32768,47104,51200,147456
.long 2347520,21521952,21520896,1073741824,21283840,21423108,1884288,1966080,1280,17016832,17360896,17361920,17362944,0,0,1073741824,21521412,21516288,21088384,21252224,1065353216,4956160,2048,1024,512,15835136,15833088,19974144,21517312,21506048,21522432,0,4846080,4928000,5009920,97280,21553152,21553152,21553152,2347520,15913472,18579456,18610176,15687680,15699968,18763776,15781888,2315040,0,0,3072,21521408,256,0,139520,139264,81920,133120,122880,97280,149504,143360,0,30720
.long 2350080,21521984,21524992,1073741824,21284864,21423112,1671680,1966080,3072,19795968,19877888,19798016,19879936,21210368,0,0,21521416,21516288,21088512,21213824,1065353216,4997120,2048,1024,512,15974400,15972352,19976192,21517312,21494784,21511168,0,7212160,7294080,7376000,112640,21553152,21553152,21553152,2388480,16052736,18640896,18671616,15712256,15724544,18763776,15761408,2335520,0,0,3072,21521408,139264,139520,0,256,128000,87040,107520,112640,32768,47104,51200,147456
.long 2352640,21522016,21529088,1073741824,21285888,21423116,1280384,1966080,3072,20599808,20681728,20601856,20683776,21275904,0,0,21521420,21516288,21088640,21254784,1065353216,5038080,2048,1024,512,16113664,16111616,19978240,21517312,21511168,21527552,0,7457920,7539840,7621760,128000,21553152,21553152,21553152,2429440,16192000,18702336,18733056,15736832,15749120,18763776,15781888,2356000,0,0,3072,21521408,139520,139264,256,0,112640,102400,92160,128000,149504,143360,0,30720
.long 2385920,21526016,21516800,21286112,21282816,21427200,819968,1966080,1280,18276352,18620416,18621440,18622464,0,0,1073741824,21525504,21516288,21129216,21221504,1065353216,4947968,2048,1024,512,15720448,15718400,20299776,21518336,21490688,21507072,1024,4610560,4692480,4774400,81920,21553152,21553152,21553152,2316800,15784448,17125376,17156096,15941632,15953920,17371136,16039936,2375840,0,0,3072,21525504,0,256,139264,139520,97280,117760,138240,81920,32768,47104,51200,147456
.long 2388480,21526048,21520896,1073741824,21283840,21427204,1884416,1966080,1280,17363968,17364992,17709056,17710080,0,0,1073741824,21525508,21516288,21129344,21262464,1065353216,4988928,2048,1024,512,15859712,15857664,20301824,21518336,21507072,21523456,1024,4856320,4938240,5020160,97280,21553152,21553152,21553152,2357760,15923712,17186816,17217536,15966208,15978496,17371136,16060416,2396320,0,0,3072,21525504,256,0,139520,139264,81920,133120,122880,97280,149504,143360,0,30720
.long 2391040,21526080,21524992,1073741824,21284864,21427208,1769984,1966080,3072,19800064,19881984,19802112,19884032,21210624,0,0,21525512,21516288,21129472,21224064,1065353216,5029888,2048,1024,512,15998976,15996928,20303872,21518336,21495808,21512192,1024,7214720,7296640,7378560,112640,21553152,21553152,21553152,2398720,16062976,17248256,17278976,15990784,16003072,17371136,16039936,2416800,0,0,3072,21525504,139264,139520,0,256,128000,87040,107520,112640,32768,47104,51200,147456
.long 2393600,21526112,21529088,1073741824,21285888,21427212,1378688,1966080,3072,20603904,20685824,20605952,20687872,21276160,0,0,21525516,21516288,21129600,21265024,1065353216,5070848,2048,1024,512,16138240,16136192,20305920,21518336,21512192,21528576,1024,7460480,7542400,7624320,128000,21553152,21553152,21553152,2439680,16202240,17309696,17340416,16015360,16027648,17371136,16060416,2437280,0,0,3072,21525504,139520,139264,256,0,112640,102400,92160,128000,149504,143360,0,30720
.long 2426880,21530112,21516800,21286128,21282816,21431296,820096,1966080,1280,18623488,18624512,18968576,18969600,0,0,1073741824,21529600,21516288,21170176,21231744,1065353216,7542784,512,20480,10240,15745024,15742976,20627456,21520384,21492736,21509120,0,4620800,4702720,4784640,81920,21553152,21553152,21553152,2327040,15794688,18518016,18548736,15941632,15953920,18763776,16039936,2376480,0,0,3072,21529600,0,256,139264,139520,97280,117760,138240,81920,32768,47104,51200,147456
.long 2429440,21530144,21520896,1073741824,21283840,21431300,1884544,1966080,1280,17711104,17712128,17713152,18057216,0,0,1073741824,21529604,21516288,21170304,21272704,1065353216,7583744,512,20480,10240,15884288,15882240,20629504,21520384,21509120,21525504,0,4866560,4948480,5030400,97280,21553152,21553152,21553152,2368000,15933952,18579456,18610176,15966208,15978496,18763776,16060416,2396960,0,0,3072,21529600,256,0,139520,139264,81920,133120,122880,97280,149504,143360,0,30720
.long 2432000,21530176,21524992,1073741824,21284864,21431304,1868288,1966080,3072,19804160,19886080,19806208,19888128,21210880,0,0,21529608,21516288,21170432,21234304,1065353216,7624704,512,20480,10240,16023552,16021504,20631552,21520384,21497856,21514240,0,7217280,7299200,7381120,112640,21553152,21553152,21553152,2408960,16073216,18640896,18671616,15990784,16003072,18763776,16039936,2417440,0,0,3072,21529600,139264,139520,0,256,128000,87040,107520,112640,32768,47104,51200,147456
.long 2434560,21530208,21529088,1073741824,21285888,21431308,1476992,1966080,3072,20608000,20689920,20610048,20691968,21276416,0,0,21529612,21516288,21170560,21275264,1065353216,7665664,512,20480,10240,16162816,16160768,20633600,21520384,21514240,21530624,0,7463040,7544960,7626880,128000,21553152,21553152,21553152,2449920,16212480,18702336,18733056,16015360,16027648,18763776,16060416,2437920,0,0,3072,21529600,139520,139264,256,0,112640,102400,92160,128000,149504,143360,0,30720
.long 1003520,21387776,21385728,21286144,21282816,21288960,820224,1966080,1280,18970624,18971648,18972672,19316736,0,0,1073741824,21387264,21385216,20893696,21206016,1051011932,999424,2048,1024,512,11218944,11223040,19726336,21385216,21357568,21373952,0,3281920,3363840,3445760,81920,21553152,21553152,21553152,988160,11310080,17473536,17504256,11206656,11218944,17719296,11304960,983360,0,0,3072,21387264,0,256,139264,139520,97280,117760,138240,81920,32768,47104,51200,147456
.long 1006080,21387808,21389824,1073741824,21283840,21288964,1884672,1966080,1280,18058240,18059264,18060288,18061312,0,0,1073741824,21387268,21385216,20893824,21246976,1051011932,1040384,2048,1024,512,11358208,11362304,19728384,21385216,21373952,21390336,0,3527680,3609600,3691520,97280,21553152,21553152,21553152,1029120,11449344,17534976,17565696,11231232,11243520,17719296,11325440,1003840,0,0,3072,21387264,256,0,139520,139264,81920,133120,122880,97280,149504,143360,0,30720
.long 1008640,21387840,21393920,1073741824,21284864,21288968,896,1966080,3072,19890176,19972096,19892224,19974144,21211136,0,0,21387272,21385216,20893952,21208576,1051011932,1081344,2048,1024,512,11497472,11501568,19730432,21385216,21362688,21379072,0,5899520,5981440,6063360,112640,21553152,21553152,21553152,1070080,11588608,17596416,17627136,11255808,11268096,17719296,11304960,1024320,0,0,3072,21387264,139264,139520,0,256,128000,87040,107520,112640,32768,47104,51200,147456
.long 1011200,21387872,21398016,1073741824,21285888,21288972,1575296,1966080,3072,20612096,20694016,20614144,20696064,21276672,0,0,21387276,21385216,20894080,21249536,1051011932,1122304,2048,1024,512,11636736,11640832,19732480,21385216,21379072,21395456,0,6145280,6227200,6309120,128000,21553152,21553152,21553152,1111040,11727872,17657856,17688576,11280384,11292672,17719296,11325440,1044800,0,0,3072,21387264,139520,139264,256,0,112640,102400,92160,128000,149504,143360,0,30720
.long 1044480,21391872,21385728,21286160,21282816,21293056,820352,1966080,1280,19317760,19318784,19319808,19320832,0,0,1073741824,21391360,21385216,20934656,21216256,1065353216,3612672,2048,1024,512,11243520,11247616,20054016,21386240,21358592,21374976,1024,3292160,3374080,3456000,81920,21553152,21553152,21553152,998400,11320320,18866176,18896896,11206656,11218944,19111936,11304960,984000,0,0,3072,21391360,0,256,139264,139520,97280,117760,138240,81920,32768,47104,51200,147456
.long 1047040,21391904,21389824,1073741824,21283840,21293060,1884800,1966080,1280,18405376,18406400,18407424,18408448,0,0,1073741824,21391364,21385216,20934784,21257216,1065353216,3653632,2048,1024,512,11382784,11386880,20056064,21386240,21374976,21391360,1024,3537920,3619840,3701760,97280,21553152,21553152,21553152,1039360,11459584,18927616,18958336,11231232,11243520,19111936,11325440,1004480,0,0,3072,21391360,256,0,139520,139264,81920,133120,122880,97280,149504,143360,0,30720
.long 1049600,21391936,21393920,1073741824,21284864,21293064,99200,1966080,3072,19894272,19976192,19896320,19978240,21211392,0,0,21391368,21385216,20934912,21218816,1065353216,3694592,2048,1024,512,11522048,11526144,20058112,21386240,21363712,21380096,1024,5902080,5984000,6065920,112640,21553152,21553152,21553152,1080320,11598848,18989056,19019776,11255808,11268096,19111936,11304960,1024960,0,0,3072,21391360,139264,139520,0,256,128000,87040,107520,112640,32768,47104,51200,147456
.long 1052160,21391968,21398016,1073741824,21285888,21293068,1673600,1966080,3072,20616192,20698112,20618240,20700160,21276928,0,0,21391372,21385216,20935040,21259776,1065353216,3735552,2048,1024,512,11661312,11665408,20060160,21386240,21380096,21396480,1024,6147840,6229760,6311680,128000,21553152,21553152,21553152,1121280,11738112,19050496,19081216,11280384,11292672,19111936,11325440,1045440,0,0,3072,21391360,139520,139264,256,0,112640,102400,92160,128000,149504,143360,0,30720
.long 1085440,21395968,21385728,21286176,21282816,21297152,860160,1966080,1280,16884736,16885760,16886784,16887808,0,0,1073741824,21395456,21385216,20975616,21226496,1065353216,6225920,512,20480,10240,11268096,11272192,20381696,21388288,21360640,21377024,0,3302400,3384320,3466240,81920,21553152,21553152,21553152,1008640,11330560,17473536,17504256,11485184,11497472,17719296,11583488,1065280,0,0,3072,21395456,0,256,139264,139520,97280,117760,138240,81920,32768,47104,51200,147456
.long 1088000,21396000,21389824,1073741824,21283840,21297156,1884928,1966080,1280,18409472,18753536,18754560,18755584,0,0,1073741824,21395460,21385216,20975744,21267456,1065353216,6266880,512,20480,10240,11407360,11411456,20383744,21388288,21377024,21393408,0,3548160,3630080,3712000,97280,21553152,21553152,21553152,1049600,11469824,17534976,17565696,11509760,11522048,17719296,11603968,1085760,0,0,3072,21395456,256,0,139520,139264,81920,133120,122880,97280,149504,143360,0,30720
.long 1090560,21396032,21393920,1073741824,21284864,21297160,197504,1966080,3072,19898368,19980288,19900416,19982336,21211648,0,0,21395464,21385216,20975872,21229056,1065353216,6307840,512,20480,10240,11546624,11550720,20385792,21388288,21365760,21382144,0,5904640,5986560,6068480,112640,21553152,21553152,21553152,1090560,11609088,17596416,17627136,11534336,11546624,17719296,11583488,1106240,0,0,3072,21395456,139264,139520,0,256,128000,87040,107520,112640,32768,47104,51200,147456
.long 1093120,21396064,21398016,1073741824,21285888,21297164,1771904,1966080,3072,20620288,20702208,20622336,20704256,21277184,0,0,21395468,21385216,20976000,21270016,1065353216,6348800,512,20480,10240,11685888,11689984,20387840,21388288,21382144,21398528,0,6150400,6232320,6314240,128000,21553152,21553152,21553152,1131520,11748352,17657856,17688576,11558912,11571200,17719296,11603968,1126720,0,0,3072,21395456,139520,139264,256,0,112640,102400,92160,128000,149504,143360,0,30720
.long 1126400,21400064,21385728,21286192,21282816,21301248,860288,1966080,1280,16888832,17232896,17233920,17234944,0,0,1073741824,21399552,21385216,21016576,21236736,1065353216,6234112,512,20480,10240,11292672,11296768,20709376,21389312,21361664,21378048,0,3312640,3394560,3476480,81920,21553152,21553152,21553152,1018880,11340800,18866176,18896896,11485184,11497472,19111936,11583488,1065920,0,0,3072,21399552,0,256,139264,139520,97280,117760,138240,81920,32768,47104,51200,147456
.long 1128960,21400096,21389824,1073741824,21283840,21301252,1885056,1966080,1280,18756608,18757632,19101696,19102720,0,0,1073741824,21399556,21385216,21016704,21277696,1065353216,6275072,512,20480,10240,11431936,11436032,20711424,21389312,21378048,21394432,0,3558400,3640320,3722240,97280,21553152,21553152,21553152,1059840,11480064,18927616,18958336,11509760,11522048,19111936,11603968,1086400,0,0,3072,21399552,256,0,139520,139264,81920,133120,122880,97280,149504,143360,0,30720
.long 1131520,21400128,21393920,1073741824,21284864,21301256,295808,1966080,3072,19902464,19984384,19904512,19986432,21211904,0,0,21399560,21385216,21016832,21239296,1065353216,6316032,512,20480,10240,11571200,11575296,20713472,21389312,21366784,21383168,0,5907200,5989120,6071040,112640,21553152,21553152,21553152,1100800,11619328,18989056,19019776,11534336,11546624,19111936,11583488,1106880,0,0,3072,21399552,139264,139520,0,256,128000,87040,107520,112640,32768,47104,51200,147456
.long 1134080,21400160,21398016,1073741824,21285888,21301260,1870208,1966080,3072,20624384,20706304,20626432,20708352,21277440,0,0,21399564,21385216,21016960,21280256,1065353216,6356992,512,20480,10240,11710464,11714560,20715520,21389312,21383168,21399552,0,6152960,6234880,6316800,128000,21553152,21553152,21553152,1141760,11758592,19050496,19081216,11558912,11571200,19111936,11603968,1127360,0,0,3072,21399552,139520,139264,256,0,112640,102400,92160,128000,149504,143360,0,30720
.long 2314240,21518848,21516800,21286208,21282816,21420032,860416,1966080,1280,17235968,17236992,17581056,17582080,0,0,1073741824,21518336,21516288,21057536,21206016,1051011932,2310144,2048,1024,512,15675392,15679488,19726336,21516288,21488640,21505024,0,4592640,4674560,4756480,81920,21553152,21553152,21553152,2298880,15766528,17473536,17504256,15663104,15675392,17719296,15761408,2294080,0,0,3072,21518336,0,256,139264,139520,97280,117760,138240,81920,32768,47104,51200,147456
.long 2316800,21518880,21520896,1073741824,21283840,21420036,1885184,1966080,1280,19103744,19104768,19105792,19449856,0,0,1073741824,21518340,21516288,21057664,21246976,1051011932,2351104,2048,1024,512,15814656,15818752,19728384,21516288,21505024,21521408,0,4838400,4920320,5002240,97280,21553152,21553152,21553152,2339840,15905792,17534976,17565696,15687680,15699968,17719296,15781888,2314560,0,0,3072,21518336,256,0,139520,139264,81920,133120,122880,97280,149504,143360,0,30720
.long 2319360,21518912,21524992,1073741824,21284864,21420040,394112,1966080,3072,19906560,19988480,19908608,19990528,21212160,0,0,21518344,21516288,21057792,21208576,1051011932,2392064,2048,1024,512,15953920,15958016,19730432,21516288,21493760,21510144,0,7210240,7292160,7374080,112640,21553152,21553152,21553152,2380800,16045056,17596416,17627136,15712256,15724544,17719296,15761408,2335040,0,0,3072,21518336,139264,139520,0,256,128000,87040,107520,112640,32768,47104,51200,147456
.long 2321920,21518944,21529088,1073741824,21285888,21420044,2816,1966080,3072,20710400,20792320,20712448,20794368,21277696,0,0,21518348,21516288,21057920,21249536,1051011932,2433024,2048,1024,512,16093184,16097280,19732480,21516288,21510144,21526528,0,7456000,7537920,7619840,128000,21553152,21553152,21553152,2421760,16184320,17657856,17688576,15736832,15749120,17719296,15781888,2355520,0,0,3072,21518336,139520,139264,256,0,112640,102400,92160,128000,149504,143360,0,30720
.long 2355200,21522944,21516800,21286224,21282816,21424128,860544,1966080,1280,17583104,17584128,17585152,17929216,0,0,1073741824,21522432,21516288,21098496,21216256,1065353216,4923392,2048,1024,512,15699968,15704064,20054016,21517312,21489664,21506048,1024,4602880,4684800,4766720,81920,21553152,21553152,21553152,2309120,15776768,18866176,18896896,15663104,15675392,19111936,15761408,2294720,0,0,3072,21522432,0,256,139264,139520,97280,117760,138240,81920,32768,47104,51200,147456
.long 2357760,21522976,21520896,1073741824,21283840,21424132,1885312,1966080,1280,19450880,19451904,19452928,19453952,0,0,1073741824,21522436,21516288,21098624,21257216,1065353216,4964352,2048,1024,512,15839232,15843328,20056064,21517312,21506048,21522432,1024,4848640,4930560,5012480,97280,21553152,21553152,21553152,2350080,15916032,18927616,18958336,15687680,15699968,19111936,15781888,2315200,0,0,3072,21522432,256,0,139520,139264,81920,133120,122880,97280,149504,143360,0,30720
.long 2360320,21523008,21524992,1073741824,21284864,21424136,492416,1966080,3072,19910656,19992576,19912704,19994624,21212416,0,0,21522440,21516288,21098752,21218816,1065353216,5005312,2048,1024,512,15978496,15982592,20058112,21517312,21494784,21511168,1024,7212800,7294720,7376640,112640,21553152,21553152,21553152,2391040,16055296,18989056,19019776,15712256,15724544,19111936,15761408,2335680,0,0,3072,21522432,139264,139520,0,256,128000,87040,107520,112640,32768,47104,51200,147456
.long 2362880,21523040,21529088,1073741824,21285888,21424140,101120,1966080,3072,20714496,20796416,20716544,20798464,21277952,0,0,21522444,21516288,21098880,21259776,1065353216,5046272,2048,1024,512,16117760,16121856,20060160,21517312,21511168,21527552,1024,7458560,7540480,7622400,128000,21553152,21553152,21553152,2432000,16194560,19050496,19081216,15736832,15749120,19111936,15781888,2356160,0,0,3072,21522432,139520,139264,256,0,112640,102400,92160,128000,149504,143360,0,30720
.long 2396160,21527040,21516800,21286240,21282816,21428224,860672,1966080,1280,17930240,17931264,17932288,17933312,0,0,1073741824,21526528,21516288,21139456,21226496,1065353216,7536640,512,20480,10240,15724544,15728640,20381696,21519360,21491712,21508096,0,4613120,4695040,4776960,81920,21553152,21553152,21553152,2319360,15787008,17473536,17504256,15941632,15953920,17719296,16039936,2376000,0,0,3072,21526528,0,256,139264,139520,97280,117760,138240,81920,32768,47104,51200,147456
.long 2398720,21527072,21520896,1073741824,21283840,21428228,1925120,1966080,1280,17017856,17018880,17019904,17020928,0,0,1073741824,21526532,21516288,21139584,21267456,1065353216,7577600,512,20480,10240,15863808,15867904,20383744,21519360,21508096,21524480,0,4858880,4940800,5022720,97280,21553152,21553152,21553152,2360320,15926272,17534976,17565696,15966208,15978496,17719296,16060416,2396480,0,0,3072,21526528,256,0,139520,139264,81920,133120,122880,97280,149504,143360,0,30720
.long 2401280,21527104,21524992,1073741824,21284864,21428232,590720,1966080,3072,19914752,19996672,19916800,19998720,21212672,0,0,21526536,21516288,21139712,21229056,1065353216,7618560,512,20480,10240,16003072,16007168,20385792,21519360,21496832,21513216,0,7215360,7297280,7379200,112640,21553152,21553152,21553152,2401280,16065536,17596416,17627136,15990784,16003072,17719296,16039936,2416960,0,0,3072,21526528,139264,139520,0,256,128000,87040,107520,112640,32768,47104,51200,147456
.long 2403840,21527136,21529088,1073741824,21285888,21428236,199424,1966080,3072,20718592,20800512,20720640,20802560,21278208,0,0,21526540,21516288,21139840,21270016,1065353216,7659520,512,20480,10240,16142336,16146432,20387840,21519360,21513216,21529600,0,7461120,7543040,7624960,128000,21553152,21553152,21553152,2442240,16204800,17657856,17688576,16015360,16027648,17719296,16060416,2437440,0,0,3072,21526528,139520,139264,256,0,112640,102400,92160,128000,149504,143360,0,30720
.long 2437120,21531136,21516800,21286256,21282816,21432320,860800,1966080,1280,18277376,18278400,18279424,18280448,0,0,1073741824,21530624,21516288,21180416,21236736,1065353216,7544832,512,20480,10240,15749120,15753216,20709376,21520384,21492736,21509120,0,4623360,4705280,4787200,81920,21553152,21553152,21553152,2329600,15797248,18866176,18896896,15941632,15953920,19111936,16039936,2376640,0,0,3072,21530624,0,256,139264,139520,97280,117760,138240,81920,32768,47104,51200,147456
.long 2439680,21531168,21520896,1073741824,21283840,21432324,1925248,1966080,1280,17021952,17366016,17367040,17368064,0,0,1073741824,21530628,21516288,21180544,21277696,1065353216,7585792,512,20480,10240,15888384,15892480,20711424,21520384,21509120,21525504,0,4869120,4951040,5032960,97280,21553152,21553152,21553152,2370560,15936512,18927616,18958336,15966208,15978496,19111936,16060416,2397120,0,0,3072,21530624,256,0,139520,139264,81920,133120,122880,97280,149504,143360,0,30720
.long 2442240,21531200,21524992,1073741824,21284864,21432328,689024,1966080,3072,19918848,20000768,19920896,20002816,21212928,0,0,21530632,21516288,21180672,21239296,1065353216,7626752,512,20480,10240,16027648,16031744,20713472,21520384,21497856,21514240,0,7217920,7299840,7381760,112640,21553152,21553152,21553152,2411520,16075776,18989056,19019776,15990784,16003072,19111936,16039936,2417600,0,0,3072,21530624,139264,139520,0,256,128000,87040,107520,112640,32768,47104,51200,147456
.long 2444800,21531232,21529088,1073741824,21285888,21432332,297728,1966080,3072,20722688,20804608,20724736,20806656,21278464,0,0,21530636,21516288,21180800,21280256,1065353216,7667712,512,20480,10240,16166912,16171008,20715520,21520384,21514240,21530624,0,7463680,7545600,7627520,128000,21553152,21553152,21553152,2452480,16215040,19050496,19081216,16015360,16027648,19111936,16060416,2438080,0,0,3072,21530624,139520,139264,256,0,112640,102400,92160,128000,149504,143360,0,30720
.long 1013760,21388800,21385728,21286272,21282816,21289984,860928,1966080,1280,18281472,18625536,18626560,18627584,0,0,1073741824,21388288,21385216,20903936,21206144,1051011932,1007616,2048,1024,512,11227136,11225088,19808256,21385216,21357568,21373952,1024,3284480,3366400,3448320,81920,21553152,21553152,21553152,990720,11312640,17821696,17852416,11206656,11218944,18067456,11304960,983520,0,0,3072,21388288,0,256,139264,139520,97280,117760,138240,81920,32768,47104,51200,147456
.long 1016320,21388832,21389824,1073741824,21283840,21289988,1925376,1966080,1280,17369088,17370112,17714176,17715200,0,0,1073741824,21388292,21385216,20904064,21247104,1051011932,1048576,2048,1024,512,11366400,11364352,19810304,21385216,21373952,21390336,1024,3530240,3612160,3694080,97280,21553152,21553152,21553152,1031680,11451904,17883136,17913856,11231232,11243520,18067456,11325440,1004000,0,0,3072,21388288,256,0,139520,139264,81920,133120,122880,97280,149504,143360,0,30720
.long 1018880,21388864,21393920,1073741824,21284864,21289992,787328,1966080,3072,19922944,20004864,19924992,20006912,21213184,0,0,21388296,21385216,20904192,21208704,1051011932,1089536,2048,1024,512,11505664,11503616,19812352,21385216,21362688,21379072,1024,5900160,5982080,6064000,112640,21553152,21553152,21553152,1072640,11591168,17944576,17975296,11255808,11268096,18067456,11304960,1024480,0,0,3072,21388288,139264,139520,0,256,128000,87040,107520,112640,32768,47104,51200,147456
.long 1021440,21388896,21398016,1073741824,21285888,21289996,396032,1966080,3072,20726784,20808704,20728832,20810752,21278720,0,0,21388300,21385216,20904320,21249664,1051011932,1130496,2048,1024,512,11644928,11642880,19814400,21385216,21379072,21395456,1024,6145920,6227840,6309760,128000,21553152,21553152,21553152,1113600,11730432,18006016,18036736,11280384,11292672,18067456,11325440,1044960,0,0,3072,21388288,139520,139264,256,0,112640,102400,92160,128000,149504,143360,0,30720
.long 1054720,21392896,21385728,21286288,21282816,21294080,861056,1966080,1280,18628608,18629632,18973696,18974720,0,0,1073741824,21392384,21385216,20944896,21216384,1065353216,3620864,2048,1024,512,11251712,11249664,20135936,21387264,21359616,21376000,0,3294720,3376640,3458560,81920,21553152,21553152,21553152,1000960,11322880,19214336,19245056,11206656,11218944,19460096,11304960,984160,0,0,3072,21392384,0,256,139264,139520,97280,117760,138240,81920,32768,47104,51200,147456
.long 1057280,21392928,21389824,1073741824,21283840,21294084,1925504,1966080,1280,17716224,17717248,17718272,18062336,0,0,1073741824,21392388,21385216,20945024,21257344,1065353216,3661824,2048,1024,512,11390976,11388928,20137984,21387264,21376000,21392384,0,3540480,3622400,3704320,97280,21553152,21553152,21553152,1041920,11462144,19275776,19306496,11231232,11243520,19460096,11325440,1004640,0,0,3072,21392384,256,0,139520,139264,81920,133120,122880,97280,149504,143360,0,30720
.long 1059840,21392960,21393920,1073741824,21284864,21294088,885632,1966080,3072,19927040,20008960,19929088,20011008,21213440,0,0,21392392,21385216,20945152,21218944,1065353216,3702784,2048,1024,512,11530240,11528192,20140032,21387264,21364736,21381120,0,5902720,5984640,6066560,112640,21553152,21553152,21553152,1082880,11601408,19337216,19367936,11255808,11268096,19460096,11304960,1025120,0,0,3072,21392384,139264,139520,0,256,128000,87040,107520,112640,32768,47104,51200,147456
.long 1062400,21392992,21398016,1073741824,21285888,21294092,494336,1966080,3072,20730880,20812800,20732928,20814848,21278976,0,0,21392396,21385216,20945280,21259904,1065353216,3743744,2048,1024,512,11669504,11667456,20142080,21387264,21381120,21397504,0,6148480,6230400,6312320,128000,21553152,21553152,21553152,1123840,11740672,19398656,19429376,11280384,11292672,19460096,11325440,1045600,0,0,3072,21392384,139520,139264,256,0,112640,102400,92160,128000,149504,143360,0,30720
.long 1095680,21396992,21385728,21286304,21282816,21298176,861184,1966080,1280,18975744,18976768,18977792,19321856,0,0,1073741824,21396480,21385216,20985856,21226624,1065353216,6227968,512,20480,10240,11276288,11274240,20463616,21388288,21360640,21377024,0,3304960,3386880,3468800,81920,21553152,21553152,21553152,1011200,11333120,17821696,17852416,11485184,11497472,18067456,11583488,1065440,0,0,3072,21396480,0,256,139264,139520,97280,117760,138240,81920,32768,47104,51200,147456
.long 1098240,21397024,21389824,1073741824,21283840,21298180,1925632,1966080,1280,18063360,18064384,18065408,18066432,0,0,1073741824,21396484,21385216,20985984,21267584,1065353216,6268928,512,20480,10240,11415552,11413504,20465664,21388288,21377024,21393408,0,3550720,3632640,3714560,97280,21553152,21553152,21553152,1052160,11472384,17883136,17913856,11509760,11522048,18067456,11603968,1085920,0,0,3072,21396480,256,0,139520,139264,81920,133120,122880,97280,149504,143360,0,30720
.long 1100800,21397056,21393920,1073741824,21284864,21298184,983936,1966080,3072,19931136,20013056,19933184,20015104,21213696,0,0,21396488,21385216,20986112,21229184,1065353216,6309888,512,20480,10240,11554816,11552768,20467712,21388288,21365760,21382144,0,5905280,5987200,6069120,112640,21553152,21553152,21553152,1093120,11611648,17944576,17975296,11534336,11546624,18067456,11583488,1106400,0,0,3072,21396480,139264,139520,0,256,128000,87040,107520,112640,32768,47104,51200,147456
.long 1103360,21397088,21398016,1073741824,21285888,21298188,592640,1966080,3072,20734976,20816896,20737024,20818944,21279232,0,0,21396492,21385216,20986240,21270144,1065353216,6350848,512,20480,10240,11694080,11692032,20469760,21388288,21382144,21398528,0,6151040,6232960,6314880,128000,21553152,21553152,21553152,1134080,11750912,18006016,18036736,11558912,11571200,18067456,11603968,1126880,0,0,3072,21396480,139520,139264,256,0,112640,102400,92160,128000,149504,143360,0,30720
.long 1136640,21401088,21385728,21286320,21282816,21302272,861312,1966080,1280,19322880,19323904,19324928,19325952,0,0,1073741824,21400576,21385216,21026816,21236864,1065353216,8847360,512,20480,10240,11300864,11298816,20791296,21389312,21361664,21378048,0,3315200,3397120,3479040,81920,21553152,21553152,21553152,1021440,11343360,19214336,19245056,11485184,11497472,19460096,11583488,1066080,0,0,3072,21400576,0,256,139264,139520,97280,117760,138240,81920,32768,47104,51200,147456
.long 1139200,21401120,21389824,1073741824,21283840,21302276,1925760,1966080,1280,18410496,18411520,18412544,18413568,0,0,1073741824,21400580,21385216,21026944,21277824,1065353216,8888320,512,20480,10240,11440128,11438080,20793344,21389312,21378048,21394432,0,3560960,3642880,3724800,97280,21553152,21553152,21553152,1062400,11482624,19275776,19306496,11509760,11522048,19460096,11603968,1086560,0,0,3072,21400576,256,0,139520,139264,81920,133120,122880,97280,149504,143360,0,30720
.long 1141760,21401152,21393920,1073741824,21284864,21302280,1082240,1966080,3072,19935232,20017152,19937280,20019200,21213952,0,0,21400584,21385216,21027072,21239424,1065353216,8929280,512,20480,10240,11579392,11577344,20795392,21389312,21366784,21383168,0,5907840,5989760,6071680,112640,21553152,21553152,21553152,1103360,11621888,19337216,19367936,11534336,11546624,19460096,11583488,1107040,0,0,3072,21400576,139264,139520,0,256,128000,87040,107520,112640,32768,47104,51200,147456
.long 1144320,21401184,21398016,1073741824,21285888,21302284,690944,1966080,3072,20739072,20820992,20741120,20823040,21279488,0,0,21400588,21385216,21027200,21280384,1065353216,8970240,512,20480,10240,11718656,11716608,20797440,21389312,21383168,21399552,0,6153600,6235520,6317440,128000,21553152,21553152,21553152,1144320,11761152,19398656,19429376,11558912,11571200,19460096,11603968,1127520,0,0,3072,21400576,139520,139264,256,0,112640,102400,92160,128000,149504,143360,0,30720
.long 2324480,21519872,21516800,21286336,21282816,21421056,901120,1966080,1280,16889856,16890880,16891904,16892928,0,0,1073741824,21519360,21516288,21067776,21206144,1051011932,2318336,2048,1024,512,15683584,15681536,19808256,21516288,21488640,21505024,1024,4595200,4677120,4759040,81920,21553152,21553152,21553152,2301440,15769088,17821696,17852416,15663104,15675392,18067456,15761408,2294240,0,0,3072,21519360,0,256,139264,139520,97280,117760,138240,81920,32768,47104,51200,147456
.long 2327040,21519904,21520896,1073741824,21283840,21421060,1925888,1966080,1280,18414592,18758656,18759680,18760704,0,0,1073741824,21519364,21516288,21067904,21247104,1051011932,2359296,2048,1024,512,15822848,15820800,19810304,21516288,21505024,21521408,1024,4840960,4922880,5004800,97280,21553152,21553152,21553152,2342400,15908352,17883136,17913856,15687680,15699968,18067456,15781888,2314720,0,0,3072,21519360,256,0,139520,139264,81920,133120,122880,97280,149504,143360,0,30720
.long 2329600,21519936,21524992,1073741824,21284864,21421064,1180544,1966080,3072,19939328,20021248,19941376,20023296,21214208,0,0,21519368,21516288,21068032,21208704,1051011932,2400256,2048,1024,512,15962112,15960064,19812352,21516288,21493760,21510144,1024,7210880,7292800,7374720,112640,21553152,21553152,21553152,2383360,16047616,17944576,17975296,15712256,15724544,18067456,15761408,2335200,0,0,3072,21519360,139264,139520,0,256,128000,87040,107520,112640,32768,47104,51200,147456
.long 2332160,21519968,21529088,1073741824,21285888,21421068,789248,1966080,3072,20743168,20825088,20745216,20827136,21279744,0,0,21519372,21516288,21068160,21249664,1051011932,2441216,2048,1024,512,16101376,16099328,19814400,21516288,21510144,21526528,1024,7456640,7538560,7620480,128000,21553152,21553152,21553152,2424320,16186880,18006016,18036736,15736832,15749120,18067456,15781888,2355680,0,0,3072,21519360,139520,139264,256,0,112640,102400,92160,128000,149504,143360,0,30720
.long 2365440,21523968,21516800,21286352,21282816,21425152,901248,1966080,1280,16893952,17238016,17239040,17240064,0,0,1073741824,21523456,21516288,21108736,21216384,1065353216,4931584,2048,1024,512,15708160,15706112,20135936,21518336,21490688,21507072,0,4605440,4687360,4769280,81920,21553152,21553152,21553152,2311680,15779328,19214336,19245056,15663104,15675392,19460096,15761408,2294880,0,0,3072,21523456,0,256,139264,139520,97280,117760,138240,81920,32768,47104,51200,147456
.long 2368000,21524000,21520896,1073741824,21283840,21425156,1926016,1966080,1280,18761728,18762752,19106816,19107840,0,0,1073741824,21523460,21516288,21108864,21257344,1065353216,4972544,2048,1024,512,15847424,15845376,20137984,21518336,21507072,21523456,0,4851200,4933120,5015040,97280,21553152,21553152,21553152,2352640,15918592,19275776,19306496,15687680,15699968,19460096,15781888,2315360,0,0,3072,21523456,256,0,139520,139264,81920,133120,122880,97280,149504,143360,0,30720
.long 2370560,21524032,21524992,1073741824,21284864,21425160,1278848,1966080,3072,19943424,20025344,19945472,20027392,21214464,0,0,21523464,21516288,21108992,21218944,1065353216,5013504,2048,1024,512,15986688,15984640,20140032,21518336,21495808,21512192,0,7213440,7295360,7377280,112640,21553152,21553152,21553152,2393600,16057856,19337216,19367936,15712256,15724544,19460096,15761408,2335840,0,0,3072,21523456,139264,139520,0,256,128000,87040,107520,112640,32768,47104,51200,147456
.long 2373120,21524064,21529088,1073741824,21285888,21425164,887552,1966080,3072,20747264,20829184,20749312,20831232,21280000,0,0,21523468,21516288,21109120,21259904,1065353216,5054464,2048,1024,512,16125952,16123904,20142080,21518336,21512192,21528576,0,7459200,7541120,7623040,128000,21553152,21553152,21553152,2434560,16197120,19398656,19429376,15736832,15749120,19460096,15781888,2356320,0,0,3072,21523456,139520,139264,256,0,112640,102400,92160,128000,149504,143360,0,30720
.long 2406400,21528064,21516800,21286368,21282816,21429248,901376,1966080,1280,17241088,17242112,17586176,17587200,0,0,1073741824,21527552,21516288,21149696,21226624,1065353216,7538688,512,20480,10240,15732736,15730688,20463616,21519360,21491712,21508096,0,4615680,4697600,4779520,81920,21553152,21553152,21553152,2321920,15789568,17821696,17852416,15941632,15953920,18067456,16039936,2376160,0,0,3072,21527552,0,256,139264,139520,97280,117760,138240,81920,32768,47104,51200,147456
.long 2408960,21528096,21520896,1073741824,21283840,21429252,1926144,1966080,1280,19108864,19109888,19110912,19454976,0,0,1073741824,21527556,21516288,21149824,21267584,1065353216,7579648,512,20480,10240,15872000,15869952,20465664,21519360,21508096,21524480,0,4861440,4943360,5025280,97280,21553152,21553152,21553152,2362880,15928832,17883136,17913856,15966208,15978496,18067456,16060416,2396640,0,0,3072,21527552,256,0,139520,139264,81920,133120,122880,97280,149504,143360,0,30720
.long 2411520,21528128,21524992,1073741824,21284864,21429256,1377152,1966080,3072,19947520,20029440,19949568,20031488,21214720,0,0,21527560,21516288,21149952,21229184,1065353216,7620608,512,20480,10240,16011264,16009216,20467712,21519360,21496832,21513216,0,7216000,7297920,7379840,112640,21553152,21553152,21553152,2403840,16068096,17944576,17975296,15990784,16003072,18067456,16039936,2417120,0,0,3072,21527552,139264,139520,0,256,128000,87040,107520,112640,32768,47104,51200,147456
.long 2414080,21528160,21529088,1073741824,21285888,21429260,985856,1966080,3072,20751360,20833280,20753408,20835328,21280256,0,0,21527564,21516288,21150080,21270144,1065353216,7661568,512,20480,10240,16150528,16148480,20469760,21519360,21513216,21529600,0,7461760,7543680,7625600,128000,21553152,21553152,21553152,2444800,16207360,18006016,18036736,16015360,16027648,18067456,16060416,2437600,0,0,3072,21527552,139520,139264,256,0,112640,102400,92160,128000,149504,143360,0,30720
.long 2447360,21532160,21516800,21286384,21282816,21433344,901504,1966080,1280,17588224,17589248,17590272,17934336,0,0,1073741824,21531648,21516288,21190656,21236864,1065353216,10158080,512,20480,10240,15757312,15755264,20791296,21520384,21492736,21509120,0,4625920,4707840,4789760,81920,21553152,21553152,21553152,2332160,15799808,19214336,19245056,15941632,15953920,19460096,16039936,2376800,0,0,3072,21531648,0,256,139264,139520,97280,117760,138240,81920,32768,47104,51200,147456
.long 2449920,21532192,21520896,1073741824,21283840,21433348,1926272,1966080,1280,19456000,19457024,19458048,19459072,0,0,1073741824,21531652,21516288,21190784,21277824,1065353216,10199040,512,20480,10240,15896576,15894528,20793344,21520384,21509120,21525504,0,4871680,4953600,5035520,97280,21553152,21553152,21553152,2373120,15939072,19275776,19306496,15966208,15978496,19460096,16060416,2397280,0,0,3072,21531648,256,0,139520,139264,81920,133120,122880,97280,149504,143360,0,30720
.long 2452480,21532224,21524992,1073741824,21284864,21433352,1475456,1966080,3072,19951616,20033536,19953664,20035584,21214976,0,0,21531656,21516288,21190912,21239424,1065353216,10240000,512,20480,10240,16035840,16033792,20795392,21520384,21497856,21514240,0,7218560,7300480,7382400,112640,21553152,21553152,21553152,2414080,16078336,19337216,19367936,15990784,16003072,19460096,16039936,2417760,0,0,3072,21531648,139264,139520,0,256,128000,87040,107520,112640,32768,47104,51200,147456
.long 2455040,21532256,21529088,1073741824,21285888,21433356,1084160,1966080,3072,20755456,20837376,20757504,20839424,21280512,0,0,21531660,21516288,21191040,21280384,1065353216,10280960,512,20480,10240,16175104,16173056,20797440,21520384,21514240,21530624,0,7464320,7546240,7628160,128000,21553152,21553152,21553152,2455040,16217600,19398656,19429376,16015360,16027648,19460096,16060416,2438240,0,0,3072,21531648,139520,139264,256,0,112640,102400,92160,128000,149504,143360,0,30720
.long 1146880,21402112,21402112,21286400,21282816,21286912,901632,1966080,1280,17935360,17936384,17937408,17938432,0,0,1073741824,21401600,21401600,20873216,21200896,1051011932,1146880,2048,1024,512,11763712,11767808,19562496,21401600,21373952,21390336,0,3440640,3522560,3604480,81920,21553152,21553152,21553152,1146880,11862016,16807936,16777216,11776000,11763712,17022976,11862016,1146880,0,0,3584,21401600,0,256,139264,139520,97280,117760,138240,81920,32768,47104,51200,147456
.long 1149440,21402144,21406208,1073741824,21283840,21286916,0,819200,1280,17022976,17024000,17025024,17026048,0,0,1073741824,21401604,21401600,20873344,21241856,1051011932,1187840,2048,1024,512,11902976,11907072,19564544,21401600,21390336,21406720,0,3686400,3768320,3850240,97280,21553152,21553152,21553152,1187840,12001280,16869376,16838656,11800576,11788288,17022976,11882496,1167360,0,0,3584,21401600,256,0,139520,139264,81920,133120,122880,97280,149504,143360,0,30720
.long 1152000,21402176,21410304,1073741824,21284864,21286920,1573760,1966080,3072,19955712,20037632,19957760,20039680,21215232,0,0,21401608,21401600,20873472,21203456,1051011932,1228800,2048,1024,512,12042240,12046336,19566592,21401600,21379072,21395456,0,6062080,6144000,6225920,112640,21553152,21553152,21553152,1228800,12140544,16930816,16900096,11825152,11812864,17022976,11862016,1187840,0,0,3584,21401600,139264,139520,0,256,128000,87040,107520,112640,32768,47104,51200,147456
.long 1154560,21402208,21414400,1073741824,21285888,21286924,1182464,1966080,3072,20759552,20841472,20761600,20843520,21280768,0,0,21401612,21401600,20873600,21244416,1051011932,1269760,2048,1024,512,12181504,12185600,19568640,21401600,21395456,21411840,0,6307840,6389760,6471680,128000,21553152,21553152,21553152,1269760,12279808,16992256,16961536,11849728,11837440,17022976,11882496,1208320,0,0,3584,21401600,139520,139264,256,0,112640,102400,92160,128000,149504,143360,0,30720
.long 1187840,21406208,21402112,21286416,21282816,21291008,901760,1966080,1280,18282496,18283520,18284544,18285568,0,0,1073741824,21405696,21401600,20914176,21211136,1051011932,1179648,2048,1024,512,11788288,11792384,19890176,21402624,21374976,21391360,0,3450880,3532800,3614720,81920,21553152,21553152,21553152,1157120,11872256,18200576,18169856,11776000,11763712,18415616,11862016,1147520,0,0,3584,21405696,0,256,139264,139520,97280,117760,138240,81920,32768,47104,51200,147456
.long 1190400,21406240,21406208,1073741824,21283840,21291012,128,819200,1280,17027072,17371136,17372160,17373184,0,0,1073741824,21405700,21401600,20914304,21252096,1051011932,1220608,2048,1024,512,11927552,11931648,19892224,21402624,21391360,21407744,0,3696640,3778560,3860480,97280,21553152,21553152,21553152,1198080,12011520,18262016,18231296,11800576,11788288,18415616,11882496,1168000,0,0,3584,21405696,256,0,139520,139264,81920,133120,122880,97280,149504,143360,0,30720
.long 1192960,21406272,21410304,1073741824,21284864,21291016,1672064,1966080,3072,19959808,20041728,19961856,20043776,21215488,0,0,21405704,21401600,20914432,21213696,1051011932,1261568,2048,1024,512,12066816,12070912,19894272,21402624,21380096,21396480,0,6064640,6146560,6228480,112640,21553152,21553152,21553152,1239040,12150784,18323456,18292736,11825152,11812864,18415616,11862016,1188480,0,0,3584,21405696,139264,139520,0,256,128000,87040,107520,112640,32768,47104,51200,147456
.long 1195520,21406304,21414400,1073741824,21285888,21291020,1280768,1966080,3072,20763648,20845568,20765696,20847616,21281024,0,0,21405708,21401600,20914560,21254656,1051011932,1302528,2048,1024,512,12206080,12210176,19896320,21402624,21396480,21412864,0,6310400,6392320,6474240,128000,21553152,21553152,21553152,1280000,12290048,18384896,18354176,11849728,11837440,18415616,11882496,1208960,0,0,3584,21405696,139520,139264,256,0,112640,102400,92160,128000,149504,143360,0,30720
.long 1228800,21410304,21402112,21286432,21282816,21295104,901888,1966080,1280,18286592,18630656,18631680,18632704,0,0,1073741824,21409792,21401600,20955136,21221376,1065353216,3792896,2048,1024,512,11812864,11816960,20217856,21403648,21376000,21392384,0,3461120,3543040,3624960,81920,21553152,21553152,21553152,1167360,11882496,16807936,16777216,12054528,12042240,17022976,12140544,1228800,0,0,3584,21409792,0,256,139264,139520,97280,117760,138240,81920,32768,47104,51200,147456
.long 1231360,21410336,21406208,1073741824,21283840,21295108,256,819200,1280,17374208,17375232,17719296,17720320,0,0,1073741824,21409796,21401600,20955264,21262336,1065353216,3833856,2048,1024,512,11952128,11956224,20219904,21403648,21392384,21408768,0,3706880,3788800,3870720,97280,21553152,21553152,21553152,1208320,12021760,16869376,16838656,12079104,12066816,17022976,12161024,1249280,0,0,3584,21409792,256,0,139520,139264,81920,133120,122880,97280,149504,143360,0,30720
.long 1233920,21410368,21410304,1073741824,21284864,21295112,1770368,1966080,3072,19963904,20045824,19965952,20047872,21215744,0,0,21409800,21401600,20955392,21223936,1065353216,3874816,2048,1024,512,12091392,12095488,20221952,21403648,21381120,21397504,0,6067200,6149120,6231040,112640,21553152,21553152,21553152,1249280,12161024,16930816,16900096,12103680,12091392,17022976,12140544,1269760,0,0,3584,21409792,139264,139520,0,256,128000,87040,107520,112640,32768,47104,51200,147456
.long 1236480,21410400,21414400,1073741824,21285888,21295116,1379072,1966080,3072,20767744,20849664,20769792,20851712,21281280,0,0,21409804,21401600,20955520,21264896,1065353216,3915776,2048,1024,512,12230656,12234752,20224000,21403648,21397504,21413888,0,6312960,6394880,6476800,128000,21553152,21553152,21553152,1290240,12300288,16992256,16961536,12128256,12115968,17022976,12161024,1290240,0,0,3584,21409792,139520,139264,256,0,112640,102400,92160,128000,149504,143360,0,30720
.long 1269760,21414400,21402112,21286448,21282816,21299200,902016,1966080,1280,18633728,18634752,18978816,18979840,0,0,1073741824,21413888,21401600,20996096,21231616,1065353216,6393856,512,20480,10240,11837440,11841536,20545536,21404672,21377024,21393408,1024,3471360,3553280,3635200,81920,21553152,21553152,21553152,1177600,11892736,18200576,18169856,12054528,12042240,18415616,12140544,1229440,0,0,3584,21413888,0,256,139264,139520,97280,117760,138240,81920,32768,47104,51200,147456
.long 1272320,21414432,21406208,1073741824,21283840,21299204,384,819200,1280,17721344,17722368,17723392,18067456,0,0,1073741824,21413892,21401600,20996224,21272576,1065353216,6434816,512,20480,10240,11976704,11980800,20547584,21404672,21393408,21409792,1024,3717120,3799040,3880960,97280,21553152,21553152,21553152,1218560,12032000,18262016,18231296,12079104,12066816,18415616,12161024,1249920,0,0,3584,21413888,256,0,139520,139264,81920,133120,122880,97280,149504,143360,0,30720
.long 1274880,21414464,21410304,1073741824,21284864,21299208,1868672,1966080,3072,19968000,20049920,19970048,20051968,21216000,0,0,21413896,21401600,20996352,21234176,1065353216,6475776,512,20480,10240,12115968,12120064,20549632,21404672,21382144,21398528,1024,6069760,6151680,6233600,112640,21553152,21553152,21553152,1259520,12171264,18323456,18292736,12103680,12091392,18415616,12140544,1270400,0,0,3584,21413888,139264,139520,0,256,128000,87040,107520,112640,32768,47104,51200,147456
.long 1277440,21414496,21414400,1073741824,21285888,21299212,1477376,1966080,3072,20771840,20853760,20773888,20855808,21281536,0,0,21413900,21401600,20996480,21275136,1065353216,6516736,512,20480,10240,12255232,12259328,20551680,21404672,21398528,21414912,1024,6315520,6397440,6479360,128000,21553152,21553152,21553152,1300480,12310528,18384896,18354176,12128256,12115968,18415616,12161024,1290880,0,0,3584,21413888,139520,139264,256,0,112640,102400,92160,128000,149504,143360,0,30720
.long 2457600,21533184,21533184,21286464,21282816,21417984,902144,1966080,1280,18980864,18981888,18982912,19326976,0,0,1073741824,21532672,21532672,21037056,21200896,1051011932,2457600,2048,1024,512,16220160,16224256,19562496,21532672,21505024,21521408,0,4751360,4833280,4915200,81920,21553152,21553152,21553152,2457600,16318464,16807936,16777216,16232448,16220160,17022976,16318464,2457600,0,0,3584,21532672,0,256,139264,139520,97280,117760,138240,81920,32768,47104,51200,147456
.long 2460160,21533216,21537280,1073741824,21283840,21417988,512,819200,1280,18068480,18069504,18070528,18071552,0,0,1073741824,21532676,21532672,21037184,21241856,1051011932,2498560,2048,1024,512,16359424,16363520,19564544,21532672,21521408,21537792,0,4997120,5079040,5160960,97280,21553152,21553152,21553152,2498560,16457728,16869376,16838656,16257024,16244736,17022976,16338944,2478080,0,0,3584,21532672,256,0,139520,139264,81920,133120,122880,97280,149504,143360,0,30720
.long 2462720,21533248,21541376,1073741824,21284864,21417992,1280,1966080,3072,20054016,20135936,20056064,20137984,21216256,0,0,21532680,21532672,21037312,21203456,1051011932,2539520,2048,1024,512,16498688,16502784,19566592,21532672,21510144,21526528,0,7372800,7454720,7536640,112640,21553152,21553152,21553152,2539520,16596992,16930816,16900096,16281600,16269312,17022976,16318464,2498560,0,0,3584,21532672,139264,139520,0,256,128000,87040,107520,112640,32768,47104,51200,147456
.long 2465280,21533280,21545472,1073741824,21285888,21417996,1575680,1966080,3072,20775936,20857856,20777984,20859904,21281792,0,0,21532684,21532672,21037440,21244416,1051011932,2580480,2048,1024,512,16637952,16642048,19568640,21532672,21526528,21542912,0,7618560,7700480,7782400,128000,21553152,21553152,21553152,2580480,16736256,16992256,16961536,16306176,16293888,17022976,16338944,2519040,0,0,3584,21532672,139520,139264,256,0,112640,102400,92160,128000,149504,143360,0,30720
.long 2498560,21537280,21533184,21286480,21282816,21422080,902272,1966080,1280,19328000,19329024,19330048,19331072,0,0,1073741824,21536768,21532672,21078016,21211136,1051011932,2490368,2048,1024,512,16244736,16248832,19890176,21533696,21506048,21522432,0,4761600,4843520,4925440,81920,21553152,21553152,21553152,2467840,16328704,18200576,18169856,16232448,16220160,18415616,16318464,2458240,0,0,3584,21536768,0,256,139264,139520,97280,117760,138240,81920,32768,47104,51200,147456
.long 2501120,21537312,21537280,1073741824,21283840,21422084,640,819200,1280,18415616,18416640,18417664,18418688,0,0,1073741824,21536772,21532672,21078144,21252096,1051011932,2531328,2048,1024,512,16384000,16388096,19892224,21533696,21522432,21538816,0,5007360,5089280,5171200,97280,21553152,21553152,21553152,2508800,16467968,18262016,18231296,16257024,16244736,18415616,16338944,2478720,0,0,3584,21536768,256,0,139520,139264,81920,133120,122880,97280,149504,143360,0,30720
.long 2503680,21537344,21541376,1073741824,21284864,21422088,99584,1966080,3072,20058112,20140032,20060160,20142080,21216512,0,0,21536776,21532672,21078272,21213696,1051011932,2572288,2048,1024,512,16523264,16527360,19894272,21533696,21511168,21527552,0,7375360,7457280,7539200,112640,21553152,21553152,21553152,2549760,16607232,18323456,18292736,16281600,16269312,18415616,16318464,2499200,0,0,3584,21536768,139264,139520,0,256,128000,87040,107520,112640,32768,47104,51200,147456
.long 2506240,21537376,21545472,1073741824,21285888,21422092,1673984,1966080,3072,20780032,20861952,20782080,20864000,21282048,0,0,21536780,21532672,21078400,21254656,1051011932,2613248,2048,1024,512,16662528,16666624,19896320,21533696,21527552,21543936,0,7621120,7703040,7784960,128000,21553152,21553152,21553152,2590720,16746496,18384896,18354176,16306176,16293888,18415616,16338944,2519680,0,0,3584,21536768,139520,139264,256,0,112640,102400,92160,128000,149504,143360,0,30720
.long 2539520,21541376,21533184,21286496,21282816,21426176,942080,1966080,1280,16894976,16896000,16897024,16898048,0,0,1073741824,21540864,21532672,21118976,21221376,1065353216,5103616,2048,1024,512,16269312,16273408,20217856,21534720,21507072,21523456,0,4771840,4853760,4935680,81920,21553152,21553152,21553152,2478080,16338944,16807936,16777216,16510976,16498688,17022976,16596992,2539520,0,0,3584,21540864,0,256,139264,139520,97280,117760,138240,81920,32768,47104,51200,147456
.long 2542080,21541408,21537280,1073741824,21283840,21426180,768,819200,1280,18419712,18763776,18764800,18765824,0,0,1073741824,21540868,21532672,21119104,21262336,1065353216,5144576,2048,1024,512,16408576,16412672,20219904,21534720,21523456,21539840,0,5017600,5099520,5181440,97280,21553152,21553152,21553152,2519040,16478208,16869376,16838656,16535552,16523264,17022976,16617472,2560000,0,0,3584,21540864,256,0,139520,139264,81920,133120,122880,97280,149504,143360,0,30720
.long 2544640,21541440,21541376,1073741824,21284864,21426184,197888,1966080,3072,20062208,20144128,20064256,20146176,21216768,0,0,21540872,21532672,21119232,21223936,1065353216,5185536,2048,1024,512,16547840,16551936,20221952,21534720,21512192,21528576,0,7377920,7459840,7541760,112640,21553152,21553152,21553152,2560000,16617472,16930816,16900096,16560128,16547840,17022976,16596992,2580480,0,0,3584,21540864,139264,139520,0,256,128000,87040,107520,112640,32768,47104,51200,147456
.long 2547200,21541472,21545472,1073741824,21285888,21426188,1772288,1966080,3072,20784128,20866048,20786176,20868096,21282304,0,0,21540876,21532672,21119360,21264896,1065353216,5226496,2048,1024,512,16687104,16691200,20224000,21534720,21528576,21544960,0,7623680,7705600,7787520,128000,21553152,21553152,21553152,2600960,16756736,16992256,16961536,16584704,16572416,17022976,16617472,2600960,0,0,3584,21540864,139520,139264,256,0,112640,102400,92160,128000,149504,143360,0,30720
.long 2580480,21545472,21533184,21286512,21282816,21430272,942208,1966080,1280,16899072,17243136,17244160,17245184,0,0,1073741824,21544960,21532672,21159936,21231616,1065353216,7704576,512,20480,10240,16293888,16297984,20545536,21535744,21508096,21524480,1024,4782080,4864000,4945920,81920,21553152,21553152,21553152,2488320,16349184,18200576,18169856,16510976,16498688,18415616,16596992,2540160,0,0,3584,21544960,0,256,139264,139520,97280,117760,138240,81920,32768,47104,51200,147456
.long 2583040,21545504,21537280,1073741824,21283840,21430276,896,819200,1280,18766848,18767872,19111936,19112960,0,0,1073741824,21544964,21532672,21160064,21272576,1065353216,7745536,512,20480,10240,16433152,16437248,20547584,21535744,21524480,21540864,1024,5027840,5109760,5191680,97280,21553152,21553152,21553152,2529280,16488448,18262016,18231296,16535552,16523264,18415616,16617472,2560640,0,0,3584,21544960,256,0,139520,139264,81920,133120,122880,97280,149504,143360,0,30720
.long 2585600,21545536,21541376,1073741824,21284864,21430280,296192,1966080,3072,20066304,20148224,20068352,20150272,21217024,0,0,21544968,21532672,21160192,21234176,1065353216,7786496,512,20480,10240,16572416,16576512,20549632,21535744,21513216,21529600,1024,7380480,7462400,7544320,112640,21553152,21553152,21553152,2570240,16627712,18323456,18292736,16560128,16547840,18415616,16596992,2581120,0,0,3584,21544960,139264,139520,0,256,128000,87040,107520,112640,32768,47104,51200,147456
.long 2588160,21545568,21545472,1073741824,21285888,21430284,1870592,1966080,3072,20788224,20870144,20790272,20872192,21282560,0,0,21544972,21532672,21160320,21275136,1065353216,7827456,512,20480,10240,16711680,16715776,20551680,21535744,21529600,21545984,1024,7626240,7708160,7790080,128000,21553152,21553152,21553152,2611200,16766976,18384896,18354176,16584704,16572416,18415616,16617472,2601600,0,0,3584,21544960,139520,139264,256,0,112640,102400,92160,128000,149504,143360,0,30720
.long 1157120,21403136,21402112,21286528,21282816,21287936,942336,1966080,1280,17246208,17247232,17591296,17592320,0,0,1073741824,21402624,21401600,20883456,21201024,1051011932,1155072,2048,1024,512,11771904,11769856,19644416,21401600,21373952,21390336,0,3443200,3525120,3607040,81920,21553152,21553152,21553152,1149440,11864576,17156096,17125376,11776000,11763712,17371136,11862016,1147040,0,0,3584,21402624,0,256,139264,139520,97280,117760,138240,81920,32768,47104,51200,147456
.long 1159680,21403168,21406208,1073741824,21283840,21287940,1024,819200,1280,19113984,19115008,19116032,19460096,0,0,1073741824,21402628,21401600,20883584,21241984,1051011932,1196032,2048,1024,512,11911168,11909120,19646464,21401600,21390336,21406720,0,3688960,3770880,3852800,97280,21553152,21553152,21553152,1190400,12003840,17217536,17186816,11800576,11788288,17371136,11882496,1167520,0,0,3584,21402624,256,0,139520,139264,81920,133120,122880,97280,149504,143360,0,30720
.long 1162240,21403200,21410304,1073741824,21284864,21287944,394496,1966080,3072,20070400,20152320,20072448,20154368,21217280,0,0,21402632,21401600,20883712,21203584,1051011932,1236992,2048,1024,512,12050432,12048384,19648512,21401600,21379072,21395456,0,6062720,6144640,6226560,112640,21553152,21553152,21553152,1231360,12143104,17278976,17248256,11825152,11812864,17371136,11862016,1188000,0,0,3584,21402624,139264,139520,0,256,128000,87040,107520,112640,32768,47104,51200,147456
.long 1164800,21403232,21414400,1073741824,21285888,21287948,1870592,0,3072,20788224,20870144,20790272,20872192,21282560,1073741824,1073741824,21402636,21401600,20883840,21244544,1051011932,1277952,2048,1024,512,12189696,12187648,19650560,21401600,21395456,21411840,0,6308480,6390400,6472320,128000,21553152,21553152,21553152,1272320,12282368,17340416,17309696,11849728,11837440,17371136,11882496,1208480,0,0,3584,21402624,139520,139264,256,0,112640,102400,92160,128000,149504,143360,0,30720
.long 1198080,21407232,21402112,21286544,21282816,21292032,942464,1966080,1280,17593344,17594368,17595392,17939456,0,0,1073741824,21406720,21401600,20924416,21211264,1065353216,3768320,2048,1024,512,11796480,11794432,19972096,21402624,21374976,21391360,0,3453440,3535360,3617280,81920,21553152,21553152,21553152,1159680,11874816,18548736,18518016,11776000,11763712,18763776,11862016,1147680,0,0,3584,21406720,0,256,139264,139520,97280,117760,138240,81920,32768,47104,51200,147456
.long 1200640,21407264,21406208,1073741824,21283840,21292036,1152,819200,1280,19461120,19462144,19463168,19464192,0,0,1073741824,21406724,21401600,20924544,21252224,1065353216,3809280,2048,1024,512,11935744,11933696,19974144,21402624,21391360,21407744,0,3699200,3781120,3863040,97280,21553152,21553152,21553152,1200640,12014080,18610176,18579456,11800576,11788288,18763776,11882496,1168160,0,0,3584,21406720,256,0,139520,139264,81920,133120,122880,97280,149504,143360,0,30720
.long 1203200,21407296,21410304,1073741824,21284864,21292040,492800,1966080,3072,20074496,20156416,20076544,20158464,21217536,0,0,21406728,21401600,20924672,21213824,1065353216,3850240,2048,1024,512,12075008,12072960,19976192,21402624,21380096,21396480,0,6065280,6147200,6229120,112640,21553152,21553152,21553152,1241600,12153344,18671616,18640896,11825152,11812864,18763776,11862016,1188640,0,0,3584,21406720,139264,139520,0,256,128000,87040,107520,112640,32768,47104,51200,147456
.long 1205760,21407328,21414400,1073741824,21285888,21292044,1870592,0,3072,20788224,20870144,20790272,20872192,21282560,1073741824,1073741824,21406732,21401600,20924800,21254784,1065353216,3891200,2048,1024,512,12214272,12212224,19978240,21402624,21396480,21412864,0,6311040,6392960,6474880,128000,21553152,21553152,21553152,1282560,12292608,18733056,18702336,11849728,11837440,18763776,11882496,1209120,0,0,3584,21406720,139520,139264,256,0,112640,102400,92160,128000,149504,143360,0,30720
.long 1239040,21411328,21402112,21286560,21282816,21296128,942592,1966080,1280,17940480,17941504,17942528,17943552,0,0,1073741824,21410816,21401600,20965376,21221504,1065353216,3801088,2048,1024,512,11821056,11819008,20299776,21403648,21376000,21392384,1024,3463680,3545600,3627520,81920,21553152,21553152,21553152,1169920,11885056,17156096,17125376,12054528,12042240,17371136,12140544,1228960,0,0,3584,21410816,0,256,139264,139520,97280,117760,138240,81920,32768,47104,51200,147456
.long 1241600,21411360,21406208,1073741824,21283840,21296132,40960,819200,1280,17028096,17029120,17030144,17031168,0,0,1073741824,21410820,21401600,20965504,21262464,1065353216,3842048,2048,1024,512,11960320,11958272,20301824,21403648,21392384,21408768,1024,3709440,3791360,3873280,97280,21553152,21553152,21553152,1210880,12024320,17217536,17186816,12079104,12066816,17371136,12161024,1249440,0,0,3584,21410816,256,0,139520,139264,81920,133120,122880,97280,149504,143360,0,30720
.long 1244160,21411392,21410304,1073741824,21284864,21296136,591104,1966080,3072,20078592,20160512,20080640,20162560,21217792,0,0,21410824,21401600,20965632,21224064,1065353216,3883008,2048,1024,512,12099584,12097536,20303872,21403648,21381120,21397504,1024,6067840,6149760,6231680,112640,21553152,21553152,21553152,1251840,12163584,17278976,17248256,12103680,12091392,17371136,12140544,1269920,0,0,3584,21410816,139264,139520,0,256,128000,87040,107520,112640,32768,47104,51200,147456
.long 1246720,21411424,21414400,1073741824,21285888,21296140,1870592,0,3072,20788224,20870144,20790272,20872192,21282560,1073741824,1073741824,21410828,21401600,20965760,21265024,1065353216,3923968,2048,1024,512,12238848,12236800,20305920,21403648,21397504,21413888,1024,6313600,6395520,6477440,128000,21553152,21553152,21553152,1292800,12302848,17340416,17309696,12128256,12115968,17371136,12161024,1290400,0,0,3584,21410816,139520,139264,256,0,112640,102400,92160,128000,149504,143360,0,30720
.long 1280000,21415424,21402112,21286576,21282816,21300224,942720,1966080,1280,18287616,18288640,18289664,18290688,0,0,1073741824,21414912,21401600,21006336,21231744,1065353216,6395904,512,20480,10240,11845632,11843584,20627456,21405696,21378048,21394432,0,3473920,3555840,3637760,81920,21553152,21553152,21553152,1180160,11895296,18548736,18518016,12054528,12042240,18763776,12140544,1229600,0,0,3584,21414912,0,256,139264,139520,97280,117760,138240,81920,32768,47104,51200,147456
.long 1282560,21415456,21406208,1073741824,21283840,21300228,41088,819200,1280,17032192,17376256,17377280,17378304,0,0,1073741824,21414916,21401600,21006464,21272704,1065353216,6436864,512,20480,10240,11984896,11982848,20629504,21405696,21394432,21410816,0,3719680,3801600,3883520,97280,21553152,21553152,21553152,1221120,12034560,18610176,18579456,12079104,12066816,18763776,12161024,1250080,0,0,3584,21414912,256,0,139520,139264,81920,133120,122880,97280,149504,143360,0,30720
.long 1285120,21415488,21410304,1073741824,21284864,21300232,689408,1966080,3072,20082688,20164608,20084736,20166656,21218048,0,0,21414920,21401600,21006592,21234304,1065353216,6477824,512,20480,10240,12124160,12122112,20631552,21405696,21383168,21399552,0,6070400,6152320,6234240,112640,21553152,21553152,21553152,1262080,12173824,18671616,18640896,12103680,12091392,18763776,12140544,1270560,0,0,3584,21414912,139264,139520,0,256,128000,87040,107520,112640,32768,47104,51200,147456
.long 1287680,21415520,21414400,1073741824,21285888,21300236,1870592,0,3072,20788224,20870144,20790272,20872192,21282560,1073741824,1073741824,21414924,21401600,21006720,21275264,1065353216,6518784,512,20480,10240,12263424,12261376,20633600,21405696,21399552,21415936,0,6316160,6398080,6480000,128000,21553152,21553152,21553152,1303040,12313088,18733056,18702336,12128256,12115968,18763776,12161024,1291040,0,0,3584,21414912,139520,139264,256,0,112640,102400,92160,128000,149504,143360,0,30720
.long 2467840,21534208,21533184,21286592,21282816,21419008,942848,1966080,1280,18291712,18635776,18636800,18637824,0,0,1073741824,21533696,21532672,21047296,21201024,1051011932,2465792,2048,1024,512,16228352,16226304,19644416,21532672,21505024,21521408,0,4753920,4835840,4917760,81920,21553152,21553152,21553152,2460160,16321024,17156096,17125376,16232448,16220160,17371136,16318464,2457760,0,0,3584,21533696,0,256,139264,139520,97280,117760,138240,81920,32768,47104,51200,147456
.long 2470400,21534240,21537280,1073741824,21283840,21419012,41216,819200,1280,17379328,17380352,17724416,17725440,0,0,1073741824,21533700,21532672,21047424,21241984,1051011932,2506752,2048,1024,512,16367616,16365568,19646464,21532672,21521408,21537792,0,4999680,5081600,5163520,97280,21553152,21553152,21553152,2501120,16460288,17217536,17186816,16257024,16244736,17371136,16338944,2478240,0,0,3584,21533696,256,0,139520,139264,81920,133120,122880,97280,149504,143360,0,30720
.long 2472960,21534272,21541376,1073741824,21284864,21419016,787712,1966080,3072,20086784,20168704,20088832,20170752,21218304,0,0,21533704,21532672,21047552,21203584,1051011932,2547712,2048,1024,512,16506880,16504832,19648512,21532672,21510144,21526528,0,7373440,7455360,7537280,112640,21553152,21553152,21553152,2542080,16599552,17278976,17248256,16281600,16269312,17371136,16318464,2498720,0,0,3584,21533696,139264,139520,0,256,128000,87040,107520,112640,32768,47104,51200,147456
.long 2475520,21534304,21545472,1073741824,21285888,21419020,1870592,0,3072,20788224,20870144,20790272,20872192,21282560,1073741824,1073741824,21533708,21532672,21047680,21244544,1051011932,2588672,2048,1024,512,16646144,16644096,19650560,21532672,21526528,21542912,0,7619200,7701120,7783040,128000,21553152,21553152,21553152,2583040,16738816,17340416,17309696,16306176,16293888,17371136,16338944,2519200,0,0,3584,21533696,139520,139264,256,0,112640,102400,92160,128000,149504,143360,0,30720
.long 2508800,21538304,21533184,21286608,21282816,21423104,942976,1966080,1280,18638848,18639872,18983936,18984960,0,0,1073741824,21537792,21532672,21088256,21211264,1065353216,5079040,2048,1024,512,16252928,16250880,19972096,21533696,21506048,21522432,0,4764160,4846080,4928000,81920,21553152,21553152,21553152,2470400,16331264,18548736,18518016,16232448,16220160,18763776,16318464,2458400,0,0,3584,21537792,0,256,139264,139520,97280,117760,138240,81920,32768,47104,51200,147456
.long 2511360,21538336,21537280,1073741824,21283840,21423108,41344,819200,1280,17726464,17727488,17728512,18072576,0,0,1073741824,21537796,21532672,21088384,21252224,1065353216,5120000,2048,1024,512,16392192,16390144,19974144,21533696,21522432,21538816,0,5009920,5091840,5173760,97280,21553152,21553152,21553152,2511360,16470528,18610176,18579456,16257024,16244736,18763776,16338944,2478880,0,0,3584,21537792,256,0,139520,139264,81920,133120,122880,97280,149504,143360,0,30720
.long 2513920,21538368,21541376,1073741824,21284864,21423112,886016,1966080,3072,20090880,20172800,20092928,20174848,21218560,0,0,21537800,21532672,21088512,21213824,1065353216,5160960,2048,1024,512,16531456,16529408,19976192,21533696,21511168,21527552,0,7376000,7457920,7539840,112640,21553152,21553152,21553152,2552320,16609792,18671616,18640896,16281600,16269312,18763776,16318464,2499360,0,0,3584,21537792,139264,139520,0,256,128000,87040,107520,112640,32768,47104,51200,147456
.long 2516480,21538400,21545472,1073741824,21285888,21423116,1870592,0,3072,20788224,20870144,20790272,20872192,21282560,1073741824,1073741824,21537804,21532672,21088640,21254784,1065353216,5201920,2048,1024,512,16670720,16668672,19978240,21533696,21527552,21543936,0,7621760,7703680,7785600,128000,21553152,21553152,21553152,2593280,16749056,18733056,18702336,16306176,16293888,18763776,16338944,2519840,0,0,3584,21537792,139520,139264,256,0,112640,102400,92160,128000,149504,143360,0,30720
.long 2549760,21542400,21533184,21286624,21282816,21427200,943104,1966080,1280,18985984,18987008,18988032,19332096,0,0,1073741824,21541888,21532672,21129216,21221504,1065353216,5111808,2048,1024,512,16277504,16275456,20299776,21534720,21507072,21523456,1024,4774400,4856320,4938240,81920,21553152,21553152,21553152,2480640,16341504,17156096,17125376,16510976,16498688,17371136,16596992,2539680,0,0,3584,21541888,0,256,139264,139520,97280,117760,138240,81920,32768,47104,51200,147456
.long 2552320,21542432,21537280,1073741824,21283840,21427204,41472,819200,1280,18073600,18074624,18075648,18076672,0,0,1073741824,21541892,21532672,21129344,21262464,1065353216,5152768,2048,1024,512,16416768,16414720,20301824,21534720,21523456,21539840,1024,5020160,5102080,5184000,97280,21553152,21553152,21553152,2521600,16480768,17217536,17186816,16535552,16523264,17371136,16617472,2560160,0,0,3584,21541888,256,0,139520,139264,81920,133120,122880,97280,149504,143360,0,30720
.long 2554880,21542464,21541376,1073741824,21284864,21427208,984320,1966080,3072,20094976,20176896,20097024,20178944,21218816,0,0,21541896,21532672,21129472,21224064,1065353216,5193728,2048,1024,512,16556032,16553984,20303872,21534720,21512192,21528576,1024,7378560,7460480,7542400,112640,21553152,21553152,21553152,2562560,16620032,17278976,17248256,16560128,16547840,17371136,16596992,2580640,0,0,3584,21541888,139264,139520,0,256,128000,87040,107520,112640,32768,47104,51200,147456
.long 2557440,21542496,21545472,1073741824,21285888,21427212,1870592,0,3072,20788224,20870144,20790272,20872192,21282560,1073741824,1073741824,21541900,21532672,21129600,21265024,1065353216,5234688,2048,1024,512,16695296,16693248,20305920,21534720,21528576,21544960,1024,7624320,7706240,7788160,128000,21553152,21553152,21553152,2603520,16759296,17340416,17309696,16584704,16572416,17371136,16617472,2601120,0,0,3584,21541888,139520,139264,256,0,112640,102400,92160,128000,149504,143360,0,30720
.long 2590720,21546496,21533184,21286640,21282816,21431296,943232,1966080,1280,19333120,19334144,19335168,19336192,0,0,1073741824,21545984,21532672,21170176,21231744,1065353216,7706624,512,20480,10240,16302080,16300032,20627456,21536768,21509120,21525504,0,4784640,4866560,4948480,81920,21553152,21553152,21553152,2490880,16351744,18548736,18518016,16510976,16498688,18763776,16596992,2540320,0,0,3584,21545984,0,256,139264,139520,97280,117760,138240,81920,32768,47104,51200,147456
.long 2593280,21546528,21537280,1073741824,21283840,21431300,41600,819200,1280,18420736,18421760,18422784,18423808,0,0,1073741824,21545988,21532672,21170304,21272704,1065353216,7747584,512,20480,10240,16441344,16439296,20629504,21536768,21525504,21541888,0,5030400,5112320,5194240,97280,21553152,21553152,21553152,2531840,16491008,18610176,18579456,16535552,16523264,18763776,16617472,2560800,0,0,3584,21545984,256,0,139520,139264,81920,133120,122880,97280,149504,143360,0,30720
.long 2595840,21546560,21541376,1073741824,21284864,21431304,1082624,1966080,3072,20099072,20180992,20101120,20183040,21219072,0,0,21545992,21532672,21170432,21234304,1065353216,7788544,512,20480,10240,16580608,16578560,20631552,21536768,21514240,21530624,0,7381120,7463040,7544960,112640,21553152,21553152,21553152,2572800,16630272,18671616,18640896,16560128,16547840,18763776,16596992,2581280,0,0,3584,21545984,139264,139520,0,256,128000,87040,107520,112640,32768,47104,51200,147456
.long 2598400,21546592,21545472,1073741824,21285888,21431308,1870592,0,3072,20788224,20870144,20790272,20872192,21282560,1073741824,1073741824,21545996,21532672,21170560,21275264,1065353216,7829504,512,20480,10240,16719872,16717824,20633600,21536768,21530624,21547008,0,7626880,7708800,7790720,128000,21553152,21553152,21553152,2613760,16769536,18733056,18702336,16584704,16572416,18763776,16617472,2601760,0,0,3584,21545984,139520,139264,256,0,112640,102400,92160,128000,149504,143360,0,30720
.long 1167360,21404160,21402112,21286656,21282816,21288960,983040,1966080,1280,16900096,16901120,16902144,16903168,0,0,1073741824,21403648,21401600,20893696,21206016,1051011932,1163264,2048,1024,512,11776000,11780096,19726336,21401600,21373952,21390336,0,3445760,3527680,3609600,81920,21553152,21553152,21553152,1152000,11867136,17504256,17473536,11776000,11763712,17719296,11862016,1147200,0,0,3584,21403648,0,256,139264,139520,97280,117760,138240,81920,32768,47104,51200,147456
.long 1169920,21404192,21406208,1073741824,21283840,21288964,41728,819200,1280,18424832,18768896,18769920,18770944,0,0,1073741824,21403652,21401600,20893824,21246976,1051011932,1204224,2048,1024,512,11915264,11919360,19728384,21401600,21390336,21406720,0,3691520,3773440,3855360,97280,21553152,21553152,21553152,1192960,12006400,17565696,17534976,11800576,11788288,17719296,11882496,1167680,0,0,3584,21403648,256,0,139520,139264,81920,133120,122880,97280,149504,143360,0,30720
.long 1172480,21404224,21410304,1073741824,21284864,21288968,1180928,1966080,3072,20103168,20185088,20105216,20187136,21219328,0,0,21403656,21401600,20893952,21208576,1051011932,1245184,2048,1024,512,12054528,12058624,19730432,21401600,21379072,21395456,0,6063360,6145280,6227200,112640,21553152,21553152,21553152,1233920,12145664,17627136,17596416,11825152,11812864,17719296,11862016,1188160,0,0,3584,21403648,139264,139520,0,256,128000,87040,107520,112640,32768,47104,51200,147456
.long 1175040,21404256,21414400,1073741824,21285888,21288972,1870592,0,3072,20788224,20870144,20790272,20872192,21282560,1073741824,1073741824,21403660,21401600,20894080,21249536,1051011932,1286144,2048,1024,512,12193792,12197888,19732480,21401600,21395456,21411840,0,6309120,6391040,6472960,128000,21553152,21553152,21553152,1274880,12284928,17688576,17657856,11849728,11837440,17719296,11882496,1208640,0,0,3584,21403648,139520,139264,256,0,112640,102400,92160,128000,149504,143360,0,30720
.long 1208320,21408256,21402112,21286672,21282816,21293056,983168,1966080,1280,16904192,17248256,17249280,17250304,0,0,1073741824,21407744,21401600,20934656,21216256,1065353216,3776512,2048,1024,512,11800576,11804672,20054016,21402624,21374976,21391360,1024,3456000,3537920,3619840,81920,21553152,21553152,21553152,1162240,11877376,18896896,18866176,11776000,11763712,19111936,11862016,1147840,0,0,3584,21407744,0,256,139264,139520,97280,117760,138240,81920,32768,47104,51200,147456
.long 1210880,21408288,21406208,1073741824,21283840,21293060,41856,819200,1280,18771968,18772992,19117056,19118080,0,0,1073741824,21407748,21401600,20934784,21257216,1065353216,3817472,2048,1024,512,11939840,11943936,20056064,21402624,21391360,21407744,1024,3701760,3783680,3865600,97280,21553152,21553152,21553152,1203200,12016640,18958336,18927616,11800576,11788288,19111936,11882496,1168320,0,0,3584,21407744,256,0,139520,139264,81920,133120,122880,97280,149504,143360,0,30720
.long 1213440,21408320,21410304,1073741824,21284864,21293064,1279232,1966080,3072,20107264,20189184,20109312,20191232,21219584,0,0,21407752,21401600,20934912,21218816,1065353216,3858432,2048,1024,512,12079104,12083200,20058112,21402624,21380096,21396480,1024,6065920,6147840,6229760,112640,21553152,21553152,21553152,1244160,12155904,19019776,18989056,11825152,11812864,19111936,11862016,1188800,0,0,3584,21407744,139264,139520,0,256,128000,87040,107520,112640,32768,47104,51200,147456
.long 1216000,21408352,21414400,1073741824,21285888,21293068,1870592,0,3072,20788224,20870144,20790272,20872192,21282560,1073741824,1073741824,21407756,21401600,20935040,21259776,1065353216,3899392,2048,1024,512,12218368,12222464,20060160,21402624,21396480,21412864,1024,6311680,6393600,6475520,128000,21553152,21553152,21553152,1285120,12295168,19081216,19050496,11849728,11837440,19111936,11882496,1209280,0,0,3584,21407744,139520,139264,256,0,112640,102400,92160,128000,149504,143360,0,30720
.long 1249280,21412352,21402112,21286688,21282816,21297152,983296,1966080,1280,17251328,17252352,17596416,17597440,0,0,1073741824,21411840,21401600,20975616,21226496,1065353216,6389760,512,20480,10240,11825152,11829248,20381696,21404672,21377024,21393408,0,3466240,3548160,3630080,81920,21553152,21553152,21553152,1172480,11887616,17504256,17473536,12054528,12042240,17719296,12140544,1229120,0,0,3584,21411840,0,256,139264,139520,97280,117760,138240,81920,32768,47104,51200,147456
.long 1251840,21412384,21406208,1073741824,21283840,21297156,41984,819200,1280,19119104,19120128,19121152,19465216,0,0,1073741824,21411844,21401600,20975744,21267456,1065353216,6430720,512,20480,10240,11964416,11968512,20383744,21404672,21393408,21409792,0,3712000,3793920,3875840,97280,21553152,21553152,21553152,1213440,12026880,17565696,17534976,12079104,12066816,17719296,12161024,1249600,0,0,3584,21411840,256,0,139520,139264,81920,133120,122880,97280,149504,143360,0,30720
.long 1254400,21412416,21410304,1073741824,21284864,21297160,1377536,1966080,3072,20111360,20193280,20113408,20195328,21219840,0,0,21411848,21401600,20975872,21229056,1065353216,6471680,512,20480,10240,12103680,12107776,20385792,21404672,21382144,21398528,0,6068480,6150400,6232320,112640,21553152,21553152,21553152,1254400,12166144,17627136,17596416,12103680,12091392,17719296,12140544,1270080,0,0,3584,21411840,139264,139520,0,256,128000,87040,107520,112640,32768,47104,51200,147456
.long 1256960,21412448,21414400,1073741824,21285888,21297164,1870592,0,3072,20788224,20870144,20790272,20872192,21282560,1073741824,1073741824,21411852,21401600,20976000,21270016,1065353216,6512640,512,20480,10240,12242944,12247040,20387840,21404672,21398528,21414912,0,6314240,6396160,6478080,128000,21553152,21553152,21553152,1295360,12305408,17688576,17657856,12128256,12115968,17719296,12161024,1290560,0,0,3584,21411840,139520,139264,256,0,112640,102400,92160,128000,149504,143360,0,30720
.long 1290240,21416448,21402112,21286704,21282816,21301248,983424,1966080,1280,17598464,17599488,17600512,17944576,0,0,1073741824,21415936,21401600,21016576,21236736,1065353216,6397952,512,20480,10240,11849728,11853824,20709376,21405696,21378048,21394432,0,3476480,3558400,3640320,81920,21553152,21553152,21553152,1182720,11897856,18896896,18866176,12054528,12042240,19111936,12140544,1229760,0,0,3584,21415936,0,256,139264,139520,97280,117760,138240,81920,32768,47104,51200,147456
.long 1292800,21416480,21406208,1073741824,21283840,21301252,42112,819200,1280,19466240,19467264,19468288,19469312,0,0,1073741824,21415940,21401600,21016704,21277696,1065353216,6438912,512,20480,10240,11988992,11993088,20711424,21405696,21394432,21410816,0,3722240,3804160,3886080,97280,21553152,21553152,21553152,1223680,12037120,18958336,18927616,12079104,12066816,19111936,12161024,1250240,0,0,3584,21415936,256,0,139520,139264,81920,133120,122880,97280,149504,143360,0,30720
.long 1295360,21416512,21410304,1073741824,21284864,21301256,1475840,1966080,3072,20115456,20197376,20117504,20199424,21220096,0,0,21415944,21401600,21016832,21239296,1065353216,6479872,512,20480,10240,12128256,12132352,20713472,21405696,21383168,21399552,0,6071040,6152960,6234880,112640,21553152,21553152,21553152,1264640,12176384,19019776,18989056,12103680,12091392,19111936,12140544,1270720,0,0,3584,21415936,139264,139520,0,256,128000,87040,107520,112640,32768,47104,51200,147456
.long 1297920,21416544,21414400,1073741824,21285888,21301260,1870592,0,3072,20788224,20870144,20790272,20872192,21282560,1073741824,1073741824,21415948,21401600,21016960,21280256,1065353216,6520832,512,20480,10240,12267520,12271616,20715520,21405696,21399552,21415936,0,6316800,6398720,6480640,128000,21553152,21553152,21553152,1305600,12315648,19081216,19050496,12128256,12115968,19111936,12161024,1291200,0,0,3584,21415936,139520,139264,256,0,112640,102400,92160,128000,149504,143360,0,30720
.long 2478080,21535232,21533184,21286720,21282816,21420032,983552,1966080,1280,17945600,17946624,17947648,17948672,0,0,1073741824,21534720,21532672,21057536,21206016,1051011932,2473984,2048,1024,512,16232448,16236544,19726336,21532672,21505024,21521408,0,4756480,4838400,4920320,81920,21553152,21553152,21553152,2462720,16323584,17504256,17473536,16232448,16220160,17719296,16318464,2457920,0,0,3584,21534720,0,256,139264,139520,97280,117760,138240,81920,32768,47104,51200,147456
.long 2480640,21535264,21537280,1073741824,21283840,21420036,81920,819200,1280,17033216,17034240,17035264,17036288,0,0,1073741824,21534724,21532672,21057664,21246976,1051011932,2514944,2048,1024,512,16371712,16375808,19728384,21532672,21521408,21537792,0,5002240,5084160,5166080,97280,21553152,21553152,21553152,2503680,16462848,17565696,17534976,16257024,16244736,17719296,16338944,2478400,0,0,3584,21534720,256,0,139520,139264,81920,133120,122880,97280,149504,143360,0,30720
.long 2483200,21535296,21541376,1073741824,21284864,21420040,1574144,1966080,3072,20119552,20201472,20121600,20203520,21220352,0,0,21534728,21532672,21057792,21208576,1051011932,2555904,2048,1024,512,16510976,16515072,19730432,21532672,21510144,21526528,0,7374080,7456000,7537920,112640,21553152,21553152,21553152,2544640,16602112,17627136,17596416,16281600,16269312,17719296,16318464,2498880,0,0,3584,21534720,139264,139520,0,256,128000,87040,107520,112640,32768,47104,51200,147456
.long 2485760,21535328,21545472,1073741824,21285888,21420044,1870592,0,3072,20788224,20870144,20790272,20872192,21282560,1073741824,1073741824,21534732,21532672,21057920,21249536,1051011932,2596864,2048,1024,512,16650240,16654336,19732480,21532672,21526528,21542912,0,7619840,7701760,7783680,128000,21553152,21553152,21553152,2585600,16741376,17688576,17657856,16306176,16293888,17719296,16338944,2519360,0,0,3584,21534720,139520,139264,256,0,112640,102400,92160,128000,149504,143360,0,30720
.long 2519040,21539328,21533184,21286736,21282816,21424128,983680,1966080,1280,18292736,18293760,18294784,18295808,0,0,1073741824,21538816,21532672,21098496,21216256,1065353216,5087232,2048,1024,512,16257024,16261120,20054016,21533696,21506048,21522432,1024,4766720,4848640,4930560,81920,21553152,21553152,21553152,2472960,16333824,18896896,18866176,16232448,16220160,19111936,16318464,2458560,0,0,3584,21538816,0,256,139264,139520,97280,117760,138240,81920,32768,47104,51200,147456
.long 2521600,21539360,21537280,1073741824,21283840,21424132,82048,819200,1280,17037312,17381376,17382400,17383424,0,0,1073741824,21538820,21532672,21098624,21257216,1065353216,5128192,2048,1024,512,16396288,16400384,20056064,21533696,21522432,21538816,1024,5012480,5094400,5176320,97280,21553152,21553152,21553152,2513920,16473088,18958336,18927616,16257024,16244736,19111936,16338944,2479040,0,0,3584,21538816,256,0,139520,139264,81920,133120,122880,97280,149504,143360,0,30720
.long 2524160,21539392,21541376,1073741824,21284864,21424136,1672448,1966080,3072,20123648,20205568,20125696,20207616,21220608,0,0,21538824,21532672,21098752,21218816,1065353216,5169152,2048,1024,512,16535552,16539648,20058112,21533696,21511168,21527552,1024,7376640,7458560,7540480,112640,21553152,21553152,21553152,2554880,16612352,19019776,18989056,16281600,16269312,19111936,16318464,2499520,0,0,3584,21538816,139264,139520,0,256,128000,87040,107520,112640,32768,47104,51200,147456
.long 2526720,21539424,21545472,1073741824,21285888,21424140,1870592,0,3072,20788224,20870144,20790272,20872192,21282560,1073741824,1073741824,21538828,21532672,21098880,21259776,1065353216,5210112,2048,1024,512,16674816,16678912,20060160,21533696,21527552,21543936,1024,7622400,7704320,7786240,128000,21553152,21553152,21553152,2595840,16751616,19081216,19050496,16306176,16293888,19111936,16338944,2520000,0,0,3584,21538816,139520,139264,256,0,112640,102400,92160,128000,149504,143360,0,30720
.long 2560000,21543424,21533184,21286752,21282816,21428224,983808,1966080,1280,18296832,18640896,18641920,18642944,0,0,1073741824,21542912,21532672,21139456,21226496,1065353216,7700480,512,20480,10240,16281600,16285696,20381696,21535744,21508096,21524480,0,4776960,4858880,4940800,81920,21553152,21553152,21553152,2483200,16344064,17504256,17473536,16510976,16498688,17719296,16596992,2539840,0,0,3584,21542912,0,256,139264,139520,97280,117760,138240,81920,32768,47104,51200,147456
.long 2562560,21543456,21537280,1073741824,21283840,21428228,82176,819200,1280,17384448,17385472,17729536,17730560,0,0,1073741824,21542916,21532672,21139584,21267456,1065353216,7741440,512,20480,10240,16420864,16424960,20383744,21535744,21524480,21540864,0,5022720,5104640,5186560,97280,21553152,21553152,21553152,2524160,16483328,17565696,17534976,16535552,16523264,17719296,16617472,2560320,0,0,3584,21542912,256,0,139520,139264,81920,133120,122880,97280,149504,143360,0,30720
.long 2565120,21543488,21541376,1073741824,21284864,21428232,1770752,1966080,3072,20127744,20209664,20129792,20211712,21220864,0,0,21542920,21532672,21139712,21229056,1065353216,7782400,512,20480,10240,16560128,16564224,20385792,21535744,21513216,21529600,0,7379200,7461120,7543040,112640,21553152,21553152,21553152,2565120,16622592,17627136,17596416,16560128,16547840,17719296,16596992,2580800,0,0,3584,21542912,139264,139520,0,256,128000,87040,107520,112640,32768,47104,51200,147456
.long 2567680,21543520,21545472,1073741824,21285888,21428236,1870592,0,3072,20788224,20870144,20790272,20872192,21282560,1073741824,1073741824,21542924,21532672,21139840,21270016,1065353216,7823360,512,20480,10240,16699392,16703488,20387840,21535744,21529600,21545984,0,7624960,7706880,7788800,128000,21553152,21553152,21553152,2606080,16761856,17688576,17657856,16584704,16572416,17719296,16617472,2601280,0,0,3584,21542912,139520,139264,256,0,112640,102400,92160,128000,149504,143360,0,30720
.long 2600960,21547520,21533184,21286768,21282816,21432320,983936,1966080,1280,18643968,18644992,18989056,18990080,0,0,1073741824,21547008,21532672,21180416,21236736,1065353216,7708672,512,20480,10240,16306176,16310272,20709376,21536768,21509120,21525504,0,4787200,4869120,4951040,81920,21553152,21553152,21553152,2493440,16354304,18896896,18866176,16510976,16498688,19111936,16596992,2540480,0,0,3584,21547008,0,256,139264,139520,97280,117760,138240,81920,32768,47104,51200,147456
.long 2603520,21547552,21537280,1073741824,21283840,21432324,82304,819200,1280,17731584,17732608,17733632,18077696,0,0,1073741824,21547012,21532672,21180544,21277696,1065353216,7749632,512,20480,10240,16445440,16449536,20711424,21536768,21525504,21541888,0,5032960,5114880,5196800,97280,21553152,21553152,21553152,2534400,16493568,18958336,18927616,16535552,16523264,19111936,16617472,2560960,0,0,3584,21547008,256,0,139520,139264,81920,133120,122880,97280,149504,143360,0,30720
.long 2606080,21547584,21541376,1073741824,21284864,21432328,1869056,1966080,3072,20131840,20213760,20133888,20215808,21221120,0,0,21547016,21532672,21180672,21239296,1065353216,7790592,512,20480,10240,16584704,16588800,20713472,21536768,21514240,21530624,0,7381760,7463680,7545600,112640,21553152,21553152,21553152,2575360,16632832,19019776,18989056,16560128,16547840,19111936,16596992,2581440,0,0,3584,21547008,139264,139520,0,256,128000,87040,107520,112640,32768,47104,51200,147456
.long 2608640,21547616,21545472,1073741824,21285888,21432332,1870592,0,3072,20788224,20870144,20790272,20872192,21282560,1073741824,1073741824,21547020,21532672,21180800,21280256,1065353216,7831552,512,20480,10240,16723968,16728064,20715520,21536768,21530624,21547008,0,7627520,7709440,7791360,128000,21553152,21553152,21553152,2616320,16772096,19081216,19050496,16584704,16572416,19111936,16617472,2601920,0,0,3584,21547008,139520,139264,256,0,112640,102400,92160,128000,149504,143360,0,30720
.long 1177600,21405184,21402112,21286784,21282816,21289984,984064,1966080,1280,18991104,18992128,18993152,19337216,0,0,1073741824,21404672,21401600,20903936,21206144,1051011932,1171456,2048,1024,512,11784192,11782144,19808256,21401600,21373952,21390336,1024,3448320,3530240,3612160,81920,21553152,21553152,21553152,1154560,11869696,17852416,17821696,11776000,11763712,18067456,11862016,1147360,0,0,3584,21404672,0,256,139264,139520,97280,117760,138240,81920,32768,47104,51200,147456
.long 1180160,21405216,21406208,1073741824,21283840,21289988,82432,819200,1280,18078720,18079744,18080768,18081792,0,0,1073741824,21404676,21401600,20904064,21247104,1051011932,1212416,2048,1024,512,11923456,11921408,19810304,21401600,21390336,21406720,1024,3694080,3776000,3857920,97280,21553152,21553152,21553152,1195520,12008960,17913856,17883136,11800576,11788288,18067456,11882496,1167840,0,0,3584,21404672,256,0,139520,139264,81920,133120,122880,97280,149504,143360,0,30720
.long 1182720,21405248,21410304,1073741824,21284864,21289992,1664,1966080,3072,20217856,20299776,20219904,20301824,21221376,0,0,21404680,21401600,20904192,21208704,1051011932,1253376,2048,1024,512,12062720,12060672,19812352,21401600,21379072,21395456,1024,6064000,6145920,6227840,112640,21553152,21553152,21553152,1236480,12148224,17975296,17944576,11825152,11812864,18067456,11862016,1188320,0,0,3584,21404672,139264,139520,0,256,128000,87040,107520,112640,32768,47104,51200,147456
.long 1185280,21405280,21414400,1073741824,21285888,21289996,1870592,0,3072,20788224,20870144,20790272,20872192,21282560,1073741824,1073741824,21404684,21401600,20904320,21249664,1051011932,1294336,2048,1024,512,12201984,12199936,19814400,21401600,21395456,21411840,1024,6309760,6391680,6473600,128000,21553152,21553152,21553152,1277440,12287488,18036736,18006016,11849728,11837440,18067456,11882496,1208800,0,0,3584,21404672,139520,139264,256,0,112640,102400,92160,128000,149504,143360,0,30720
.long 1218560,21409280,21402112,21286800,21282816,21294080,984192,1966080,1280,19338240,19339264,19340288,19341312,0,0,1073741824,21408768,21401600,20944896,21216384,1065353216,3784704,2048,1024,512,11808768,11806720,20135936,21403648,21376000,21392384,0,3458560,3540480,3622400,81920,21553152,21553152,21553152,1164800,11879936,19245056,19214336,11776000,11763712,19460096,11862016,1148000,0,0,3584,21408768,0,256,139264,139520,97280,117760,138240,81920,32768,47104,51200,147456
.long 1221120,21409312,21406208,1073741824,21283840,21294084,82560,819200,1280,18425856,18426880,18427904,18428928,0,0,1073741824,21408772,21401600,20945024,21257344,1065353216,3825664,2048,1024,512,11948032,11945984,20137984,21403648,21392384,21408768,0,3704320,3786240,3868160,97280,21553152,21553152,21553152,1205760,12019200,19306496,19275776,11800576,11788288,19460096,11882496,1168480,0,0,3584,21408768,256,0,139520,139264,81920,133120,122880,97280,149504,143360,0,30720
.long 1223680,21409344,21410304,1073741824,21284864,21294088,99968,1966080,3072,20221952,20303872,20224000,20305920,21221632,0,0,21408776,21401600,20945152,21218944,1065353216,3866624,2048,1024,512,12087296,12085248,20140032,21403648,21381120,21397504,0,6066560,6148480,6230400,112640,21553152,21553152,21553152,1246720,12158464,19367936,19337216,11825152,11812864,19460096,11862016,1188960,0,0,3584,21408768,139264,139520,0,256,128000,87040,107520,112640,32768,47104,51200,147456
.long 1226240,21409376,21414400,1073741824,21285888,21294092,1870592,0,3072,20788224,20870144,20790272,20872192,21282560,1073741824,1073741824,21408780,21401600,20945280,21259904,1065353216,3907584,2048,1024,512,12226560,12224512,20142080,21403648,21397504,21413888,0,6312320,6394240,6476160,128000,21553152,21553152,21553152,1287680,12297728,19429376,19398656,11849728,11837440,19460096,11882496,1209440,0,0,3584,21408768,139520,139264,256,0,112640,102400,92160,128000,149504,143360,0,30720
.long 1259520,21413376,21402112,21286816,21282816,21298176,1024000,1966080,1280,16905216,16906240,16907264,16908288,0,0,1073741824,21412864,21401600,20985856,21226624,1065353216,6391808,512,20480,10240,11833344,11831296,20463616,21404672,21377024,21393408,0,3468800,3550720,3632640,81920,21553152,21553152,21553152,1175040,11890176,17852416,17821696,12054528,12042240,18067456,12140544,1229280,0,0,3584,21412864,0,256,139264,139520,97280,117760,138240,81920,32768,47104,51200,147456
.long 1262080,21413408,21406208,1073741824,21283840,21298180,82688,819200,1280,18429952,18774016,18775040,18776064,0,0,1073741824,21412868,21401600,20985984,21267584,1065353216,6432768,512,20480,10240,11972608,11970560,20465664,21404672,21393408,21409792,0,3714560,3796480,3878400,97280,21553152,21553152,21553152,1216000,12029440,17913856,17883136,12079104,12066816,18067456,12161024,1249760,0,0,3584,21412864,256,0,139520,139264,81920,133120,122880,97280,149504,143360,0,30720
.long 1264640,21413440,21410304,1073741824,21284864,21298184,198272,1966080,3072,20226048,20307968,20228096,20310016,21221888,0,0,21412872,21401600,20986112,21229184,1065353216,6473728,512,20480,10240,12111872,12109824,20467712,21404672,21382144,21398528,0,6069120,6151040,6232960,112640,21553152,21553152,21553152,1256960,12168704,17975296,17944576,12103680,12091392,18067456,12140544,1270240,0,0,3584,21412864,139264,139520,0,256,128000,87040,107520,112640,32768,47104,51200,147456
.long 1267200,21413472,21414400,1073741824,21285888,21298188,1870592,0,3072,20788224,20870144,20790272,20872192,21282560,1073741824,1073741824,21412876,21401600,20986240,21270144,1065353216,6514688,512,20480,10240,12251136,12249088,20469760,21404672,21398528,21414912,0,6314880,6396800,6478720,128000,21553152,21553152,21553152,1297920,12307968,18036736,18006016,12128256,12115968,18067456,12161024,1290720,0,0,3584,21412864,139520,139264,256,0,112640,102400,92160,128000,149504,143360,0,30720
.long 1300480,21417472,21402112,21286832,21282816,21302272,1024128,1966080,1280,16909312,17253376,17254400,17255424,0,0,1073741824,21416960,21401600,21026816,21236864,1065353216,9011200,512,20480,10240,11857920,11855872,20791296,21405696,21378048,21394432,0,3479040,3560960,3642880,81920,21553152,21553152,21553152,1185280,11900416,19245056,19214336,12054528,12042240,19460096,12140544,1229920,0,0,3584,21416960,0,256,139264,139520,97280,117760,138240,81920,32768,47104,51200,147456
.long 1303040,21417504,21406208,1073741824,21283840,21302276,82816,819200,1280,18777088,18778112,19122176,19123200,0,0,1073741824,21416964,21401600,21026944,21277824,1065353216,9052160,512,20480,10240,11997184,11995136,20793344,21405696,21394432,21410816,0,3724800,3806720,3888640,97280,21553152,21553152,21553152,1226240,12039680,19306496,19275776,12079104,12066816,19460096,12161024,1250400,0,0,3584,21416960,256,0,139520,139264,81920,133120,122880,97280,149504,143360,0,30720
.long 1305600,21417536,21410304,1073741824,21284864,21302280,296576,1966080,3072,20230144,20312064,20232192,20314112,21222144,0,0,21416968,21401600,21027072,21239424,1065353216,9093120,512,20480,10240,12136448,12134400,20795392,21405696,21383168,21399552,0,6071680,6153600,6235520,112640,21553152,21553152,21553152,1267200,12178944,19367936,19337216,12103680,12091392,19460096,12140544,1270880,0,0,3584,21416960,139264,139520,0,256,128000,87040,107520,112640,32768,47104,51200,147456
.long 1308160,21417568,21414400,1073741824,21285888,21302284,1870592,0,3072,20788224,20870144,20790272,20872192,21282560,1073741824,1073741824,21416972,21401600,21027200,21280384,1065353216,9134080,512,20480,10240,12275712,12273664,20797440,21405696,21399552,21415936,0,6317440,6399360,6481280,128000,21553152,21553152,21553152,1308160,12318208,19429376,19398656,12128256,12115968,19460096,12161024,1291360,0,0,3584,21416960,139520,139264,256,0,112640,102400,92160,128000,149504,143360,0,30720
.long 2488320,21536256,21533184,21286848,21282816,21421056,1024256,1966080,1280,17256448,17257472,17601536,17602560,0,0,1073741824,21535744,21532672,21067776,21206144,1051011932,2482176,2048,1024,512,16240640,16238592,19808256,21532672,21505024,21521408,1024,4759040,4840960,4922880,81920,21553152,21553152,21553152,2465280,16326144,17852416,17821696,16232448,16220160,18067456,16318464,2458080,0,0,3584,21535744,0,256,139264,139520,97280,117760,138240,81920,32768,47104,51200,147456
.long 2490880,21536288,21537280,1073741824,21283840,21421060,82944,819200,1280,19124224,19125248,19126272,19470336,0,0,1073741824,21535748,21532672,21067904,21247104,1051011932,2523136,2048,1024,512,16379904,16377856,19810304,21532672,21521408,21537792,1024,5004800,5086720,5168640,97280,21553152,21553152,21553152,2506240,16465408,17913856,17883136,16257024,16244736,18067456,16338944,2478560,0,0,3584,21535744,256,0,139520,139264,81920,133120,122880,97280,149504,143360,0,30720
.long 2493440,21536320,21541376,1073741824,21284864,21421064,394880,1966080,3072,20234240,20316160,20236288,20318208,21222400,0,0,21535752,21532672,21068032,21208704,1051011932,2564096,2048,1024,512,16519168,16517120,19812352,21532672,21510144,21526528,1024,7374720,7456640,7538560,112640,21553152,21553152,21553152,2547200,16604672,17975296,17944576,16281600,16269312,18067456,16318464,2499040,0,0,3584,21535744,139264,139520,0,256,128000,87040,107520,112640,32768,47104,51200,147456
.long 2496000,21536352,21545472,1073741824,21285888,21421068,1870592,0,3072,20788224,20870144,20790272,20872192,21282560,1073741824,1073741824,21535756,21532672,21068160,21249664,1051011932,2605056,2048,1024,512,16658432,16656384,19814400,21532672,21526528,21542912,1024,7620480,7702400,7784320,128000,21553152,21553152,21553152,2588160,16743936,18036736,18006016,16306176,16293888,18067456,16338944,2519520,0,0,3584,21535744,139520,139264,256,0,112640,102400,92160,128000,149504,143360,0,30720
.long 2529280,21540352,21533184,21286864,21282816,21425152,1024384,1966080,1280,17603584,17604608,17605632,17949696,0,0,1073741824,21539840,21532672,21108736,21216384,1065353216,5095424,2048,1024,512,16265216,16263168,20135936,21534720,21507072,21523456,0,4769280,4851200,4933120,81920,21553152,21553152,21553152,2475520,16336384,19245056,19214336,16232448,16220160,19460096,16318464,2458720,0,0,3584,21539840,0,256,139264,139520,97280,117760,138240,81920,32768,47104,51200,147456
.long 2531840,21540384,21537280,1073741824,21283840,21425156,83072,819200,1280,19471360,19472384,19473408,19474432,0,0,1073741824,21539844,21532672,21108864,21257344,1065353216,5136384,2048,1024,512,16404480,16402432,20137984,21534720,21523456,21539840,0,5015040,5096960,5178880,97280,21553152,21553152,21553152,2516480,16475648,19306496,19275776,16257024,16244736,19460096,16338944,2479200,0,0,3584,21539840,256,0,139520,139264,81920,133120,122880,97280,149504,143360,0,30720
.long 2534400,21540416,21541376,1073741824,21284864,21425160,493184,1966080,3072,20238336,20320256,20240384,20322304,21222656,0,0,21539848,21532672,21108992,21218944,1065353216,5177344,2048,1024,512,16543744,16541696,20140032,21534720,21512192,21528576,0,7377280,7459200,7541120,112640,21553152,21553152,21553152,2557440,16614912,19367936,19337216,16281600,16269312,19460096,16318464,2499680,0,0,3584,21539840,139264,139520,0,256,128000,87040,107520,112640,32768,47104,51200,147456
.long 2536960,21540448,21545472,1073741824,21285888,21425164,1870592,0,3072,20788224,20870144,20790272,20872192,21282560,1073741824,1073741824,21539852,21532672,21109120,21259904,1065353216,5218304,2048,1024,512,16683008,16680960,20142080,21534720,21528576,21544960,0,7623040,7704960,7786880,128000,21553152,21553152,21553152,2598400,16754176,19429376,19398656,16306176,16293888,19460096,16338944,2520160,0,0,3584,21539840,139520,139264,256,0,112640,102400,92160,128000,149504,143360,0,30720
.long 2570240,21544448,21533184,21286880,21282816,21429248,1024512,1966080,1280,17950720,17951744,17952768,17953792,0,0,1073741824,21543936,21532672,21149696,21226624,1065353216,7702528,512,20480,10240,16289792,16287744,20463616,21535744,21508096,21524480,0,4779520,4861440,4943360,81920,21553152,21553152,21553152,2485760,16346624,17852416,17821696,16510976,16498688,18067456,16596992,2540000,0,0,3584,21543936,0,256,139264,139520,97280,117760,138240,81920,32768,47104,51200,147456
.long 2572800,21544480,21537280,1073741824,21283840,21429252,122880,819200,1280,17038336,17039360,17040384,17041408,0,0,1073741824,21543940,21532672,21149824,21267584,1065353216,7743488,512,20480,10240,16429056,16427008,20465664,21535744,21524480,21540864,0,5025280,5107200,5189120,97280,21553152,21553152,21553152,2526720,16485888,17913856,17883136,16535552,16523264,18067456,16617472,2560480,0,0,3584,21543936,256,0,139520,139264,81920,133120,122880,97280,149504,143360,0,30720
.long 2575360,21544512,21541376,1073741824,21284864,21429256,591488,1966080,3072,20242432,20324352,20244480,20326400,21222912,0,0,21543944,21532672,21149952,21229184,1065353216,7784448,512,20480,10240,16568320,16566272,20467712,21535744,21513216,21529600,0,7379840,7461760,7543680,112640,21553152,21553152,21553152,2567680,16625152,17975296,17944576,16560128,16547840,18067456,16596992,2580960,0,0,3584,21543936,139264,139520,0,256,128000,87040,107520,112640,32768,47104,51200,147456
.long 2577920,21544544,21545472,1073741824,21285888,21429260,1870592,0,3072,20788224,20870144,20790272,20872192,21282560,1073741824,1073741824,21543948,21532672,21150080,21270144,1065353216,7825408,512,20480,10240,16707584,16705536,20469760,21535744,21529600,21545984,0,7625600,7707520,7789440,128000,21553152,21553152,21553152,2608640,16764416,18036736,18006016,16584704,16572416,18067456,16617472,2601440,0,0,3584,21543936,139520,139264,256,0,112640,102400,92160,128000,149504,143360,0,30720
.long 2611200,21548544,21533184,21286896,21282816,21433344,1024640,1966080,1280,18297856,18298880,18299904,18300928,0,0,1073741824,21548032,21532672,21190656,21236864,1065353216,10321920,512,20480,10240,16314368,16312320,20791296,21536768,21509120,21525504,0,4789760,4871680,4953600,81920,21553152,21553152,21553152,2496000,16356864,19245056,19214336,16510976,16498688,19460096,16596992,2540640,0,0,3584,21548032,0,256,139264,139520,97280,117760,138240,81920,32768,47104,51200,147456
.long 2613760,21548576,21537280,1073741824,21283840,21433348,123008,819200,1280,17042432,17386496,17387520,17388544,0,0,1073741824,21548036,21532672,21190784,21277824,1065353216,10362880,512,20480,10240,16453632,16451584,20793344,21536768,21525504,21541888,0,5035520,5117440,5199360,97280,21553152,21553152,21553152,2536960,16496128,19306496,19275776,16535552,16523264,19460096,16617472,2561120,0,0,3584,21548032,256,0,139520,139264,81920,133120,122880,97280,149504,143360,0,30720
.long 2616320,21548608,21541376,1073741824,21284864,21433352,689792,1966080,3072,20246528,20328448,20248576,20330496,21223168,0,0,21548040,21532672,21190912,21239424,1065353216,10403840,512,20480,10240,16592896,16590848,20795392,21536768,21514240,21530624,0,7382400,7464320,7546240,112640,21553152,21553152,21553152,2577920,16635392,19367936,19337216,16560128,16547840,19460096,16596992,2581600,0,0,3584,21548032,139264,139520,0,256,128000,87040,107520,112640,32768,47104,51200,147456
.long 2618880,21548640,21545472,1073741824,21285888,21433356,1870592,0,3072,20788224,20870144,20790272,20872192,21282560,1073741824,1073741824,21548044,21532672,21191040,21280384,1065353216,10444800,512,20480,10240,16732160,16730112,20797440,21536768,21530624,21547008,0,7628160,7710080,7792000,128000,21553152,21553152,21553152,2618880,16774656,19429376,19398656,16584704,16572416,19460096,16617472,2602080,0,0,3584,21548032,139520,139264,256,0,112640,102400,92160,128000,149504,143360,0,30720
.size wave_params, 262144
.section .rodata,"a"
.p2align 6
.amdhsa_kernel parallel_sum__sliding_block__glu_gated_geglu__prompt_kernel
  .amdhsa_next_free_vgpr 512
  .amdhsa_next_free_sgpr 102
  .amdhsa_accum_offset 256
  .amdhsa_group_segment_fixed_size 0
  .amdhsa_kernarg_size 80
  .amdhsa_user_sgpr_count 2
  .amdhsa_user_sgpr_kernarg_segment_ptr 1
  .amdhsa_system_sgpr_workgroup_id_x 1
.end_amdhsa_kernel
```
